```python
import torch

def _softmax(x, axis=-1):
    return torch.softmax(x, dim=axis)
def _gelu(x):
    return torch.nn.functional.gelu(x, approximate="tanh")
def _silu(x):
    return torch.nn.functional.silu(x)
def _sigmoid(x):
    return torch.sigmoid(x)
def _layernorm(x, axis=-1, eps=1e-5):
    m = x.mean(dim=axis, keepdim=True)
    v = x.var(dim=axis, keepdim=True, unbiased=False)
    return (x - m) / torch.sqrt(v + eps)
def _scatter_add(tgt, idx, src, axis=0):
    return tgt.clone().index_add_(axis, idx, src)
def _segment_sum(src, seg, n):
    out = torch.zeros((n,) + src.shape[1:], dtype=src.dtype)
    return out.index_add_(0, seg, src)
def _pad(x, pw):
    flat = tuple(v for pair in reversed(pw) for v in pair)
    return torch.nn.functional.pad(x, flat)

kernel_name = 'standalone__gqa_block_cached__near_ridge'

def setup_inputs():

    _w = (lambda a: (lambda t: t.to(torch.bfloat16) if t.is_floating_point() else t)(torch.as_tensor(a)))
    B, Sq, D = 32, 112, 640
    Hq, Hkv, Sk, Dh = 32, 32, 512, 128
    assert Hq % Hkv == 0, (Hq, Hkv)
    return {
        "x": _w((lambda *s: torch.randn(*s, dtype=torch.bfloat16) * 0.8)(B, Sq, D)),
        "k_cache": _w((lambda *s: torch.randn(*s, dtype=torch.bfloat16) * 0.8)(B, Hkv, Sk, Dh)),
        "v_cache": _w((lambda *s: torch.randn(*s, dtype=torch.bfloat16) * 0.05)(B, Hkv, Sk, Dh)),
        "wq": _w((lambda *s: torch.randn(*s, dtype=torch.bfloat16) * 0.8)(D, Hq * Dh) * (D ** -0.5)),
        "wo": _w((lambda *s: torch.randn(*s, dtype=torch.bfloat16) * 0.05)(Hq * Dh, D) * ((Hq * Dh) ** -0.5)),
    }

def reference(x, k_cache, v_cache, wq, wo):
    B, Sq, D = x.shape
    Hq, Dh = 32, 128
    Hkv = k_cache.shape[1]
    rep = Hq // Hkv
    q = (lambda x, *d: x.permute(*d))((x @ wq).reshape(B, Sq, Hq, Dh), 0, 2, 1, 3)
    k = (lambda x, n, axis: torch.repeat_interleave(x, n, dim=axis))(k_cache, rep, axis=1)
    v = (lambda x, n, axis: torch.repeat_interleave(x, n, dim=axis))(v_cache, rep, axis=1)
    scores = torch.einsum("bhqd,bhkd->bhqk", q, k) * (Dh ** -0.5)
    p = _softmax(scores, axis=-1)
    o = torch.einsum("bhqk,bhkd->bhqd", p, v)
    return (lambda x, *d: x.permute(*d))(o, 0, 2, 1, 3).reshape(B, Sq, Hq * Dh) @ wo
```

```asm
; @launch kernel=attn_kernel grid=(256,1,1) block=(512,1,1) lds=156416
; @launch kernel=oproj_kernel grid=(256,1,1) block=(512,1,1) lds=148480
.amdgcn_target "amdgcn-amd-amdhsa--gfx950"
.text
.globl attn_kernel
.p2align 8
.type attn_kernel,@function
attn_kernel:
    s_cmp_ge_u32 s2, 256
    s_cbranch_scc1 L_exit
    s_load_dwordx16 s[4:19], s[0:1], 0
    v_lshrrev_b32 v1, 6, v0
    v_and_b32 v2, 63, v0
    v_readfirstlane_b32 s3, v1
    s_lshr_b32 s46, s2, 3
    s_bfe_u32 s59, s2, 0x20001
    s_lshl_b32 s44, s59, 3
    s_lshr_b32 s45, s46, 2
    s_add_u32 s44, s44, s45
    s_and_b32 s45, s46, 3
    s_and_b32 s58, s2, 1
    s_lshl_b32 s58, s58, 4
    s_and_b32 s47, s3, 3
    s_mov_b32 s50, 0
    s_getpc_b64 s[70:71]
L_pc:
    s_cmp_ge_u32 s46, 9
    s_cbranch_scc1 L_noct
    s_cmp_lg_u32 s3, 3
    s_cbranch_scc1 L_noct
    s_lshl_b32 s72, s46, 13
    s_min_u32 s72, s72, (L2_exit - L_pc - 8192)
    v_lshlrev_b32 v4, 7, v2
    v_add_u32 v4, s72, v4
    global_load_dword v21, v4, s[70:71]
L_noct:
    s_add_u32 s57, s50, s59
    s_and_b32 s57, s57, 3
    s_lshl_b32 s57, s57, 2
    s_add_u32 s57, s57, s58
    v_lshrrev_b32 v4, 3, v2
    v_lshlrev_b32 v4, 13, v4
    v_and_b32 v5, 7, v2
    v_lshl_add_u32 v12, v5, 7, v4
    v_lshlrev_b32 v5, 7, v2
    s_mul_i32 s56, s46, 20
    s_mul_i32 s51, s3, 8
    s_add_u32 s56, s56, s51
    s_lshl_b32 s56, s56, 13
    s_lshl_b32 s57, s57, 8
    s_add_u32 s51, s56, s57
    s_mul_i32 s52, s44, 143360
    s_mul_i32 s57, s45, 35840
    s_add_u32 s52, s52, s57
    s_sub_u32 s57, s3, 3
    s_lshl_b32 s57, s57, 13
    s_add_u32 s52, s52, s57
    s_waitcnt lgkmcnt(0)
    s_mov_b32 s32, s10
    s_and_b32 s33, s11, 0xffff
    s_mov_b32 s34, 5242880
    s_mov_b32 s35, 0x20000
    s_mov_b32 s28, s4
    s_and_b32 s29, s5, 0xffff
    s_mov_b32 s30, 4587520
    s_mov_b32 s31, 0x20000
    s_cmp_ge_u32 s3, 3
    s_cbranch_scc1 L_tx
    buffer_load_dword v13, v12, s[32:35], s51 offen
    s_branch L_td
L_tx:
    buffer_load_dword v13, v5, s[28:31], s52 offen
L_td:
    s_mov_b32 s20, s6
    s_and_b32 s21, s7, 0xffff
    s_mov_b32 s22, 134217728
    s_mov_b32 s23, 0x20000
    s_mov_b32 s24, s8
    s_and_b32 s25, s9, 0xffff
    s_mov_b32 s26, 134217728
    s_mov_b32 s27, 0x20000
    s_mov_b32 s36, s12
    s_and_b32 s37, s13, 0xffff
    s_mov_b32 s38, 5242880
    s_mov_b32 s39, 0x20000
    s_mov_b32 s40, s18
    s_and_b32 s41, s19, 0xffff
    s_mov_b32 s42, 38797312
    s_mov_b32 s43, 0x20000
    v_and_b32 v27, 15, v2
    v_lshrrev_b32 v28, 4, v2
    v_lshrrev_b32 v29, 2, v27
    v_and_b32 v30, 3, v2
    s_lshl_b32 s53, s47, 13
    s_add_u32 s53, s53, 109312
    s_cmp_ge_u32 s3, 4
    s_cbranch_scc1 L_proj
    v_lshlrev_b32 v32, 10, v29
    v_lshrrev_b32 v33, 1, v29
    v_lshl_add_u32 v32, v33, 5, v32
    v_lshl_add_u32 v32, v30, 8, v32
    v_lshl_add_u32 v32, v28, 4, v32
    v_mul_u32_u24 v33, 1056, v28
    v_lshl_add_u32 v33, v29, 8, v33
    v_lshl_add_u32 v33, v30, 3, v33
    v_xor_b32 v34, 0, v30
    v_lshl_add_u32 v4, v34, 6, v32
    v_xor_b32 v34, 0, v29
    v_lshl_add_u32 v8, v34, 6, v33
    v_xor_b32 v34, 1, v30
    v_lshl_add_u32 v5, v34, 6, v32
    v_xor_b32 v34, 1, v29
    v_lshl_add_u32 v9, v34, 6, v33
    v_xor_b32 v34, 2, v30
    v_lshl_add_u32 v6, v34, 6, v32
    v_xor_b32 v34, 2, v29
    v_lshl_add_u32 v10, v34, 6, v33
    v_xor_b32 v34, 3, v30
    v_lshl_add_u32 v7, v34, 6, v32
    v_xor_b32 v34, 3, v29
    v_lshl_add_u32 v11, v34, 6, v33
    v_lshlrev_b32 v15, 4, v2
    v_add_u32 v14, s53, v15
    s_mov_b32 s55, 0x41000000
    v_mov_b32 v0, 0x3f803f80
    v_mov_b32 v1, 0x3f803f80
    v_mov_b32 v2, 0x3f803f80
    v_mov_b32 v3, 0x3f803f80
    s_cmp_eq_u32 s3, 3
    s_cbranch_scc1 L_att1
    s_add_u32 s54, s50, s59
    s_add_u32 s54, s54, 1
    s_and_b32 s54, s54, 3
    s_lshl_b32 s54, s54, 2
    s_add_u32 s54, s54, s58
    s_lshl_b32 s54, s54, 8
    s_add_u32 s54, s54, s56
    s_cmp_ge_u32 s50, 3
    s_cselect_b32 s54, 1073741824, s54
    s_mov_b32 s57, s53
    v_mov_b32 v22, v14
    v_lshrrev_b32 v36, 4, v15
    s_lshr_b32 s48, s2, 1
    s_and_b32 s49, s2, 1
    s_lshl_b32 s62, s48, 5
    s_lshl_b32 s63, s47, 3
    s_add_u32 s62, s62, s63
    s_mul_i32 s62, s62, 1280
    s_mul_i32 s52, s49, 640
    s_add_u32 s62, s62, s52
    s_mul_i32 s63, s63, 656
    v_lshrrev_b32 v37, 2, v36
    v_and_b32 v38, 3, v36
    v_mul_u32_u24 v37, 656, v37
    v_lshl_add_u32 v37, v38, 3, v37
    s_mul_i32 s52, s47, 160
    v_add_u32 v37, s52, v37
    s_lshl_b32 s52, s49, 2
    s_add_u32 s52, s52, s47
    s_lshl_b32 s52, s52, 7
    s_add_u32 s52, s52, s48
    s_mul_i32 s52, s52, 5120
    s_add_u32 s52, s52, 33554432
    s_add_u32 s48, s52, 4096
    s_barrier
    s_barrier
    s_barrier
    s_barrier
    s_barrier
    s_barrier
    s_mov_b32 exec_lo, -1
    s_mov_b32 exec_hi, 0xff
    s_add_u32 m0, s63, 0
    s_add_u32 s51, s62, 0
    buffer_load_dwordx4 v15, s[36:39], s51 offen lds
    s_add_u32 m0, s63, 656
    s_add_u32 s51, s62, 1280
    buffer_load_dwordx4 v15, s[36:39], s51 offen lds
    s_add_u32 m0, s63, 1312
    s_add_u32 s51, s62, 2560
    buffer_load_dwordx4 v15, s[36:39], s51 offen lds
    s_add_u32 m0, s63, 1968
    s_add_u32 s51, s62, 3840
    buffer_load_dwordx4 v15, s[36:39], s51 offen lds
    s_add_u32 m0, s63, 2624
    s_add_u32 s51, s62, 5120
    buffer_load_dwordx4 v15, s[36:39], s51 offen lds
    s_add_u32 m0, s63, 3280
    s_add_u32 s51, s62, 6400
    buffer_load_dwordx4 v15, s[36:39], s51 offen lds
    s_add_u32 m0, s63, 3936
    s_add_u32 s51, s62, 7680
    buffer_load_dwordx4 v15, s[36:39], s51 offen lds
    s_add_u32 m0, s63, 4592
    s_add_u32 s51, s62, 8960
    buffer_load_dwordx4 v15, s[36:39], s51 offen lds
    s_mov_b64 exec, -1
    s_barrier
    buffer_load_dword v13, v12, s[32:35], s54 offen
    s_barrier
    s_waitcnt vmcnt(0)
    s_barrier
    ds_read_b64_tr_b16 v[96:97], v37 offset:0
    ds_read_b64_tr_b16 v[98:99], v37 offset:10496
    ds_read_b64_tr_b16 v[100:101], v37 offset:32
    ds_read_b64_tr_b16 v[102:103], v37 offset:10528
    ds_read_b64_tr_b16 v[104:105], v37 offset:64
    ds_read_b64_tr_b16 v[106:107], v37 offset:10560
    ds_read_b64_tr_b16 v[108:109], v37 offset:96
    ds_read_b64_tr_b16 v[110:111], v37 offset:10592
    ds_read_b64_tr_b16 v[112:113], v37 offset:128
    ds_read_b64_tr_b16 v[114:115], v37 offset:10624
    s_waitcnt lgkmcnt(0)
    s_barrier
    s_barrier
    s_add_u32 s54, s50, s59
    s_add_u32 s54, s54, 2
    s_and_b32 s54, s54, 3
    s_lshl_b32 s54, s54, 2
    s_add_u32 s54, s54, s58
    s_lshl_b32 s54, s54, 8
    s_add_u32 s54, s54, s56
    s_cmp_ge_u32 s50, 2
    s_cselect_b32 s54, 1073741824, s54
    ds_read_b128 v[32:35], v14 offset:0
    ds_read_b128 v[48:51], v14 offset:4096
    ds_read_b128 v[36:39], v14 offset:1024
    ds_read_b128 v[52:55], v14 offset:5120
    ds_read_b128 v[40:43], v14 offset:2048
    ds_read_b128 v[56:59], v14 offset:6144
    ds_read_b128 v[44:47], v14 offset:3072
    ds_read_b128 v[60:63], v14 offset:7168
    ds_read_b128 v[208:211], v4 offset:50688
    ds_read_b128 v[212:215], v5 offset:50688
    ds_read_b128 v[216:219], v6 offset:50688
    ds_read_b128 v[220:223], v7 offset:50688
    ds_read_b128 v[224:227], v4 offset:54848
    ds_read_b128 v[228:231], v5 offset:54848
    ds_read_b128 v[232:235], v6 offset:54848
    s_waitcnt lgkmcnt(6)
    v_mfma_f32_16x16x32_bf16 v[64:67], v[208:211], v[32:35], 0
    v_mfma_f32_16x16x32_bf16 v[68:71], v[208:211], v[48:51], 0
    ds_read_b128 v[236:239], v7 offset:54848
    s_waitcnt lgkmcnt(6)
    v_mfma_f32_16x16x32_bf16 v[64:67], v[212:215], v[36:39], v[64:67]
    v_mfma_f32_16x16x32_bf16 v[68:71], v[212:215], v[52:55], v[68:71]
    ds_read_b128 v[208:211], v4 offset:59008
    s_waitcnt lgkmcnt(6)
    v_mfma_f32_16x16x32_bf16 v[64:67], v[216:219], v[40:43], v[64:67]
    v_mfma_f32_16x16x32_bf16 v[68:71], v[216:219], v[56:59], v[68:71]
    ds_read_b128 v[212:215], v5 offset:59008
    s_waitcnt lgkmcnt(6)
    v_mfma_f32_16x16x32_bf16 v[64:67], v[220:223], v[44:47], v[64:67]
    v_mfma_f32_16x16x32_bf16 v[68:71], v[220:223], v[60:63], v[68:71]
    ds_read_b128 v[216:219], v6 offset:59008
    s_waitcnt lgkmcnt(6)
    v_mfma_f32_16x16x32_bf16 v[72:75], v[224:227], v[32:35], 0
    v_mfma_f32_16x16x32_bf16 v[76:79], v[224:227], v[48:51], 0
    ds_read_b128 v[220:223], v7 offset:59008
    s_waitcnt lgkmcnt(6)
    v_mfma_f32_16x16x32_bf16 v[72:75], v[228:231], v[36:39], v[72:75]
    v_mfma_f32_16x16x32_bf16 v[76:79], v[228:231], v[52:55], v[76:79]
    ds_read_b128 v[224:227], v4 offset:63168
    s_waitcnt lgkmcnt(6)
    v_mfma_f32_16x16x32_bf16 v[72:75], v[232:235], v[40:43], v[72:75]
    v_mfma_f32_16x16x32_bf16 v[76:79], v[232:235], v[56:59], v[76:79]
    ds_read_b128 v[228:231], v5 offset:63168
    s_waitcnt lgkmcnt(6)
    v_mfma_f32_16x16x32_bf16 v[72:75], v[236:239], v[44:47], v[72:75]
    v_mfma_f32_16x16x32_bf16 v[76:79], v[236:239], v[60:63], v[76:79]
    ds_read_b128 v[232:235], v6 offset:63168
    s_waitcnt lgkmcnt(6)
    v_mfma_f32_16x16x32_bf16 v[80:83], v[208:211], v[32:35], 0
    v_mfma_f32_16x16x32_bf16 v[84:87], v[208:211], v[48:51], 0
    ds_read_b128 v[236:239], v7 offset:63168
    s_waitcnt lgkmcnt(6)
    v_mfma_f32_16x16x32_bf16 v[80:83], v[212:215], v[36:39], v[80:83]
    v_mfma_f32_16x16x32_bf16 v[84:87], v[212:215], v[52:55], v[84:87]
    s_waitcnt lgkmcnt(5)
    v_mfma_f32_16x16x32_bf16 v[80:83], v[216:219], v[40:43], v[80:83]
    v_mfma_f32_16x16x32_bf16 v[84:87], v[216:219], v[56:59], v[84:87]
    s_waitcnt lgkmcnt(4)
    v_mfma_f32_16x16x32_bf16 v[80:83], v[220:223], v[44:47], v[80:83]
    v_mfma_f32_16x16x32_bf16 v[84:87], v[220:223], v[60:63], v[84:87]
    s_waitcnt lgkmcnt(0)
    s_barrier
    v_mfma_f32_16x16x32_bf16 v[88:91], v[224:227], v[32:35], 0
    v_mfma_f32_16x16x32_bf16 v[92:95], v[224:227], v[48:51], 0
    v_mfma_f32_16x16x32_bf16 v[88:91], v[228:231], v[36:39], v[88:91]
    v_mfma_f32_16x16x32_bf16 v[92:95], v[228:231], v[52:55], v[92:95]
    v_mfma_f32_16x16x32_bf16 v[88:91], v[232:235], v[40:43], v[88:91]
    v_mfma_f32_16x16x32_bf16 v[92:95], v[232:235], v[56:59], v[92:95]
    v_mfma_f32_16x16x32_bf16 v[88:91], v[236:239], v[44:47], v[88:91]
    v_mfma_f32_16x16x32_bf16 v[92:95], v[236:239], v[60:63], v[92:95]
    s_nop 7
    v_max3_f32 v16, v64, v65, v66
    v_max3_f32 v17, v68, v69, v70
    v_max3_f32 v16, v16, v67, v72
    v_max3_f32 v17, v17, v71, v76
    v_max3_f32 v16, v16, v73, v74
    v_max3_f32 v17, v17, v77, v78
    v_max3_f32 v16, v16, v75, v80
    v_max3_f32 v17, v17, v79, v84
    v_max3_f32 v16, v16, v81, v82
    s_barrier
    ds_read_b128 v[208:211], v4 offset:16896
    ds_read_b128 v[212:215], v5 offset:16896
    ds_read_b128 v[216:219], v6 offset:16896
    ds_read_b128 v[220:223], v7 offset:16896
    ds_read_b128 v[224:227], v4 offset:21056
    v_max3_f32 v17, v17, v85, v86
    v_max3_f32 v16, v16, v83, v88
    v_max3_f32 v17, v17, v87, v92
    ds_read_b128 v[228:231], v5 offset:21056
    v_max3_f32 v16, v16, v89, v90
    v_max3_f32 v17, v17, v93, v94
    ds_read_b128 v[232:235], v6 offset:21056
    v_max_f32 v16, v16, v91
    v_max_f32 v17, v17, v95
    buffer_store_dwordx4 v[96:99], v15, s[40:43], s52 offen offset:0
    buffer_store_dwordx4 v[100:103], v15, s[40:43], s52 offen offset:1024
    buffer_store_dwordx4 v[104:107], v15, s[40:43], s52 offen offset:2048
    buffer_store_dwordx4 v[108:111], v15, s[40:43], s52 offen offset:3072
    buffer_store_dwordx4 v[112:115], v15, s[40:43], s48 offen offset:0
    v_mov_b32 v18, v16
    v_mov_b32 v19, v17
    s_nop 1
    v_permlane16_swap_b32 v16, v18
    v_permlane16_swap_b32 v17, v19
    s_nop 0
    v_max_f32 v16, v16, v18
    v_max_f32 v17, v17, v19
    v_mov_b32 v18, v16
    v_mov_b32 v19, v17
    s_nop 1
    v_permlane32_swap_b32 v16, v18
    v_permlane32_swap_b32 v17, v19
    s_nop 0
    v_max_f32 v16, v16, v18
    v_max_f32 v17, v17, v19
    v_sub_f32 v240, 0, v16
    v_sub_f32 v241, 0, v16
    v_sub_f32 v242, 0, v16
    v_sub_f32 v243, 0, v16
    v_sub_f32 v244, 0, v17
    v_sub_f32 v245, 0, v17
    v_sub_f32 v246, 0, v17
    v_sub_f32 v247, 0, v17
    s_nop 1
L_itema:
    s_waitcnt lgkmcnt(6)
    v_mfma_f32_16x16x32_bf16 v[96:99], v[208:211], v[32:35], v[240:243]
    v_rcp_f32 v20, v24
    v_rcp_f32 v21, v28
    s_nop 0
    v_mul_f32 v144, v144, v20
    v_mul_f32 v145, v145, v20
    v_mul_f32 v146, v146, v20
    v_mfma_f32_16x16x32_bf16 v[100:103], v[208:211], v[48:51], v[244:247]
    ds_read_b128 v[236:239], v7 offset:21056
    v_mul_f32 v147, v147, v20
    v_mul_f32 v148, v148, v20
    v_mul_f32 v149, v149, v20
    v_mul_f32 v150, v150, v20
    v_mul_f32 v151, v151, v20
    s_waitcnt lgkmcnt(6)
    v_mfma_f32_16x16x32_bf16 v[96:99], v[212:215], v[36:39], v[96:99]
    v_cvt_pk_bf16_f32 v144, v144, v145
    v_cvt_pk_bf16_f32 v145, v146, v147
    v_cvt_pk_bf16_f32 v146, v148, v149
    v_cvt_pk_bf16_f32 v147, v150, v151
    ds_write_b128 v22, v[144:147] offset:0
    v_mul_f32 v176, v176, v21
    v_mfma_f32_16x16x32_bf16 v[100:103], v[212:215], v[52:55], v[100:103]
    ds_read_b128 v[208:211], v4 offset:25216
    v_mul_f32 v177, v177, v21
    v_mul_f32 v178, v178, v21
    v_mul_f32 v179, v179, v21
    v_mul_f32 v180, v180, v21
    s_waitcnt lgkmcnt(7)
    v_mfma_f32_16x16x32_bf16 v[96:99], v[216:219], v[40:43], v[96:99]
    v_mul_f32 v181, v181, v21
    v_mul_f32 v182, v182, v21
    v_mul_f32 v183, v183, v21
    v_cvt_pk_bf16_f32 v176, v176, v177
    v_cvt_pk_bf16_f32 v177, v178, v179
    v_cvt_pk_bf16_f32 v178, v180, v181
    v_mfma_f32_16x16x32_bf16 v[100:103], v[216:219], v[56:59], v[100:103]
    ds_read_b128 v[212:215], v5 offset:25216
    v_cvt_pk_bf16_f32 v179, v182, v183
    ds_write_b128 v22, v[176:179] offset:1024
    v_mul_f32 v152, v152, v20
    v_mul_f32 v153, v153, v20
    v_mul_f32 v154, v154, v20
    s_waitcnt lgkmcnt(8)
    v_mfma_f32_16x16x32_bf16 v[96:99], v[220:223], v[44:47], v[96:99]
    v_mul_f32 v155, v155, v20
    v_mul_f32 v156, v156, v20
    v_mul_f32 v157, v157, v20
    v_mul_f32 v158, v158, v20
    v_mul_f32 v159, v159, v20
    v_cvt_pk_bf16_f32 v152, v152, v153
    v_mfma_f32_16x16x32_bf16 v[100:103], v[220:223], v[60:63], v[100:103]
    ds_read_b128 v[216:219], v6 offset:25216
    v_cvt_pk_bf16_f32 v153, v154, v155
    v_cvt_pk_bf16_f32 v154, v156, v157
    v_cvt_pk_bf16_f32 v155, v158, v159
    ds_write_b128 v22, v[152:155] offset:2048
    s_waitcnt lgkmcnt(9)
    v_mfma_f32_16x16x32_bf16 v[104:107], v[224:227], v[32:35], v[240:243]
    v_mul_f32 v184, v184, v21
    v_mul_f32 v185, v185, v21
    v_mul_f32 v186, v186, v21
    v_mul_f32 v187, v187, v21
    v_mul_f32 v188, v188, v21
    v_mul_f32 v189, v189, v21
    v_mul_f32 v190, v190, v21
    v_mfma_f32_16x16x32_bf16 v[108:111], v[224:227], v[48:51], v[244:247]
    ds_read_b128 v[220:223], v7 offset:25216
    v_mul_f32 v191, v191, v21
    v_cvt_pk_bf16_f32 v184, v184, v185
    v_cvt_pk_bf16_f32 v185, v186, v187
    v_cvt_pk_bf16_f32 v186, v188, v189
    v_add_f32 v64, v64, v240
    s_waitcnt lgkmcnt(9)
    v_mfma_f32_16x16x32_bf16 v[104:107], v[228:231], v[36:39], v[104:107]
    v_cvt_pk_bf16_f32 v187, v190, v191
    ds_write_b128 v22, v[184:187] offset:3072
    v_mul_f32 v160, v160, v20
    v_mul_f32 v161, v161, v20
    v_mul_f32 v162, v162, v20
    v_mul_f32 v163, v163, v20
    v_mfma_f32_16x16x32_bf16 v[108:111], v[228:231], v[52:55], v[108:111]
    ds_read_b128 v[224:227], v4 offset:29376
    v_mul_f32 v164, v164, v20
    v_mul_f32 v165, v165, v20
    v_mul_f32 v166, v166, v20
    v_mul_f32 v167, v167, v20
    v_cvt_pk_bf16_f32 v160, v160, v161
    s_waitcnt lgkmcnt(10)
    v_mfma_f32_16x16x32_bf16 v[104:107], v[232:235], v[40:43], v[104:107]
    v_cvt_pk_bf16_f32 v161, v162, v163
    v_cvt_pk_bf16_f32 v162, v164, v165
    v_cvt_pk_bf16_f32 v163, v166, v167
    ds_write_b128 v22, v[160:163] offset:4096
    v_mul_f32 v192, v192, v21
    v_mul_f32 v193, v193, v21
    v_mul_f32 v194, v194, v21
    v_mfma_f32_16x16x32_bf16 v[108:111], v[232:235], v[56:59], v[108:111]
    ds_read_b128 v[228:231], v5 offset:29376
    v_mul_f32 v195, v195, v21
    v_mul_f32 v196, v196, v21
    v_mul_f32 v197, v197, v21
    v_add_f32 v65, v65, v240
    v_add_f32 v66, v66, v240
    s_waitcnt lgkmcnt(11)
    v_mfma_f32_16x16x32_bf16 v[104:107], v[236:239], v[44:47], v[104:107]
    v_mul_f32 v198, v198, v21
    v_mul_f32 v199, v199, v21
    v_cvt_pk_bf16_f32 v192, v192, v193
    v_cvt_pk_bf16_f32 v193, v194, v195
    v_cvt_pk_bf16_f32 v194, v196, v197
    v_cvt_pk_bf16_f32 v195, v198, v199
    ds_write_b128 v22, v[192:195] offset:5120
    v_mfma_f32_16x16x32_bf16 v[108:111], v[236:239], v[60:63], v[108:111]
    ds_read_b128 v[232:235], v6 offset:29376
    v_mul_f32 v168, v168, v20
    v_mul_f32 v169, v169, v20
    v_mul_f32 v170, v170, v20
    v_mul_f32 v171, v171, v20
    v_add_f32 v67, v67, v240
    s_waitcnt lgkmcnt(11)
    v_mfma_f32_16x16x32_bf16 v[112:115], v[208:211], v[32:35], v[240:243]
    v_mul_f32 v172, v172, v20
    v_mul_f32 v173, v173, v20
    v_mul_f32 v174, v174, v20
    v_mul_f32 v175, v175, v20
    v_cvt_pk_bf16_f32 v168, v168, v169
    v_cvt_pk_bf16_f32 v169, v170, v171
    v_cvt_pk_bf16_f32 v170, v172, v173
    v_mfma_f32_16x16x32_bf16 v[116:119], v[208:211], v[48:51], v[244:247]
    ds_read_b128 v[236:239], v7 offset:29376
    v_cvt_pk_bf16_f32 v171, v174, v175
    ds_write_b128 v14, v[168:171] offset:6144
    v_mul_f32 v200, v200, v21
    v_add_f32 v72, v72, v240
    v_add_f32 v73, v73, v240
    s_waitcnt lgkmcnt(12)
    v_mfma_f32_16x16x32_bf16 v[112:115], v[212:215], v[36:39], v[112:115]
    v_mul_f32 v201, v201, v21
    v_mul_f32 v202, v202, v21
    v_mul_f32 v203, v203, v21
    v_mul_f32 v204, v204, v21
    v_mul_f32 v205, v205, v21
    v_mul_f32 v206, v206, v21
    v_mfma_f32_16x16x32_bf16 v[116:119], v[212:215], v[52:55], v[116:119]
    v_mul_f32 v207, v207, v21
    v_cvt_pk_bf16_f32 v200, v200, v201
    v_cvt_pk_bf16_f32 v201, v202, v203
    v_cvt_pk_bf16_f32 v202, v204, v205
    v_cvt_pk_bf16_f32 v203, v206, v207
    ds_write_b128 v14, v[200:203] offset:7168
    s_waitcnt lgkmcnt(11)
    v_mfma_f32_16x16x32_bf16 v[112:115], v[216:219], v[40:43], v[112:115]
    v_add_f32 v74, v74, v240
    v_add_f32 v75, v75, v240
    v_exp_f32 v64, v64
    v_exp_f32 v65, v65
    v_mfma_f32_16x16x32_bf16 v[116:119], v[216:219], v[56:59], v[116:119]
    v_exp_f32 v66, v66
    v_exp_f32 v67, v67
    v_cvt_pk_bf16_f32 v128, v64, v65
    v_exp_f32 v72, v72
    s_waitcnt lgkmcnt(9)
    v_mfma_f32_16x16x32_bf16 v[112:115], v[220:223], v[44:47], v[112:115]
    v_exp_f32 v73, v73
    v_cvt_pk_bf16_f32 v129, v66, v67
    v_exp_f32 v74, v74
    v_mfma_f32_16x16x32_bf16 v[116:119], v[220:223], v[60:63], v[116:119]
    s_waitcnt lgkmcnt(0)
    s_barrier
    ds_read_b64_tr_b16 v[208:209], v8 offset:33792
    ds_read_b64_tr_b16 v[210:211], v8 offset:38016
    ds_read_b64_tr_b16 v[212:213], v8 offset:33824
    ds_read_b64_tr_b16 v[214:215], v8 offset:38048
    v_exp_f32 v75, v75
    v_mfma_f32_16x16x32_bf16 v[120:123], v[224:227], v[32:35], v[240:243]
    v_cvt_pk_bf16_f32 v130, v72, v73
    v_cvt_pk_bf16_f32 v131, v74, v75
    v_add_f32 v68, v68, v244
    v_add_f32 v69, v69, v244
    v_add_f32 v70, v70, v244
    v_add_f32 v71, v71, v244
    v_add_f32 v76, v76, v244
    v_mfma_f32_16x16x32_bf16 v[124:127], v[224:227], v[48:51], v[244:247]
    s_cmp_lg_u32 s50, 1
    s_cbranch_scc1 L_pk_1
    v_mov_b32 v248, v168
    v_mov_b32 v249, v169
    v_mov_b32 v250, v170
    v_mov_b32 v251, v171
    v_mov_b32 v252, v200
    v_mov_b32 v253, v201
    v_mov_b32 v254, v202
    v_mov_b32 v255, v203
L_pk_1:
    ds_read_b64_tr_b16 v[216:217], v9 offset:33792
    ds_read_b64_tr_b16 v[218:219], v9 offset:38016
    ds_read_b64_tr_b16 v[220:221], v9 offset:33824
    ds_read_b64_tr_b16 v[222:223], v9 offset:38048
    v_add_f32 v77, v77, v244
    v_add_f32 v78, v78, v244
    v_mfma_f32_16x16x32_bf16 v[120:123], v[228:231], v[36:39], v[120:123]
    v_add_f32 v79, v79, v244
    v_exp_f32 v68, v68
    v_exp_f32 v69, v69
    v_mfma_f32_16x16x32_bf16 v[124:127], v[228:231], v[52:55], v[124:127]
    ds_read_b64_tr_b16 v[224:225], v10 offset:33792
    ds_read_b64_tr_b16 v[226:227], v10 offset:38016
    v_exp_f32 v70, v70
    v_exp_f32 v71, v71
    v_cvt_pk_bf16_f32 v132, v68, v69
    v_mfma_f32_16x16x32_bf16 v[120:123], v[232:235], v[40:43], v[120:123]
    v_exp_f32 v76, v76
    v_exp_f32 v77, v77
    v_cvt_pk_bf16_f32 v133, v70, v71
    v_exp_f32 v78, v78
    v_mfma_f32_16x16x32_bf16 v[124:127], v[232:235], v[56:59], v[124:127]
    ds_read_b64_tr_b16 v[228:229], v10 offset:33824
    ds_read_b64_tr_b16 v[230:231], v10 offset:38048
    v_exp_f32 v79, v79
    v_cvt_pk_bf16_f32 v134, v76, v77
    v_cvt_pk_bf16_f32 v135, v78, v79
    v_mfma_f32_16x16x32_bf16 v[120:123], v[236:239], v[44:47], v[120:123]
    v_add_f32 v80, v80, v240
    v_add_f32 v81, v81, v240
    v_add_f32 v82, v82, v240
    v_add_f32 v83, v83, v240
    v_add_f32 v88, v88, v240
    v_mfma_f32_16x16x32_bf16 v[124:127], v[236:239], v[60:63], v[124:127]
    ds_read_b64_tr_b16 v[232:233], v11 offset:33792
    ds_read_b64_tr_b16 v[234:235], v11 offset:38016
    v_add_f32 v89, v89, v240
    v_add_f32 v90, v90, v240
    v_add_f32 v91, v91, v240
    s_waitcnt lgkmcnt(12)
    v_mfma_f32_16x16x32_bf16 v[144:147], v[208:211], v[128:131], 0
    v_exp_f32 v80, v80
    v_exp_f32 v81, v81
    v_mfma_f32_16x16x32_bf16 v[176:179], v[208:211], v[132:135], 0
    ds_read_b64_tr_b16 v[236:237], v11 offset:33824
    ds_read_b64_tr_b16 v[238:239], v11 offset:38048
    v_exp_f32 v82, v82
    s_waitcnt lgkmcnt(12)
    v_mfma_f32_16x16x32_bf16 v[148:151], v[212:215], v[128:131], 0
    v_exp_f32 v83, v83
    v_mfma_f32_16x16x32_bf16 v[180:183], v[212:215], v[132:135], 0
    v_cvt_pk_bf16_f32 v136, v80, v81
    v_mfma_f32_16x16x32_bf16 v[24:27], v[0:3], v[128:131], 0
    v_exp_f32 v88, v88
    v_mfma_f32_16x16x32_bf16 v[28:31], v[0:3], v[132:135], 0
    ds_read_b64_tr_b16 v[208:209], v8 offset:42240
    ds_read_b64_tr_b16 v[210:211], v8 offset:46464
    s_waitcnt lgkmcnt(12)
    v_mfma_f32_16x16x32_bf16 v[152:155], v[216:219], v[128:131], 0
    v_exp_f32 v89, v89
    v_cvt_pk_bf16_f32 v137, v82, v83
    v_exp_f32 v90, v90
    v_mfma_f32_16x16x32_bf16 v[184:187], v[216:219], v[132:135], 0
    ds_read_b64_tr_b16 v[212:213], v8 offset:42272
    ds_read_b64_tr_b16 v[214:215], v8 offset:46496
    v_exp_f32 v91, v91
    s_waitcnt lgkmcnt(12)
    v_mfma_f32_16x16x32_bf16 v[156:159], v[220:223], v[128:131], 0
    v_cvt_pk_bf16_f32 v138, v88, v89
    v_cvt_pk_bf16_f32 v139, v90, v91
    v_add_f32 v84, v84, v244
    v_add_f32 v85, v85, v244
    v_add_f32 v86, v86, v244
    v_mfma_f32_16x16x32_bf16 v[188:191], v[220:223], v[132:135], 0
    ds_read_b64_tr_b16 v[216:217], v9 offset:42240
    ds_read_b64_tr_b16 v[218:219], v9 offset:46464
    v_add_f32 v87, v87, v244
    v_add_f32 v92, v92, v244
    v_add_f32 v93, v93, v244
    s_waitcnt lgkmcnt(12)
    v_mfma_f32_16x16x32_bf16 v[160:163], v[224:227], v[128:131], 0
    v_add_f32 v94, v94, v244
    v_add_f32 v95, v95, v244
    v_exp_f32 v84, v84
    v_mfma_f32_16x16x32_bf16 v[192:195], v[224:227], v[132:135], 0
    ds_read_b64_tr_b16 v[220:221], v9 offset:42272
    ds_read_b64_tr_b16 v[222:223], v9 offset:46496
    v_exp_f32 v85, v85
    s_waitcnt lgkmcnt(12)
    v_mfma_f32_16x16x32_bf16 v[164:167], v[228:231], v[128:131], 0
    v_exp_f32 v86, v86
    v_exp_f32 v87, v87
    v_cvt_pk_bf16_f32 v140, v84, v85
    v_mfma_f32_16x16x32_bf16 v[196:199], v[228:231], v[132:135], 0
    ds_read_b64_tr_b16 v[224:225], v10 offset:42240
    ds_read_b64_tr_b16 v[226:227], v10 offset:46464
    v_exp_f32 v92, v92
    v_exp_f32 v93, v93
    s_waitcnt lgkmcnt(12)
    v_mfma_f32_16x16x32_bf16 v[168:171], v[232:235], v[128:131], 0
    v_cvt_pk_bf16_f32 v141, v86, v87
    v_exp_f32 v94, v94
    v_exp_f32 v95, v95
    v_mfma_f32_16x16x32_bf16 v[200:203], v[232:235], v[132:135], 0
    ds_read_b64_tr_b16 v[228:229], v10 offset:42272
    ds_read_b64_tr_b16 v[230:231], v10 offset:46496
    v_cvt_pk_bf16_f32 v142, v92, v93
    v_cvt_pk_bf16_f32 v143, v94, v95
    s_waitcnt lgkmcnt(12)
    v_mfma_f32_16x16x32_bf16 v[172:175], v[236:239], v[128:131], 0
    v_max3_f32 v16, v96, v97, v98
    v_max3_f32 v17, v100, v101, v102
    v_mfma_f32_16x16x32_bf16 v[204:207], v[236:239], v[132:135], 0
    ds_read_b64_tr_b16 v[232:233], v11 offset:42240
    ds_read_b64_tr_b16 v[234:235], v11 offset:46464
    s_waitcnt lgkmcnt(12)
    v_mfma_f32_16x16x32_bf16 v[144:147], v[208:211], v[136:139], v[144:147]
    v_max3_f32 v16, v16, v99, v104
    v_mfma_f32_16x16x32_bf16 v[176:179], v[208:211], v[140:143], v[176:179]
    ds_read_b64_tr_b16 v[236:237], v11 offset:42272
    ds_read_b64_tr_b16 v[238:239], v11 offset:46496
    s_waitcnt lgkmcnt(12)
    v_mfma_f32_16x16x32_bf16 v[148:151], v[212:215], v[136:139], v[148:151]
    v_mfma_f32_16x16x32_bf16 v[180:183], v[212:215], v[140:143], v[180:183]
    v_mfma_f32_16x16x32_bf16 v[24:27], v[0:3], v[136:139], v[24:27]
    v_mfma_f32_16x16x32_bf16 v[28:31], v[0:3], v[140:143], v[28:31]
    s_waitcnt lgkmcnt(10)
    v_mfma_f32_16x16x32_bf16 v[152:155], v[216:219], v[136:139], v[152:155]
    v_max3_f32 v17, v17, v103, v108
    v_max3_f32 v16, v16, v105, v106
    v_mfma_f32_16x16x32_bf16 v[184:187], v[216:219], v[140:143], v[184:187]
    v_max3_f32 v17, v17, v109, v110
    v_max3_f32 v16, v16, v107, v112
    s_waitcnt lgkmcnt(8)
    v_mfma_f32_16x16x32_bf16 v[156:159], v[220:223], v[136:139], v[156:159]
    v_mfma_f32_16x16x32_bf16 v[188:191], v[220:223], v[140:143], v[188:191]
    s_waitcnt lgkmcnt(0)
    s_barrier
    ds_read_b128 v[208:211], v4 offset:50688
    ds_read_b128 v[212:215], v5 offset:50688
    v_mfma_f32_16x16x32_bf16 v[160:163], v[224:227], v[136:139], v[160:163]
    v_max3_f32 v17, v17, v111, v116
    v_mfma_f32_16x16x32_bf16 v[192:195], v[224:227], v[140:143], v[192:195]
    ds_read_b128 v[216:219], v6 offset:50688
    ds_read_b128 v[220:223], v7 offset:50688
    v_mfma_f32_16x16x32_bf16 v[164:167], v[228:231], v[136:139], v[164:167]
    v_max3_f32 v16, v16, v113, v114
    v_max3_f32 v17, v17, v117, v118
    v_mfma_f32_16x16x32_bf16 v[196:199], v[228:231], v[140:143], v[196:199]
    ds_read_b128 v[224:227], v4 offset:54848
    v_max3_f32 v16, v16, v115, v120
    v_mfma_f32_16x16x32_bf16 v[168:171], v[232:235], v[136:139], v[168:171]
    v_max3_f32 v17, v17, v119, v124
    v_max3_f32 v16, v16, v121, v122
    v_mfma_f32_16x16x32_bf16 v[200:203], v[232:235], v[140:143], v[200:203]
    ds_read_b128 v[228:231], v5 offset:54848
    v_mfma_f32_16x16x32_bf16 v[172:175], v[236:239], v[136:139], v[172:175]
    v_max3_f32 v17, v17, v125, v126
    v_max_f32 v16, v16, v123
    v_mfma_f32_16x16x32_bf16 v[204:207], v[236:239], v[140:143], v[204:207]
    ds_read_b128 v[232:235], v6 offset:54848
    v_max_f32 v17, v17, v127
    v_max_f32 v18, v16, v17
    v_cmp_lt_f32 vcc, s55, v18
    s_cbranch_vccz L_nors_2
    s_call_b64 s[60:61], L_rescale1a
L_nors_2:
    s_waitcnt lgkmcnt(6)
    v_mfma_f32_16x16x32_bf16 v[64:67], v[208:211], v[32:35], v[240:243]
    v_exp_f32 v96, v96
    v_mfma_f32_16x16x32_bf16 v[68:71], v[208:211], v[48:51], v[244:247]
    ds_read_b128 v[236:239], v7 offset:54848
    v_exp_f32 v97, v97
    s_waitcnt lgkmcnt(6)
    v_mfma_f32_16x16x32_bf16 v[64:67], v[212:215], v[36:39], v[64:67]
    v_exp_f32 v98, v98
    v_mfma_f32_16x16x32_bf16 v[68:71], v[212:215], v[52:55], v[68:71]
    ds_read_b128 v[208:211], v4 offset:59008
    s_waitcnt lgkmcnt(6)
    v_mfma_f32_16x16x32_bf16 v[64:67], v[216:219], v[40:43], v[64:67]
    v_exp_f32 v99, v99
    v_cvt_pk_bf16_f32 v128, v96, v97
    v_mfma_f32_16x16x32_bf16 v[68:71], v[216:219], v[56:59], v[68:71]
    ds_read_b128 v[212:215], v5 offset:59008
    v_exp_f32 v104, v104
    s_waitcnt lgkmcnt(6)
    v_mfma_f32_16x16x32_bf16 v[64:67], v[220:223], v[44:47], v[64:67]
    v_exp_f32 v105, v105
    v_mfma_f32_16x16x32_bf16 v[68:71], v[220:223], v[60:63], v[68:71]
    ds_read_b128 v[216:219], v6 offset:59008
    v_cvt_pk_bf16_f32 v129, v98, v99
    s_waitcnt lgkmcnt(6)
    v_mfma_f32_16x16x32_bf16 v[72:75], v[224:227], v[32:35], v[240:243]
    v_exp_f32 v106, v106
    v_mfma_f32_16x16x32_bf16 v[76:79], v[224:227], v[48:51], v[244:247]
    ds_read_b128 v[220:223], v7 offset:59008
    v_exp_f32 v107, v107
    s_waitcnt lgkmcnt(6)
    v_mfma_f32_16x16x32_bf16 v[72:75], v[228:231], v[36:39], v[72:75]
    v_cvt_pk_bf16_f32 v130, v104, v105
    v_cvt_pk_bf16_f32 v131, v106, v107
    v_mfma_f32_16x16x32_bf16 v[76:79], v[228:231], v[52:55], v[76:79]
    ds_read_b128 v[224:227], v4 offset:63168
    s_waitcnt lgkmcnt(6)
    v_mfma_f32_16x16x32_bf16 v[72:75], v[232:235], v[40:43], v[72:75]
    v_exp_f32 v100, v100
    v_mfma_f32_16x16x32_bf16 v[76:79], v[232:235], v[56:59], v[76:79]
    ds_read_b128 v[228:231], v5 offset:63168
    v_exp_f32 v101, v101
    s_waitcnt lgkmcnt(6)
    v_mfma_f32_16x16x32_bf16 v[72:75], v[236:239], v[44:47], v[72:75]
    v_exp_f32 v102, v102
    v_mfma_f32_16x16x32_bf16 v[76:79], v[236:239], v[60:63], v[76:79]
    ds_read_b128 v[232:235], v6 offset:63168
    v_exp_f32 v103, v103
    v_cvt_pk_bf16_f32 v132, v100, v101
    s_waitcnt lgkmcnt(6)
    v_mfma_f32_16x16x32_bf16 v[80:83], v[208:211], v[32:35], v[240:243]
    v_exp_f32 v108, v108
    v_mfma_f32_16x16x32_bf16 v[84:87], v[208:211], v[48:51], v[244:247]
    ds_read_b128 v[236:239], v7 offset:63168
    s_waitcnt lgkmcnt(6)
    v_mfma_f32_16x16x32_bf16 v[80:83], v[212:215], v[36:39], v[80:83]
    v_exp_f32 v109, v109
    v_cvt_pk_bf16_f32 v133, v102, v103
    v_mfma_f32_16x16x32_bf16 v[84:87], v[212:215], v[52:55], v[84:87]
    v_exp_f32 v110, v110
    s_waitcnt lgkmcnt(5)
    v_mfma_f32_16x16x32_bf16 v[80:83], v[216:219], v[40:43], v[80:83]
    v_exp_f32 v111, v111
    v_mfma_f32_16x16x32_bf16 v[84:87], v[216:219], v[56:59], v[84:87]
    v_cvt_pk_bf16_f32 v134, v108, v109
    v_cvt_pk_bf16_f32 v135, v110, v111
    s_waitcnt lgkmcnt(4)
    v_mfma_f32_16x16x32_bf16 v[80:83], v[220:223], v[44:47], v[80:83]
    v_mfma_f32_16x16x32_bf16 v[84:87], v[220:223], v[60:63], v[84:87]
    s_waitcnt lgkmcnt(0)
    s_barrier
    ds_read_b64_tr_b16 v[208:209], v8 offset:0
    ds_read_b64_tr_b16 v[210:211], v8 offset:4224
    ds_read_b64_tr_b16 v[212:213], v8 offset:32
    ds_read_b64_tr_b16 v[214:215], v8 offset:4256
    v_mfma_f32_16x16x32_bf16 v[88:91], v[224:227], v[32:35], v[240:243]
    v_exp_f32 v112, v112
    v_mfma_f32_16x16x32_bf16 v[92:95], v[224:227], v[48:51], v[244:247]
    ds_read_b64_tr_b16 v[216:217], v9 offset:0
    ds_read_b64_tr_b16 v[218:219], v9 offset:4224
    ds_read_b64_tr_b16 v[220:221], v9 offset:32
    ds_read_b64_tr_b16 v[222:223], v9 offset:4256
    v_mfma_f32_16x16x32_bf16 v[88:91], v[228:231], v[36:39], v[88:91]
    v_exp_f32 v113, v113
    v_mfma_f32_16x16x32_bf16 v[92:95], v[228:231], v[52:55], v[92:95]
    ds_read_b64_tr_b16 v[224:225], v10 offset:0
    ds_read_b64_tr_b16 v[226:227], v10 offset:4224
    v_exp_f32 v114, v114
    v_mfma_f32_16x16x32_bf16 v[88:91], v[232:235], v[40:43], v[88:91]
    v_exp_f32 v115, v115
    v_cvt_pk_bf16_f32 v136, v112, v113
    v_mfma_f32_16x16x32_bf16 v[92:95], v[232:235], v[56:59], v[92:95]
    ds_read_b64_tr_b16 v[228:229], v10 offset:32
    ds_read_b64_tr_b16 v[230:231], v10 offset:4256
    v_exp_f32 v120, v120
    v_mfma_f32_16x16x32_bf16 v[88:91], v[236:239], v[44:47], v[88:91]
    v_exp_f32 v121, v121
    v_cvt_pk_bf16_f32 v137, v114, v115
    v_mfma_f32_16x16x32_bf16 v[92:95], v[236:239], v[60:63], v[92:95]
    ds_read_b64_tr_b16 v[232:233], v11 offset:0
    ds_read_b64_tr_b16 v[234:235], v11 offset:4224
    s_waitcnt lgkmcnt(12)
    v_mfma_f32_16x16x32_bf16 v[144:147], v[208:211], v[128:131], v[144:147]
    v_exp_f32 v122, v122
    v_exp_f32 v123, v123
    v_mfma_f32_16x16x32_bf16 v[176:179], v[208:211], v[132:135], v[176:179]
    ds_read_b64_tr_b16 v[236:237], v11 offset:32
    ds_read_b64_tr_b16 v[238:239], v11 offset:4256
    v_cvt_pk_bf16_f32 v138, v120, v121
    s_waitcnt lgkmcnt(12)
    v_mfma_f32_16x16x32_bf16 v[148:151], v[212:215], v[128:131], v[148:151]
    v_mfma_f32_16x16x32_bf16 v[180:183], v[212:215], v[132:135], v[180:183]
    v_mfma_f32_16x16x32_bf16 v[24:27], v[0:3], v[128:131], v[24:27]
    v_mfma_f32_16x16x32_bf16 v[28:31], v[0:3], v[132:135], v[28:31]
    ds_read_b64_tr_b16 v[208:209], v8 offset:8448
    ds_read_b64_tr_b16 v[210:211], v8 offset:12672
    s_waitcnt lgkmcnt(12)
    v_mfma_f32_16x16x32_bf16 v[152:155], v[216:219], v[128:131], v[152:155]
    v_cvt_pk_bf16_f32 v139, v122, v123
    v_exp_f32 v116, v116
    v_mfma_f32_16x16x32_bf16 v[184:187], v[216:219], v[132:135], v[184:187]
    ds_read_b64_tr_b16 v[212:213], v8 offset:8480
    ds_read_b64_tr_b16 v[214:215], v8 offset:12704
    s_waitcnt lgkmcnt(12)
    v_mfma_f32_16x16x32_bf16 v[156:159], v[220:223], v[128:131], v[156:159]
    v_exp_f32 v117, v117
    v_mfma_f32_16x16x32_bf16 v[188:191], v[220:223], v[132:135], v[188:191]
    ds_read_b64_tr_b16 v[216:217], v9 offset:8448
    ds_read_b64_tr_b16 v[218:219], v9 offset:12672
    v_exp_f32 v118, v118
    s_waitcnt lgkmcnt(12)
    v_mfma_f32_16x16x32_bf16 v[160:163], v[224:227], v[128:131], v[160:163]
    v_exp_f32 v119, v119
    v_cvt_pk_bf16_f32 v140, v116, v117
    v_mfma_f32_16x16x32_bf16 v[192:195], v[224:227], v[132:135], v[192:195]
    ds_read_b64_tr_b16 v[220:221], v9 offset:8480
    ds_read_b64_tr_b16 v[222:223], v9 offset:12704
    v_exp_f32 v124, v124
    s_waitcnt lgkmcnt(12)
    v_mfma_f32_16x16x32_bf16 v[164:167], v[228:231], v[128:131], v[164:167]
    v_exp_f32 v125, v125
    v_cvt_pk_bf16_f32 v141, v118, v119
    v_mfma_f32_16x16x32_bf16 v[196:199], v[228:231], v[132:135], v[196:199]
    ds_read_b64_tr_b16 v[224:225], v10 offset:8448
    ds_read_b64_tr_b16 v[226:227], v10 offset:12672
    v_exp_f32 v126, v126
    s_waitcnt lgkmcnt(12)
    v_mfma_f32_16x16x32_bf16 v[168:171], v[232:235], v[128:131], v[168:171]
    v_exp_f32 v127, v127
    v_cvt_pk_bf16_f32 v142, v124, v125
    v_mfma_f32_16x16x32_bf16 v[200:203], v[232:235], v[132:135], v[200:203]
    ds_read_b64_tr_b16 v[228:229], v10 offset:8480
    ds_read_b64_tr_b16 v[230:231], v10 offset:12704
    v_cvt_pk_bf16_f32 v143, v126, v127
    s_waitcnt lgkmcnt(12)
    v_mfma_f32_16x16x32_bf16 v[172:175], v[236:239], v[128:131], v[172:175]
    v_max3_f32 v16, v64, v65, v66
    v_max3_f32 v17, v68, v69, v70
    v_mfma_f32_16x16x32_bf16 v[204:207], v[236:239], v[132:135], v[204:207]
    ds_read_b64_tr_b16 v[232:233], v11 offset:8448
    ds_read_b64_tr_b16 v[234:235], v11 offset:12672
    s_waitcnt lgkmcnt(12)
    v_mfma_f32_16x16x32_bf16 v[144:147], v[208:211], v[136:139], v[144:147]
    v_max3_f32 v16, v16, v67, v72
    v_mfma_f32_16x16x32_bf16 v[176:179], v[208:211], v[140:143], v[176:179]
    ds_read_b64_tr_b16 v[236:237], v11 offset:8480
    ds_read_b64_tr_b16 v[238:239], v11 offset:12704
    s_waitcnt lgkmcnt(12)
    v_mfma_f32_16x16x32_bf16 v[148:151], v[212:215], v[136:139], v[148:151]
    v_mfma_f32_16x16x32_bf16 v[180:183], v[212:215], v[140:143], v[180:183]
    v_mfma_f32_16x16x32_bf16 v[24:27], v[0:3], v[136:139], v[24:27]
    v_mfma_f32_16x16x32_bf16 v[28:31], v[0:3], v[140:143], v[28:31]
    s_waitcnt lgkmcnt(10)
    v_mfma_f32_16x16x32_bf16 v[152:155], v[216:219], v[136:139], v[152:155]
    v_max3_f32 v17, v17, v71, v76
    v_max3_f32 v16, v16, v73, v74
    v_mfma_f32_16x16x32_bf16 v[184:187], v[216:219], v[140:143], v[184:187]
    v_max3_f32 v17, v17, v77, v78
    v_max3_f32 v16, v16, v75, v80
    s_waitcnt lgkmcnt(8)
    v_mfma_f32_16x16x32_bf16 v[156:159], v[220:223], v[136:139], v[156:159]
    v_mfma_f32_16x16x32_bf16 v[188:191], v[220:223], v[140:143], v[188:191]
    s_waitcnt lgkmcnt(0)
    s_barrier
    ds_read_b128 v[208:211], v4 offset:16896
    ds_read_b128 v[212:215], v5 offset:16896
    v_mfma_f32_16x16x32_bf16 v[160:163], v[224:227], v[136:139], v[160:163]
    v_max3_f32 v17, v17, v79, v84
    v_mfma_f32_16x16x32_bf16 v[192:195], v[224:227], v[140:143], v[192:195]
    ds_read_b128 v[216:219], v6 offset:16896
    ds_read_b128 v[220:223], v7 offset:16896
    v_mfma_f32_16x16x32_bf16 v[164:167], v[228:231], v[136:139], v[164:167]
    v_max3_f32 v16, v16, v81, v82
    v_max3_f32 v17, v17, v85, v86
    v_mfma_f32_16x16x32_bf16 v[196:199], v[228:231], v[140:143], v[196:199]
    ds_read_b128 v[224:227], v4 offset:21056
    v_max3_f32 v16, v16, v83, v88
    v_mfma_f32_16x16x32_bf16 v[168:171], v[232:235], v[136:139], v[168:171]
    v_max3_f32 v17, v17, v87, v92
    v_max3_f32 v16, v16, v89, v90
    v_mfma_f32_16x16x32_bf16 v[200:203], v[232:235], v[140:143], v[200:203]
    ds_read_b128 v[228:231], v5 offset:21056
    v_mfma_f32_16x16x32_bf16 v[172:175], v[236:239], v[136:139], v[172:175]
    v_max3_f32 v17, v17, v93, v94
    v_max_f32 v16, v16, v91
    v_mfma_f32_16x16x32_bf16 v[204:207], v[236:239], v[140:143], v[204:207]
    ds_read_b128 v[232:235], v6 offset:21056
    v_max_f32 v17, v17, v95
    v_max_f32 v18, v16, v17
    v_cmp_lt_f32 vcc, s55, v18
    s_cbranch_vccz L_nors_3
    s_call_b64 s[60:61], L_rescale0a
L_nors_3:
    s_waitcnt lgkmcnt(6)
    v_mfma_f32_16x16x32_bf16 v[96:99], v[208:211], v[32:35], v[240:243]
    v_exp_f32 v64, v64
    v_mfma_f32_16x16x32_bf16 v[100:103], v[208:211], v[48:51], v[244:247]
    ds_read_b128 v[236:239], v7 offset:21056
    v_exp_f32 v65, v65
    s_waitcnt lgkmcnt(6)
    v_mfma_f32_16x16x32_bf16 v[96:99], v[212:215], v[36:39], v[96:99]
    v_exp_f32 v66, v66
    v_mfma_f32_16x16x32_bf16 v[100:103], v[212:215], v[52:55], v[100:103]
    ds_read_b128 v[208:211], v4 offset:25216
    s_waitcnt lgkmcnt(6)
    v_mfma_f32_16x16x32_bf16 v[96:99], v[216:219], v[40:43], v[96:99]
    v_exp_f32 v67, v67
    v_cvt_pk_bf16_f32 v128, v64, v65
    v_mfma_f32_16x16x32_bf16 v[100:103], v[216:219], v[56:59], v[100:103]
    ds_read_b128 v[212:215], v5 offset:25216
    v_exp_f32 v72, v72
    s_waitcnt lgkmcnt(6)
    v_mfma_f32_16x16x32_bf16 v[96:99], v[220:223], v[44:47], v[96:99]
    v_exp_f32 v73, v73
    v_mfma_f32_16x16x32_bf16 v[100:103], v[220:223], v[60:63], v[100:103]
    ds_read_b128 v[216:219], v6 offset:25216
    v_cvt_pk_bf16_f32 v129, v66, v67
    s_waitcnt lgkmcnt(6)
    v_mfma_f32_16x16x32_bf16 v[104:107], v[224:227], v[32:35], v[240:243]
    v_exp_f32 v74, v74
    v_mfma_f32_16x16x32_bf16 v[108:111], v[224:227], v[48:51], v[244:247]
    ds_read_b128 v[220:223], v7 offset:25216
    v_exp_f32 v75, v75
    s_waitcnt lgkmcnt(6)
    v_mfma_f32_16x16x32_bf16 v[104:107], v[228:231], v[36:39], v[104:107]
    v_cvt_pk_bf16_f32 v130, v72, v73
    v_cvt_pk_bf16_f32 v131, v74, v75
    v_mfma_f32_16x16x32_bf16 v[108:111], v[228:231], v[52:55], v[108:111]
    ds_read_b128 v[224:227], v4 offset:29376
    s_waitcnt lgkmcnt(6)
    v_mfma_f32_16x16x32_bf16 v[104:107], v[232:235], v[40:43], v[104:107]
    v_exp_f32 v68, v68
    v_mfma_f32_16x16x32_bf16 v[108:111], v[232:235], v[56:59], v[108:111]
    ds_read_b128 v[228:231], v5 offset:29376
    v_exp_f32 v69, v69
    s_waitcnt lgkmcnt(6)
    v_mfma_f32_16x16x32_bf16 v[104:107], v[236:239], v[44:47], v[104:107]
    v_exp_f32 v70, v70
    v_mfma_f32_16x16x32_bf16 v[108:111], v[236:239], v[60:63], v[108:111]
    ds_read_b128 v[232:235], v6 offset:29376
    v_exp_f32 v71, v71
    v_cvt_pk_bf16_f32 v132, v68, v69
    s_waitcnt lgkmcnt(6)
    v_mfma_f32_16x16x32_bf16 v[112:115], v[208:211], v[32:35], v[240:243]
    v_exp_f32 v76, v76
    v_mfma_f32_16x16x32_bf16 v[116:119], v[208:211], v[48:51], v[244:247]
    ds_read_b128 v[236:239], v7 offset:29376
    s_waitcnt lgkmcnt(6)
    v_mfma_f32_16x16x32_bf16 v[112:115], v[212:215], v[36:39], v[112:115]
    v_exp_f32 v77, v77
    v_cvt_pk_bf16_f32 v133, v70, v71
    v_mfma_f32_16x16x32_bf16 v[116:119], v[212:215], v[52:55], v[116:119]
    buffer_load_dword v13, v12, s[32:35], s54 offen
    v_exp_f32 v78, v78
    s_waitcnt lgkmcnt(5)
    v_mfma_f32_16x16x32_bf16 v[112:115], v[216:219], v[40:43], v[112:115]
    v_exp_f32 v79, v79
    v_mfma_f32_16x16x32_bf16 v[116:119], v[216:219], v[56:59], v[116:119]
    v_cvt_pk_bf16_f32 v134, v76, v77
    v_cvt_pk_bf16_f32 v135, v78, v79
    s_waitcnt lgkmcnt(4)
    v_mfma_f32_16x16x32_bf16 v[112:115], v[220:223], v[44:47], v[112:115]
    v_mfma_f32_16x16x32_bf16 v[116:119], v[220:223], v[60:63], v[116:119]
    s_waitcnt lgkmcnt(0)
    s_barrier
    ds_read_b64_tr_b16 v[208:209], v8 offset:33792
    ds_read_b64_tr_b16 v[210:211], v8 offset:38016
    ds_read_b64_tr_b16 v[212:213], v8 offset:33824
    ds_read_b64_tr_b16 v[214:215], v8 offset:38048
    v_mfma_f32_16x16x32_bf16 v[120:123], v[224:227], v[32:35], v[240:243]
    v_exp_f32 v80, v80
    v_mfma_f32_16x16x32_bf16 v[124:127], v[224:227], v[48:51], v[244:247]
    ds_read_b64_tr_b16 v[216:217], v9 offset:33792
    ds_read_b64_tr_b16 v[218:219], v9 offset:38016
    ds_read_b64_tr_b16 v[220:221], v9 offset:33824
    ds_read_b64_tr_b16 v[222:223], v9 offset:38048
    v_mfma_f32_16x16x32_bf16 v[120:123], v[228:231], v[36:39], v[120:123]
    v_exp_f32 v81, v81
    v_mfma_f32_16x16x32_bf16 v[124:127], v[228:231], v[52:55], v[124:127]
    ds_read_b64_tr_b16 v[224:225], v10 offset:33792
    ds_read_b64_tr_b16 v[226:227], v10 offset:38016
    v_exp_f32 v82, v82
    v_mfma_f32_16x16x32_bf16 v[120:123], v[232:235], v[40:43], v[120:123]
    v_exp_f32 v83, v83
    v_cvt_pk_bf16_f32 v136, v80, v81
    v_mfma_f32_16x16x32_bf16 v[124:127], v[232:235], v[56:59], v[124:127]
    ds_read_b64_tr_b16 v[228:229], v10 offset:33824
    ds_read_b64_tr_b16 v[230:231], v10 offset:38048
    v_exp_f32 v88, v88
    v_mfma_f32_16x16x32_bf16 v[120:123], v[236:239], v[44:47], v[120:123]
    v_exp_f32 v89, v89
    v_cvt_pk_bf16_f32 v137, v82, v83
    v_mfma_f32_16x16x32_bf16 v[124:127], v[236:239], v[60:63], v[124:127]
    ds_read_b64_tr_b16 v[232:233], v11 offset:33792
    ds_read_b64_tr_b16 v[234:235], v11 offset:38016
    s_waitcnt lgkmcnt(12)
    v_mfma_f32_16x16x32_bf16 v[144:147], v[208:211], v[128:131], v[144:147]
    v_exp_f32 v90, v90
    v_exp_f32 v91, v91
    v_mfma_f32_16x16x32_bf16 v[176:179], v[208:211], v[132:135], v[176:179]
    ds_read_b64_tr_b16 v[236:237], v11 offset:33824
    ds_read_b64_tr_b16 v[238:239], v11 offset:38048
    v_cvt_pk_bf16_f32 v138, v88, v89
    s_waitcnt lgkmcnt(12)
    v_mfma_f32_16x16x32_bf16 v[148:151], v[212:215], v[128:131], v[148:151]
    v_mfma_f32_16x16x32_bf16 v[180:183], v[212:215], v[132:135], v[180:183]
    v_mfma_f32_16x16x32_bf16 v[24:27], v[0:3], v[128:131], v[24:27]
    v_mfma_f32_16x16x32_bf16 v[28:31], v[0:3], v[132:135], v[28:31]
    ds_read_b64_tr_b16 v[208:209], v8 offset:42240
    ds_read_b64_tr_b16 v[210:211], v8 offset:46464
    s_waitcnt lgkmcnt(12)
    v_mfma_f32_16x16x32_bf16 v[152:155], v[216:219], v[128:131], v[152:155]
    v_cvt_pk_bf16_f32 v139, v90, v91
    v_exp_f32 v84, v84
    v_mfma_f32_16x16x32_bf16 v[184:187], v[216:219], v[132:135], v[184:187]
    ds_read_b64_tr_b16 v[212:213], v8 offset:42272
    ds_read_b64_tr_b16 v[214:215], v8 offset:46496
    s_waitcnt lgkmcnt(12)
    v_mfma_f32_16x16x32_bf16 v[156:159], v[220:223], v[128:131], v[156:159]
    v_exp_f32 v85, v85
    v_mfma_f32_16x16x32_bf16 v[188:191], v[220:223], v[132:135], v[188:191]
    ds_read_b64_tr_b16 v[216:217], v9 offset:42240
    ds_read_b64_tr_b16 v[218:219], v9 offset:46464
    v_exp_f32 v86, v86
    s_waitcnt lgkmcnt(12)
    v_mfma_f32_16x16x32_bf16 v[160:163], v[224:227], v[128:131], v[160:163]
    v_exp_f32 v87, v87
    v_cvt_pk_bf16_f32 v140, v84, v85
    v_mfma_f32_16x16x32_bf16 v[192:195], v[224:227], v[132:135], v[192:195]
    ds_read_b64_tr_b16 v[220:221], v9 offset:42272
    ds_read_b64_tr_b16 v[222:223], v9 offset:46496
    v_exp_f32 v92, v92
    s_waitcnt lgkmcnt(12)
    v_mfma_f32_16x16x32_bf16 v[164:167], v[228:231], v[128:131], v[164:167]
    v_exp_f32 v93, v93
    v_cvt_pk_bf16_f32 v141, v86, v87
    v_mfma_f32_16x16x32_bf16 v[196:199], v[228:231], v[132:135], v[196:199]
    ds_read_b64_tr_b16 v[224:225], v10 offset:42240
    ds_read_b64_tr_b16 v[226:227], v10 offset:46464
    v_exp_f32 v94, v94
    s_waitcnt lgkmcnt(12)
    v_mfma_f32_16x16x32_bf16 v[168:171], v[232:235], v[128:131], v[168:171]
    v_exp_f32 v95, v95
    v_cvt_pk_bf16_f32 v142, v92, v93
    v_mfma_f32_16x16x32_bf16 v[200:203], v[232:235], v[132:135], v[200:203]
    ds_read_b64_tr_b16 v[228:229], v10 offset:42272
    ds_read_b64_tr_b16 v[230:231], v10 offset:46496
    v_cvt_pk_bf16_f32 v143, v94, v95
    s_waitcnt lgkmcnt(12)
    v_mfma_f32_16x16x32_bf16 v[172:175], v[236:239], v[128:131], v[172:175]
    v_max3_f32 v16, v96, v97, v98
    v_max3_f32 v17, v100, v101, v102
    v_mfma_f32_16x16x32_bf16 v[204:207], v[236:239], v[132:135], v[204:207]
    ds_read_b64_tr_b16 v[232:233], v11 offset:42240
    ds_read_b64_tr_b16 v[234:235], v11 offset:46464
    s_waitcnt lgkmcnt(12)
    v_mfma_f32_16x16x32_bf16 v[144:147], v[208:211], v[136:139], v[144:147]
    v_max3_f32 v16, v16, v99, v104
    v_mfma_f32_16x16x32_bf16 v[176:179], v[208:211], v[140:143], v[176:179]
    ds_read_b64_tr_b16 v[236:237], v11 offset:42272
    ds_read_b64_tr_b16 v[238:239], v11 offset:46496
    s_waitcnt lgkmcnt(12)
    v_mfma_f32_16x16x32_bf16 v[148:151], v[212:215], v[136:139], v[148:151]
    v_mfma_f32_16x16x32_bf16 v[180:183], v[212:215], v[140:143], v[180:183]
    v_mfma_f32_16x16x32_bf16 v[24:27], v[0:3], v[136:139], v[24:27]
    v_mfma_f32_16x16x32_bf16 v[28:31], v[0:3], v[140:143], v[28:31]
    s_waitcnt lgkmcnt(10)
    v_mfma_f32_16x16x32_bf16 v[152:155], v[216:219], v[136:139], v[152:155]
    v_max3_f32 v17, v17, v103, v108
    v_max3_f32 v16, v16, v105, v106
    v_mfma_f32_16x16x32_bf16 v[184:187], v[216:219], v[140:143], v[184:187]
    v_max3_f32 v17, v17, v109, v110
    v_max3_f32 v16, v16, v107, v112
    s_waitcnt lgkmcnt(8)
    v_mfma_f32_16x16x32_bf16 v[156:159], v[220:223], v[136:139], v[156:159]
    v_mfma_f32_16x16x32_bf16 v[188:191], v[220:223], v[140:143], v[188:191]
    s_waitcnt lgkmcnt(0)
    s_barrier
    ds_read_b128 v[208:211], v4 offset:50688
    ds_read_b128 v[212:215], v5 offset:50688
    v_mfma_f32_16x16x32_bf16 v[160:163], v[224:227], v[136:139], v[160:163]
    v_max3_f32 v17, v17, v111, v116
    v_mfma_f32_16x16x32_bf16 v[192:195], v[224:227], v[140:143], v[192:195]
    ds_read_b128 v[216:219], v6 offset:50688
    ds_read_b128 v[220:223], v7 offset:50688
    v_mfma_f32_16x16x32_bf16 v[164:167], v[228:231], v[136:139], v[164:167]
    v_max3_f32 v16, v16, v113, v114
    v_max3_f32 v17, v17, v117, v118
    v_mfma_f32_16x16x32_bf16 v[196:199], v[228:231], v[140:143], v[196:199]
    ds_read_b128 v[224:227], v4 offset:54848
    v_max3_f32 v16, v16, v115, v120
    v_mfma_f32_16x16x32_bf16 v[168:171], v[232:235], v[136:139], v[168:171]
    v_max3_f32 v17, v17, v119, v124
    v_max3_f32 v16, v16, v121, v122
    v_mfma_f32_16x16x32_bf16 v[200:203], v[232:235], v[140:143], v[200:203]
    ds_read_b128 v[228:231], v5 offset:54848
    v_mfma_f32_16x16x32_bf16 v[172:175], v[236:239], v[136:139], v[172:175]
    v_max3_f32 v17, v17, v125, v126
    v_max_f32 v16, v16, v123
    v_mfma_f32_16x16x32_bf16 v[204:207], v[236:239], v[140:143], v[204:207]
    ds_read_b128 v[232:235], v6 offset:54848
    v_max_f32 v17, v17, v127
    v_max_f32 v18, v16, v17
    v_cmp_lt_f32 vcc, s55, v18
    s_cbranch_vccz L_nors_4
    s_call_b64 s[60:61], L_rescale1a
L_nors_4:
    s_waitcnt lgkmcnt(6)
    v_mfma_f32_16x16x32_bf16 v[64:67], v[208:211], v[32:35], v[240:243]
    v_exp_f32 v96, v96
    v_mfma_f32_16x16x32_bf16 v[68:71], v[208:211], v[48:51], v[244:247]
    ds_read_b128 v[236:239], v7 offset:54848
    v_exp_f32 v97, v97
    s_waitcnt lgkmcnt(6)
    v_mfma_f32_16x16x32_bf16 v[64:67], v[212:215], v[36:39], v[64:67]
    v_exp_f32 v98, v98
    v_mfma_f32_16x16x32_bf16 v[68:71], v[212:215], v[52:55], v[68:71]
    ds_read_b128 v[208:211], v4 offset:59008
    s_waitcnt lgkmcnt(6)
    v_mfma_f32_16x16x32_bf16 v[64:67], v[216:219], v[40:43], v[64:67]
    v_exp_f32 v99, v99
    v_cvt_pk_bf16_f32 v128, v96, v97
    v_mfma_f32_16x16x32_bf16 v[68:71], v[216:219], v[56:59], v[68:71]
    ds_read_b128 v[212:215], v5 offset:59008
    v_exp_f32 v104, v104
    s_waitcnt lgkmcnt(6)
    v_mfma_f32_16x16x32_bf16 v[64:67], v[220:223], v[44:47], v[64:67]
    v_exp_f32 v105, v105
    v_mfma_f32_16x16x32_bf16 v[68:71], v[220:223], v[60:63], v[68:71]
    ds_read_b128 v[216:219], v6 offset:59008
    v_cvt_pk_bf16_f32 v129, v98, v99
    s_waitcnt lgkmcnt(6)
    v_mfma_f32_16x16x32_bf16 v[72:75], v[224:227], v[32:35], v[240:243]
    v_exp_f32 v106, v106
    v_mfma_f32_16x16x32_bf16 v[76:79], v[224:227], v[48:51], v[244:247]
    ds_read_b128 v[220:223], v7 offset:59008
    v_exp_f32 v107, v107
    s_waitcnt lgkmcnt(6)
    v_mfma_f32_16x16x32_bf16 v[72:75], v[228:231], v[36:39], v[72:75]
    v_cvt_pk_bf16_f32 v130, v104, v105
    v_cvt_pk_bf16_f32 v131, v106, v107
    v_mfma_f32_16x16x32_bf16 v[76:79], v[228:231], v[52:55], v[76:79]
    ds_read_b128 v[224:227], v4 offset:63168
    s_waitcnt lgkmcnt(6)
    v_mfma_f32_16x16x32_bf16 v[72:75], v[232:235], v[40:43], v[72:75]
    v_exp_f32 v100, v100
    v_mfma_f32_16x16x32_bf16 v[76:79], v[232:235], v[56:59], v[76:79]
    ds_read_b128 v[228:231], v5 offset:63168
    v_exp_f32 v101, v101
    s_waitcnt lgkmcnt(6)
    v_mfma_f32_16x16x32_bf16 v[72:75], v[236:239], v[44:47], v[72:75]
    v_exp_f32 v102, v102
    v_mfma_f32_16x16x32_bf16 v[76:79], v[236:239], v[60:63], v[76:79]
    ds_read_b128 v[232:235], v6 offset:63168
    v_exp_f32 v103, v103
    v_cvt_pk_bf16_f32 v132, v100, v101
    s_waitcnt lgkmcnt(6)
    v_mfma_f32_16x16x32_bf16 v[80:83], v[208:211], v[32:35], v[240:243]
    v_exp_f32 v108, v108
    v_mfma_f32_16x16x32_bf16 v[84:87], v[208:211], v[48:51], v[244:247]
    ds_read_b128 v[236:239], v7 offset:63168
    s_waitcnt lgkmcnt(6)
    v_mfma_f32_16x16x32_bf16 v[80:83], v[212:215], v[36:39], v[80:83]
    v_exp_f32 v109, v109
    v_cvt_pk_bf16_f32 v133, v102, v103
    v_mfma_f32_16x16x32_bf16 v[84:87], v[212:215], v[52:55], v[84:87]
    v_exp_f32 v110, v110
    s_waitcnt lgkmcnt(5)
    v_mfma_f32_16x16x32_bf16 v[80:83], v[216:219], v[40:43], v[80:83]
    v_exp_f32 v111, v111
    v_mfma_f32_16x16x32_bf16 v[84:87], v[216:219], v[56:59], v[84:87]
    v_cvt_pk_bf16_f32 v134, v108, v109
    v_cvt_pk_bf16_f32 v135, v110, v111
    s_waitcnt lgkmcnt(4)
    v_mfma_f32_16x16x32_bf16 v[80:83], v[220:223], v[44:47], v[80:83]
    v_mfma_f32_16x16x32_bf16 v[84:87], v[220:223], v[60:63], v[84:87]
    s_waitcnt lgkmcnt(0)
    s_barrier
    ds_read_b64_tr_b16 v[208:209], v8 offset:0
    ds_read_b64_tr_b16 v[210:211], v8 offset:4224
    ds_read_b64_tr_b16 v[212:213], v8 offset:32
    ds_read_b64_tr_b16 v[214:215], v8 offset:4256
    v_mfma_f32_16x16x32_bf16 v[88:91], v[224:227], v[32:35], v[240:243]
    v_exp_f32 v112, v112
    v_mfma_f32_16x16x32_bf16 v[92:95], v[224:227], v[48:51], v[244:247]
    ds_read_b64_tr_b16 v[216:217], v9 offset:0
    ds_read_b64_tr_b16 v[218:219], v9 offset:4224
    ds_read_b64_tr_b16 v[220:221], v9 offset:32
    ds_read_b64_tr_b16 v[222:223], v9 offset:4256
    v_mfma_f32_16x16x32_bf16 v[88:91], v[228:231], v[36:39], v[88:91]
    v_exp_f32 v113, v113
    v_mfma_f32_16x16x32_bf16 v[92:95], v[228:231], v[52:55], v[92:95]
    ds_read_b64_tr_b16 v[224:225], v10 offset:0
    ds_read_b64_tr_b16 v[226:227], v10 offset:4224
    v_exp_f32 v114, v114
    v_mfma_f32_16x16x32_bf16 v[88:91], v[232:235], v[40:43], v[88:91]
    v_exp_f32 v115, v115
    v_cvt_pk_bf16_f32 v136, v112, v113
    v_mfma_f32_16x16x32_bf16 v[92:95], v[232:235], v[56:59], v[92:95]
    ds_read_b64_tr_b16 v[228:229], v10 offset:32
    ds_read_b64_tr_b16 v[230:231], v10 offset:4256
    v_exp_f32 v120, v120
    v_mfma_f32_16x16x32_bf16 v[88:91], v[236:239], v[44:47], v[88:91]
    v_exp_f32 v121, v121
    v_cvt_pk_bf16_f32 v137, v114, v115
    v_mfma_f32_16x16x32_bf16 v[92:95], v[236:239], v[60:63], v[92:95]
    ds_read_b64_tr_b16 v[232:233], v11 offset:0
    ds_read_b64_tr_b16 v[234:235], v11 offset:4224
    s_waitcnt lgkmcnt(12)
    v_mfma_f32_16x16x32_bf16 v[144:147], v[208:211], v[128:131], v[144:147]
    v_exp_f32 v122, v122
    v_exp_f32 v123, v123
    v_mfma_f32_16x16x32_bf16 v[176:179], v[208:211], v[132:135], v[176:179]
    ds_read_b64_tr_b16 v[236:237], v11 offset:32
    ds_read_b64_tr_b16 v[238:239], v11 offset:4256
    v_cvt_pk_bf16_f32 v138, v120, v121
    s_waitcnt lgkmcnt(12)
    v_mfma_f32_16x16x32_bf16 v[148:151], v[212:215], v[128:131], v[148:151]
    v_mfma_f32_16x16x32_bf16 v[180:183], v[212:215], v[132:135], v[180:183]
    v_mfma_f32_16x16x32_bf16 v[24:27], v[0:3], v[128:131], v[24:27]
    v_mfma_f32_16x16x32_bf16 v[28:31], v[0:3], v[132:135], v[28:31]
    ds_read_b64_tr_b16 v[208:209], v8 offset:8448
    ds_read_b64_tr_b16 v[210:211], v8 offset:12672
    s_waitcnt lgkmcnt(12)
    v_mfma_f32_16x16x32_bf16 v[152:155], v[216:219], v[128:131], v[152:155]
    v_cvt_pk_bf16_f32 v139, v122, v123
    v_exp_f32 v116, v116
    v_mfma_f32_16x16x32_bf16 v[184:187], v[216:219], v[132:135], v[184:187]
    ds_read_b64_tr_b16 v[212:213], v8 offset:8480
    ds_read_b64_tr_b16 v[214:215], v8 offset:12704
    s_waitcnt lgkmcnt(12)
    v_mfma_f32_16x16x32_bf16 v[156:159], v[220:223], v[128:131], v[156:159]
    v_exp_f32 v117, v117
    v_mfma_f32_16x16x32_bf16 v[188:191], v[220:223], v[132:135], v[188:191]
    ds_read_b64_tr_b16 v[216:217], v9 offset:8448
    ds_read_b64_tr_b16 v[218:219], v9 offset:12672
    v_exp_f32 v118, v118
    s_waitcnt lgkmcnt(12)
    v_mfma_f32_16x16x32_bf16 v[160:163], v[224:227], v[128:131], v[160:163]
    v_exp_f32 v119, v119
    v_cvt_pk_bf16_f32 v140, v116, v117
    v_mfma_f32_16x16x32_bf16 v[192:195], v[224:227], v[132:135], v[192:195]
    ds_read_b64_tr_b16 v[220:221], v9 offset:8480
    ds_read_b64_tr_b16 v[222:223], v9 offset:12704
    v_exp_f32 v124, v124
    s_waitcnt lgkmcnt(12)
    v_mfma_f32_16x16x32_bf16 v[164:167], v[228:231], v[128:131], v[164:167]
    v_exp_f32 v125, v125
    v_cvt_pk_bf16_f32 v141, v118, v119
    v_mfma_f32_16x16x32_bf16 v[196:199], v[228:231], v[132:135], v[196:199]
    ds_read_b64_tr_b16 v[224:225], v10 offset:8448
    ds_read_b64_tr_b16 v[226:227], v10 offset:12672
    v_exp_f32 v126, v126
    s_waitcnt lgkmcnt(12)
    v_mfma_f32_16x16x32_bf16 v[168:171], v[232:235], v[128:131], v[168:171]
    v_exp_f32 v127, v127
    v_cvt_pk_bf16_f32 v142, v124, v125
    v_mfma_f32_16x16x32_bf16 v[200:203], v[232:235], v[132:135], v[200:203]
    ds_read_b64_tr_b16 v[228:229], v10 offset:8480
    ds_read_b64_tr_b16 v[230:231], v10 offset:12704
    v_cvt_pk_bf16_f32 v143, v126, v127
    s_waitcnt lgkmcnt(12)
    v_mfma_f32_16x16x32_bf16 v[172:175], v[236:239], v[128:131], v[172:175]
    v_max3_f32 v16, v64, v65, v66
    v_max3_f32 v17, v68, v69, v70
    v_mfma_f32_16x16x32_bf16 v[204:207], v[236:239], v[132:135], v[204:207]
    ds_read_b64_tr_b16 v[232:233], v11 offset:8448
    ds_read_b64_tr_b16 v[234:235], v11 offset:12672
    s_waitcnt lgkmcnt(12)
    v_mfma_f32_16x16x32_bf16 v[144:147], v[208:211], v[136:139], v[144:147]
    v_max3_f32 v16, v16, v67, v72
    v_mfma_f32_16x16x32_bf16 v[176:179], v[208:211], v[140:143], v[176:179]
    ds_read_b64_tr_b16 v[236:237], v11 offset:8480
    ds_read_b64_tr_b16 v[238:239], v11 offset:12704
    s_waitcnt lgkmcnt(12)
    v_mfma_f32_16x16x32_bf16 v[148:151], v[212:215], v[136:139], v[148:151]
    v_mfma_f32_16x16x32_bf16 v[180:183], v[212:215], v[140:143], v[180:183]
    v_mfma_f32_16x16x32_bf16 v[24:27], v[0:3], v[136:139], v[24:27]
    v_mfma_f32_16x16x32_bf16 v[28:31], v[0:3], v[140:143], v[28:31]
    s_waitcnt lgkmcnt(10)
    v_mfma_f32_16x16x32_bf16 v[152:155], v[216:219], v[136:139], v[152:155]
    v_max3_f32 v17, v17, v71, v76
    v_max3_f32 v16, v16, v73, v74
    v_mfma_f32_16x16x32_bf16 v[184:187], v[216:219], v[140:143], v[184:187]
    v_max3_f32 v17, v17, v77, v78
    v_max3_f32 v16, v16, v75, v80
    s_waitcnt lgkmcnt(8)
    v_mfma_f32_16x16x32_bf16 v[156:159], v[220:223], v[136:139], v[156:159]
    v_mfma_f32_16x16x32_bf16 v[188:191], v[220:223], v[140:143], v[188:191]
    s_waitcnt lgkmcnt(0)
    s_barrier
    ds_read_b128 v[208:211], v4 offset:16896
    ds_read_b128 v[212:215], v5 offset:16896
    v_mfma_f32_16x16x32_bf16 v[160:163], v[224:227], v[136:139], v[160:163]
    v_max3_f32 v17, v17, v79, v84
    v_mfma_f32_16x16x32_bf16 v[192:195], v[224:227], v[140:143], v[192:195]
    ds_read_b128 v[216:219], v6 offset:16896
    ds_read_b128 v[220:223], v7 offset:16896
    v_mfma_f32_16x16x32_bf16 v[164:167], v[228:231], v[136:139], v[164:167]
    v_max3_f32 v16, v16, v81, v82
    v_max3_f32 v17, v17, v85, v86
    v_mfma_f32_16x16x32_bf16 v[196:199], v[228:231], v[140:143], v[196:199]
    ds_read_b128 v[224:227], v4 offset:21056
    v_max3_f32 v16, v16, v83, v88
    v_mfma_f32_16x16x32_bf16 v[168:171], v[232:235], v[136:139], v[168:171]
    v_max3_f32 v17, v17, v87, v92
    v_max3_f32 v16, v16, v89, v90
    v_mfma_f32_16x16x32_bf16 v[200:203], v[232:235], v[140:143], v[200:203]
    ds_read_b128 v[228:231], v5 offset:21056
    v_mfma_f32_16x16x32_bf16 v[172:175], v[236:239], v[136:139], v[172:175]
    v_max3_f32 v17, v17, v93, v94
    v_max_f32 v16, v16, v91
    v_mfma_f32_16x16x32_bf16 v[204:207], v[236:239], v[140:143], v[204:207]
    ds_read_b128 v[232:235], v6 offset:21056
    v_max_f32 v17, v17, v95
    v_max_f32 v18, v16, v17
    v_cmp_lt_f32 vcc, s55, v18
    s_cbranch_vccz L_nors_5
    s_call_b64 s[60:61], L_rescale0a
L_nors_5:
    s_waitcnt lgkmcnt(6)
    v_mfma_f32_16x16x32_bf16 v[96:99], v[208:211], v[32:35], v[240:243]
    v_exp_f32 v64, v64
    v_mfma_f32_16x16x32_bf16 v[100:103], v[208:211], v[48:51], v[244:247]
    ds_read_b128 v[236:239], v7 offset:21056
    v_exp_f32 v65, v65
    s_waitcnt lgkmcnt(6)
    v_mfma_f32_16x16x32_bf16 v[96:99], v[212:215], v[36:39], v[96:99]
    v_exp_f32 v66, v66
    v_mfma_f32_16x16x32_bf16 v[100:103], v[212:215], v[52:55], v[100:103]
    ds_read_b128 v[208:211], v4 offset:25216
    s_waitcnt lgkmcnt(6)
    v_mfma_f32_16x16x32_bf16 v[96:99], v[216:219], v[40:43], v[96:99]
    v_exp_f32 v67, v67
    v_cvt_pk_bf16_f32 v128, v64, v65
    v_mfma_f32_16x16x32_bf16 v[100:103], v[216:219], v[56:59], v[100:103]
    ds_read_b128 v[212:215], v5 offset:25216
    v_exp_f32 v72, v72
    s_waitcnt lgkmcnt(6)
    v_mfma_f32_16x16x32_bf16 v[96:99], v[220:223], v[44:47], v[96:99]
    v_exp_f32 v73, v73
    v_mfma_f32_16x16x32_bf16 v[100:103], v[220:223], v[60:63], v[100:103]
    ds_read_b128 v[216:219], v6 offset:25216
    v_cvt_pk_bf16_f32 v129, v66, v67
    s_waitcnt lgkmcnt(6)
    v_mfma_f32_16x16x32_bf16 v[104:107], v[224:227], v[32:35], v[240:243]
    v_exp_f32 v74, v74
    v_mfma_f32_16x16x32_bf16 v[108:111], v[224:227], v[48:51], v[244:247]
    ds_read_b128 v[220:223], v7 offset:25216
    v_exp_f32 v75, v75
    s_waitcnt lgkmcnt(6)
    v_mfma_f32_16x16x32_bf16 v[104:107], v[228:231], v[36:39], v[104:107]
    v_cvt_pk_bf16_f32 v130, v72, v73
    v_cvt_pk_bf16_f32 v131, v74, v75
    v_mfma_f32_16x16x32_bf16 v[108:111], v[228:231], v[52:55], v[108:111]
    ds_read_b128 v[224:227], v4 offset:29376
    s_waitcnt lgkmcnt(6)
    v_mfma_f32_16x16x32_bf16 v[104:107], v[232:235], v[40:43], v[104:107]
    v_exp_f32 v68, v68
    v_mfma_f32_16x16x32_bf16 v[108:111], v[232:235], v[56:59], v[108:111]
    ds_read_b128 v[228:231], v5 offset:29376
    v_exp_f32 v69, v69
    s_waitcnt lgkmcnt(6)
    v_mfma_f32_16x16x32_bf16 v[104:107], v[236:239], v[44:47], v[104:107]
    v_exp_f32 v70, v70
    v_mfma_f32_16x16x32_bf16 v[108:111], v[236:239], v[60:63], v[108:111]
    ds_read_b128 v[232:235], v6 offset:29376
    v_exp_f32 v71, v71
    v_cvt_pk_bf16_f32 v132, v68, v69
    s_waitcnt lgkmcnt(6)
    v_mfma_f32_16x16x32_bf16 v[112:115], v[208:211], v[32:35], v[240:243]
    v_exp_f32 v76, v76
    v_mfma_f32_16x16x32_bf16 v[116:119], v[208:211], v[48:51], v[244:247]
    ds_read_b128 v[236:239], v7 offset:29376
    s_waitcnt lgkmcnt(6)
    v_mfma_f32_16x16x32_bf16 v[112:115], v[212:215], v[36:39], v[112:115]
    v_exp_f32 v77, v77
    v_cvt_pk_bf16_f32 v133, v70, v71
    v_mfma_f32_16x16x32_bf16 v[116:119], v[212:215], v[52:55], v[116:119]
    v_exp_f32 v78, v78
    s_waitcnt lgkmcnt(5)
    v_mfma_f32_16x16x32_bf16 v[112:115], v[216:219], v[40:43], v[112:115]
    v_exp_f32 v79, v79
    v_mfma_f32_16x16x32_bf16 v[116:119], v[216:219], v[56:59], v[116:119]
    v_cvt_pk_bf16_f32 v134, v76, v77
    v_cvt_pk_bf16_f32 v135, v78, v79
    s_waitcnt lgkmcnt(4)
    v_mfma_f32_16x16x32_bf16 v[112:115], v[220:223], v[44:47], v[112:115]
    v_mfma_f32_16x16x32_bf16 v[116:119], v[220:223], v[60:63], v[116:119]
    s_waitcnt lgkmcnt(0)
    s_barrier
    ds_read_b64_tr_b16 v[208:209], v8 offset:33792
    ds_read_b64_tr_b16 v[210:211], v8 offset:38016
    ds_read_b64_tr_b16 v[212:213], v8 offset:33824
    ds_read_b64_tr_b16 v[214:215], v8 offset:38048
    v_mfma_f32_16x16x32_bf16 v[120:123], v[224:227], v[32:35], v[240:243]
    v_exp_f32 v80, v80
    v_mfma_f32_16x16x32_bf16 v[124:127], v[224:227], v[48:51], v[244:247]
    ds_read_b64_tr_b16 v[216:217], v9 offset:33792
    ds_read_b64_tr_b16 v[218:219], v9 offset:38016
    ds_read_b64_tr_b16 v[220:221], v9 offset:33824
    ds_read_b64_tr_b16 v[222:223], v9 offset:38048
    v_mfma_f32_16x16x32_bf16 v[120:123], v[228:231], v[36:39], v[120:123]
    v_exp_f32 v81, v81
    v_mfma_f32_16x16x32_bf16 v[124:127], v[228:231], v[52:55], v[124:127]
    ds_read_b64_tr_b16 v[224:225], v10 offset:33792
    ds_read_b64_tr_b16 v[226:227], v10 offset:38016
    v_exp_f32 v82, v82
    v_mfma_f32_16x16x32_bf16 v[120:123], v[232:235], v[40:43], v[120:123]
    v_exp_f32 v83, v83
    v_cvt_pk_bf16_f32 v136, v80, v81
    v_mfma_f32_16x16x32_bf16 v[124:127], v[232:235], v[56:59], v[124:127]
    ds_read_b64_tr_b16 v[228:229], v10 offset:33824
    ds_read_b64_tr_b16 v[230:231], v10 offset:38048
    v_exp_f32 v88, v88
    v_mfma_f32_16x16x32_bf16 v[120:123], v[236:239], v[44:47], v[120:123]
    v_exp_f32 v89, v89
    v_cvt_pk_bf16_f32 v137, v82, v83
    v_mfma_f32_16x16x32_bf16 v[124:127], v[236:239], v[60:63], v[124:127]
    ds_read_b64_tr_b16 v[232:233], v11 offset:33792
    ds_read_b64_tr_b16 v[234:235], v11 offset:38016
    s_waitcnt lgkmcnt(12)
    v_mfma_f32_16x16x32_bf16 v[144:147], v[208:211], v[128:131], v[144:147]
    v_exp_f32 v90, v90
    v_exp_f32 v91, v91
    v_mfma_f32_16x16x32_bf16 v[176:179], v[208:211], v[132:135], v[176:179]
    ds_read_b64_tr_b16 v[236:237], v11 offset:33824
    ds_read_b64_tr_b16 v[238:239], v11 offset:38048
    v_cvt_pk_bf16_f32 v138, v88, v89
    s_waitcnt lgkmcnt(12)
    v_mfma_f32_16x16x32_bf16 v[148:151], v[212:215], v[128:131], v[148:151]
    v_mfma_f32_16x16x32_bf16 v[180:183], v[212:215], v[132:135], v[180:183]
    v_mfma_f32_16x16x32_bf16 v[24:27], v[0:3], v[128:131], v[24:27]
    v_mfma_f32_16x16x32_bf16 v[28:31], v[0:3], v[132:135], v[28:31]
    ds_read_b64_tr_b16 v[208:209], v8 offset:42240
    ds_read_b64_tr_b16 v[210:211], v8 offset:46464
    s_waitcnt lgkmcnt(12)
    v_mfma_f32_16x16x32_bf16 v[152:155], v[216:219], v[128:131], v[152:155]
    v_cvt_pk_bf16_f32 v139, v90, v91
    v_exp_f32 v84, v84
    v_mfma_f32_16x16x32_bf16 v[184:187], v[216:219], v[132:135], v[184:187]
    ds_read_b64_tr_b16 v[212:213], v8 offset:42272
    ds_read_b64_tr_b16 v[214:215], v8 offset:46496
    s_waitcnt lgkmcnt(12)
    v_mfma_f32_16x16x32_bf16 v[156:159], v[220:223], v[128:131], v[156:159]
    v_exp_f32 v85, v85
    v_mfma_f32_16x16x32_bf16 v[188:191], v[220:223], v[132:135], v[188:191]
    ds_read_b64_tr_b16 v[216:217], v9 offset:42240
    ds_read_b64_tr_b16 v[218:219], v9 offset:46464
    v_exp_f32 v86, v86
    s_waitcnt lgkmcnt(12)
    v_mfma_f32_16x16x32_bf16 v[160:163], v[224:227], v[128:131], v[160:163]
    v_exp_f32 v87, v87
    v_cvt_pk_bf16_f32 v140, v84, v85
    v_mfma_f32_16x16x32_bf16 v[192:195], v[224:227], v[132:135], v[192:195]
    ds_read_b64_tr_b16 v[220:221], v9 offset:42272
    ds_read_b64_tr_b16 v[222:223], v9 offset:46496
    v_exp_f32 v92, v92
    s_waitcnt lgkmcnt(12)
    v_mfma_f32_16x16x32_bf16 v[164:167], v[228:231], v[128:131], v[164:167]
    v_exp_f32 v93, v93
    v_cvt_pk_bf16_f32 v141, v86, v87
    v_mfma_f32_16x16x32_bf16 v[196:199], v[228:231], v[132:135], v[196:199]
    ds_read_b64_tr_b16 v[224:225], v10 offset:42240
    ds_read_b64_tr_b16 v[226:227], v10 offset:46464
    v_exp_f32 v94, v94
    s_waitcnt lgkmcnt(12)
    v_mfma_f32_16x16x32_bf16 v[168:171], v[232:235], v[128:131], v[168:171]
    v_exp_f32 v95, v95
    v_cvt_pk_bf16_f32 v142, v92, v93
    v_mfma_f32_16x16x32_bf16 v[200:203], v[232:235], v[132:135], v[200:203]
    ds_read_b64_tr_b16 v[228:229], v10 offset:42272
    ds_read_b64_tr_b16 v[230:231], v10 offset:46496
    v_cvt_pk_bf16_f32 v143, v94, v95
    s_waitcnt lgkmcnt(12)
    v_mfma_f32_16x16x32_bf16 v[172:175], v[236:239], v[128:131], v[172:175]
    v_max3_f32 v16, v96, v97, v98
    v_max3_f32 v17, v100, v101, v102
    v_mfma_f32_16x16x32_bf16 v[204:207], v[236:239], v[132:135], v[204:207]
    ds_read_b64_tr_b16 v[232:233], v11 offset:42240
    ds_read_b64_tr_b16 v[234:235], v11 offset:46464
    s_waitcnt lgkmcnt(12)
    v_mfma_f32_16x16x32_bf16 v[144:147], v[208:211], v[136:139], v[144:147]
    v_max3_f32 v16, v16, v99, v104
    v_mfma_f32_16x16x32_bf16 v[176:179], v[208:211], v[140:143], v[176:179]
    ds_read_b64_tr_b16 v[236:237], v11 offset:42272
    ds_read_b64_tr_b16 v[238:239], v11 offset:46496
    s_waitcnt lgkmcnt(12)
    v_mfma_f32_16x16x32_bf16 v[148:151], v[212:215], v[136:139], v[148:151]
    v_mfma_f32_16x16x32_bf16 v[180:183], v[212:215], v[140:143], v[180:183]
    v_mfma_f32_16x16x32_bf16 v[24:27], v[0:3], v[136:139], v[24:27]
    v_mfma_f32_16x16x32_bf16 v[28:31], v[0:3], v[140:143], v[28:31]
    s_waitcnt lgkmcnt(10)
    v_mfma_f32_16x16x32_bf16 v[152:155], v[216:219], v[136:139], v[152:155]
    v_max3_f32 v17, v17, v103, v108
    v_max3_f32 v16, v16, v105, v106
    v_mfma_f32_16x16x32_bf16 v[184:187], v[216:219], v[140:143], v[184:187]
    v_max3_f32 v17, v17, v109, v110
    v_max3_f32 v16, v16, v107, v112
    s_waitcnt lgkmcnt(8)
    v_mfma_f32_16x16x32_bf16 v[156:159], v[220:223], v[136:139], v[156:159]
    v_mfma_f32_16x16x32_bf16 v[188:191], v[220:223], v[140:143], v[188:191]
    s_waitcnt lgkmcnt(0)
    s_barrier
    ds_read_b128 v[208:211], v4 offset:50688
    ds_read_b128 v[212:215], v5 offset:50688
    v_mfma_f32_16x16x32_bf16 v[160:163], v[224:227], v[136:139], v[160:163]
    v_max3_f32 v17, v17, v111, v116
    v_mfma_f32_16x16x32_bf16 v[192:195], v[224:227], v[140:143], v[192:195]
    ds_read_b128 v[216:219], v6 offset:50688
    ds_read_b128 v[220:223], v7 offset:50688
    v_mfma_f32_16x16x32_bf16 v[164:167], v[228:231], v[136:139], v[164:167]
    v_max3_f32 v16, v16, v113, v114
    v_max3_f32 v17, v17, v117, v118
    v_mfma_f32_16x16x32_bf16 v[196:199], v[228:231], v[140:143], v[196:199]
    ds_read_b128 v[224:227], v4 offset:54848
    v_max3_f32 v16, v16, v115, v120
    v_mfma_f32_16x16x32_bf16 v[168:171], v[232:235], v[136:139], v[168:171]
    v_max3_f32 v17, v17, v119, v124
    v_max3_f32 v16, v16, v121, v122
    v_mfma_f32_16x16x32_bf16 v[200:203], v[232:235], v[140:143], v[200:203]
    ds_read_b128 v[228:231], v5 offset:54848
    v_mfma_f32_16x16x32_bf16 v[172:175], v[236:239], v[136:139], v[172:175]
    v_max3_f32 v17, v17, v125, v126
    v_max_f32 v16, v16, v123
    v_mfma_f32_16x16x32_bf16 v[204:207], v[236:239], v[140:143], v[204:207]
    ds_read_b128 v[232:235], v6 offset:54848
    v_max_f32 v17, v17, v127
    v_max_f32 v18, v16, v17
    v_cmp_lt_f32 vcc, s55, v18
    s_cbranch_vccz L_nors_6
    s_call_b64 s[60:61], L_rescale1a
L_nors_6:
    s_waitcnt lgkmcnt(6)
    v_mfma_f32_16x16x32_bf16 v[64:67], v[208:211], v[32:35], v[240:243]
    v_exp_f32 v96, v96
    v_mfma_f32_16x16x32_bf16 v[68:71], v[208:211], v[48:51], v[244:247]
    ds_read_b128 v[236:239], v7 offset:54848
    v_exp_f32 v97, v97
    s_waitcnt lgkmcnt(6)
    v_mfma_f32_16x16x32_bf16 v[64:67], v[212:215], v[36:39], v[64:67]
    v_exp_f32 v98, v98
    v_mfma_f32_16x16x32_bf16 v[68:71], v[212:215], v[52:55], v[68:71]
    ds_read_b128 v[208:211], v4 offset:59008
    s_waitcnt lgkmcnt(6)
    v_mfma_f32_16x16x32_bf16 v[64:67], v[216:219], v[40:43], v[64:67]
    v_exp_f32 v99, v99
    v_cvt_pk_bf16_f32 v128, v96, v97
    v_mfma_f32_16x16x32_bf16 v[68:71], v[216:219], v[56:59], v[68:71]
    ds_read_b128 v[212:215], v5 offset:59008
    v_exp_f32 v104, v104
    s_waitcnt lgkmcnt(6)
    v_mfma_f32_16x16x32_bf16 v[64:67], v[220:223], v[44:47], v[64:67]
    v_exp_f32 v105, v105
    v_mfma_f32_16x16x32_bf16 v[68:71], v[220:223], v[60:63], v[68:71]
    ds_read_b128 v[216:219], v6 offset:59008
    v_cvt_pk_bf16_f32 v129, v98, v99
    s_waitcnt lgkmcnt(6)
    v_mfma_f32_16x16x32_bf16 v[72:75], v[224:227], v[32:35], v[240:243]
    v_exp_f32 v106, v106
    v_mfma_f32_16x16x32_bf16 v[76:79], v[224:227], v[48:51], v[244:247]
    ds_read_b128 v[220:223], v7 offset:59008
    v_exp_f32 v107, v107
    s_waitcnt lgkmcnt(6)
    v_mfma_f32_16x16x32_bf16 v[72:75], v[228:231], v[36:39], v[72:75]
    v_cvt_pk_bf16_f32 v130, v104, v105
    v_cvt_pk_bf16_f32 v131, v106, v107
    v_mfma_f32_16x16x32_bf16 v[76:79], v[228:231], v[52:55], v[76:79]
    ds_read_b128 v[224:227], v4 offset:63168
    s_waitcnt lgkmcnt(6)
    v_mfma_f32_16x16x32_bf16 v[72:75], v[232:235], v[40:43], v[72:75]
    v_exp_f32 v100, v100
    v_mfma_f32_16x16x32_bf16 v[76:79], v[232:235], v[56:59], v[76:79]
    ds_read_b128 v[228:231], v5 offset:63168
    v_exp_f32 v101, v101
    s_waitcnt lgkmcnt(6)
    v_mfma_f32_16x16x32_bf16 v[72:75], v[236:239], v[44:47], v[72:75]
    v_exp_f32 v102, v102
    v_mfma_f32_16x16x32_bf16 v[76:79], v[236:239], v[60:63], v[76:79]
    ds_read_b128 v[232:235], v6 offset:63168
    v_exp_f32 v103, v103
    v_cvt_pk_bf16_f32 v132, v100, v101
    s_waitcnt lgkmcnt(6)
    v_mfma_f32_16x16x32_bf16 v[80:83], v[208:211], v[32:35], v[240:243]
    v_exp_f32 v108, v108
    v_mfma_f32_16x16x32_bf16 v[84:87], v[208:211], v[48:51], v[244:247]
    ds_read_b128 v[236:239], v7 offset:63168
    s_waitcnt lgkmcnt(6)
    v_mfma_f32_16x16x32_bf16 v[80:83], v[212:215], v[36:39], v[80:83]
    v_exp_f32 v109, v109
    v_cvt_pk_bf16_f32 v133, v102, v103
    v_mfma_f32_16x16x32_bf16 v[84:87], v[212:215], v[52:55], v[84:87]
    v_exp_f32 v110, v110
    s_waitcnt lgkmcnt(5)
    v_mfma_f32_16x16x32_bf16 v[80:83], v[216:219], v[40:43], v[80:83]
    v_exp_f32 v111, v111
    v_mfma_f32_16x16x32_bf16 v[84:87], v[216:219], v[56:59], v[84:87]
    v_cvt_pk_bf16_f32 v134, v108, v109
    v_cvt_pk_bf16_f32 v135, v110, v111
    s_waitcnt lgkmcnt(4)
    v_mfma_f32_16x16x32_bf16 v[80:83], v[220:223], v[44:47], v[80:83]
    v_mfma_f32_16x16x32_bf16 v[84:87], v[220:223], v[60:63], v[84:87]
    s_waitcnt lgkmcnt(0)
    s_barrier
    ds_read_b64_tr_b16 v[208:209], v8 offset:0
    ds_read_b64_tr_b16 v[210:211], v8 offset:4224
    ds_read_b64_tr_b16 v[212:213], v8 offset:32
    ds_read_b64_tr_b16 v[214:215], v8 offset:4256
    v_mfma_f32_16x16x32_bf16 v[88:91], v[224:227], v[32:35], v[240:243]
    v_exp_f32 v112, v112
    v_mfma_f32_16x16x32_bf16 v[92:95], v[224:227], v[48:51], v[244:247]
    ds_read_b64_tr_b16 v[216:217], v9 offset:0
    ds_read_b64_tr_b16 v[218:219], v9 offset:4224
    ds_read_b64_tr_b16 v[220:221], v9 offset:32
    ds_read_b64_tr_b16 v[222:223], v9 offset:4256
    v_mfma_f32_16x16x32_bf16 v[88:91], v[228:231], v[36:39], v[88:91]
    v_exp_f32 v113, v113
    v_mfma_f32_16x16x32_bf16 v[92:95], v[228:231], v[52:55], v[92:95]
    ds_read_b64_tr_b16 v[224:225], v10 offset:0
    ds_read_b64_tr_b16 v[226:227], v10 offset:4224
    v_exp_f32 v114, v114
    v_mfma_f32_16x16x32_bf16 v[88:91], v[232:235], v[40:43], v[88:91]
    v_exp_f32 v115, v115
    v_cvt_pk_bf16_f32 v136, v112, v113
    v_mfma_f32_16x16x32_bf16 v[92:95], v[232:235], v[56:59], v[92:95]
    ds_read_b64_tr_b16 v[228:229], v10 offset:32
    ds_read_b64_tr_b16 v[230:231], v10 offset:4256
    v_exp_f32 v120, v120
    v_mfma_f32_16x16x32_bf16 v[88:91], v[236:239], v[44:47], v[88:91]
    v_exp_f32 v121, v121
    v_cvt_pk_bf16_f32 v137, v114, v115
    v_mfma_f32_16x16x32_bf16 v[92:95], v[236:239], v[60:63], v[92:95]
    ds_read_b64_tr_b16 v[232:233], v11 offset:0
    ds_read_b64_tr_b16 v[234:235], v11 offset:4224
    s_waitcnt lgkmcnt(12)
    v_mfma_f32_16x16x32_bf16 v[144:147], v[208:211], v[128:131], v[144:147]
    v_exp_f32 v122, v122
    v_exp_f32 v123, v123
    v_mfma_f32_16x16x32_bf16 v[176:179], v[208:211], v[132:135], v[176:179]
    ds_read_b64_tr_b16 v[236:237], v11 offset:32
    ds_read_b64_tr_b16 v[238:239], v11 offset:4256
    v_cvt_pk_bf16_f32 v138, v120, v121
    s_waitcnt lgkmcnt(12)
    v_mfma_f32_16x16x32_bf16 v[148:151], v[212:215], v[128:131], v[148:151]
    v_mfma_f32_16x16x32_bf16 v[180:183], v[212:215], v[132:135], v[180:183]
    v_mfma_f32_16x16x32_bf16 v[24:27], v[0:3], v[128:131], v[24:27]
    v_mfma_f32_16x16x32_bf16 v[28:31], v[0:3], v[132:135], v[28:31]
    ds_read_b64_tr_b16 v[208:209], v8 offset:8448
    ds_read_b64_tr_b16 v[210:211], v8 offset:12672
    s_waitcnt lgkmcnt(12)
    v_mfma_f32_16x16x32_bf16 v[152:155], v[216:219], v[128:131], v[152:155]
    v_cvt_pk_bf16_f32 v139, v122, v123
    v_exp_f32 v116, v116
    v_mfma_f32_16x16x32_bf16 v[184:187], v[216:219], v[132:135], v[184:187]
    ds_read_b64_tr_b16 v[212:213], v8 offset:8480
    ds_read_b64_tr_b16 v[214:215], v8 offset:12704
    s_waitcnt lgkmcnt(12)
    v_mfma_f32_16x16x32_bf16 v[156:159], v[220:223], v[128:131], v[156:159]
    v_exp_f32 v117, v117
    v_mfma_f32_16x16x32_bf16 v[188:191], v[220:223], v[132:135], v[188:191]
    ds_read_b64_tr_b16 v[216:217], v9 offset:8448
    ds_read_b64_tr_b16 v[218:219], v9 offset:12672
    v_exp_f32 v118, v118
    s_waitcnt lgkmcnt(12)
    v_mfma_f32_16x16x32_bf16 v[160:163], v[224:227], v[128:131], v[160:163]
    v_exp_f32 v119, v119
    v_cvt_pk_bf16_f32 v140, v116, v117
    v_mfma_f32_16x16x32_bf16 v[192:195], v[224:227], v[132:135], v[192:195]
    ds_read_b64_tr_b16 v[220:221], v9 offset:8480
    ds_read_b64_tr_b16 v[222:223], v9 offset:12704
    v_exp_f32 v124, v124
    s_waitcnt lgkmcnt(12)
    v_mfma_f32_16x16x32_bf16 v[164:167], v[228:231], v[128:131], v[164:167]
    v_exp_f32 v125, v125
    v_cvt_pk_bf16_f32 v141, v118, v119
    v_mfma_f32_16x16x32_bf16 v[196:199], v[228:231], v[132:135], v[196:199]
    ds_read_b64_tr_b16 v[224:225], v10 offset:8448
    ds_read_b64_tr_b16 v[226:227], v10 offset:12672
    v_exp_f32 v126, v126
    s_waitcnt lgkmcnt(12)
    v_mfma_f32_16x16x32_bf16 v[168:171], v[232:235], v[128:131], v[168:171]
    v_exp_f32 v127, v127
    v_cvt_pk_bf16_f32 v142, v124, v125
    v_mfma_f32_16x16x32_bf16 v[200:203], v[232:235], v[132:135], v[200:203]
    ds_read_b64_tr_b16 v[228:229], v10 offset:8480
    ds_read_b64_tr_b16 v[230:231], v10 offset:12704
    v_cvt_pk_bf16_f32 v143, v126, v127
    s_waitcnt lgkmcnt(12)
    v_mfma_f32_16x16x32_bf16 v[172:175], v[236:239], v[128:131], v[172:175]
    v_max3_f32 v16, v64, v65, v66
    v_max3_f32 v17, v68, v69, v70
    v_mfma_f32_16x16x32_bf16 v[204:207], v[236:239], v[132:135], v[204:207]
    ds_read_b64_tr_b16 v[232:233], v11 offset:8448
    ds_read_b64_tr_b16 v[234:235], v11 offset:12672
    s_waitcnt lgkmcnt(12)
    v_mfma_f32_16x16x32_bf16 v[144:147], v[208:211], v[136:139], v[144:147]
    v_max3_f32 v16, v16, v67, v72
    v_mfma_f32_16x16x32_bf16 v[176:179], v[208:211], v[140:143], v[176:179]
    ds_read_b64_tr_b16 v[236:237], v11 offset:8480
    ds_read_b64_tr_b16 v[238:239], v11 offset:12704
    s_waitcnt lgkmcnt(12)
    v_mfma_f32_16x16x32_bf16 v[148:151], v[212:215], v[136:139], v[148:151]
    v_mfma_f32_16x16x32_bf16 v[180:183], v[212:215], v[140:143], v[180:183]
    v_mfma_f32_16x16x32_bf16 v[24:27], v[0:3], v[136:139], v[24:27]
    v_mfma_f32_16x16x32_bf16 v[28:31], v[0:3], v[140:143], v[28:31]
    s_waitcnt lgkmcnt(10)
    v_mfma_f32_16x16x32_bf16 v[152:155], v[216:219], v[136:139], v[152:155]
    v_max3_f32 v17, v17, v71, v76
    v_max3_f32 v16, v16, v73, v74
    v_mfma_f32_16x16x32_bf16 v[184:187], v[216:219], v[140:143], v[184:187]
    v_max3_f32 v17, v17, v77, v78
    v_max3_f32 v16, v16, v75, v80
    s_waitcnt lgkmcnt(8)
    v_mfma_f32_16x16x32_bf16 v[156:159], v[220:223], v[136:139], v[156:159]
    v_mfma_f32_16x16x32_bf16 v[188:191], v[220:223], v[140:143], v[188:191]
    s_waitcnt lgkmcnt(0)
    s_barrier
    ds_read_b128 v[208:211], v4 offset:16896
    ds_read_b128 v[212:215], v5 offset:16896
    v_mfma_f32_16x16x32_bf16 v[160:163], v[224:227], v[136:139], v[160:163]
    v_max3_f32 v17, v17, v79, v84
    v_mfma_f32_16x16x32_bf16 v[192:195], v[224:227], v[140:143], v[192:195]
    ds_read_b128 v[216:219], v6 offset:16896
    ds_read_b128 v[220:223], v7 offset:16896
    v_mfma_f32_16x16x32_bf16 v[164:167], v[228:231], v[136:139], v[164:167]
    v_max3_f32 v16, v16, v81, v82
    v_max3_f32 v17, v17, v85, v86
    v_mfma_f32_16x16x32_bf16 v[196:199], v[228:231], v[140:143], v[196:199]
    ds_read_b128 v[224:227], v4 offset:21056
    v_max3_f32 v16, v16, v83, v88
    v_mfma_f32_16x16x32_bf16 v[168:171], v[232:235], v[136:139], v[168:171]
    v_max3_f32 v17, v17, v87, v92
    v_max3_f32 v16, v16, v89, v90
    v_mfma_f32_16x16x32_bf16 v[200:203], v[232:235], v[140:143], v[200:203]
    ds_read_b128 v[228:231], v5 offset:21056
    v_mfma_f32_16x16x32_bf16 v[172:175], v[236:239], v[136:139], v[172:175]
    v_max3_f32 v17, v17, v93, v94
    v_max_f32 v16, v16, v91
    v_mfma_f32_16x16x32_bf16 v[204:207], v[236:239], v[140:143], v[204:207]
    ds_read_b128 v[232:235], v6 offset:21056
    v_max_f32 v17, v17, v95
    v_max_f32 v18, v16, v17
    v_cmp_lt_f32 vcc, s55, v18
    s_cbranch_vccz L_nors_7
    s_call_b64 s[60:61], L_rescale0a
L_nors_7:
    s_waitcnt lgkmcnt(6)
    v_mfma_f32_16x16x32_bf16 v[96:99], v[208:211], v[32:35], v[240:243]
    v_exp_f32 v64, v64
    v_mfma_f32_16x16x32_bf16 v[100:103], v[208:211], v[48:51], v[244:247]
    ds_read_b128 v[236:239], v7 offset:21056
    v_exp_f32 v65, v65
    s_waitcnt lgkmcnt(6)
    v_mfma_f32_16x16x32_bf16 v[96:99], v[212:215], v[36:39], v[96:99]
    v_exp_f32 v66, v66
    v_mfma_f32_16x16x32_bf16 v[100:103], v[212:215], v[52:55], v[100:103]
    ds_read_b128 v[208:211], v4 offset:25216
    s_waitcnt lgkmcnt(6)
    v_mfma_f32_16x16x32_bf16 v[96:99], v[216:219], v[40:43], v[96:99]
    v_exp_f32 v67, v67
    v_cvt_pk_bf16_f32 v128, v64, v65
    v_mfma_f32_16x16x32_bf16 v[100:103], v[216:219], v[56:59], v[100:103]
    ds_read_b128 v[212:215], v5 offset:25216
    v_exp_f32 v72, v72
    s_waitcnt lgkmcnt(6)
    v_mfma_f32_16x16x32_bf16 v[96:99], v[220:223], v[44:47], v[96:99]
    v_exp_f32 v73, v73
    v_mfma_f32_16x16x32_bf16 v[100:103], v[220:223], v[60:63], v[100:103]
    ds_read_b128 v[216:219], v6 offset:25216
    v_cvt_pk_bf16_f32 v129, v66, v67
    s_waitcnt lgkmcnt(6)
    v_mfma_f32_16x16x32_bf16 v[104:107], v[224:227], v[32:35], v[240:243]
    v_exp_f32 v74, v74
    v_mfma_f32_16x16x32_bf16 v[108:111], v[224:227], v[48:51], v[244:247]
    ds_read_b128 v[220:223], v7 offset:25216
    v_exp_f32 v75, v75
    s_waitcnt lgkmcnt(6)
    v_mfma_f32_16x16x32_bf16 v[104:107], v[228:231], v[36:39], v[104:107]
    v_cvt_pk_bf16_f32 v130, v72, v73
    v_cvt_pk_bf16_f32 v131, v74, v75
    v_mfma_f32_16x16x32_bf16 v[108:111], v[228:231], v[52:55], v[108:111]
    ds_read_b128 v[224:227], v4 offset:29376
    s_waitcnt lgkmcnt(6)
    v_mfma_f32_16x16x32_bf16 v[104:107], v[232:235], v[40:43], v[104:107]
    v_exp_f32 v68, v68
    v_mfma_f32_16x16x32_bf16 v[108:111], v[232:235], v[56:59], v[108:111]
    ds_read_b128 v[228:231], v5 offset:29376
    v_exp_f32 v69, v69
    s_waitcnt lgkmcnt(6)
    v_mfma_f32_16x16x32_bf16 v[104:107], v[236:239], v[44:47], v[104:107]
    v_exp_f32 v70, v70
    v_mfma_f32_16x16x32_bf16 v[108:111], v[236:239], v[60:63], v[108:111]
    ds_read_b128 v[232:235], v6 offset:29376
    v_exp_f32 v71, v71
    v_cvt_pk_bf16_f32 v132, v68, v69
    s_waitcnt lgkmcnt(6)
    v_mfma_f32_16x16x32_bf16 v[112:115], v[208:211], v[32:35], v[240:243]
    v_exp_f32 v76, v76
    v_mfma_f32_16x16x32_bf16 v[116:119], v[208:211], v[48:51], v[244:247]
    ds_read_b128 v[236:239], v7 offset:29376
    s_waitcnt lgkmcnt(6)
    v_mfma_f32_16x16x32_bf16 v[112:115], v[212:215], v[36:39], v[112:115]
    v_exp_f32 v77, v77
    v_cvt_pk_bf16_f32 v133, v70, v71
    v_mfma_f32_16x16x32_bf16 v[116:119], v[212:215], v[52:55], v[116:119]
    v_exp_f32 v78, v78
    s_waitcnt lgkmcnt(5)
    v_mfma_f32_16x16x32_bf16 v[112:115], v[216:219], v[40:43], v[112:115]
    v_exp_f32 v79, v79
    v_mfma_f32_16x16x32_bf16 v[116:119], v[216:219], v[56:59], v[116:119]
    v_cvt_pk_bf16_f32 v134, v76, v77
    v_cvt_pk_bf16_f32 v135, v78, v79
    s_waitcnt lgkmcnt(4)
    v_mfma_f32_16x16x32_bf16 v[112:115], v[220:223], v[44:47], v[112:115]
    v_mfma_f32_16x16x32_bf16 v[116:119], v[220:223], v[60:63], v[116:119]
    s_waitcnt lgkmcnt(0)
    s_barrier
    ds_read_b64_tr_b16 v[208:209], v8 offset:33792
    ds_read_b64_tr_b16 v[210:211], v8 offset:38016
    ds_read_b64_tr_b16 v[212:213], v8 offset:33824
    ds_read_b64_tr_b16 v[214:215], v8 offset:38048
    v_mfma_f32_16x16x32_bf16 v[120:123], v[224:227], v[32:35], v[240:243]
    v_exp_f32 v80, v80
    v_mfma_f32_16x16x32_bf16 v[124:127], v[224:227], v[48:51], v[244:247]
    ds_read_b64_tr_b16 v[216:217], v9 offset:33792
    ds_read_b64_tr_b16 v[218:219], v9 offset:38016
    ds_read_b64_tr_b16 v[220:221], v9 offset:33824
    ds_read_b64_tr_b16 v[222:223], v9 offset:38048
    v_mfma_f32_16x16x32_bf16 v[120:123], v[228:231], v[36:39], v[120:123]
    v_exp_f32 v81, v81
    v_mfma_f32_16x16x32_bf16 v[124:127], v[228:231], v[52:55], v[124:127]
    ds_read_b64_tr_b16 v[224:225], v10 offset:33792
    ds_read_b64_tr_b16 v[226:227], v10 offset:38016
    v_exp_f32 v82, v82
    v_mfma_f32_16x16x32_bf16 v[120:123], v[232:235], v[40:43], v[120:123]
    v_exp_f32 v83, v83
    v_cvt_pk_bf16_f32 v136, v80, v81
    v_mfma_f32_16x16x32_bf16 v[124:127], v[232:235], v[56:59], v[124:127]
    ds_read_b64_tr_b16 v[228:229], v10 offset:33824
    ds_read_b64_tr_b16 v[230:231], v10 offset:38048
    v_exp_f32 v88, v88
    v_mfma_f32_16x16x32_bf16 v[120:123], v[236:239], v[44:47], v[120:123]
    v_exp_f32 v89, v89
    v_cvt_pk_bf16_f32 v137, v82, v83
    v_mfma_f32_16x16x32_bf16 v[124:127], v[236:239], v[60:63], v[124:127]
    ds_read_b64_tr_b16 v[232:233], v11 offset:33792
    ds_read_b64_tr_b16 v[234:235], v11 offset:38016
    s_waitcnt lgkmcnt(12)
    v_mfma_f32_16x16x32_bf16 v[144:147], v[208:211], v[128:131], v[144:147]
    v_exp_f32 v90, v90
    v_exp_f32 v91, v91
    v_mfma_f32_16x16x32_bf16 v[176:179], v[208:211], v[132:135], v[176:179]
    ds_read_b64_tr_b16 v[236:237], v11 offset:33824
    ds_read_b64_tr_b16 v[238:239], v11 offset:38048
    v_cvt_pk_bf16_f32 v138, v88, v89
    s_waitcnt lgkmcnt(12)
    v_mfma_f32_16x16x32_bf16 v[148:151], v[212:215], v[128:131], v[148:151]
    v_mfma_f32_16x16x32_bf16 v[180:183], v[212:215], v[132:135], v[180:183]
    v_mfma_f32_16x16x32_bf16 v[24:27], v[0:3], v[128:131], v[24:27]
    v_mfma_f32_16x16x32_bf16 v[28:31], v[0:3], v[132:135], v[28:31]
    ds_read_b64_tr_b16 v[208:209], v8 offset:42240
    ds_read_b64_tr_b16 v[210:211], v8 offset:46464
    s_waitcnt lgkmcnt(12)
    v_mfma_f32_16x16x32_bf16 v[152:155], v[216:219], v[128:131], v[152:155]
    v_cvt_pk_bf16_f32 v139, v90, v91
    v_exp_f32 v84, v84
    v_mfma_f32_16x16x32_bf16 v[184:187], v[216:219], v[132:135], v[184:187]
    ds_read_b64_tr_b16 v[212:213], v8 offset:42272
    ds_read_b64_tr_b16 v[214:215], v8 offset:46496
    s_waitcnt lgkmcnt(12)
    v_mfma_f32_16x16x32_bf16 v[156:159], v[220:223], v[128:131], v[156:159]
    v_exp_f32 v85, v85
    v_mfma_f32_16x16x32_bf16 v[188:191], v[220:223], v[132:135], v[188:191]
    ds_read_b64_tr_b16 v[216:217], v9 offset:42240
    ds_read_b64_tr_b16 v[218:219], v9 offset:46464
    v_exp_f32 v86, v86
    s_waitcnt lgkmcnt(12)
    v_mfma_f32_16x16x32_bf16 v[160:163], v[224:227], v[128:131], v[160:163]
    v_exp_f32 v87, v87
    v_cvt_pk_bf16_f32 v140, v84, v85
    v_mfma_f32_16x16x32_bf16 v[192:195], v[224:227], v[132:135], v[192:195]
    ds_read_b64_tr_b16 v[220:221], v9 offset:42272
    ds_read_b64_tr_b16 v[222:223], v9 offset:46496
    v_exp_f32 v92, v92
    s_waitcnt lgkmcnt(12)
    v_mfma_f32_16x16x32_bf16 v[164:167], v[228:231], v[128:131], v[164:167]
    v_exp_f32 v93, v93
    v_cvt_pk_bf16_f32 v141, v86, v87
    v_mfma_f32_16x16x32_bf16 v[196:199], v[228:231], v[132:135], v[196:199]
    ds_read_b64_tr_b16 v[224:225], v10 offset:42240
    ds_read_b64_tr_b16 v[226:227], v10 offset:46464
    v_exp_f32 v94, v94
    s_waitcnt lgkmcnt(12)
    v_mfma_f32_16x16x32_bf16 v[168:171], v[232:235], v[128:131], v[168:171]
    v_exp_f32 v95, v95
    v_cvt_pk_bf16_f32 v142, v92, v93
    v_mfma_f32_16x16x32_bf16 v[200:203], v[232:235], v[132:135], v[200:203]
    ds_read_b64_tr_b16 v[228:229], v10 offset:42272
    ds_read_b64_tr_b16 v[230:231], v10 offset:46496
    v_cvt_pk_bf16_f32 v143, v94, v95
    s_waitcnt lgkmcnt(12)
    v_mfma_f32_16x16x32_bf16 v[172:175], v[236:239], v[128:131], v[172:175]
    v_max3_f32 v16, v96, v97, v98
    v_max3_f32 v17, v100, v101, v102
    v_max3_f32 v16, v16, v99, v104
    v_mfma_f32_16x16x32_bf16 v[204:207], v[236:239], v[132:135], v[204:207]
    ds_read_b64_tr_b16 v[232:233], v11 offset:42240
    ds_read_b64_tr_b16 v[234:235], v11 offset:46464
    s_waitcnt lgkmcnt(12)
    v_mfma_f32_16x16x32_bf16 v[144:147], v[208:211], v[136:139], v[144:147]
    v_max3_f32 v17, v17, v103, v108
    v_max3_f32 v16, v16, v105, v106
    v_mfma_f32_16x16x32_bf16 v[176:179], v[208:211], v[140:143], v[176:179]
    ds_read_b64_tr_b16 v[236:237], v11 offset:42272
    ds_read_b64_tr_b16 v[238:239], v11 offset:46496
    s_waitcnt lgkmcnt(12)
    v_mfma_f32_16x16x32_bf16 v[148:151], v[212:215], v[136:139], v[148:151]
    v_mfma_f32_16x16x32_bf16 v[180:183], v[212:215], v[140:143], v[180:183]
    v_mfma_f32_16x16x32_bf16 v[24:27], v[0:3], v[136:139], v[24:27]
    v_mfma_f32_16x16x32_bf16 v[28:31], v[0:3], v[140:143], v[28:31]
    v_max3_f32 v17, v17, v109, v110
    s_waitcnt lgkmcnt(10)
    v_mfma_f32_16x16x32_bf16 v[152:155], v[216:219], v[136:139], v[152:155]
    v_max3_f32 v16, v16, v107, v112
    v_max3_f32 v17, v17, v111, v116
    v_mfma_f32_16x16x32_bf16 v[184:187], v[216:219], v[140:143], v[184:187]
    v_max3_f32 v16, v16, v113, v114
    v_max3_f32 v17, v17, v117, v118
    s_waitcnt lgkmcnt(8)
    v_mfma_f32_16x16x32_bf16 v[156:159], v[220:223], v[136:139], v[156:159]
    v_mfma_f32_16x16x32_bf16 v[188:191], v[220:223], v[140:143], v[188:191]
    s_waitcnt lgkmcnt(0)
    s_barrier
    ds_read_b128 v[208:211], v4 offset:50688
    ds_read_b128 v[212:215], v5 offset:50688
    ds_read_b128 v[32:35], v14 offset:0
    ds_read_b128 v[48:51], v14 offset:4096
    v_mfma_f32_16x16x32_bf16 v[160:163], v[224:227], v[136:139], v[160:163]
    v_mfma_f32_16x16x32_bf16 v[192:195], v[224:227], v[140:143], v[192:195]
    ds_read_b128 v[216:219], v6 offset:50688
    ds_read_b128 v[220:223], v7 offset:50688
    ds_read_b128 v[36:39], v14 offset:1024
    ds_read_b128 v[52:55], v14 offset:5120
    v_mfma_f32_16x16x32_bf16 v[164:167], v[228:231], v[136:139], v[164:167]
    v_max3_f32 v16, v16, v115, v120
    v_mfma_f32_16x16x32_bf16 v[196:199], v[228:231], v[140:143], v[196:199]
    ds_read_b128 v[224:227], v4 offset:54848
    ds_read_b128 v[40:43], v14 offset:2048
    ds_read_b128 v[56:59], v14 offset:6144
    v_mfma_f32_16x16x32_bf16 v[168:171], v[232:235], v[136:139], v[168:171]
    v_max3_f32 v17, v17, v119, v124
    v_mfma_f32_16x16x32_bf16 v[200:203], v[232:235], v[140:143], v[200:203]
    ds_read_b128 v[228:231], v5 offset:54848
    ds_read_b128 v[44:47], v14 offset:3072
    ds_read_b128 v[60:63], v14 offset:7168
    v_mfma_f32_16x16x32_bf16 v[172:175], v[236:239], v[136:139], v[172:175]
    v_max3_f32 v16, v16, v121, v122
    v_max3_f32 v17, v17, v125, v126
    v_max_f32 v16, v16, v123
    v_mfma_f32_16x16x32_bf16 v[204:207], v[236:239], v[140:143], v[204:207]
    ds_read_b128 v[232:235], v6 offset:54848
    v_max_f32 v17, v17, v127
    v_max_f32 v18, v16, v17
    v_cmp_lt_f32 vcc, s55, v18
    s_cbranch_vccz L_nors_8
    s_call_b64 s[60:61], L_rescale1a
L_nors_8:
    s_waitcnt lgkmcnt(14)
    s_waitcnt lgkmcnt(11)
    v_mfma_f32_16x16x32_bf16 v[64:67], v[208:211], v[32:35], 0
    v_exp_f32 v96, v96
    v_mfma_f32_16x16x32_bf16 v[68:71], v[208:211], v[48:51], 0
    ds_read_b128 v[236:239], v7 offset:54848
    v_exp_f32 v97, v97
    s_waitcnt lgkmcnt(8)
    v_mfma_f32_16x16x32_bf16 v[64:67], v[212:215], v[36:39], v[64:67]
    v_exp_f32 v98, v98
    v_mfma_f32_16x16x32_bf16 v[68:71], v[212:215], v[52:55], v[68:71]
    ds_read_b128 v[208:211], v4 offset:59008
    s_waitcnt lgkmcnt(6)
    v_mfma_f32_16x16x32_bf16 v[64:67], v[216:219], v[40:43], v[64:67]
    v_exp_f32 v99, v99
    v_cvt_pk_bf16_f32 v128, v96, v97
    v_mfma_f32_16x16x32_bf16 v[68:71], v[216:219], v[56:59], v[68:71]
    ds_read_b128 v[212:215], v5 offset:59008
    v_exp_f32 v104, v104
    s_waitcnt lgkmcnt(4)
    v_mfma_f32_16x16x32_bf16 v[64:67], v[220:223], v[44:47], v[64:67]
    v_exp_f32 v105, v105
    v_mfma_f32_16x16x32_bf16 v[68:71], v[220:223], v[60:63], v[68:71]
    ds_read_b128 v[216:219], v6 offset:59008
    v_cvt_pk_bf16_f32 v129, v98, v99
    v_mfma_f32_16x16x32_bf16 v[72:75], v[224:227], v[32:35], 0
    v_exp_f32 v106, v106
    v_mfma_f32_16x16x32_bf16 v[76:79], v[224:227], v[48:51], 0
    ds_read_b128 v[220:223], v7 offset:59008
    v_exp_f32 v107, v107
    v_mfma_f32_16x16x32_bf16 v[72:75], v[228:231], v[36:39], v[72:75]
    v_cvt_pk_bf16_f32 v130, v104, v105
    v_cvt_pk_bf16_f32 v131, v106, v107
    v_mfma_f32_16x16x32_bf16 v[76:79], v[228:231], v[52:55], v[76:79]
    ds_read_b128 v[224:227], v4 offset:63168
    s_waitcnt lgkmcnt(6)
    v_mfma_f32_16x16x32_bf16 v[72:75], v[232:235], v[40:43], v[72:75]
    v_exp_f32 v100, v100
    v_mfma_f32_16x16x32_bf16 v[76:79], v[232:235], v[56:59], v[76:79]
    ds_read_b128 v[228:231], v5 offset:63168
    v_exp_f32 v101, v101
    s_waitcnt lgkmcnt(6)
    v_mfma_f32_16x16x32_bf16 v[72:75], v[236:239], v[44:47], v[72:75]
    v_exp_f32 v102, v102
    v_mfma_f32_16x16x32_bf16 v[76:79], v[236:239], v[60:63], v[76:79]
    ds_read_b128 v[232:235], v6 offset:63168
    v_exp_f32 v103, v103
    v_cvt_pk_bf16_f32 v132, v100, v101
    s_waitcnt lgkmcnt(6)
    v_mfma_f32_16x16x32_bf16 v[80:83], v[208:211], v[32:35], 0
    v_exp_f32 v108, v108
    v_mfma_f32_16x16x32_bf16 v[84:87], v[208:211], v[48:51], 0
    ds_read_b128 v[236:239], v7 offset:63168
    s_waitcnt lgkmcnt(6)
    v_mfma_f32_16x16x32_bf16 v[80:83], v[212:215], v[36:39], v[80:83]
    v_exp_f32 v109, v109
    v_cvt_pk_bf16_f32 v133, v102, v103
    v_mfma_f32_16x16x32_bf16 v[84:87], v[212:215], v[52:55], v[84:87]
    v_exp_f32 v110, v110
    s_waitcnt lgkmcnt(5)
    v_mfma_f32_16x16x32_bf16 v[80:83], v[216:219], v[40:43], v[80:83]
    v_exp_f32 v111, v111
    v_mfma_f32_16x16x32_bf16 v[84:87], v[216:219], v[56:59], v[84:87]
    v_cvt_pk_bf16_f32 v134, v108, v109
    v_cvt_pk_bf16_f32 v135, v110, v111
    s_waitcnt lgkmcnt(4)
    v_mfma_f32_16x16x32_bf16 v[80:83], v[220:223], v[44:47], v[80:83]
    v_mfma_f32_16x16x32_bf16 v[84:87], v[220:223], v[60:63], v[84:87]
    s_waitcnt lgkmcnt(0)
    s_barrier
    ds_read_b64_tr_b16 v[208:209], v8 offset:0
    ds_read_b64_tr_b16 v[210:211], v8 offset:4224
    ds_read_b64_tr_b16 v[212:213], v8 offset:32
    ds_read_b64_tr_b16 v[214:215], v8 offset:4256
    v_mfma_f32_16x16x32_bf16 v[88:91], v[224:227], v[32:35], 0
    v_exp_f32 v112, v112
    v_mfma_f32_16x16x32_bf16 v[92:95], v[224:227], v[48:51], 0
    ds_read_b64_tr_b16 v[216:217], v9 offset:0
    ds_read_b64_tr_b16 v[218:219], v9 offset:4224
    ds_read_b64_tr_b16 v[220:221], v9 offset:32
    ds_read_b64_tr_b16 v[222:223], v9 offset:4256
    v_mfma_f32_16x16x32_bf16 v[88:91], v[228:231], v[36:39], v[88:91]
    v_exp_f32 v113, v113
    v_mfma_f32_16x16x32_bf16 v[92:95], v[228:231], v[52:55], v[92:95]
    ds_read_b64_tr_b16 v[224:225], v10 offset:0
    ds_read_b64_tr_b16 v[226:227], v10 offset:4224
    v_exp_f32 v114, v114
    v_mfma_f32_16x16x32_bf16 v[88:91], v[232:235], v[40:43], v[88:91]
    v_exp_f32 v115, v115
    v_cvt_pk_bf16_f32 v136, v112, v113
    v_mfma_f32_16x16x32_bf16 v[92:95], v[232:235], v[56:59], v[92:95]
    ds_read_b64_tr_b16 v[228:229], v10 offset:32
    ds_read_b64_tr_b16 v[230:231], v10 offset:4256
    v_exp_f32 v120, v120
    v_mfma_f32_16x16x32_bf16 v[88:91], v[236:239], v[44:47], v[88:91]
    v_exp_f32 v121, v121
    v_cvt_pk_bf16_f32 v137, v114, v115
    v_mfma_f32_16x16x32_bf16 v[92:95], v[236:239], v[60:63], v[92:95]
    ds_read_b64_tr_b16 v[232:233], v11 offset:0
    ds_read_b64_tr_b16 v[234:235], v11 offset:4224
    s_waitcnt lgkmcnt(12)
    v_mfma_f32_16x16x32_bf16 v[144:147], v[208:211], v[128:131], v[144:147]
    v_exp_f32 v122, v122
    v_exp_f32 v123, v123
    v_mfma_f32_16x16x32_bf16 v[176:179], v[208:211], v[132:135], v[176:179]
    ds_read_b64_tr_b16 v[236:237], v11 offset:32
    ds_read_b64_tr_b16 v[238:239], v11 offset:4256
    v_cvt_pk_bf16_f32 v138, v120, v121
    s_waitcnt lgkmcnt(12)
    v_mfma_f32_16x16x32_bf16 v[148:151], v[212:215], v[128:131], v[148:151]
    v_mfma_f32_16x16x32_bf16 v[180:183], v[212:215], v[132:135], v[180:183]
    v_mfma_f32_16x16x32_bf16 v[24:27], v[0:3], v[128:131], v[24:27]
    v_mfma_f32_16x16x32_bf16 v[28:31], v[0:3], v[132:135], v[28:31]
    ds_read_b64_tr_b16 v[208:209], v8 offset:8448
    ds_read_b64_tr_b16 v[210:211], v8 offset:12672
    s_waitcnt lgkmcnt(12)
    v_mfma_f32_16x16x32_bf16 v[152:155], v[216:219], v[128:131], v[152:155]
    v_cvt_pk_bf16_f32 v139, v122, v123
    v_exp_f32 v116, v116
    v_mfma_f32_16x16x32_bf16 v[184:187], v[216:219], v[132:135], v[184:187]
    ds_read_b64_tr_b16 v[212:213], v8 offset:8480
    ds_read_b64_tr_b16 v[214:215], v8 offset:12704
    s_waitcnt lgkmcnt(12)
    v_mfma_f32_16x16x32_bf16 v[156:159], v[220:223], v[128:131], v[156:159]
    v_exp_f32 v117, v117
    v_mfma_f32_16x16x32_bf16 v[188:191], v[220:223], v[132:135], v[188:191]
    ds_read_b64_tr_b16 v[216:217], v9 offset:8448
    ds_read_b64_tr_b16 v[218:219], v9 offset:12672
    v_exp_f32 v118, v118
    s_waitcnt lgkmcnt(12)
    v_mfma_f32_16x16x32_bf16 v[160:163], v[224:227], v[128:131], v[160:163]
    v_exp_f32 v119, v119
    v_cvt_pk_bf16_f32 v140, v116, v117
    v_mfma_f32_16x16x32_bf16 v[192:195], v[224:227], v[132:135], v[192:195]
    ds_read_b64_tr_b16 v[220:221], v9 offset:8480
    ds_read_b64_tr_b16 v[222:223], v9 offset:12704
    v_exp_f32 v124, v124
    s_waitcnt lgkmcnt(12)
    v_mfma_f32_16x16x32_bf16 v[164:167], v[228:231], v[128:131], v[164:167]
    v_exp_f32 v125, v125
    v_cvt_pk_bf16_f32 v141, v118, v119
    v_mfma_f32_16x16x32_bf16 v[196:199], v[228:231], v[132:135], v[196:199]
    ds_read_b64_tr_b16 v[224:225], v10 offset:8448
    ds_read_b64_tr_b16 v[226:227], v10 offset:12672
    v_exp_f32 v126, v126
    s_waitcnt lgkmcnt(12)
    v_mfma_f32_16x16x32_bf16 v[168:171], v[232:235], v[128:131], v[168:171]
    v_exp_f32 v127, v127
    v_cvt_pk_bf16_f32 v142, v124, v125
    v_mfma_f32_16x16x32_bf16 v[200:203], v[232:235], v[132:135], v[200:203]
    ds_read_b64_tr_b16 v[228:229], v10 offset:8480
    ds_read_b64_tr_b16 v[230:231], v10 offset:12704
    v_cvt_pk_bf16_f32 v143, v126, v127
    s_waitcnt lgkmcnt(12)
    v_mfma_f32_16x16x32_bf16 v[172:175], v[236:239], v[128:131], v[172:175]
    v_max3_f32 v16, v64, v65, v66
    v_max3_f32 v17, v68, v69, v70
    v_mfma_f32_16x16x32_bf16 v[204:207], v[236:239], v[132:135], v[204:207]
    ds_read_b64_tr_b16 v[232:233], v11 offset:8448
    ds_read_b64_tr_b16 v[234:235], v11 offset:12672
    s_waitcnt lgkmcnt(12)
    v_mfma_f32_16x16x32_bf16 v[144:147], v[208:211], v[136:139], v[144:147]
    v_max3_f32 v16, v16, v67, v72
    v_mfma_f32_16x16x32_bf16 v[176:179], v[208:211], v[140:143], v[176:179]
    ds_read_b64_tr_b16 v[236:237], v11 offset:8480
    ds_read_b64_tr_b16 v[238:239], v11 offset:12704
    s_waitcnt lgkmcnt(12)
    v_mfma_f32_16x16x32_bf16 v[148:151], v[212:215], v[136:139], v[148:151]
    v_mfma_f32_16x16x32_bf16 v[180:183], v[212:215], v[140:143], v[180:183]
    v_mfma_f32_16x16x32_bf16 v[24:27], v[0:3], v[136:139], v[24:27]
    v_mfma_f32_16x16x32_bf16 v[28:31], v[0:3], v[140:143], v[28:31]
    s_waitcnt lgkmcnt(10)
    v_mfma_f32_16x16x32_bf16 v[152:155], v[216:219], v[136:139], v[152:155]
    v_max3_f32 v17, v17, v71, v76
    v_max3_f32 v16, v16, v73, v74
    v_mfma_f32_16x16x32_bf16 v[184:187], v[216:219], v[140:143], v[184:187]
    v_max3_f32 v17, v17, v77, v78
    v_max3_f32 v16, v16, v75, v80
    s_waitcnt lgkmcnt(8)
    v_mfma_f32_16x16x32_bf16 v[156:159], v[220:223], v[136:139], v[156:159]
    v_mfma_f32_16x16x32_bf16 v[188:191], v[220:223], v[140:143], v[188:191]
    s_waitcnt lgkmcnt(0)
    s_barrier
    ds_read_b128 v[208:211], v4 offset:16896
    ds_read_b128 v[212:215], v5 offset:16896
    v_mfma_f32_16x16x32_bf16 v[160:163], v[224:227], v[136:139], v[160:163]
    v_max3_f32 v17, v17, v79, v84
    v_mfma_f32_16x16x32_bf16 v[192:195], v[224:227], v[140:143], v[192:195]
    ds_read_b128 v[216:219], v6 offset:16896
    ds_read_b128 v[220:223], v7 offset:16896
    v_mfma_f32_16x16x32_bf16 v[164:167], v[228:231], v[136:139], v[164:167]
    v_max3_f32 v16, v16, v81, v82
    v_max3_f32 v17, v17, v85, v86
    v_mfma_f32_16x16x32_bf16 v[196:199], v[228:231], v[140:143], v[196:199]
    ds_read_b128 v[224:227], v4 offset:21056
    v_max3_f32 v16, v16, v83, v88
    v_mfma_f32_16x16x32_bf16 v[168:171], v[232:235], v[136:139], v[168:171]
    v_max3_f32 v17, v17, v87, v92
    v_max3_f32 v16, v16, v89, v90
    v_mfma_f32_16x16x32_bf16 v[200:203], v[232:235], v[140:143], v[200:203]
    ds_read_b128 v[228:231], v5 offset:21056
    v_mfma_f32_16x16x32_bf16 v[172:175], v[236:239], v[136:139], v[172:175]
    v_max3_f32 v17, v17, v93, v94
    v_max_f32 v16, v16, v91
    v_mfma_f32_16x16x32_bf16 v[204:207], v[236:239], v[140:143], v[204:207]
    ds_read_b128 v[232:235], v6 offset:21056
    v_max_f32 v17, v17, v95
    s_cmp_eq_u32 s50, 3
    s_cbranch_scc1 L_fina
    v_mov_b32 v18, v16
    v_mov_b32 v19, v17
    s_nop 1
    v_permlane16_swap_b32 v16, v18
    v_permlane16_swap_b32 v17, v19
    s_nop 0
    v_max_f32 v16, v16, v18
    v_max_f32 v17, v17, v19
    v_mov_b32 v18, v16
    v_mov_b32 v19, v17
    s_nop 1
    v_permlane32_swap_b32 v16, v18
    v_permlane32_swap_b32 v17, v19
    s_nop 0
    v_max_f32 v16, v16, v18
    v_max_f32 v17, v17, v19
    v_sub_f32 v240, 0, v16
    v_sub_f32 v241, 0, v16
    v_sub_f32 v242, 0, v16
    v_sub_f32 v243, 0, v16
    v_sub_f32 v244, 0, v17
    v_sub_f32 v245, 0, v17
    v_sub_f32 v246, 0, v17
    v_sub_f32 v247, 0, v17
    s_nop 1
    s_add_u32 s50, s50, 1
    s_add_u32 s54, s50, s59
    s_add_u32 s54, s54, 2
    s_and_b32 s54, s54, 3
    s_lshl_b32 s54, s54, 2
    s_add_u32 s54, s54, s58
    s_lshl_b32 s54, s54, 8
    s_add_u32 s54, s54, s56
    s_cmp_ge_u32 s50, 2
    s_cselect_b32 s54, 1073741824, s54
    s_mul_i32 s51, s47, 6144
    s_add_u32 s51, s51, 137984
    s_cmp_eq_u32 s50, 1
    s_cselect_b32 s51, s51, s57
    v_add_u32 v22, s51, v15
    s_branch L_itema
L_fina:
    s_add_u32 s49, s50, s59
    s_and_b32 s49, s49, 3
    s_lshl_b32 s49, s49, 2
    s_add_u32 s49, s49, s58
    s_add_u32 s51, s50, 0
    s_and_b32 s51, s51, 3
    s_add_u32 s51, s51, s45
    s_and_b32 s51, s51, 3
    s_add_u32 s49, s49, s51
    s_lshl_b32 s51, s44, 5
    s_add_u32 s49, s49, s51
    s_mul_i32 s49, s49, 28672
    s_lshl_b32 s51, s47, 11
    s_add_u32 s49, s49, s51
    v_rcp_f32 v20, v24
    v_rcp_f32 v21, v28
    s_nop 0
    v_mul_f32 v144, v144, v20
    v_mul_f32 v145, v145, v20
    v_mul_f32 v146, v146, v20
    v_mul_f32 v147, v147, v20
    v_mul_f32 v148, v148, v20
    v_mul_f32 v149, v149, v20
    v_mul_f32 v150, v150, v20
    v_mul_f32 v151, v151, v20
    v_cvt_pk_bf16_f32 v144, v144, v145
    v_cvt_pk_bf16_f32 v145, v146, v147
    v_cvt_pk_bf16_f32 v146, v148, v149
    v_cvt_pk_bf16_f32 v147, v150, v151
    s_add_u32 s51, s49, 0
    buffer_store_dwordx4 v[144:147], v15, s[40:43], s51 offen offset:0
    v_mul_f32 v176, v176, v21
    v_mul_f32 v177, v177, v21
    v_mul_f32 v178, v178, v21
    v_mul_f32 v179, v179, v21
    v_mul_f32 v180, v180, v21
    v_mul_f32 v181, v181, v21
    v_mul_f32 v182, v182, v21
    v_mul_f32 v183, v183, v21
    v_cvt_pk_bf16_f32 v176, v176, v177
    v_cvt_pk_bf16_f32 v177, v178, v179
    v_cvt_pk_bf16_f32 v178, v180, v181
    v_cvt_pk_bf16_f32 v179, v182, v183
    s_add_u32 s51, s49, 0
    buffer_store_dwordx4 v[176:179], v15, s[40:43], s51 offen offset:1024
    v_mul_f32 v152, v152, v20
    v_mul_f32 v153, v153, v20
    v_mul_f32 v154, v154, v20
    v_mul_f32 v155, v155, v20
    v_mul_f32 v156, v156, v20
    v_mul_f32 v157, v157, v20
    v_mul_f32 v158, v158, v20
    v_mul_f32 v159, v159, v20
    v_cvt_pk_bf16_f32 v152, v152, v153
    v_cvt_pk_bf16_f32 v153, v154, v155
    v_cvt_pk_bf16_f32 v154, v156, v157
    v_cvt_pk_bf16_f32 v155, v158, v159
    s_add_u32 s51, s49, 7168
    buffer_store_dwordx4 v[152:155], v15, s[40:43], s51 offen offset:0
    v_mul_f32 v184, v184, v21
    v_mul_f32 v185, v185, v21
    v_mul_f32 v186, v186, v21
    v_mul_f32 v187, v187, v21
    v_mul_f32 v188, v188, v21
    v_mul_f32 v189, v189, v21
    v_mul_f32 v190, v190, v21
    v_mul_f32 v191, v191, v21
    v_cvt_pk_bf16_f32 v184, v184, v185
    v_cvt_pk_bf16_f32 v185, v186, v187
    v_cvt_pk_bf16_f32 v186, v188, v189
    v_cvt_pk_bf16_f32 v187, v190, v191
    s_add_u32 s51, s49, 7168
    buffer_store_dwordx4 v[184:187], v15, s[40:43], s51 offen offset:1024
    v_mul_f32 v160, v160, v20
    v_mul_f32 v161, v161, v20
    v_mul_f32 v162, v162, v20
    v_mul_f32 v163, v163, v20
    v_mul_f32 v164, v164, v20
    v_mul_f32 v165, v165, v20
    v_mul_f32 v166, v166, v20
    v_mul_f32 v167, v167, v20
    v_cvt_pk_bf16_f32 v160, v160, v161
    v_cvt_pk_bf16_f32 v161, v162, v163
    v_cvt_pk_bf16_f32 v162, v164, v165
    v_cvt_pk_bf16_f32 v163, v166, v167
    s_add_u32 s51, s49, 14336
    buffer_store_dwordx4 v[160:163], v15, s[40:43], s51 offen offset:0
    v_mul_f32 v192, v192, v21
    v_mul_f32 v193, v193, v21
    v_mul_f32 v194, v194, v21
    v_mul_f32 v195, v195, v21
    v_mul_f32 v196, v196, v21
    v_mul_f32 v197, v197, v21
    v_mul_f32 v198, v198, v21
    v_mul_f32 v199, v199, v21
    v_cvt_pk_bf16_f32 v192, v192, v193
    v_cvt_pk_bf16_f32 v193, v194, v195
    v_cvt_pk_bf16_f32 v194, v196, v197
    v_cvt_pk_bf16_f32 v195, v198, v199
    s_add_u32 s51, s49, 14336
    buffer_store_dwordx4 v[192:195], v15, s[40:43], s51 offen offset:1024
    v_mul_f32 v168, v168, v20
    v_mul_f32 v169, v169, v20
    v_mul_f32 v170, v170, v20
    v_mul_f32 v171, v171, v20
    v_mul_f32 v172, v172, v20
    v_mul_f32 v173, v173, v20
    v_mul_f32 v174, v174, v20
    v_mul_f32 v175, v175, v20
    v_cvt_pk_bf16_f32 v168, v168, v169
    v_cvt_pk_bf16_f32 v169, v170, v171
    v_cvt_pk_bf16_f32 v170, v172, v173
    v_cvt_pk_bf16_f32 v171, v174, v175
    s_add_u32 s51, s49, 21504
    buffer_store_dwordx4 v[168:171], v15, s[40:43], s51 offen offset:0
    v_mul_f32 v200, v200, v21
    v_mul_f32 v201, v201, v21
    v_mul_f32 v202, v202, v21
    v_mul_f32 v203, v203, v21
    v_mul_f32 v204, v204, v21
    v_mul_f32 v205, v205, v21
    v_mul_f32 v206, v206, v21
    v_mul_f32 v207, v207, v21
    v_cvt_pk_bf16_f32 v200, v200, v201
    v_cvt_pk_bf16_f32 v201, v202, v203
    v_cvt_pk_bf16_f32 v202, v204, v205
    v_cvt_pk_bf16_f32 v203, v206, v207
    s_add_u32 s51, s49, 21504
    buffer_store_dwordx4 v[200:203], v15, s[40:43], s51 offen offset:1024
    s_add_u32 s49, s50, s59
    s_add_u32 s49, s49, 1
    s_and_b32 s49, s49, 3
    s_lshl_b32 s49, s49, 2
    s_add_u32 s49, s49, s58
    s_add_u32 s51, s50, 1
    s_and_b32 s51, s51, 3
    s_add_u32 s51, s51, s45
    s_and_b32 s51, s51, 3
    s_add_u32 s49, s49, s51
    s_lshl_b32 s51, s44, 5
    s_add_u32 s49, s49, s51
    s_mul_i32 s49, s49, 28672
    s_lshl_b32 s51, s47, 11
    s_add_u32 s49, s49, s51
    s_add_u32 s51, s49, 21504
    buffer_store_dwordx4 v[248:251], v15, s[40:43], s51 offen offset:0
    buffer_store_dwordx4 v[252:255], v15, s[40:43], s51 offen offset:1024
    s_endpgm
L_rescale0a:
    v_mov_b32 v18, v16
    v_mov_b32 v19, v17
    s_nop 1
    v_permlane16_swap_b32 v16, v18
    v_permlane16_swap_b32 v17, v19
    s_nop 0
    v_max_f32 v16, v16, v18
    v_max_f32 v17, v17, v19
    v_mov_b32 v18, v16
    v_mov_b32 v19, v17
    s_nop 1
    v_permlane32_swap_b32 v16, v18
    v_permlane32_swap_b32 v17, v19
    s_nop 0
    v_max_f32 v16, v16, v18
    v_max_f32 v17, v17, v19
    v_max_f32 v16, 0, v16
    v_sub_f32 v18, 0, v16
    v_exp_f32 v18, v18
    v_max_f32 v17, 0, v17
    v_sub_f32 v19, 0, v17
    v_exp_f32 v19, v19
    v_sub_f32 v240, v240, v16
    v_sub_f32 v241, v241, v16
    v_sub_f32 v242, v242, v16
    v_sub_f32 v243, v243, v16
    v_sub_f32 v64, v64, v16
    v_sub_f32 v65, v65, v16
    v_sub_f32 v66, v66, v16
    v_sub_f32 v67, v67, v16
    v_sub_f32 v72, v72, v16
    v_sub_f32 v73, v73, v16
    v_sub_f32 v74, v74, v16
    v_sub_f32 v75, v75, v16
    v_sub_f32 v80, v80, v16
    v_sub_f32 v81, v81, v16
    v_sub_f32 v82, v82, v16
    v_sub_f32 v83, v83, v16
    v_sub_f32 v88, v88, v16
    v_sub_f32 v89, v89, v16
    v_sub_f32 v90, v90, v16
    v_sub_f32 v91, v91, v16
    v_mul_f32 v24, v24, v18
    v_mul_f32 v25, v25, v18
    v_mul_f32 v26, v26, v18
    v_mul_f32 v27, v27, v18
    v_mul_f32 v144, v144, v18
    v_mul_f32 v145, v145, v18
    v_mul_f32 v146, v146, v18
    v_mul_f32 v147, v147, v18
    v_mul_f32 v148, v148, v18
    v_mul_f32 v149, v149, v18
    v_mul_f32 v150, v150, v18
    v_mul_f32 v151, v151, v18
    v_mul_f32 v152, v152, v18
    v_mul_f32 v153, v153, v18
    v_mul_f32 v154, v154, v18
    v_mul_f32 v155, v155, v18
    v_mul_f32 v156, v156, v18
    v_mul_f32 v157, v157, v18
    v_mul_f32 v158, v158, v18
    v_mul_f32 v159, v159, v18
    v_mul_f32 v160, v160, v18
    v_mul_f32 v161, v161, v18
    v_mul_f32 v162, v162, v18
    v_mul_f32 v163, v163, v18
    v_mul_f32 v164, v164, v18
    v_mul_f32 v165, v165, v18
    v_mul_f32 v166, v166, v18
    v_mul_f32 v167, v167, v18
    v_mul_f32 v168, v168, v18
    v_mul_f32 v169, v169, v18
    v_mul_f32 v170, v170, v18
    v_mul_f32 v171, v171, v18
    v_mul_f32 v172, v172, v18
    v_mul_f32 v173, v173, v18
    v_mul_f32 v174, v174, v18
    v_mul_f32 v175, v175, v18
    v_sub_f32 v244, v244, v17
    v_sub_f32 v245, v245, v17
    v_sub_f32 v246, v246, v17
    v_sub_f32 v247, v247, v17
    v_sub_f32 v68, v68, v17
    v_sub_f32 v69, v69, v17
    v_sub_f32 v70, v70, v17
    v_sub_f32 v71, v71, v17
    v_sub_f32 v76, v76, v17
    v_sub_f32 v77, v77, v17
    v_sub_f32 v78, v78, v17
    v_sub_f32 v79, v79, v17
    v_sub_f32 v84, v84, v17
    v_sub_f32 v85, v85, v17
    v_sub_f32 v86, v86, v17
    v_sub_f32 v87, v87, v17
    v_sub_f32 v92, v92, v17
    v_sub_f32 v93, v93, v17
    v_sub_f32 v94, v94, v17
    v_sub_f32 v95, v95, v17
    v_mul_f32 v28, v28, v19
    v_mul_f32 v29, v29, v19
    v_mul_f32 v30, v30, v19
    v_mul_f32 v31, v31, v19
    v_mul_f32 v176, v176, v19
    v_mul_f32 v177, v177, v19
    v_mul_f32 v178, v178, v19
    v_mul_f32 v179, v179, v19
    v_mul_f32 v180, v180, v19
    v_mul_f32 v181, v181, v19
    v_mul_f32 v182, v182, v19
    v_mul_f32 v183, v183, v19
    v_mul_f32 v184, v184, v19
    v_mul_f32 v185, v185, v19
    v_mul_f32 v186, v186, v19
    v_mul_f32 v187, v187, v19
    v_mul_f32 v188, v188, v19
    v_mul_f32 v189, v189, v19
    v_mul_f32 v190, v190, v19
    v_mul_f32 v191, v191, v19
    v_mul_f32 v192, v192, v19
    v_mul_f32 v193, v193, v19
    v_mul_f32 v194, v194, v19
    v_mul_f32 v195, v195, v19
    v_mul_f32 v196, v196, v19
    v_mul_f32 v197, v197, v19
    v_mul_f32 v198, v198, v19
    v_mul_f32 v199, v199, v19
    v_mul_f32 v200, v200, v19
    v_mul_f32 v201, v201, v19
    v_mul_f32 v202, v202, v19
    v_mul_f32 v203, v203, v19
    v_mul_f32 v204, v204, v19
    v_mul_f32 v205, v205, v19
    v_mul_f32 v206, v206, v19
    v_mul_f32 v207, v207, v19
    s_nop 1
    s_setpc_b64 s[60:61]
L_rescale1a:
    v_mov_b32 v18, v16
    v_mov_b32 v19, v17
    s_nop 1
    v_permlane16_swap_b32 v16, v18
    v_permlane16_swap_b32 v17, v19
    s_nop 0
    v_max_f32 v16, v16, v18
    v_max_f32 v17, v17, v19
    v_mov_b32 v18, v16
    v_mov_b32 v19, v17
    s_nop 1
    v_permlane32_swap_b32 v16, v18
    v_permlane32_swap_b32 v17, v19
    s_nop 0
    v_max_f32 v16, v16, v18
    v_max_f32 v17, v17, v19
    v_max_f32 v16, 0, v16
    v_sub_f32 v18, 0, v16
    v_exp_f32 v18, v18
    v_max_f32 v17, 0, v17
    v_sub_f32 v19, 0, v17
    v_exp_f32 v19, v19
    v_sub_f32 v240, v240, v16
    v_sub_f32 v241, v241, v16
    v_sub_f32 v242, v242, v16
    v_sub_f32 v243, v243, v16
    v_sub_f32 v96, v96, v16
    v_sub_f32 v97, v97, v16
    v_sub_f32 v98, v98, v16
    v_sub_f32 v99, v99, v16
    v_sub_f32 v104, v104, v16
    v_sub_f32 v105, v105, v16
    v_sub_f32 v106, v106, v16
    v_sub_f32 v107, v107, v16
    v_sub_f32 v112, v112, v16
    v_sub_f32 v113, v113, v16
    v_sub_f32 v114, v114, v16
    v_sub_f32 v115, v115, v16
    v_sub_f32 v120, v120, v16
    v_sub_f32 v121, v121, v16
    v_sub_f32 v122, v122, v16
    v_sub_f32 v123, v123, v16
    v_mul_f32 v24, v24, v18
    v_mul_f32 v25, v25, v18
    v_mul_f32 v26, v26, v18
    v_mul_f32 v27, v27, v18
    v_mul_f32 v144, v144, v18
    v_mul_f32 v145, v145, v18
    v_mul_f32 v146, v146, v18
    v_mul_f32 v147, v147, v18
    v_mul_f32 v148, v148, v18
    v_mul_f32 v149, v149, v18
    v_mul_f32 v150, v150, v18
    v_mul_f32 v151, v151, v18
    v_mul_f32 v152, v152, v18
    v_mul_f32 v153, v153, v18
    v_mul_f32 v154, v154, v18
    v_mul_f32 v155, v155, v18
    v_mul_f32 v156, v156, v18
    v_mul_f32 v157, v157, v18
    v_mul_f32 v158, v158, v18
    v_mul_f32 v159, v159, v18
    v_mul_f32 v160, v160, v18
    v_mul_f32 v161, v161, v18
    v_mul_f32 v162, v162, v18
    v_mul_f32 v163, v163, v18
    v_mul_f32 v164, v164, v18
    v_mul_f32 v165, v165, v18
    v_mul_f32 v166, v166, v18
    v_mul_f32 v167, v167, v18
    v_mul_f32 v168, v168, v18
    v_mul_f32 v169, v169, v18
    v_mul_f32 v170, v170, v18
    v_mul_f32 v171, v171, v18
    v_mul_f32 v172, v172, v18
    v_mul_f32 v173, v173, v18
    v_mul_f32 v174, v174, v18
    v_mul_f32 v175, v175, v18
    v_sub_f32 v244, v244, v17
    v_sub_f32 v245, v245, v17
    v_sub_f32 v246, v246, v17
    v_sub_f32 v247, v247, v17
    v_sub_f32 v100, v100, v17
    v_sub_f32 v101, v101, v17
    v_sub_f32 v102, v102, v17
    v_sub_f32 v103, v103, v17
    v_sub_f32 v108, v108, v17
    v_sub_f32 v109, v109, v17
    v_sub_f32 v110, v110, v17
    v_sub_f32 v111, v111, v17
    v_sub_f32 v116, v116, v17
    v_sub_f32 v117, v117, v17
    v_sub_f32 v118, v118, v17
    v_sub_f32 v119, v119, v17
    v_sub_f32 v124, v124, v17
    v_sub_f32 v125, v125, v17
    v_sub_f32 v126, v126, v17
    v_sub_f32 v127, v127, v17
    v_mul_f32 v28, v28, v19
    v_mul_f32 v29, v29, v19
    v_mul_f32 v30, v30, v19
    v_mul_f32 v31, v31, v19
    v_mul_f32 v176, v176, v19
    v_mul_f32 v177, v177, v19
    v_mul_f32 v178, v178, v19
    v_mul_f32 v179, v179, v19
    v_mul_f32 v180, v180, v19
    v_mul_f32 v181, v181, v19
    v_mul_f32 v182, v182, v19
    v_mul_f32 v183, v183, v19
    v_mul_f32 v184, v184, v19
    v_mul_f32 v185, v185, v19
    v_mul_f32 v186, v186, v19
    v_mul_f32 v187, v187, v19
    v_mul_f32 v188, v188, v19
    v_mul_f32 v189, v189, v19
    v_mul_f32 v190, v190, v19
    v_mul_f32 v191, v191, v19
    v_mul_f32 v192, v192, v19
    v_mul_f32 v193, v193, v19
    v_mul_f32 v194, v194, v19
    v_mul_f32 v195, v195, v19
    v_mul_f32 v196, v196, v19
    v_mul_f32 v197, v197, v19
    v_mul_f32 v198, v198, v19
    v_mul_f32 v199, v199, v19
    v_mul_f32 v200, v200, v19
    v_mul_f32 v201, v201, v19
    v_mul_f32 v202, v202, v19
    v_mul_f32 v203, v203, v19
    v_mul_f32 v204, v204, v19
    v_mul_f32 v205, v205, v19
    v_mul_f32 v206, v206, v19
    v_mul_f32 v207, v207, v19
    s_nop 1
    s_setpc_b64 s[60:61]
L_att1:
    s_add_u32 s54, s50, s59
    s_add_u32 s54, s54, 1
    s_and_b32 s54, s54, 3
    s_lshl_b32 s54, s54, 2
    s_add_u32 s54, s54, s58
    s_lshl_b32 s54, s54, 8
    s_add_u32 s54, s54, s56
    s_cmp_ge_u32 s50, 3
    s_cselect_b32 s54, 1073741824, s54
    s_mov_b32 s57, s53
    v_mov_b32 v22, v14
    v_lshrrev_b32 v36, 4, v15
    s_lshr_b32 s48, s2, 1
    s_and_b32 s49, s2, 1
    s_lshl_b32 s62, s48, 5
    s_lshl_b32 s63, s47, 3
    s_add_u32 s62, s62, s63
    s_mul_i32 s62, s62, 1280
    s_mul_i32 s52, s49, 640
    s_add_u32 s62, s62, s52
    s_mul_i32 s63, s63, 656
    v_lshrrev_b32 v37, 2, v36
    v_and_b32 v38, 3, v36
    v_mul_u32_u24 v37, 656, v37
    v_lshl_add_u32 v37, v38, 3, v37
    s_mul_i32 s52, s47, 160
    v_add_u32 v37, s52, v37
    s_lshl_b32 s52, s49, 2
    s_add_u32 s52, s52, s47
    s_lshl_b32 s52, s52, 7
    s_add_u32 s52, s52, s48
    s_mul_i32 s52, s52, 5120
    s_add_u32 s52, s52, 33554432
    s_add_u32 s48, s52, 4096
    s_barrier
    s_barrier
    s_barrier
    s_barrier
    s_barrier
    s_barrier
    s_mov_b32 exec_lo, -1
    s_mov_b32 exec_hi, 0xff
    s_add_u32 m0, s63, 0
    s_add_u32 s51, s62, 0
    buffer_load_dwordx4 v15, s[36:39], s51 offen lds
    s_add_u32 m0, s63, 656
    s_add_u32 s51, s62, 1280
    buffer_load_dwordx4 v15, s[36:39], s51 offen lds
    s_add_u32 m0, s63, 1312
    s_add_u32 s51, s62, 2560
    buffer_load_dwordx4 v15, s[36:39], s51 offen lds
    s_add_u32 m0, s63, 1968
    s_add_u32 s51, s62, 3840
    buffer_load_dwordx4 v15, s[36:39], s51 offen lds
    s_add_u32 m0, s63, 2624
    s_add_u32 s51, s62, 5120
    buffer_load_dwordx4 v15, s[36:39], s51 offen lds
    s_add_u32 m0, s63, 3280
    s_add_u32 s51, s62, 6400
    buffer_load_dwordx4 v15, s[36:39], s51 offen lds
    s_add_u32 m0, s63, 3936
    s_add_u32 s51, s62, 7680
    buffer_load_dwordx4 v15, s[36:39], s51 offen lds
    s_add_u32 m0, s63, 4592
    s_add_u32 s51, s62, 8960
    buffer_load_dwordx4 v15, s[36:39], s51 offen lds
    s_mov_b64 exec, -1
    s_barrier
    s_barrier
    s_waitcnt vmcnt(0)
    s_barrier
    ds_read_b64_tr_b16 v[96:97], v37 offset:0
    ds_read_b64_tr_b16 v[98:99], v37 offset:10496
    ds_read_b64_tr_b16 v[100:101], v37 offset:32
    ds_read_b64_tr_b16 v[102:103], v37 offset:10528
    ds_read_b64_tr_b16 v[104:105], v37 offset:64
    ds_read_b64_tr_b16 v[106:107], v37 offset:10560
    ds_read_b64_tr_b16 v[108:109], v37 offset:96
    ds_read_b64_tr_b16 v[110:111], v37 offset:10592
    ds_read_b64_tr_b16 v[112:113], v37 offset:128
    ds_read_b64_tr_b16 v[114:115], v37 offset:10624
    s_waitcnt lgkmcnt(0)
    s_barrier
    s_barrier
    s_add_u32 s54, s50, s59
    s_add_u32 s54, s54, 2
    s_and_b32 s54, s54, 3
    s_lshl_b32 s54, s54, 2
    s_add_u32 s54, s54, s58
    s_lshl_b32 s54, s54, 8
    s_add_u32 s54, s54, s56
    s_cmp_ge_u32 s50, 2
    s_cselect_b32 s54, 1073741824, s54
    ds_read_b128 v[32:35], v14 offset:0
    ds_read_b128 v[36:39], v14 offset:1024
    ds_read_b128 v[40:43], v14 offset:2048
    ds_read_b128 v[44:47], v14 offset:3072
    ds_read_b128 v[208:211], v4 offset:50688
    ds_read_b128 v[212:215], v5 offset:50688
    ds_read_b128 v[216:219], v6 offset:50688
    ds_read_b128 v[220:223], v7 offset:50688
    ds_read_b128 v[224:227], v4 offset:54848
    ds_read_b128 v[228:231], v5 offset:54848
    ds_read_b128 v[232:235], v6 offset:54848
    s_waitcnt lgkmcnt(6)
    v_mfma_f32_16x16x32_bf16 v[64:67], v[208:211], v[32:35], 0
    ds_read_b128 v[236:239], v7 offset:54848
    s_waitcnt lgkmcnt(6)
    v_mfma_f32_16x16x32_bf16 v[64:67], v[212:215], v[36:39], v[64:67]
    ds_read_b128 v[208:211], v4 offset:59008
    s_waitcnt lgkmcnt(6)
    v_mfma_f32_16x16x32_bf16 v[64:67], v[216:219], v[40:43], v[64:67]
    ds_read_b128 v[212:215], v5 offset:59008
    s_waitcnt lgkmcnt(6)
    v_mfma_f32_16x16x32_bf16 v[64:67], v[220:223], v[44:47], v[64:67]
    ds_read_b128 v[216:219], v6 offset:59008
    s_waitcnt lgkmcnt(6)
    v_mfma_f32_16x16x32_bf16 v[72:75], v[224:227], v[32:35], 0
    ds_read_b128 v[220:223], v7 offset:59008
    s_waitcnt lgkmcnt(6)
    v_mfma_f32_16x16x32_bf16 v[72:75], v[228:231], v[36:39], v[72:75]
    ds_read_b128 v[224:227], v4 offset:63168
    s_waitcnt lgkmcnt(6)
    v_mfma_f32_16x16x32_bf16 v[72:75], v[232:235], v[40:43], v[72:75]
    ds_read_b128 v[228:231], v5 offset:63168
    s_waitcnt lgkmcnt(6)
    v_mfma_f32_16x16x32_bf16 v[72:75], v[236:239], v[44:47], v[72:75]
    ds_read_b128 v[232:235], v6 offset:63168
    s_waitcnt lgkmcnt(6)
    v_mfma_f32_16x16x32_bf16 v[80:83], v[208:211], v[32:35], 0
    ds_read_b128 v[236:239], v7 offset:63168
    s_waitcnt lgkmcnt(6)
    v_mfma_f32_16x16x32_bf16 v[80:83], v[212:215], v[36:39], v[80:83]
    s_waitcnt lgkmcnt(5)
    v_mfma_f32_16x16x32_bf16 v[80:83], v[216:219], v[40:43], v[80:83]
    s_waitcnt lgkmcnt(4)
    v_mfma_f32_16x16x32_bf16 v[80:83], v[220:223], v[44:47], v[80:83]
    s_waitcnt lgkmcnt(0)
    s_barrier
    v_mfma_f32_16x16x32_bf16 v[88:91], v[224:227], v[32:35], 0
    v_mfma_f32_16x16x32_bf16 v[88:91], v[228:231], v[36:39], v[88:91]
    v_mfma_f32_16x16x32_bf16 v[88:91], v[232:235], v[40:43], v[88:91]
    v_mfma_f32_16x16x32_bf16 v[88:91], v[236:239], v[44:47], v[88:91]
    s_nop 7
    v_max3_f32 v16, v64, v65, v66
    v_max3_f32 v16, v16, v67, v72
    v_max3_f32 v16, v16, v73, v74
    v_max3_f32 v16, v16, v75, v80
    v_max3_f32 v16, v16, v81, v82
    v_max3_f32 v16, v16, v83, v88
    s_barrier
    ds_read_b128 v[208:211], v4 offset:16896
    ds_read_b128 v[212:215], v5 offset:16896
    ds_read_b128 v[216:219], v6 offset:16896
    ds_read_b128 v[220:223], v7 offset:16896
    ds_read_b128 v[224:227], v4 offset:21056
    ds_read_b128 v[228:231], v5 offset:21056
    v_max3_f32 v16, v16, v89, v90
    ds_read_b128 v[232:235], v6 offset:21056
    v_max_f32 v16, v16, v91
    buffer_store_dwordx4 v[96:99], v15, s[40:43], s52 offen offset:0
    buffer_store_dwordx4 v[100:103], v15, s[40:43], s52 offen offset:1024
    buffer_store_dwordx4 v[104:107], v15, s[40:43], s52 offen offset:2048
    buffer_store_dwordx4 v[108:111], v15, s[40:43], s52 offen offset:3072
    buffer_store_dwordx4 v[112:115], v15, s[40:43], s48 offen offset:0
    v_mov_b32 v18, v16
    s_nop 1
    v_permlane16_swap_b32 v16, v18
    s_nop 0
    v_max_f32 v16, v16, v18
    v_mov_b32 v18, v16
    s_nop 1
    v_permlane32_swap_b32 v16, v18
    s_nop 0
    v_max_f32 v16, v16, v18
    v_sub_f32 v240, 0, v16
    v_sub_f32 v241, 0, v16
    v_sub_f32 v242, 0, v16
    v_sub_f32 v243, 0, v16
    s_nop 1
L_itemb:
    s_waitcnt lgkmcnt(6)
    v_mfma_f32_16x16x32_bf16 v[96:99], v[208:211], v[32:35], v[240:243]
    ds_read_b128 v[236:239], v7 offset:21056
    v_rcp_f32 v20, v24
    s_nop 0
    v_mul_f32 v144, v144, v20
    v_mul_f32 v145, v145, v20
    v_mul_f32 v146, v146, v20
    s_waitcnt lgkmcnt(6)
    v_mfma_f32_16x16x32_bf16 v[96:99], v[212:215], v[36:39], v[96:99]
    ds_read_b128 v[208:211], v4 offset:25216
    v_mul_f32 v147, v147, v20
    v_mul_f32 v148, v148, v20
    v_mul_f32 v149, v149, v20
    v_mul_f32 v150, v150, v20
    v_mul_f32 v151, v151, v20
    v_cvt_pk_bf16_f32 v144, v144, v145
    s_waitcnt lgkmcnt(6)
    v_mfma_f32_16x16x32_bf16 v[96:99], v[216:219], v[40:43], v[96:99]
    ds_read_b128 v[212:215], v5 offset:25216
    v_cvt_pk_bf16_f32 v145, v146, v147
    v_cvt_pk_bf16_f32 v146, v148, v149
    v_cvt_pk_bf16_f32 v147, v150, v151
    v_mul_f32 v152, v152, v20
    s_waitcnt lgkmcnt(6)
    v_mfma_f32_16x16x32_bf16 v[96:99], v[220:223], v[44:47], v[96:99]
    ds_read_b128 v[216:219], v6 offset:25216
    v_mul_f32 v153, v153, v20
    v_mul_f32 v154, v154, v20
    v_mul_f32 v155, v155, v20
    v_mul_f32 v156, v156, v20
    v_mul_f32 v157, v157, v20
    s_waitcnt lgkmcnt(6)
    v_mfma_f32_16x16x32_bf16 v[104:107], v[224:227], v[32:35], v[240:243]
    ds_read_b128 v[220:223], v7 offset:25216
    v_mul_f32 v158, v158, v20
    v_mul_f32 v159, v159, v20
    v_cvt_pk_bf16_f32 v152, v152, v153
    v_cvt_pk_bf16_f32 v153, v154, v155
    v_cvt_pk_bf16_f32 v154, v156, v157
    v_cvt_pk_bf16_f32 v155, v158, v159
    s_waitcnt lgkmcnt(6)
    v_mfma_f32_16x16x32_bf16 v[104:107], v[228:231], v[36:39], v[104:107]
    ds_read_b128 v[224:227], v4 offset:29376
    v_mul_f32 v160, v160, v20
    v_mul_f32 v161, v161, v20
    v_mul_f32 v162, v162, v20
    v_mul_f32 v163, v163, v20
    v_add_f32 v64, v64, v240
    v_add_f32 v65, v65, v240
    s_waitcnt lgkmcnt(6)
    v_mfma_f32_16x16x32_bf16 v[104:107], v[232:235], v[40:43], v[104:107]
    ds_read_b128 v[228:231], v5 offset:29376
    v_mul_f32 v164, v164, v20
    v_mul_f32 v165, v165, v20
    v_mul_f32 v166, v166, v20
    v_mul_f32 v167, v167, v20
    v_cvt_pk_bf16_f32 v160, v160, v161
    v_add_f32 v66, v66, v240
    s_waitcnt lgkmcnt(6)
    v_mfma_f32_16x16x32_bf16 v[104:107], v[236:239], v[44:47], v[104:107]
    ds_read_b128 v[232:235], v6 offset:29376
    v_cvt_pk_bf16_f32 v161, v162, v163
    v_cvt_pk_bf16_f32 v162, v164, v165
    v_cvt_pk_bf16_f32 v163, v166, v167
    v_mul_f32 v168, v168, v20
    v_add_f32 v67, v67, v240
    s_waitcnt lgkmcnt(6)
    v_mfma_f32_16x16x32_bf16 v[112:115], v[208:211], v[32:35], v[240:243]
    ds_read_b128 v[236:239], v7 offset:29376
    v_mul_f32 v169, v169, v20
    v_mul_f32 v170, v170, v20
    v_mul_f32 v171, v171, v20
    v_mul_f32 v172, v172, v20
    v_mul_f32 v173, v173, v20
    v_mul_f32 v174, v174, v20
    s_waitcnt lgkmcnt(6)
    v_mfma_f32_16x16x32_bf16 v[112:115], v[212:215], v[36:39], v[112:115]
    v_mul_f32 v175, v175, v20
    v_cvt_pk_bf16_f32 v168, v168, v169
    v_cvt_pk_bf16_f32 v169, v170, v171
    v_cvt_pk_bf16_f32 v170, v172, v173
    v_cvt_pk_bf16_f32 v171, v174, v175
    v_add_f32 v72, v72, v240
    v_add_f32 v73, v73, v240
    s_waitcnt lgkmcnt(5)
    v_mfma_f32_16x16x32_bf16 v[112:115], v[216:219], v[40:43], v[112:115]
    v_add_f32 v74, v74, v240
    v_add_f32 v75, v75, v240
    v_exp_f32 v64, v64
    v_exp_f32 v65, v65
    s_waitcnt lgkmcnt(4)
    v_mfma_f32_16x16x32_bf16 v[112:115], v[220:223], v[44:47], v[112:115]
    s_waitcnt lgkmcnt(0)
    s_barrier
    ds_read_b64_tr_b16 v[208:209], v8 offset:33792
    ds_read_b64_tr_b16 v[210:211], v8 offset:38016
    ds_read_b64_tr_b16 v[212:213], v8 offset:33824
    ds_read_b64_tr_b16 v[214:215], v8 offset:38048
    v_exp_f32 v66, v66
    v_mfma_f32_16x16x32_bf16 v[120:123], v[224:227], v[32:35], v[240:243]
    s_cmp_lg_u32 s50, 1
    s_cbranch_scc1 L_pk_9
    v_mov_b32 v176, v144
    v_mov_b32 v177, v145
    v_mov_b32 v178, v146
    v_mov_b32 v179, v147
    v_mov_b32 v180, v152
    v_mov_b32 v181, v153
    v_mov_b32 v182, v154
    v_mov_b32 v183, v155
    v_mov_b32 v184, v160
    v_mov_b32 v185, v161
    v_mov_b32 v186, v162
    v_mov_b32 v187, v163
    v_mov_b32 v188, v168
    v_mov_b32 v189, v169
    v_mov_b32 v190, v170
    v_mov_b32 v191, v171
L_pk_9:
    s_cmp_lg_u32 s50, 2
    s_cbranch_scc1 L_pk_10
    v_mov_b32 v192, v144
    v_mov_b32 v193, v145
    v_mov_b32 v194, v146
    v_mov_b32 v195, v147
    v_mov_b32 v196, v152
    v_mov_b32 v197, v153
    v_mov_b32 v198, v154
    v_mov_b32 v199, v155
    v_mov_b32 v200, v160
    v_mov_b32 v201, v161
    v_mov_b32 v202, v162
    v_mov_b32 v203, v163
    v_mov_b32 v204, v168
    v_mov_b32 v205, v169
    v_mov_b32 v206, v170
    v_mov_b32 v207, v171
L_pk_10:
    s_cmp_lg_u32 s50, 3
    s_cbranch_scc1 L_pk_11
    v_mov_b32 v48, v144
    v_mov_b32 v49, v145
    v_mov_b32 v50, v146
    v_mov_b32 v51, v147
    v_mov_b32 v52, v152
    v_mov_b32 v53, v153
    v_mov_b32 v54, v154
    v_mov_b32 v55, v155
    v_mov_b32 v56, v160
    v_mov_b32 v57, v161
    v_mov_b32 v58, v162
    v_mov_b32 v59, v163
    v_mov_b32 v60, v168
    v_mov_b32 v61, v169
    v_mov_b32 v62, v170
    v_mov_b32 v63, v171
L_pk_11:
    ds_read_b64_tr_b16 v[216:217], v9 offset:33792
    ds_read_b64_tr_b16 v[218:219], v9 offset:38016
    ds_read_b64_tr_b16 v[220:221], v9 offset:33824
    ds_read_b64_tr_b16 v[222:223], v9 offset:38048
    v_exp_f32 v67, v67
    v_cvt_pk_bf16_f32 v128, v64, v65
    v_mfma_f32_16x16x32_bf16 v[120:123], v[228:231], v[36:39], v[120:123]
    ds_read_b64_tr_b16 v[224:225], v10 offset:33792
    ds_read_b64_tr_b16 v[226:227], v10 offset:38016
    v_exp_f32 v72, v72
    v_exp_f32 v73, v73
    v_cvt_pk_bf16_f32 v129, v66, v67
    v_mfma_f32_16x16x32_bf16 v[120:123], v[232:235], v[40:43], v[120:123]
    ds_read_b64_tr_b16 v[228:229], v10 offset:33824
    ds_read_b64_tr_b16 v[230:231], v10 offset:38048
    v_exp_f32 v74, v74
    v_exp_f32 v75, v75
    v_cvt_pk_bf16_f32 v130, v72, v73
    v_cvt_pk_bf16_f32 v131, v74, v75
    v_mfma_f32_16x16x32_bf16 v[120:123], v[236:239], v[44:47], v[120:123]
    ds_read_b64_tr_b16 v[232:233], v11 offset:33792
    ds_read_b64_tr_b16 v[234:235], v11 offset:38016
    v_add_f32 v80, v80, v240
    v_add_f32 v81, v81, v240
    v_add_f32 v82, v82, v240
    v_add_f32 v83, v83, v240
    s_waitcnt lgkmcnt(12)
    v_mfma_f32_16x16x32_bf16 v[144:147], v[208:211], v[128:131], 0
    ds_read_b64_tr_b16 v[236:237], v11 offset:33824
    ds_read_b64_tr_b16 v[238:239], v11 offset:38048
    v_add_f32 v88, v88, v240
    v_add_f32 v89, v89, v240
    v_add_f32 v90, v90, v240
    v_add_f32 v91, v91, v240
    s_waitcnt lgkmcnt(12)
    v_mfma_f32_16x16x32_bf16 v[148:151], v[212:215], v[128:131], 0
    v_mfma_f32_16x16x32_bf16 v[24:27], v[0:3], v[128:131], 0
    ds_read_b64_tr_b16 v[208:209], v8 offset:42240
    ds_read_b64_tr_b16 v[210:211], v8 offset:46464
    s_waitcnt lgkmcnt(12)
    v_mfma_f32_16x16x32_bf16 v[152:155], v[216:219], v[128:131], 0
    ds_read_b64_tr_b16 v[212:213], v8 offset:42272
    ds_read_b64_tr_b16 v[214:215], v8 offset:46496
    v_exp_f32 v80, v80
    v_exp_f32 v81, v81
    s_waitcnt lgkmcnt(12)
    v_mfma_f32_16x16x32_bf16 v[156:159], v[220:223], v[128:131], 0
    ds_read_b64_tr_b16 v[216:217], v9 offset:42240
    ds_read_b64_tr_b16 v[218:219], v9 offset:46464
    v_exp_f32 v82, v82
    v_exp_f32 v83, v83
    v_cvt_pk_bf16_f32 v136, v80, v81
    s_waitcnt lgkmcnt(12)
    v_mfma_f32_16x16x32_bf16 v[160:163], v[224:227], v[128:131], 0
    ds_read_b64_tr_b16 v[220:221], v9 offset:42272
    ds_read_b64_tr_b16 v[222:223], v9 offset:46496
    v_exp_f32 v88, v88
    v_exp_f32 v89, v89
    s_waitcnt lgkmcnt(12)
    v_mfma_f32_16x16x32_bf16 v[164:167], v[228:231], v[128:131], 0
    ds_read_b64_tr_b16 v[224:225], v10 offset:42240
    ds_read_b64_tr_b16 v[226:227], v10 offset:46464
    v_cvt_pk_bf16_f32 v137, v82, v83
    v_exp_f32 v90, v90
    s_waitcnt lgkmcnt(12)
    v_mfma_f32_16x16x32_bf16 v[168:171], v[232:235], v[128:131], 0
    ds_read_b64_tr_b16 v[228:229], v10 offset:42272
    ds_read_b64_tr_b16 v[230:231], v10 offset:46496
    v_exp_f32 v91, v91
    v_cvt_pk_bf16_f32 v138, v88, v89
    v_cvt_pk_bf16_f32 v139, v90, v91
    s_waitcnt lgkmcnt(12)
    v_mfma_f32_16x16x32_bf16 v[172:175], v[236:239], v[128:131], 0
    ds_read_b64_tr_b16 v[232:233], v11 offset:42240
    ds_read_b64_tr_b16 v[234:235], v11 offset:46464
    v_max3_f32 v16, v96, v97, v98
    s_waitcnt lgkmcnt(12)
    v_mfma_f32_16x16x32_bf16 v[144:147], v[208:211], v[136:139], v[144:147]
    ds_read_b64_tr_b16 v[236:237], v11 offset:42272
    ds_read_b64_tr_b16 v[238:239], v11 offset:46496
    s_waitcnt lgkmcnt(12)
    v_mfma_f32_16x16x32_bf16 v[148:151], v[212:215], v[136:139], v[148:151]
    v_max3_f32 v16, v16, v99, v104
    v_mfma_f32_16x16x32_bf16 v[24:27], v[0:3], v[136:139], v[24:27]
    s_waitcnt lgkmcnt(10)
    v_mfma_f32_16x16x32_bf16 v[152:155], v[216:219], v[136:139], v[152:155]
    v_max3_f32 v16, v16, v105, v106
    v_max3_f32 v16, v16, v107, v112
    s_waitcnt lgkmcnt(8)
    v_mfma_f32_16x16x32_bf16 v[156:159], v[220:223], v[136:139], v[156:159]
    s_waitcnt lgkmcnt(0)
    s_barrier
    ds_read_b128 v[208:211], v4 offset:50688
    ds_read_b128 v[212:215], v5 offset:50688
    v_mfma_f32_16x16x32_bf16 v[160:163], v[224:227], v[136:139], v[160:163]
    ds_read_b128 v[216:219], v6 offset:50688
    ds_read_b128 v[220:223], v7 offset:50688
    v_mfma_f32_16x16x32_bf16 v[164:167], v[228:231], v[136:139], v[164:167]
    ds_read_b128 v[224:227], v4 offset:54848
    v_max3_f32 v16, v16, v113, v114
    v_mfma_f32_16x16x32_bf16 v[168:171], v[232:235], v[136:139], v[168:171]
    ds_read_b128 v[228:231], v5 offset:54848
    v_max3_f32 v16, v16, v115, v120
    v_mfma_f32_16x16x32_bf16 v[172:175], v[236:239], v[136:139], v[172:175]
    ds_read_b128 v[232:235], v6 offset:54848
    v_max3_f32 v16, v16, v121, v122
    v_max_f32 v16, v16, v123
    v_cmp_lt_f32 vcc, s55, v16
    s_cbranch_vccz L_nors_12
    s_call_b64 s[60:61], L_rescale1b
L_nors_12:
    s_waitcnt lgkmcnt(6)
    v_mfma_f32_16x16x32_bf16 v[64:67], v[208:211], v[32:35], v[240:243]
    ds_read_b128 v[236:239], v7 offset:54848
    v_exp_f32 v96, v96
    s_waitcnt lgkmcnt(6)
    v_mfma_f32_16x16x32_bf16 v[64:67], v[212:215], v[36:39], v[64:67]
    ds_read_b128 v[208:211], v4 offset:59008
    v_exp_f32 v97, v97
    s_waitcnt lgkmcnt(6)
    v_mfma_f32_16x16x32_bf16 v[64:67], v[216:219], v[40:43], v[64:67]
    ds_read_b128 v[212:215], v5 offset:59008
    v_exp_f32 v98, v98
    s_waitcnt lgkmcnt(6)
    v_mfma_f32_16x16x32_bf16 v[64:67], v[220:223], v[44:47], v[64:67]
    ds_read_b128 v[216:219], v6 offset:59008
    v_exp_f32 v99, v99
    s_waitcnt lgkmcnt(6)
    v_mfma_f32_16x16x32_bf16 v[72:75], v[224:227], v[32:35], v[240:243]
    ds_read_b128 v[220:223], v7 offset:59008
    v_cvt_pk_bf16_f32 v128, v96, v97
    s_waitcnt lgkmcnt(6)
    v_mfma_f32_16x16x32_bf16 v[72:75], v[228:231], v[36:39], v[72:75]
    ds_read_b128 v[224:227], v4 offset:63168
    v_exp_f32 v104, v104
    s_waitcnt lgkmcnt(6)
    v_mfma_f32_16x16x32_bf16 v[72:75], v[232:235], v[40:43], v[72:75]
    ds_read_b128 v[228:231], v5 offset:63168
    v_exp_f32 v105, v105
    s_waitcnt lgkmcnt(6)
    v_mfma_f32_16x16x32_bf16 v[72:75], v[236:239], v[44:47], v[72:75]
    ds_read_b128 v[232:235], v6 offset:63168
    v_cvt_pk_bf16_f32 v129, v98, v99
    s_waitcnt lgkmcnt(6)
    v_mfma_f32_16x16x32_bf16 v[80:83], v[208:211], v[32:35], v[240:243]
    ds_read_b128 v[236:239], v7 offset:63168
    v_exp_f32 v106, v106
    s_waitcnt lgkmcnt(6)
    v_mfma_f32_16x16x32_bf16 v[80:83], v[212:215], v[36:39], v[80:83]
    v_exp_f32 v107, v107
    v_cvt_pk_bf16_f32 v130, v104, v105
    v_cvt_pk_bf16_f32 v131, v106, v107
    s_waitcnt lgkmcnt(5)
    v_mfma_f32_16x16x32_bf16 v[80:83], v[216:219], v[40:43], v[80:83]
    s_waitcnt lgkmcnt(4)
    v_mfma_f32_16x16x32_bf16 v[80:83], v[220:223], v[44:47], v[80:83]
    s_waitcnt lgkmcnt(0)
    s_barrier
    ds_read_b64_tr_b16 v[208:209], v8 offset:0
    ds_read_b64_tr_b16 v[210:211], v8 offset:4224
    ds_read_b64_tr_b16 v[212:213], v8 offset:32
    ds_read_b64_tr_b16 v[214:215], v8 offset:4256
    v_mfma_f32_16x16x32_bf16 v[88:91], v[224:227], v[32:35], v[240:243]
    ds_read_b64_tr_b16 v[216:217], v9 offset:0
    ds_read_b64_tr_b16 v[218:219], v9 offset:4224
    ds_read_b64_tr_b16 v[220:221], v9 offset:32
    ds_read_b64_tr_b16 v[222:223], v9 offset:4256
    v_mfma_f32_16x16x32_bf16 v[88:91], v[228:231], v[36:39], v[88:91]
    ds_read_b64_tr_b16 v[224:225], v10 offset:0
    ds_read_b64_tr_b16 v[226:227], v10 offset:4224
    v_exp_f32 v112, v112
    v_mfma_f32_16x16x32_bf16 v[88:91], v[232:235], v[40:43], v[88:91]
    ds_read_b64_tr_b16 v[228:229], v10 offset:32
    ds_read_b64_tr_b16 v[230:231], v10 offset:4256
    v_exp_f32 v113, v113
    v_mfma_f32_16x16x32_bf16 v[88:91], v[236:239], v[44:47], v[88:91]
    ds_read_b64_tr_b16 v[232:233], v11 offset:0
    ds_read_b64_tr_b16 v[234:235], v11 offset:4224
    v_exp_f32 v114, v114
    s_waitcnt lgkmcnt(12)
    v_mfma_f32_16x16x32_bf16 v[144:147], v[208:211], v[128:131], v[144:147]
    ds_read_b64_tr_b16 v[236:237], v11 offset:32
    ds_read_b64_tr_b16 v[238:239], v11 offset:4256
    v_exp_f32 v115, v115
    v_cvt_pk_bf16_f32 v136, v112, v113
    s_waitcnt lgkmcnt(12)
    v_mfma_f32_16x16x32_bf16 v[148:151], v[212:215], v[128:131], v[148:151]
    v_mfma_f32_16x16x32_bf16 v[24:27], v[0:3], v[128:131], v[24:27]
    ds_read_b64_tr_b16 v[208:209], v8 offset:8448
    ds_read_b64_tr_b16 v[210:211], v8 offset:12672
    s_waitcnt lgkmcnt(12)
    v_mfma_f32_16x16x32_bf16 v[152:155], v[216:219], v[128:131], v[152:155]
    ds_read_b64_tr_b16 v[212:213], v8 offset:8480
    ds_read_b64_tr_b16 v[214:215], v8 offset:12704
    v_exp_f32 v120, v120
    s_waitcnt lgkmcnt(12)
    v_mfma_f32_16x16x32_bf16 v[156:159], v[220:223], v[128:131], v[156:159]
    ds_read_b64_tr_b16 v[216:217], v9 offset:8448
    ds_read_b64_tr_b16 v[218:219], v9 offset:12672
    v_exp_f32 v121, v121
    s_waitcnt lgkmcnt(12)
    v_mfma_f32_16x16x32_bf16 v[160:163], v[224:227], v[128:131], v[160:163]
    ds_read_b64_tr_b16 v[220:221], v9 offset:8480
    ds_read_b64_tr_b16 v[222:223], v9 offset:12704
    v_cvt_pk_bf16_f32 v137, v114, v115
    v_exp_f32 v122, v122
    s_waitcnt lgkmcnt(12)
    v_mfma_f32_16x16x32_bf16 v[164:167], v[228:231], v[128:131], v[164:167]
    ds_read_b64_tr_b16 v[224:225], v10 offset:8448
    ds_read_b64_tr_b16 v[226:227], v10 offset:12672
    v_exp_f32 v123, v123
    s_waitcnt lgkmcnt(12)
    v_mfma_f32_16x16x32_bf16 v[168:171], v[232:235], v[128:131], v[168:171]
    ds_read_b64_tr_b16 v[228:229], v10 offset:8480
    ds_read_b64_tr_b16 v[230:231], v10 offset:12704
    v_cvt_pk_bf16_f32 v138, v120, v121
    v_cvt_pk_bf16_f32 v139, v122, v123
    s_waitcnt lgkmcnt(12)
    v_mfma_f32_16x16x32_bf16 v[172:175], v[236:239], v[128:131], v[172:175]
    ds_read_b64_tr_b16 v[232:233], v11 offset:8448
    ds_read_b64_tr_b16 v[234:235], v11 offset:12672
    v_max3_f32 v16, v64, v65, v66
    s_waitcnt lgkmcnt(12)
    v_mfma_f32_16x16x32_bf16 v[144:147], v[208:211], v[136:139], v[144:147]
    ds_read_b64_tr_b16 v[236:237], v11 offset:8480
    ds_read_b64_tr_b16 v[238:239], v11 offset:12704
    s_waitcnt lgkmcnt(12)
    v_mfma_f32_16x16x32_bf16 v[148:151], v[212:215], v[136:139], v[148:151]
    v_max3_f32 v16, v16, v67, v72
    v_mfma_f32_16x16x32_bf16 v[24:27], v[0:3], v[136:139], v[24:27]
    s_waitcnt lgkmcnt(10)
    v_mfma_f32_16x16x32_bf16 v[152:155], v[216:219], v[136:139], v[152:155]
    v_max3_f32 v16, v16, v73, v74
    v_max3_f32 v16, v16, v75, v80
    s_waitcnt lgkmcnt(8)
    v_mfma_f32_16x16x32_bf16 v[156:159], v[220:223], v[136:139], v[156:159]
    s_waitcnt lgkmcnt(0)
    s_barrier
    ds_read_b128 v[208:211], v4 offset:16896
    ds_read_b128 v[212:215], v5 offset:16896
    v_mfma_f32_16x16x32_bf16 v[160:163], v[224:227], v[136:139], v[160:163]
    ds_read_b128 v[216:219], v6 offset:16896
    ds_read_b128 v[220:223], v7 offset:16896
    v_mfma_f32_16x16x32_bf16 v[164:167], v[228:231], v[136:139], v[164:167]
    ds_read_b128 v[224:227], v4 offset:21056
    v_max3_f32 v16, v16, v81, v82
    v_mfma_f32_16x16x32_bf16 v[168:171], v[232:235], v[136:139], v[168:171]
    ds_read_b128 v[228:231], v5 offset:21056
    v_max3_f32 v16, v16, v83, v88
    v_mfma_f32_16x16x32_bf16 v[172:175], v[236:239], v[136:139], v[172:175]
    ds_read_b128 v[232:235], v6 offset:21056
    v_max3_f32 v16, v16, v89, v90
    v_max_f32 v16, v16, v91
    v_cmp_lt_f32 vcc, s55, v16
    s_cbranch_vccz L_nors_13
    s_call_b64 s[60:61], L_rescale0b
L_nors_13:
    s_waitcnt lgkmcnt(6)
    v_mfma_f32_16x16x32_bf16 v[96:99], v[208:211], v[32:35], v[240:243]
    ds_read_b128 v[236:239], v7 offset:21056
    v_exp_f32 v64, v64
    s_waitcnt lgkmcnt(6)
    v_mfma_f32_16x16x32_bf16 v[96:99], v[212:215], v[36:39], v[96:99]
    ds_read_b128 v[208:211], v4 offset:25216
    v_exp_f32 v65, v65
    s_waitcnt lgkmcnt(6)
    v_mfma_f32_16x16x32_bf16 v[96:99], v[216:219], v[40:43], v[96:99]
    ds_read_b128 v[212:215], v5 offset:25216
    v_exp_f32 v66, v66
    s_waitcnt lgkmcnt(6)
    v_mfma_f32_16x16x32_bf16 v[96:99], v[220:223], v[44:47], v[96:99]
    ds_read_b128 v[216:219], v6 offset:25216
    v_exp_f32 v67, v67
    s_waitcnt lgkmcnt(6)
    v_mfma_f32_16x16x32_bf16 v[104:107], v[224:227], v[32:35], v[240:243]
    ds_read_b128 v[220:223], v7 offset:25216
    v_cvt_pk_bf16_f32 v128, v64, v65
    s_waitcnt lgkmcnt(6)
    v_mfma_f32_16x16x32_bf16 v[104:107], v[228:231], v[36:39], v[104:107]
    ds_read_b128 v[224:227], v4 offset:29376
    v_exp_f32 v72, v72
    s_waitcnt lgkmcnt(6)
    v_mfma_f32_16x16x32_bf16 v[104:107], v[232:235], v[40:43], v[104:107]
    ds_read_b128 v[228:231], v5 offset:29376
    v_exp_f32 v73, v73
    s_waitcnt lgkmcnt(6)
    v_mfma_f32_16x16x32_bf16 v[104:107], v[236:239], v[44:47], v[104:107]
    ds_read_b128 v[232:235], v6 offset:29376
    v_cvt_pk_bf16_f32 v129, v66, v67
    s_waitcnt lgkmcnt(6)
    v_mfma_f32_16x16x32_bf16 v[112:115], v[208:211], v[32:35], v[240:243]
    ds_read_b128 v[236:239], v7 offset:29376
    v_exp_f32 v74, v74
    s_waitcnt lgkmcnt(6)
    v_mfma_f32_16x16x32_bf16 v[112:115], v[212:215], v[36:39], v[112:115]
    v_exp_f32 v75, v75
    v_cvt_pk_bf16_f32 v130, v72, v73
    v_cvt_pk_bf16_f32 v131, v74, v75
    s_waitcnt lgkmcnt(5)
    v_mfma_f32_16x16x32_bf16 v[112:115], v[216:219], v[40:43], v[112:115]
    s_waitcnt lgkmcnt(4)
    v_mfma_f32_16x16x32_bf16 v[112:115], v[220:223], v[44:47], v[112:115]
    s_waitcnt lgkmcnt(0)
    s_barrier
    ds_read_b64_tr_b16 v[208:209], v8 offset:33792
    ds_read_b64_tr_b16 v[210:211], v8 offset:38016
    ds_read_b64_tr_b16 v[212:213], v8 offset:33824
    ds_read_b64_tr_b16 v[214:215], v8 offset:38048
    v_mfma_f32_16x16x32_bf16 v[120:123], v[224:227], v[32:35], v[240:243]
    ds_read_b64_tr_b16 v[216:217], v9 offset:33792
    ds_read_b64_tr_b16 v[218:219], v9 offset:38016
    ds_read_b64_tr_b16 v[220:221], v9 offset:33824
    ds_read_b64_tr_b16 v[222:223], v9 offset:38048
    v_mfma_f32_16x16x32_bf16 v[120:123], v[228:231], v[36:39], v[120:123]
    ds_read_b64_tr_b16 v[224:225], v10 offset:33792
    ds_read_b64_tr_b16 v[226:227], v10 offset:38016
    v_exp_f32 v80, v80
    v_mfma_f32_16x16x32_bf16 v[120:123], v[232:235], v[40:43], v[120:123]
    ds_read_b64_tr_b16 v[228:229], v10 offset:33824
    ds_read_b64_tr_b16 v[230:231], v10 offset:38048
    v_exp_f32 v81, v81
    v_mfma_f32_16x16x32_bf16 v[120:123], v[236:239], v[44:47], v[120:123]
    ds_read_b64_tr_b16 v[232:233], v11 offset:33792
    ds_read_b64_tr_b16 v[234:235], v11 offset:38016
    v_exp_f32 v82, v82
    s_waitcnt lgkmcnt(12)
    v_mfma_f32_16x16x32_bf16 v[144:147], v[208:211], v[128:131], v[144:147]
    ds_read_b64_tr_b16 v[236:237], v11 offset:33824
    ds_read_b64_tr_b16 v[238:239], v11 offset:38048
    v_exp_f32 v83, v83
    v_cvt_pk_bf16_f32 v136, v80, v81
    s_waitcnt lgkmcnt(12)
    v_mfma_f32_16x16x32_bf16 v[148:151], v[212:215], v[128:131], v[148:151]
    v_mfma_f32_16x16x32_bf16 v[24:27], v[0:3], v[128:131], v[24:27]
    ds_read_b64_tr_b16 v[208:209], v8 offset:42240
    ds_read_b64_tr_b16 v[210:211], v8 offset:46464
    s_waitcnt lgkmcnt(12)
    v_mfma_f32_16x16x32_bf16 v[152:155], v[216:219], v[128:131], v[152:155]
    ds_read_b64_tr_b16 v[212:213], v8 offset:42272
    ds_read_b64_tr_b16 v[214:215], v8 offset:46496
    v_exp_f32 v88, v88
    s_waitcnt lgkmcnt(12)
    v_mfma_f32_16x16x32_bf16 v[156:159], v[220:223], v[128:131], v[156:159]
    ds_read_b64_tr_b16 v[216:217], v9 offset:42240
    ds_read_b64_tr_b16 v[218:219], v9 offset:46464
    v_exp_f32 v89, v89
    s_waitcnt lgkmcnt(12)
    v_mfma_f32_16x16x32_bf16 v[160:163], v[224:227], v[128:131], v[160:163]
    ds_read_b64_tr_b16 v[220:221], v9 offset:42272
    ds_read_b64_tr_b16 v[222:223], v9 offset:46496
    v_cvt_pk_bf16_f32 v137, v82, v83
    v_exp_f32 v90, v90
    s_waitcnt lgkmcnt(12)
    v_mfma_f32_16x16x32_bf16 v[164:167], v[228:231], v[128:131], v[164:167]
    ds_read_b64_tr_b16 v[224:225], v10 offset:42240
    ds_read_b64_tr_b16 v[226:227], v10 offset:46464
    v_exp_f32 v91, v91
    s_waitcnt lgkmcnt(12)
    v_mfma_f32_16x16x32_bf16 v[168:171], v[232:235], v[128:131], v[168:171]
    ds_read_b64_tr_b16 v[228:229], v10 offset:42272
    ds_read_b64_tr_b16 v[230:231], v10 offset:46496
    v_cvt_pk_bf16_f32 v138, v88, v89
    v_cvt_pk_bf16_f32 v139, v90, v91
    s_waitcnt lgkmcnt(12)
    v_mfma_f32_16x16x32_bf16 v[172:175], v[236:239], v[128:131], v[172:175]
    ds_read_b64_tr_b16 v[232:233], v11 offset:42240
    ds_read_b64_tr_b16 v[234:235], v11 offset:46464
    v_max3_f32 v16, v96, v97, v98
    s_waitcnt lgkmcnt(12)
    v_mfma_f32_16x16x32_bf16 v[144:147], v[208:211], v[136:139], v[144:147]
    ds_read_b64_tr_b16 v[236:237], v11 offset:42272
    ds_read_b64_tr_b16 v[238:239], v11 offset:46496
    s_waitcnt lgkmcnt(12)
    v_mfma_f32_16x16x32_bf16 v[148:151], v[212:215], v[136:139], v[148:151]
    v_max3_f32 v16, v16, v99, v104
    v_mfma_f32_16x16x32_bf16 v[24:27], v[0:3], v[136:139], v[24:27]
    s_waitcnt lgkmcnt(10)
    v_mfma_f32_16x16x32_bf16 v[152:155], v[216:219], v[136:139], v[152:155]
    v_max3_f32 v16, v16, v105, v106
    v_max3_f32 v16, v16, v107, v112
    s_waitcnt lgkmcnt(8)
    v_mfma_f32_16x16x32_bf16 v[156:159], v[220:223], v[136:139], v[156:159]
    s_waitcnt lgkmcnt(0)
    s_barrier
    ds_read_b128 v[208:211], v4 offset:50688
    ds_read_b128 v[212:215], v5 offset:50688
    v_mfma_f32_16x16x32_bf16 v[160:163], v[224:227], v[136:139], v[160:163]
    ds_read_b128 v[216:219], v6 offset:50688
    ds_read_b128 v[220:223], v7 offset:50688
    v_mfma_f32_16x16x32_bf16 v[164:167], v[228:231], v[136:139], v[164:167]
    ds_read_b128 v[224:227], v4 offset:54848
    v_max3_f32 v16, v16, v113, v114
    v_mfma_f32_16x16x32_bf16 v[168:171], v[232:235], v[136:139], v[168:171]
    ds_read_b128 v[228:231], v5 offset:54848
    v_max3_f32 v16, v16, v115, v120
    v_mfma_f32_16x16x32_bf16 v[172:175], v[236:239], v[136:139], v[172:175]
    ds_read_b128 v[232:235], v6 offset:54848
    v_max3_f32 v16, v16, v121, v122
    v_max_f32 v16, v16, v123
    v_cmp_lt_f32 vcc, s55, v16
    s_cbranch_vccz L_nors_14
    s_call_b64 s[60:61], L_rescale1b
L_nors_14:
    s_waitcnt lgkmcnt(6)
    v_mfma_f32_16x16x32_bf16 v[64:67], v[208:211], v[32:35], v[240:243]
    ds_read_b128 v[236:239], v7 offset:54848
    v_exp_f32 v96, v96
    s_waitcnt lgkmcnt(6)
    v_mfma_f32_16x16x32_bf16 v[64:67], v[212:215], v[36:39], v[64:67]
    ds_read_b128 v[208:211], v4 offset:59008
    v_exp_f32 v97, v97
    s_waitcnt lgkmcnt(6)
    v_mfma_f32_16x16x32_bf16 v[64:67], v[216:219], v[40:43], v[64:67]
    ds_read_b128 v[212:215], v5 offset:59008
    v_exp_f32 v98, v98
    s_waitcnt lgkmcnt(6)
    v_mfma_f32_16x16x32_bf16 v[64:67], v[220:223], v[44:47], v[64:67]
    ds_read_b128 v[216:219], v6 offset:59008
    v_exp_f32 v99, v99
    s_waitcnt lgkmcnt(6)
    v_mfma_f32_16x16x32_bf16 v[72:75], v[224:227], v[32:35], v[240:243]
    ds_read_b128 v[220:223], v7 offset:59008
    v_cvt_pk_bf16_f32 v128, v96, v97
    s_waitcnt lgkmcnt(6)
    v_mfma_f32_16x16x32_bf16 v[72:75], v[228:231], v[36:39], v[72:75]
    ds_read_b128 v[224:227], v4 offset:63168
    v_exp_f32 v104, v104
    s_waitcnt lgkmcnt(6)
    v_mfma_f32_16x16x32_bf16 v[72:75], v[232:235], v[40:43], v[72:75]
    ds_read_b128 v[228:231], v5 offset:63168
    v_exp_f32 v105, v105
    s_waitcnt lgkmcnt(6)
    v_mfma_f32_16x16x32_bf16 v[72:75], v[236:239], v[44:47], v[72:75]
    ds_read_b128 v[232:235], v6 offset:63168
    v_cvt_pk_bf16_f32 v129, v98, v99
    s_waitcnt lgkmcnt(6)
    v_mfma_f32_16x16x32_bf16 v[80:83], v[208:211], v[32:35], v[240:243]
    ds_read_b128 v[236:239], v7 offset:63168
    v_exp_f32 v106, v106
    s_waitcnt lgkmcnt(6)
    v_mfma_f32_16x16x32_bf16 v[80:83], v[212:215], v[36:39], v[80:83]
    v_exp_f32 v107, v107
    v_cvt_pk_bf16_f32 v130, v104, v105
    v_cvt_pk_bf16_f32 v131, v106, v107
    s_waitcnt lgkmcnt(5)
    v_mfma_f32_16x16x32_bf16 v[80:83], v[216:219], v[40:43], v[80:83]
    s_waitcnt lgkmcnt(4)
    v_mfma_f32_16x16x32_bf16 v[80:83], v[220:223], v[44:47], v[80:83]
    s_waitcnt lgkmcnt(0)
    s_barrier
    ds_read_b64_tr_b16 v[208:209], v8 offset:0
    ds_read_b64_tr_b16 v[210:211], v8 offset:4224
    ds_read_b64_tr_b16 v[212:213], v8 offset:32
    ds_read_b64_tr_b16 v[214:215], v8 offset:4256
    v_mfma_f32_16x16x32_bf16 v[88:91], v[224:227], v[32:35], v[240:243]
    ds_read_b64_tr_b16 v[216:217], v9 offset:0
    ds_read_b64_tr_b16 v[218:219], v9 offset:4224
    ds_read_b64_tr_b16 v[220:221], v9 offset:32
    ds_read_b64_tr_b16 v[222:223], v9 offset:4256
    v_mfma_f32_16x16x32_bf16 v[88:91], v[228:231], v[36:39], v[88:91]
    ds_read_b64_tr_b16 v[224:225], v10 offset:0
    ds_read_b64_tr_b16 v[226:227], v10 offset:4224
    v_exp_f32 v112, v112
    v_mfma_f32_16x16x32_bf16 v[88:91], v[232:235], v[40:43], v[88:91]
    ds_read_b64_tr_b16 v[228:229], v10 offset:32
    ds_read_b64_tr_b16 v[230:231], v10 offset:4256
    v_exp_f32 v113, v113
    v_mfma_f32_16x16x32_bf16 v[88:91], v[236:239], v[44:47], v[88:91]
    ds_read_b64_tr_b16 v[232:233], v11 offset:0
    ds_read_b64_tr_b16 v[234:235], v11 offset:4224
    v_exp_f32 v114, v114
    s_waitcnt lgkmcnt(12)
    v_mfma_f32_16x16x32_bf16 v[144:147], v[208:211], v[128:131], v[144:147]
    ds_read_b64_tr_b16 v[236:237], v11 offset:32
    ds_read_b64_tr_b16 v[238:239], v11 offset:4256
    v_exp_f32 v115, v115
    v_cvt_pk_bf16_f32 v136, v112, v113
    s_waitcnt lgkmcnt(12)
    v_mfma_f32_16x16x32_bf16 v[148:151], v[212:215], v[128:131], v[148:151]
    v_mfma_f32_16x16x32_bf16 v[24:27], v[0:3], v[128:131], v[24:27]
    ds_read_b64_tr_b16 v[208:209], v8 offset:8448
    ds_read_b64_tr_b16 v[210:211], v8 offset:12672
    s_waitcnt lgkmcnt(12)
    v_mfma_f32_16x16x32_bf16 v[152:155], v[216:219], v[128:131], v[152:155]
    ds_read_b64_tr_b16 v[212:213], v8 offset:8480
    ds_read_b64_tr_b16 v[214:215], v8 offset:12704
    v_exp_f32 v120, v120
    s_waitcnt lgkmcnt(12)
    v_mfma_f32_16x16x32_bf16 v[156:159], v[220:223], v[128:131], v[156:159]
    ds_read_b64_tr_b16 v[216:217], v9 offset:8448
    ds_read_b64_tr_b16 v[218:219], v9 offset:12672
    v_exp_f32 v121, v121
    s_waitcnt lgkmcnt(12)
    v_mfma_f32_16x16x32_bf16 v[160:163], v[224:227], v[128:131], v[160:163]
    ds_read_b64_tr_b16 v[220:221], v9 offset:8480
    ds_read_b64_tr_b16 v[222:223], v9 offset:12704
    v_cvt_pk_bf16_f32 v137, v114, v115
    v_exp_f32 v122, v122
    s_waitcnt lgkmcnt(12)
    v_mfma_f32_16x16x32_bf16 v[164:167], v[228:231], v[128:131], v[164:167]
    ds_read_b64_tr_b16 v[224:225], v10 offset:8448
    ds_read_b64_tr_b16 v[226:227], v10 offset:12672
    v_exp_f32 v123, v123
    s_waitcnt lgkmcnt(12)
    v_mfma_f32_16x16x32_bf16 v[168:171], v[232:235], v[128:131], v[168:171]
    ds_read_b64_tr_b16 v[228:229], v10 offset:8480
    ds_read_b64_tr_b16 v[230:231], v10 offset:12704
    v_cvt_pk_bf16_f32 v138, v120, v121
    v_cvt_pk_bf16_f32 v139, v122, v123
    s_waitcnt lgkmcnt(12)
    v_mfma_f32_16x16x32_bf16 v[172:175], v[236:239], v[128:131], v[172:175]
    ds_read_b64_tr_b16 v[232:233], v11 offset:8448
    ds_read_b64_tr_b16 v[234:235], v11 offset:12672
    v_max3_f32 v16, v64, v65, v66
    s_waitcnt lgkmcnt(12)
    v_mfma_f32_16x16x32_bf16 v[144:147], v[208:211], v[136:139], v[144:147]
    ds_read_b64_tr_b16 v[236:237], v11 offset:8480
    ds_read_b64_tr_b16 v[238:239], v11 offset:12704
    s_waitcnt lgkmcnt(12)
    v_mfma_f32_16x16x32_bf16 v[148:151], v[212:215], v[136:139], v[148:151]
    v_max3_f32 v16, v16, v67, v72
    v_mfma_f32_16x16x32_bf16 v[24:27], v[0:3], v[136:139], v[24:27]
    s_waitcnt lgkmcnt(10)
    v_mfma_f32_16x16x32_bf16 v[152:155], v[216:219], v[136:139], v[152:155]
    v_max3_f32 v16, v16, v73, v74
    v_max3_f32 v16, v16, v75, v80
    s_waitcnt lgkmcnt(8)
    v_mfma_f32_16x16x32_bf16 v[156:159], v[220:223], v[136:139], v[156:159]
    s_waitcnt lgkmcnt(0)
    s_barrier
    ds_read_b128 v[208:211], v4 offset:16896
    ds_read_b128 v[212:215], v5 offset:16896
    v_mfma_f32_16x16x32_bf16 v[160:163], v[224:227], v[136:139], v[160:163]
    ds_read_b128 v[216:219], v6 offset:16896
    ds_read_b128 v[220:223], v7 offset:16896
    v_mfma_f32_16x16x32_bf16 v[164:167], v[228:231], v[136:139], v[164:167]
    ds_read_b128 v[224:227], v4 offset:21056
    v_max3_f32 v16, v16, v81, v82
    v_mfma_f32_16x16x32_bf16 v[168:171], v[232:235], v[136:139], v[168:171]
    ds_read_b128 v[228:231], v5 offset:21056
    v_max3_f32 v16, v16, v83, v88
    v_mfma_f32_16x16x32_bf16 v[172:175], v[236:239], v[136:139], v[172:175]
    ds_read_b128 v[232:235], v6 offset:21056
    v_max3_f32 v16, v16, v89, v90
    v_max_f32 v16, v16, v91
    v_cmp_lt_f32 vcc, s55, v16
    s_cbranch_vccz L_nors_15
    s_call_b64 s[60:61], L_rescale0b
L_nors_15:
    s_waitcnt lgkmcnt(6)
    v_mfma_f32_16x16x32_bf16 v[96:99], v[208:211], v[32:35], v[240:243]
    ds_read_b128 v[236:239], v7 offset:21056
    v_exp_f32 v64, v64
    s_waitcnt lgkmcnt(6)
    v_mfma_f32_16x16x32_bf16 v[96:99], v[212:215], v[36:39], v[96:99]
    ds_read_b128 v[208:211], v4 offset:25216
    v_exp_f32 v65, v65
    s_waitcnt lgkmcnt(6)
    v_mfma_f32_16x16x32_bf16 v[96:99], v[216:219], v[40:43], v[96:99]
    ds_read_b128 v[212:215], v5 offset:25216
    v_exp_f32 v66, v66
    s_waitcnt lgkmcnt(6)
    v_mfma_f32_16x16x32_bf16 v[96:99], v[220:223], v[44:47], v[96:99]
    ds_read_b128 v[216:219], v6 offset:25216
    v_exp_f32 v67, v67
    s_waitcnt lgkmcnt(6)
    v_mfma_f32_16x16x32_bf16 v[104:107], v[224:227], v[32:35], v[240:243]
    ds_read_b128 v[220:223], v7 offset:25216
    v_cvt_pk_bf16_f32 v128, v64, v65
    s_waitcnt lgkmcnt(6)
    v_mfma_f32_16x16x32_bf16 v[104:107], v[228:231], v[36:39], v[104:107]
    ds_read_b128 v[224:227], v4 offset:29376
    v_exp_f32 v72, v72
    s_waitcnt lgkmcnt(6)
    v_mfma_f32_16x16x32_bf16 v[104:107], v[232:235], v[40:43], v[104:107]
    ds_read_b128 v[228:231], v5 offset:29376
    v_exp_f32 v73, v73
    s_waitcnt lgkmcnt(6)
    v_mfma_f32_16x16x32_bf16 v[104:107], v[236:239], v[44:47], v[104:107]
    ds_read_b128 v[232:235], v6 offset:29376
    v_cvt_pk_bf16_f32 v129, v66, v67
    s_waitcnt lgkmcnt(6)
    v_mfma_f32_16x16x32_bf16 v[112:115], v[208:211], v[32:35], v[240:243]
    ds_read_b128 v[236:239], v7 offset:29376
    v_exp_f32 v74, v74
    s_waitcnt lgkmcnt(6)
    v_mfma_f32_16x16x32_bf16 v[112:115], v[212:215], v[36:39], v[112:115]
    v_exp_f32 v75, v75
    v_cvt_pk_bf16_f32 v130, v72, v73
    v_cvt_pk_bf16_f32 v131, v74, v75
    s_waitcnt lgkmcnt(5)
    v_mfma_f32_16x16x32_bf16 v[112:115], v[216:219], v[40:43], v[112:115]
    s_waitcnt lgkmcnt(4)
    v_mfma_f32_16x16x32_bf16 v[112:115], v[220:223], v[44:47], v[112:115]
    s_waitcnt lgkmcnt(0)
    s_barrier
    ds_read_b64_tr_b16 v[208:209], v8 offset:33792
    ds_read_b64_tr_b16 v[210:211], v8 offset:38016
    ds_read_b64_tr_b16 v[212:213], v8 offset:33824
    ds_read_b64_tr_b16 v[214:215], v8 offset:38048
    v_mfma_f32_16x16x32_bf16 v[120:123], v[224:227], v[32:35], v[240:243]
    ds_read_b64_tr_b16 v[216:217], v9 offset:33792
    ds_read_b64_tr_b16 v[218:219], v9 offset:38016
    ds_read_b64_tr_b16 v[220:221], v9 offset:33824
    ds_read_b64_tr_b16 v[222:223], v9 offset:38048
    v_mfma_f32_16x16x32_bf16 v[120:123], v[228:231], v[36:39], v[120:123]
    ds_read_b64_tr_b16 v[224:225], v10 offset:33792
    ds_read_b64_tr_b16 v[226:227], v10 offset:38016
    v_exp_f32 v80, v80
    v_mfma_f32_16x16x32_bf16 v[120:123], v[232:235], v[40:43], v[120:123]
    ds_read_b64_tr_b16 v[228:229], v10 offset:33824
    ds_read_b64_tr_b16 v[230:231], v10 offset:38048
    v_exp_f32 v81, v81
    v_mfma_f32_16x16x32_bf16 v[120:123], v[236:239], v[44:47], v[120:123]
    ds_read_b64_tr_b16 v[232:233], v11 offset:33792
    ds_read_b64_tr_b16 v[234:235], v11 offset:38016
    v_exp_f32 v82, v82
    s_waitcnt lgkmcnt(12)
    v_mfma_f32_16x16x32_bf16 v[144:147], v[208:211], v[128:131], v[144:147]
    ds_read_b64_tr_b16 v[236:237], v11 offset:33824
    ds_read_b64_tr_b16 v[238:239], v11 offset:38048
    v_exp_f32 v83, v83
    v_cvt_pk_bf16_f32 v136, v80, v81
    s_waitcnt lgkmcnt(12)
    v_mfma_f32_16x16x32_bf16 v[148:151], v[212:215], v[128:131], v[148:151]
    v_mfma_f32_16x16x32_bf16 v[24:27], v[0:3], v[128:131], v[24:27]
    ds_read_b64_tr_b16 v[208:209], v8 offset:42240
    ds_read_b64_tr_b16 v[210:211], v8 offset:46464
    s_waitcnt lgkmcnt(12)
    v_mfma_f32_16x16x32_bf16 v[152:155], v[216:219], v[128:131], v[152:155]
    ds_read_b64_tr_b16 v[212:213], v8 offset:42272
    ds_read_b64_tr_b16 v[214:215], v8 offset:46496
    v_exp_f32 v88, v88
    s_waitcnt lgkmcnt(12)
    v_mfma_f32_16x16x32_bf16 v[156:159], v[220:223], v[128:131], v[156:159]
    ds_read_b64_tr_b16 v[216:217], v9 offset:42240
    ds_read_b64_tr_b16 v[218:219], v9 offset:46464
    v_exp_f32 v89, v89
    s_waitcnt lgkmcnt(12)
    v_mfma_f32_16x16x32_bf16 v[160:163], v[224:227], v[128:131], v[160:163]
    ds_read_b64_tr_b16 v[220:221], v9 offset:42272
    ds_read_b64_tr_b16 v[222:223], v9 offset:46496
    v_cvt_pk_bf16_f32 v137, v82, v83
    v_exp_f32 v90, v90
    s_waitcnt lgkmcnt(12)
    v_mfma_f32_16x16x32_bf16 v[164:167], v[228:231], v[128:131], v[164:167]
    ds_read_b64_tr_b16 v[224:225], v10 offset:42240
    ds_read_b64_tr_b16 v[226:227], v10 offset:46464
    v_exp_f32 v91, v91
    s_waitcnt lgkmcnt(12)
    v_mfma_f32_16x16x32_bf16 v[168:171], v[232:235], v[128:131], v[168:171]
    ds_read_b64_tr_b16 v[228:229], v10 offset:42272
    ds_read_b64_tr_b16 v[230:231], v10 offset:46496
    v_cvt_pk_bf16_f32 v138, v88, v89
    v_cvt_pk_bf16_f32 v139, v90, v91
    s_waitcnt lgkmcnt(12)
    v_mfma_f32_16x16x32_bf16 v[172:175], v[236:239], v[128:131], v[172:175]
    ds_read_b64_tr_b16 v[232:233], v11 offset:42240
    ds_read_b64_tr_b16 v[234:235], v11 offset:46464
    v_max3_f32 v16, v96, v97, v98
    s_waitcnt lgkmcnt(12)
    v_mfma_f32_16x16x32_bf16 v[144:147], v[208:211], v[136:139], v[144:147]
    ds_read_b64_tr_b16 v[236:237], v11 offset:42272
    ds_read_b64_tr_b16 v[238:239], v11 offset:46496
    s_waitcnt lgkmcnt(12)
    v_mfma_f32_16x16x32_bf16 v[148:151], v[212:215], v[136:139], v[148:151]
    v_max3_f32 v16, v16, v99, v104
    v_mfma_f32_16x16x32_bf16 v[24:27], v[0:3], v[136:139], v[24:27]
    s_waitcnt lgkmcnt(10)
    v_mfma_f32_16x16x32_bf16 v[152:155], v[216:219], v[136:139], v[152:155]
    v_max3_f32 v16, v16, v105, v106
    v_max3_f32 v16, v16, v107, v112
    s_waitcnt lgkmcnt(8)
    v_mfma_f32_16x16x32_bf16 v[156:159], v[220:223], v[136:139], v[156:159]
    s_waitcnt lgkmcnt(0)
    s_barrier
    ds_read_b128 v[208:211], v4 offset:50688
    ds_read_b128 v[212:215], v5 offset:50688
    v_mfma_f32_16x16x32_bf16 v[160:163], v[224:227], v[136:139], v[160:163]
    ds_read_b128 v[216:219], v6 offset:50688
    ds_read_b128 v[220:223], v7 offset:50688
    v_mfma_f32_16x16x32_bf16 v[164:167], v[228:231], v[136:139], v[164:167]
    ds_read_b128 v[224:227], v4 offset:54848
    v_max3_f32 v16, v16, v113, v114
    v_mfma_f32_16x16x32_bf16 v[168:171], v[232:235], v[136:139], v[168:171]
    ds_read_b128 v[228:231], v5 offset:54848
    v_max3_f32 v16, v16, v115, v120
    v_mfma_f32_16x16x32_bf16 v[172:175], v[236:239], v[136:139], v[172:175]
    ds_read_b128 v[232:235], v6 offset:54848
    v_max3_f32 v16, v16, v121, v122
    v_max_f32 v16, v16, v123
    v_cmp_lt_f32 vcc, s55, v16
    s_cbranch_vccz L_nors_16
    s_call_b64 s[60:61], L_rescale1b
L_nors_16:
    s_waitcnt lgkmcnt(6)
    v_mfma_f32_16x16x32_bf16 v[64:67], v[208:211], v[32:35], v[240:243]
    ds_read_b128 v[236:239], v7 offset:54848
    v_exp_f32 v96, v96
    s_waitcnt lgkmcnt(6)
    v_mfma_f32_16x16x32_bf16 v[64:67], v[212:215], v[36:39], v[64:67]
    ds_read_b128 v[208:211], v4 offset:59008
    v_exp_f32 v97, v97
    s_waitcnt lgkmcnt(6)
    v_mfma_f32_16x16x32_bf16 v[64:67], v[216:219], v[40:43], v[64:67]
    ds_read_b128 v[212:215], v5 offset:59008
    v_exp_f32 v98, v98
    s_waitcnt lgkmcnt(6)
    v_mfma_f32_16x16x32_bf16 v[64:67], v[220:223], v[44:47], v[64:67]
    ds_read_b128 v[216:219], v6 offset:59008
    v_exp_f32 v99, v99
    s_waitcnt lgkmcnt(6)
    v_mfma_f32_16x16x32_bf16 v[72:75], v[224:227], v[32:35], v[240:243]
    ds_read_b128 v[220:223], v7 offset:59008
    v_cvt_pk_bf16_f32 v128, v96, v97
    s_waitcnt lgkmcnt(6)
    v_mfma_f32_16x16x32_bf16 v[72:75], v[228:231], v[36:39], v[72:75]
    ds_read_b128 v[224:227], v4 offset:63168
    v_exp_f32 v104, v104
    s_waitcnt lgkmcnt(6)
    v_mfma_f32_16x16x32_bf16 v[72:75], v[232:235], v[40:43], v[72:75]
    ds_read_b128 v[228:231], v5 offset:63168
    v_exp_f32 v105, v105
    s_waitcnt lgkmcnt(6)
    v_mfma_f32_16x16x32_bf16 v[72:75], v[236:239], v[44:47], v[72:75]
    ds_read_b128 v[232:235], v6 offset:63168
    v_cvt_pk_bf16_f32 v129, v98, v99
    s_waitcnt lgkmcnt(6)
    v_mfma_f32_16x16x32_bf16 v[80:83], v[208:211], v[32:35], v[240:243]
    ds_read_b128 v[236:239], v7 offset:63168
    v_exp_f32 v106, v106
    s_waitcnt lgkmcnt(6)
    v_mfma_f32_16x16x32_bf16 v[80:83], v[212:215], v[36:39], v[80:83]
    v_exp_f32 v107, v107
    v_cvt_pk_bf16_f32 v130, v104, v105
    v_cvt_pk_bf16_f32 v131, v106, v107
    s_waitcnt lgkmcnt(5)
    v_mfma_f32_16x16x32_bf16 v[80:83], v[216:219], v[40:43], v[80:83]
    s_waitcnt lgkmcnt(4)
    v_mfma_f32_16x16x32_bf16 v[80:83], v[220:223], v[44:47], v[80:83]
    s_waitcnt lgkmcnt(0)
    s_barrier
    ds_read_b64_tr_b16 v[208:209], v8 offset:0
    ds_read_b64_tr_b16 v[210:211], v8 offset:4224
    ds_read_b64_tr_b16 v[212:213], v8 offset:32
    ds_read_b64_tr_b16 v[214:215], v8 offset:4256
    v_mfma_f32_16x16x32_bf16 v[88:91], v[224:227], v[32:35], v[240:243]
    ds_read_b64_tr_b16 v[216:217], v9 offset:0
    ds_read_b64_tr_b16 v[218:219], v9 offset:4224
    ds_read_b64_tr_b16 v[220:221], v9 offset:32
    ds_read_b64_tr_b16 v[222:223], v9 offset:4256
    v_mfma_f32_16x16x32_bf16 v[88:91], v[228:231], v[36:39], v[88:91]
    ds_read_b64_tr_b16 v[224:225], v10 offset:0
    ds_read_b64_tr_b16 v[226:227], v10 offset:4224
    v_exp_f32 v112, v112
    v_mfma_f32_16x16x32_bf16 v[88:91], v[232:235], v[40:43], v[88:91]
    ds_read_b64_tr_b16 v[228:229], v10 offset:32
    ds_read_b64_tr_b16 v[230:231], v10 offset:4256
    v_exp_f32 v113, v113
    v_mfma_f32_16x16x32_bf16 v[88:91], v[236:239], v[44:47], v[88:91]
    ds_read_b64_tr_b16 v[232:233], v11 offset:0
    ds_read_b64_tr_b16 v[234:235], v11 offset:4224
    v_exp_f32 v114, v114
    s_waitcnt lgkmcnt(12)
    v_mfma_f32_16x16x32_bf16 v[144:147], v[208:211], v[128:131], v[144:147]
    ds_read_b64_tr_b16 v[236:237], v11 offset:32
    ds_read_b64_tr_b16 v[238:239], v11 offset:4256
    v_exp_f32 v115, v115
    v_cvt_pk_bf16_f32 v136, v112, v113
    s_waitcnt lgkmcnt(12)
    v_mfma_f32_16x16x32_bf16 v[148:151], v[212:215], v[128:131], v[148:151]
    v_mfma_f32_16x16x32_bf16 v[24:27], v[0:3], v[128:131], v[24:27]
    ds_read_b64_tr_b16 v[208:209], v8 offset:8448
    ds_read_b64_tr_b16 v[210:211], v8 offset:12672
    s_waitcnt lgkmcnt(12)
    v_mfma_f32_16x16x32_bf16 v[152:155], v[216:219], v[128:131], v[152:155]
    ds_read_b64_tr_b16 v[212:213], v8 offset:8480
    ds_read_b64_tr_b16 v[214:215], v8 offset:12704
    v_exp_f32 v120, v120
    s_waitcnt lgkmcnt(12)
    v_mfma_f32_16x16x32_bf16 v[156:159], v[220:223], v[128:131], v[156:159]
    ds_read_b64_tr_b16 v[216:217], v9 offset:8448
    ds_read_b64_tr_b16 v[218:219], v9 offset:12672
    v_exp_f32 v121, v121
    s_waitcnt lgkmcnt(12)
    v_mfma_f32_16x16x32_bf16 v[160:163], v[224:227], v[128:131], v[160:163]
    ds_read_b64_tr_b16 v[220:221], v9 offset:8480
    ds_read_b64_tr_b16 v[222:223], v9 offset:12704
    v_cvt_pk_bf16_f32 v137, v114, v115
    v_exp_f32 v122, v122
    s_waitcnt lgkmcnt(12)
    v_mfma_f32_16x16x32_bf16 v[164:167], v[228:231], v[128:131], v[164:167]
    ds_read_b64_tr_b16 v[224:225], v10 offset:8448
    ds_read_b64_tr_b16 v[226:227], v10 offset:12672
    v_exp_f32 v123, v123
    s_waitcnt lgkmcnt(12)
    v_mfma_f32_16x16x32_bf16 v[168:171], v[232:235], v[128:131], v[168:171]
    ds_read_b64_tr_b16 v[228:229], v10 offset:8480
    ds_read_b64_tr_b16 v[230:231], v10 offset:12704
    v_cvt_pk_bf16_f32 v138, v120, v121
    v_cvt_pk_bf16_f32 v139, v122, v123
    s_waitcnt lgkmcnt(12)
    v_mfma_f32_16x16x32_bf16 v[172:175], v[236:239], v[128:131], v[172:175]
    ds_read_b64_tr_b16 v[232:233], v11 offset:8448
    ds_read_b64_tr_b16 v[234:235], v11 offset:12672
    v_max3_f32 v16, v64, v65, v66
    s_waitcnt lgkmcnt(12)
    v_mfma_f32_16x16x32_bf16 v[144:147], v[208:211], v[136:139], v[144:147]
    ds_read_b64_tr_b16 v[236:237], v11 offset:8480
    ds_read_b64_tr_b16 v[238:239], v11 offset:12704
    s_waitcnt lgkmcnt(12)
    v_mfma_f32_16x16x32_bf16 v[148:151], v[212:215], v[136:139], v[148:151]
    v_max3_f32 v16, v16, v67, v72
    v_mfma_f32_16x16x32_bf16 v[24:27], v[0:3], v[136:139], v[24:27]
    s_waitcnt lgkmcnt(10)
    v_mfma_f32_16x16x32_bf16 v[152:155], v[216:219], v[136:139], v[152:155]
    v_max3_f32 v16, v16, v73, v74
    v_max3_f32 v16, v16, v75, v80
    s_waitcnt lgkmcnt(8)
    v_mfma_f32_16x16x32_bf16 v[156:159], v[220:223], v[136:139], v[156:159]
    s_waitcnt lgkmcnt(0)
    s_barrier
    ds_read_b128 v[208:211], v4 offset:16896
    ds_read_b128 v[212:215], v5 offset:16896
    v_mfma_f32_16x16x32_bf16 v[160:163], v[224:227], v[136:139], v[160:163]
    ds_read_b128 v[216:219], v6 offset:16896
    ds_read_b128 v[220:223], v7 offset:16896
    v_mfma_f32_16x16x32_bf16 v[164:167], v[228:231], v[136:139], v[164:167]
    ds_read_b128 v[224:227], v4 offset:21056
    v_max3_f32 v16, v16, v81, v82
    v_mfma_f32_16x16x32_bf16 v[168:171], v[232:235], v[136:139], v[168:171]
    ds_read_b128 v[228:231], v5 offset:21056
    v_max3_f32 v16, v16, v83, v88
    v_mfma_f32_16x16x32_bf16 v[172:175], v[236:239], v[136:139], v[172:175]
    ds_read_b128 v[232:235], v6 offset:21056
    v_max3_f32 v16, v16, v89, v90
    v_max_f32 v16, v16, v91
    v_cmp_lt_f32 vcc, s55, v16
    s_cbranch_vccz L_nors_17
    s_call_b64 s[60:61], L_rescale0b
L_nors_17:
    s_waitcnt lgkmcnt(6)
    v_mfma_f32_16x16x32_bf16 v[96:99], v[208:211], v[32:35], v[240:243]
    ds_read_b128 v[236:239], v7 offset:21056
    v_exp_f32 v64, v64
    s_waitcnt lgkmcnt(6)
    v_mfma_f32_16x16x32_bf16 v[96:99], v[212:215], v[36:39], v[96:99]
    ds_read_b128 v[208:211], v4 offset:25216
    v_exp_f32 v65, v65
    s_waitcnt lgkmcnt(6)
    v_mfma_f32_16x16x32_bf16 v[96:99], v[216:219], v[40:43], v[96:99]
    ds_read_b128 v[212:215], v5 offset:25216
    v_exp_f32 v66, v66
    s_waitcnt lgkmcnt(6)
    v_mfma_f32_16x16x32_bf16 v[96:99], v[220:223], v[44:47], v[96:99]
    ds_read_b128 v[216:219], v6 offset:25216
    v_exp_f32 v67, v67
    s_waitcnt lgkmcnt(6)
    v_mfma_f32_16x16x32_bf16 v[104:107], v[224:227], v[32:35], v[240:243]
    ds_read_b128 v[220:223], v7 offset:25216
    v_cvt_pk_bf16_f32 v128, v64, v65
    s_waitcnt lgkmcnt(6)
    v_mfma_f32_16x16x32_bf16 v[104:107], v[228:231], v[36:39], v[104:107]
    ds_read_b128 v[224:227], v4 offset:29376
    v_exp_f32 v72, v72
    s_waitcnt lgkmcnt(6)
    v_mfma_f32_16x16x32_bf16 v[104:107], v[232:235], v[40:43], v[104:107]
    ds_read_b128 v[228:231], v5 offset:29376
    v_exp_f32 v73, v73
    s_waitcnt lgkmcnt(6)
    v_mfma_f32_16x16x32_bf16 v[104:107], v[236:239], v[44:47], v[104:107]
    ds_read_b128 v[232:235], v6 offset:29376
    v_cvt_pk_bf16_f32 v129, v66, v67
    s_waitcnt lgkmcnt(6)
    v_mfma_f32_16x16x32_bf16 v[112:115], v[208:211], v[32:35], v[240:243]
    ds_read_b128 v[236:239], v7 offset:29376
    v_exp_f32 v74, v74
    s_waitcnt lgkmcnt(6)
    v_mfma_f32_16x16x32_bf16 v[112:115], v[212:215], v[36:39], v[112:115]
    v_exp_f32 v75, v75
    v_cvt_pk_bf16_f32 v130, v72, v73
    v_cvt_pk_bf16_f32 v131, v74, v75
    s_waitcnt lgkmcnt(5)
    v_mfma_f32_16x16x32_bf16 v[112:115], v[216:219], v[40:43], v[112:115]
    s_waitcnt lgkmcnt(4)
    v_mfma_f32_16x16x32_bf16 v[112:115], v[220:223], v[44:47], v[112:115]
    s_waitcnt lgkmcnt(0)
    s_barrier
    ds_read_b64_tr_b16 v[208:209], v8 offset:33792
    ds_read_b64_tr_b16 v[210:211], v8 offset:38016
    ds_read_b64_tr_b16 v[212:213], v8 offset:33824
    ds_read_b64_tr_b16 v[214:215], v8 offset:38048
    v_mfma_f32_16x16x32_bf16 v[120:123], v[224:227], v[32:35], v[240:243]
    ds_read_b64_tr_b16 v[216:217], v9 offset:33792
    ds_read_b64_tr_b16 v[218:219], v9 offset:38016
    ds_read_b64_tr_b16 v[220:221], v9 offset:33824
    ds_read_b64_tr_b16 v[222:223], v9 offset:38048
    v_mfma_f32_16x16x32_bf16 v[120:123], v[228:231], v[36:39], v[120:123]
    ds_read_b64_tr_b16 v[224:225], v10 offset:33792
    ds_read_b64_tr_b16 v[226:227], v10 offset:38016
    v_exp_f32 v80, v80
    v_mfma_f32_16x16x32_bf16 v[120:123], v[232:235], v[40:43], v[120:123]
    ds_read_b64_tr_b16 v[228:229], v10 offset:33824
    ds_read_b64_tr_b16 v[230:231], v10 offset:38048
    v_exp_f32 v81, v81
    v_mfma_f32_16x16x32_bf16 v[120:123], v[236:239], v[44:47], v[120:123]
    ds_read_b64_tr_b16 v[232:233], v11 offset:33792
    ds_read_b64_tr_b16 v[234:235], v11 offset:38016
    v_exp_f32 v82, v82
    s_waitcnt lgkmcnt(12)
    v_mfma_f32_16x16x32_bf16 v[144:147], v[208:211], v[128:131], v[144:147]
    ds_read_b64_tr_b16 v[236:237], v11 offset:33824
    ds_read_b64_tr_b16 v[238:239], v11 offset:38048
    v_exp_f32 v83, v83
    v_cvt_pk_bf16_f32 v136, v80, v81
    s_waitcnt lgkmcnt(12)
    v_mfma_f32_16x16x32_bf16 v[148:151], v[212:215], v[128:131], v[148:151]
    v_mfma_f32_16x16x32_bf16 v[24:27], v[0:3], v[128:131], v[24:27]
    ds_read_b64_tr_b16 v[208:209], v8 offset:42240
    ds_read_b64_tr_b16 v[210:211], v8 offset:46464
    s_waitcnt lgkmcnt(12)
    v_mfma_f32_16x16x32_bf16 v[152:155], v[216:219], v[128:131], v[152:155]
    ds_read_b64_tr_b16 v[212:213], v8 offset:42272
    ds_read_b64_tr_b16 v[214:215], v8 offset:46496
    v_exp_f32 v88, v88
    s_waitcnt lgkmcnt(12)
    v_mfma_f32_16x16x32_bf16 v[156:159], v[220:223], v[128:131], v[156:159]
    ds_read_b64_tr_b16 v[216:217], v9 offset:42240
    ds_read_b64_tr_b16 v[218:219], v9 offset:46464
    v_exp_f32 v89, v89
    s_waitcnt lgkmcnt(12)
    v_mfma_f32_16x16x32_bf16 v[160:163], v[224:227], v[128:131], v[160:163]
    ds_read_b64_tr_b16 v[220:221], v9 offset:42272
    ds_read_b64_tr_b16 v[222:223], v9 offset:46496
    v_cvt_pk_bf16_f32 v137, v82, v83
    v_exp_f32 v90, v90
    s_waitcnt lgkmcnt(12)
    v_mfma_f32_16x16x32_bf16 v[164:167], v[228:231], v[128:131], v[164:167]
    ds_read_b64_tr_b16 v[224:225], v10 offset:42240
    ds_read_b64_tr_b16 v[226:227], v10 offset:46464
    v_exp_f32 v91, v91
    s_waitcnt lgkmcnt(12)
    v_mfma_f32_16x16x32_bf16 v[168:171], v[232:235], v[128:131], v[168:171]
    ds_read_b64_tr_b16 v[228:229], v10 offset:42272
    ds_read_b64_tr_b16 v[230:231], v10 offset:46496
    v_cvt_pk_bf16_f32 v138, v88, v89
    v_cvt_pk_bf16_f32 v139, v90, v91
    s_waitcnt lgkmcnt(12)
    v_mfma_f32_16x16x32_bf16 v[172:175], v[236:239], v[128:131], v[172:175]
    ds_read_b64_tr_b16 v[232:233], v11 offset:42240
    ds_read_b64_tr_b16 v[234:235], v11 offset:46464
    v_max3_f32 v16, v96, v97, v98
    s_waitcnt lgkmcnt(12)
    v_mfma_f32_16x16x32_bf16 v[144:147], v[208:211], v[136:139], v[144:147]
    ds_read_b64_tr_b16 v[236:237], v11 offset:42272
    ds_read_b64_tr_b16 v[238:239], v11 offset:46496
    v_max3_f32 v16, v16, v99, v104
    s_waitcnt lgkmcnt(12)
    v_mfma_f32_16x16x32_bf16 v[148:151], v[212:215], v[136:139], v[148:151]
    v_max3_f32 v16, v16, v105, v106
    v_mfma_f32_16x16x32_bf16 v[24:27], v[0:3], v[136:139], v[24:27]
    s_waitcnt lgkmcnt(10)
    v_mfma_f32_16x16x32_bf16 v[152:155], v[216:219], v[136:139], v[152:155]
    v_max3_f32 v16, v16, v107, v112
    v_max3_f32 v16, v16, v113, v114
    v_max3_f32 v16, v16, v115, v120
    s_waitcnt lgkmcnt(8)
    v_mfma_f32_16x16x32_bf16 v[156:159], v[220:223], v[136:139], v[156:159]
    s_waitcnt lgkmcnt(0)
    s_barrier
    ds_read_b128 v[208:211], v4 offset:50688
    ds_read_b128 v[212:215], v5 offset:50688
    ds_read_b128 v[32:35], v14 offset:0
    v_mfma_f32_16x16x32_bf16 v[160:163], v[224:227], v[136:139], v[160:163]
    ds_read_b128 v[216:219], v6 offset:50688
    ds_read_b128 v[220:223], v7 offset:50688
    ds_read_b128 v[36:39], v14 offset:1024
    v_mfma_f32_16x16x32_bf16 v[164:167], v[228:231], v[136:139], v[164:167]
    ds_read_b128 v[224:227], v4 offset:54848
    ds_read_b128 v[40:43], v14 offset:2048
    v_mfma_f32_16x16x32_bf16 v[168:171], v[232:235], v[136:139], v[168:171]
    ds_read_b128 v[228:231], v5 offset:54848
    ds_read_b128 v[44:47], v14 offset:3072
    v_mfma_f32_16x16x32_bf16 v[172:175], v[236:239], v[136:139], v[172:175]
    ds_read_b128 v[232:235], v6 offset:54848
    v_max3_f32 v16, v16, v121, v122
    v_max_f32 v16, v16, v123
    v_cmp_lt_f32 vcc, s55, v16
    s_cbranch_vccz L_nors_18
    s_call_b64 s[60:61], L_rescale1b
L_nors_18:
    s_waitcnt lgkmcnt(10)
    s_waitcnt lgkmcnt(8)
    v_mfma_f32_16x16x32_bf16 v[64:67], v[208:211], v[32:35], 0
    ds_read_b128 v[236:239], v7 offset:54848
    v_exp_f32 v96, v96
    s_waitcnt lgkmcnt(6)
    v_mfma_f32_16x16x32_bf16 v[64:67], v[212:215], v[36:39], v[64:67]
    ds_read_b128 v[208:211], v4 offset:59008
    v_exp_f32 v97, v97
    s_waitcnt lgkmcnt(5)
    v_mfma_f32_16x16x32_bf16 v[64:67], v[216:219], v[40:43], v[64:67]
    ds_read_b128 v[212:215], v5 offset:59008
    v_exp_f32 v98, v98
    s_waitcnt lgkmcnt(4)
    v_mfma_f32_16x16x32_bf16 v[64:67], v[220:223], v[44:47], v[64:67]
    ds_read_b128 v[216:219], v6 offset:59008
    v_exp_f32 v99, v99
    v_mfma_f32_16x16x32_bf16 v[72:75], v[224:227], v[32:35], 0
    ds_read_b128 v[220:223], v7 offset:59008
    v_cvt_pk_bf16_f32 v128, v96, v97
    v_mfma_f32_16x16x32_bf16 v[72:75], v[228:231], v[36:39], v[72:75]
    ds_read_b128 v[224:227], v4 offset:63168
    v_exp_f32 v104, v104
    s_waitcnt lgkmcnt(6)
    v_mfma_f32_16x16x32_bf16 v[72:75], v[232:235], v[40:43], v[72:75]
    ds_read_b128 v[228:231], v5 offset:63168
    v_exp_f32 v105, v105
    s_waitcnt lgkmcnt(6)
    v_mfma_f32_16x16x32_bf16 v[72:75], v[236:239], v[44:47], v[72:75]
    ds_read_b128 v[232:235], v6 offset:63168
    v_cvt_pk_bf16_f32 v129, v98, v99
    s_waitcnt lgkmcnt(6)
    v_mfma_f32_16x16x32_bf16 v[80:83], v[208:211], v[32:35], 0
    ds_read_b128 v[236:239], v7 offset:63168
    v_exp_f32 v106, v106
    s_waitcnt lgkmcnt(6)
    v_mfma_f32_16x16x32_bf16 v[80:83], v[212:215], v[36:39], v[80:83]
    v_exp_f32 v107, v107
    v_cvt_pk_bf16_f32 v130, v104, v105
    v_cvt_pk_bf16_f32 v131, v106, v107
    s_waitcnt lgkmcnt(5)
    v_mfma_f32_16x16x32_bf16 v[80:83], v[216:219], v[40:43], v[80:83]
    s_waitcnt lgkmcnt(4)
    v_mfma_f32_16x16x32_bf16 v[80:83], v[220:223], v[44:47], v[80:83]
    s_waitcnt lgkmcnt(0)
    s_barrier
    ds_read_b64_tr_b16 v[208:209], v8 offset:0
    ds_read_b64_tr_b16 v[210:211], v8 offset:4224
    ds_read_b64_tr_b16 v[212:213], v8 offset:32
    ds_read_b64_tr_b16 v[214:215], v8 offset:4256
    v_mfma_f32_16x16x32_bf16 v[88:91], v[224:227], v[32:35], 0
    ds_read_b64_tr_b16 v[216:217], v9 offset:0
    ds_read_b64_tr_b16 v[218:219], v9 offset:4224
    ds_read_b64_tr_b16 v[220:221], v9 offset:32
    ds_read_b64_tr_b16 v[222:223], v9 offset:4256
    v_mfma_f32_16x16x32_bf16 v[88:91], v[228:231], v[36:39], v[88:91]
    ds_read_b64_tr_b16 v[224:225], v10 offset:0
    ds_read_b64_tr_b16 v[226:227], v10 offset:4224
    v_exp_f32 v112, v112
    v_mfma_f32_16x16x32_bf16 v[88:91], v[232:235], v[40:43], v[88:91]
    ds_read_b64_tr_b16 v[228:229], v10 offset:32
    ds_read_b64_tr_b16 v[230:231], v10 offset:4256
    v_exp_f32 v113, v113
    v_mfma_f32_16x16x32_bf16 v[88:91], v[236:239], v[44:47], v[88:91]
    ds_read_b64_tr_b16 v[232:233], v11 offset:0
    ds_read_b64_tr_b16 v[234:235], v11 offset:4224
    v_exp_f32 v114, v114
    s_waitcnt lgkmcnt(12)
    v_mfma_f32_16x16x32_bf16 v[144:147], v[208:211], v[128:131], v[144:147]
    ds_read_b64_tr_b16 v[236:237], v11 offset:32
    ds_read_b64_tr_b16 v[238:239], v11 offset:4256
    v_exp_f32 v115, v115
    v_cvt_pk_bf16_f32 v136, v112, v113
    s_waitcnt lgkmcnt(12)
    v_mfma_f32_16x16x32_bf16 v[148:151], v[212:215], v[128:131], v[148:151]
    v_mfma_f32_16x16x32_bf16 v[24:27], v[0:3], v[128:131], v[24:27]
    ds_read_b64_tr_b16 v[208:209], v8 offset:8448
    ds_read_b64_tr_b16 v[210:211], v8 offset:12672
    s_waitcnt lgkmcnt(12)
    v_mfma_f32_16x16x32_bf16 v[152:155], v[216:219], v[128:131], v[152:155]
    ds_read_b64_tr_b16 v[212:213], v8 offset:8480
    ds_read_b64_tr_b16 v[214:215], v8 offset:12704
    v_exp_f32 v120, v120
    s_waitcnt lgkmcnt(12)
    v_mfma_f32_16x16x32_bf16 v[156:159], v[220:223], v[128:131], v[156:159]
    ds_read_b64_tr_b16 v[216:217], v9 offset:8448
    ds_read_b64_tr_b16 v[218:219], v9 offset:12672
    v_exp_f32 v121, v121
    s_waitcnt lgkmcnt(12)
    v_mfma_f32_16x16x32_bf16 v[160:163], v[224:227], v[128:131], v[160:163]
    ds_read_b64_tr_b16 v[220:221], v9 offset:8480
    ds_read_b64_tr_b16 v[222:223], v9 offset:12704
    v_cvt_pk_bf16_f32 v137, v114, v115
    v_exp_f32 v122, v122
    s_waitcnt lgkmcnt(12)
    v_mfma_f32_16x16x32_bf16 v[164:167], v[228:231], v[128:131], v[164:167]
    ds_read_b64_tr_b16 v[224:225], v10 offset:8448
    ds_read_b64_tr_b16 v[226:227], v10 offset:12672
    v_exp_f32 v123, v123
    s_waitcnt lgkmcnt(12)
    v_mfma_f32_16x16x32_bf16 v[168:171], v[232:235], v[128:131], v[168:171]
    ds_read_b64_tr_b16 v[228:229], v10 offset:8480
    ds_read_b64_tr_b16 v[230:231], v10 offset:12704
    v_cvt_pk_bf16_f32 v138, v120, v121
    v_cvt_pk_bf16_f32 v139, v122, v123
    s_waitcnt lgkmcnt(12)
    v_mfma_f32_16x16x32_bf16 v[172:175], v[236:239], v[128:131], v[172:175]
    ds_read_b64_tr_b16 v[232:233], v11 offset:8448
    ds_read_b64_tr_b16 v[234:235], v11 offset:12672
    v_max3_f32 v16, v64, v65, v66
    s_waitcnt lgkmcnt(12)
    v_mfma_f32_16x16x32_bf16 v[144:147], v[208:211], v[136:139], v[144:147]
    ds_read_b64_tr_b16 v[236:237], v11 offset:8480
    ds_read_b64_tr_b16 v[238:239], v11 offset:12704
    s_waitcnt lgkmcnt(12)
    v_mfma_f32_16x16x32_bf16 v[148:151], v[212:215], v[136:139], v[148:151]
    v_max3_f32 v16, v16, v67, v72
    v_mfma_f32_16x16x32_bf16 v[24:27], v[0:3], v[136:139], v[24:27]
    s_waitcnt lgkmcnt(10)
    v_mfma_f32_16x16x32_bf16 v[152:155], v[216:219], v[136:139], v[152:155]
    v_max3_f32 v16, v16, v73, v74
    v_max3_f32 v16, v16, v75, v80
    s_waitcnt lgkmcnt(8)
    v_mfma_f32_16x16x32_bf16 v[156:159], v[220:223], v[136:139], v[156:159]
    s_waitcnt lgkmcnt(0)
    s_barrier
    ds_read_b128 v[208:211], v4 offset:16896
    ds_read_b128 v[212:215], v5 offset:16896
    v_mfma_f32_16x16x32_bf16 v[160:163], v[224:227], v[136:139], v[160:163]
    ds_read_b128 v[216:219], v6 offset:16896
    ds_read_b128 v[220:223], v7 offset:16896
    v_mfma_f32_16x16x32_bf16 v[164:167], v[228:231], v[136:139], v[164:167]
    ds_read_b128 v[224:227], v4 offset:21056
    v_max3_f32 v16, v16, v81, v82
    v_mfma_f32_16x16x32_bf16 v[168:171], v[232:235], v[136:139], v[168:171]
    ds_read_b128 v[228:231], v5 offset:21056
    v_max3_f32 v16, v16, v83, v88
    v_mfma_f32_16x16x32_bf16 v[172:175], v[236:239], v[136:139], v[172:175]
    ds_read_b128 v[232:235], v6 offset:21056
    v_max3_f32 v16, v16, v89, v90
    v_max_f32 v16, v16, v91
    s_cmp_eq_u32 s50, 3
    s_cbranch_scc1 L_finb
    v_mov_b32 v18, v16
    s_nop 1
    v_permlane16_swap_b32 v16, v18
    s_nop 0
    v_max_f32 v16, v16, v18
    v_mov_b32 v18, v16
    s_nop 1
    v_permlane32_swap_b32 v16, v18
    s_nop 0
    v_max_f32 v16, v16, v18
    v_sub_f32 v240, 0, v16
    v_sub_f32 v241, 0, v16
    v_sub_f32 v242, 0, v16
    v_sub_f32 v243, 0, v16
    s_nop 1
    s_add_u32 s50, s50, 1
    s_add_u32 s54, s50, s59
    s_add_u32 s54, s54, 2
    s_and_b32 s54, s54, 3
    s_lshl_b32 s54, s54, 2
    s_add_u32 s54, s54, s58
    s_lshl_b32 s54, s54, 8
    s_add_u32 s54, s54, s56
    s_cmp_ge_u32 s50, 2
    s_cselect_b32 s54, 1073741824, s54
    s_branch L_itemb
L_finb:
    s_add_u32 s49, s50, s59
    s_add_u32 s49, s49, 1
    s_and_b32 s49, s49, 3
    s_lshl_b32 s49, s49, 2
    s_add_u32 s49, s49, s58
    s_add_u32 s51, s50, 1
    s_and_b32 s51, s51, 3
    s_add_u32 s51, s51, s45
    s_and_b32 s51, s51, 3
    s_add_u32 s49, s49, s51
    s_lshl_b32 s51, s44, 5
    s_add_u32 s49, s49, s51
    s_mul_i32 s49, s49, 28672
    s_lshl_b32 s51, s47, 11
    s_add_u32 s49, s49, s51
    s_add_u32 s51, s49, 0
    buffer_store_dwordx4 v[176:179], v15, s[40:43], s51 offen
    s_add_u32 s51, s49, 7168
    buffer_store_dwordx4 v[180:183], v15, s[40:43], s51 offen
    s_add_u32 s51, s49, 14336
    buffer_store_dwordx4 v[184:187], v15, s[40:43], s51 offen
    s_add_u32 s51, s49, 21504
    buffer_store_dwordx4 v[188:191], v15, s[40:43], s51 offen
    s_add_u32 s49, s50, s59
    s_add_u32 s49, s49, 2
    s_and_b32 s49, s49, 3
    s_lshl_b32 s49, s49, 2
    s_add_u32 s49, s49, s58
    s_add_u32 s51, s50, 2
    s_and_b32 s51, s51, 3
    s_add_u32 s51, s51, s45
    s_and_b32 s51, s51, 3
    s_add_u32 s49, s49, s51
    s_lshl_b32 s51, s44, 5
    s_add_u32 s49, s49, s51
    s_mul_i32 s49, s49, 28672
    s_lshl_b32 s51, s47, 11
    s_add_u32 s49, s49, s51
    s_add_u32 s51, s49, 0
    buffer_store_dwordx4 v[192:195], v15, s[40:43], s51 offen
    s_add_u32 s51, s49, 7168
    buffer_store_dwordx4 v[196:199], v15, s[40:43], s51 offen
    s_add_u32 s51, s49, 14336
    buffer_store_dwordx4 v[200:203], v15, s[40:43], s51 offen
    s_add_u32 s51, s49, 21504
    buffer_store_dwordx4 v[204:207], v15, s[40:43], s51 offen
    s_add_u32 s49, s50, s59
    s_add_u32 s49, s49, 3
    s_and_b32 s49, s49, 3
    s_lshl_b32 s49, s49, 2
    s_add_u32 s49, s49, s58
    s_add_u32 s51, s50, 3
    s_and_b32 s51, s51, 3
    s_add_u32 s51, s51, s45
    s_and_b32 s51, s51, 3
    s_add_u32 s49, s49, s51
    s_lshl_b32 s51, s44, 5
    s_add_u32 s49, s49, s51
    s_mul_i32 s49, s49, 28672
    s_lshl_b32 s51, s47, 11
    s_add_u32 s49, s49, s51
    s_add_u32 s51, s49, 0
    buffer_store_dwordx4 v[48:51], v15, s[40:43], s51 offen
    s_add_u32 s51, s49, 7168
    buffer_store_dwordx4 v[52:55], v15, s[40:43], s51 offen
    s_add_u32 s51, s49, 14336
    buffer_store_dwordx4 v[56:59], v15, s[40:43], s51 offen
    s_add_u32 s51, s49, 21504
    buffer_store_dwordx4 v[60:63], v15, s[40:43], s51 offen
    s_add_u32 s49, s50, s59
    s_and_b32 s49, s49, 3
    s_lshl_b32 s49, s49, 2
    s_add_u32 s49, s49, s58
    s_add_u32 s51, s50, 0
    s_and_b32 s51, s51, 3
    s_add_u32 s51, s51, s45
    s_and_b32 s51, s51, 3
    s_add_u32 s49, s49, s51
    s_lshl_b32 s51, s44, 5
    s_add_u32 s49, s49, s51
    s_mul_i32 s49, s49, 28672
    s_lshl_b32 s51, s47, 11
    s_add_u32 s49, s49, s51
    v_rcp_f32 v20, v24
    s_nop 0
    v_mul_f32 v144, v144, v20
    v_mul_f32 v145, v145, v20
    v_mul_f32 v146, v146, v20
    v_mul_f32 v147, v147, v20
    v_mul_f32 v148, v148, v20
    v_mul_f32 v149, v149, v20
    v_mul_f32 v150, v150, v20
    v_mul_f32 v151, v151, v20
    v_cvt_pk_bf16_f32 v144, v144, v145
    v_cvt_pk_bf16_f32 v145, v146, v147
    v_cvt_pk_bf16_f32 v146, v148, v149
    v_cvt_pk_bf16_f32 v147, v150, v151
    s_add_u32 s51, s49, 0
    buffer_store_dwordx4 v[144:147], v15, s[40:43], s51 offen offset:0
    v_mul_f32 v152, v152, v20
    v_mul_f32 v153, v153, v20
    v_mul_f32 v154, v154, v20
    v_mul_f32 v155, v155, v20
    v_mul_f32 v156, v156, v20
    v_mul_f32 v157, v157, v20
    v_mul_f32 v158, v158, v20
    v_mul_f32 v159, v159, v20
    v_cvt_pk_bf16_f32 v152, v152, v153
    v_cvt_pk_bf16_f32 v153, v154, v155
    v_cvt_pk_bf16_f32 v154, v156, v157
    v_cvt_pk_bf16_f32 v155, v158, v159
    s_add_u32 s51, s49, 7168
    buffer_store_dwordx4 v[152:155], v15, s[40:43], s51 offen offset:0
    v_mul_f32 v160, v160, v20
    v_mul_f32 v161, v161, v20
    v_mul_f32 v162, v162, v20
    v_mul_f32 v163, v163, v20
    v_mul_f32 v164, v164, v20
    v_mul_f32 v165, v165, v20
    v_mul_f32 v166, v166, v20
    v_mul_f32 v167, v167, v20
    v_cvt_pk_bf16_f32 v160, v160, v161
    v_cvt_pk_bf16_f32 v161, v162, v163
    v_cvt_pk_bf16_f32 v162, v164, v165
    v_cvt_pk_bf16_f32 v163, v166, v167
    s_add_u32 s51, s49, 14336
    buffer_store_dwordx4 v[160:163], v15, s[40:43], s51 offen offset:0
    v_mul_f32 v168, v168, v20
    v_mul_f32 v169, v169, v20
    v_mul_f32 v170, v170, v20
    v_mul_f32 v171, v171, v20
    v_mul_f32 v172, v172, v20
    v_mul_f32 v173, v173, v20
    v_mul_f32 v174, v174, v20
    v_mul_f32 v175, v175, v20
    v_cvt_pk_bf16_f32 v168, v168, v169
    v_cvt_pk_bf16_f32 v169, v170, v171
    v_cvt_pk_bf16_f32 v170, v172, v173
    v_cvt_pk_bf16_f32 v171, v174, v175
    s_add_u32 s51, s49, 21504
    buffer_store_dwordx4 v[168:171], v15, s[40:43], s51 offen offset:0
    s_endpgm
L_rescale0b:
    v_mov_b32 v18, v16
    s_nop 1
    v_permlane16_swap_b32 v16, v18
    s_nop 0
    v_max_f32 v16, v16, v18
    v_mov_b32 v18, v16
    s_nop 1
    v_permlane32_swap_b32 v16, v18
    s_nop 0
    v_max_f32 v16, v16, v18
    v_max_f32 v16, 0, v16
    v_sub_f32 v18, 0, v16
    v_exp_f32 v18, v18
    v_sub_f32 v240, v240, v16
    v_sub_f32 v241, v241, v16
    v_sub_f32 v242, v242, v16
    v_sub_f32 v243, v243, v16
    v_sub_f32 v64, v64, v16
    v_sub_f32 v65, v65, v16
    v_sub_f32 v66, v66, v16
    v_sub_f32 v67, v67, v16
    v_sub_f32 v72, v72, v16
    v_sub_f32 v73, v73, v16
    v_sub_f32 v74, v74, v16
    v_sub_f32 v75, v75, v16
    v_sub_f32 v80, v80, v16
    v_sub_f32 v81, v81, v16
    v_sub_f32 v82, v82, v16
    v_sub_f32 v83, v83, v16
    v_sub_f32 v88, v88, v16
    v_sub_f32 v89, v89, v16
    v_sub_f32 v90, v90, v16
    v_sub_f32 v91, v91, v16
    v_mul_f32 v24, v24, v18
    v_mul_f32 v25, v25, v18
    v_mul_f32 v26, v26, v18
    v_mul_f32 v27, v27, v18
    v_mul_f32 v144, v144, v18
    v_mul_f32 v145, v145, v18
    v_mul_f32 v146, v146, v18
    v_mul_f32 v147, v147, v18
    v_mul_f32 v148, v148, v18
    v_mul_f32 v149, v149, v18
    v_mul_f32 v150, v150, v18
    v_mul_f32 v151, v151, v18
    v_mul_f32 v152, v152, v18
    v_mul_f32 v153, v153, v18
    v_mul_f32 v154, v154, v18
    v_mul_f32 v155, v155, v18
    v_mul_f32 v156, v156, v18
    v_mul_f32 v157, v157, v18
    v_mul_f32 v158, v158, v18
    v_mul_f32 v159, v159, v18
    v_mul_f32 v160, v160, v18
    v_mul_f32 v161, v161, v18
    v_mul_f32 v162, v162, v18
    v_mul_f32 v163, v163, v18
    v_mul_f32 v164, v164, v18
    v_mul_f32 v165, v165, v18
    v_mul_f32 v166, v166, v18
    v_mul_f32 v167, v167, v18
    v_mul_f32 v168, v168, v18
    v_mul_f32 v169, v169, v18
    v_mul_f32 v170, v170, v18
    v_mul_f32 v171, v171, v18
    v_mul_f32 v172, v172, v18
    v_mul_f32 v173, v173, v18
    v_mul_f32 v174, v174, v18
    v_mul_f32 v175, v175, v18
    s_nop 1
    s_setpc_b64 s[60:61]
L_rescale1b:
    v_mov_b32 v18, v16
    s_nop 1
    v_permlane16_swap_b32 v16, v18
    s_nop 0
    v_max_f32 v16, v16, v18
    v_mov_b32 v18, v16
    s_nop 1
    v_permlane32_swap_b32 v16, v18
    s_nop 0
    v_max_f32 v16, v16, v18
    v_max_f32 v16, 0, v16
    v_sub_f32 v18, 0, v16
    v_exp_f32 v18, v18
    v_sub_f32 v240, v240, v16
    v_sub_f32 v241, v241, v16
    v_sub_f32 v242, v242, v16
    v_sub_f32 v243, v243, v16
    v_sub_f32 v96, v96, v16
    v_sub_f32 v97, v97, v16
    v_sub_f32 v98, v98, v16
    v_sub_f32 v99, v99, v16
    v_sub_f32 v104, v104, v16
    v_sub_f32 v105, v105, v16
    v_sub_f32 v106, v106, v16
    v_sub_f32 v107, v107, v16
    v_sub_f32 v112, v112, v16
    v_sub_f32 v113, v113, v16
    v_sub_f32 v114, v114, v16
    v_sub_f32 v115, v115, v16
    v_sub_f32 v120, v120, v16
    v_sub_f32 v121, v121, v16
    v_sub_f32 v122, v122, v16
    v_sub_f32 v123, v123, v16
    v_mul_f32 v24, v24, v18
    v_mul_f32 v25, v25, v18
    v_mul_f32 v26, v26, v18
    v_mul_f32 v27, v27, v18
    v_mul_f32 v144, v144, v18
    v_mul_f32 v145, v145, v18
    v_mul_f32 v146, v146, v18
    v_mul_f32 v147, v147, v18
    v_mul_f32 v148, v148, v18
    v_mul_f32 v149, v149, v18
    v_mul_f32 v150, v150, v18
    v_mul_f32 v151, v151, v18
    v_mul_f32 v152, v152, v18
    v_mul_f32 v153, v153, v18
    v_mul_f32 v154, v154, v18
    v_mul_f32 v155, v155, v18
    v_mul_f32 v156, v156, v18
    v_mul_f32 v157, v157, v18
    v_mul_f32 v158, v158, v18
    v_mul_f32 v159, v159, v18
    v_mul_f32 v160, v160, v18
    v_mul_f32 v161, v161, v18
    v_mul_f32 v162, v162, v18
    v_mul_f32 v163, v163, v18
    v_mul_f32 v164, v164, v18
    v_mul_f32 v165, v165, v18
    v_mul_f32 v166, v166, v18
    v_mul_f32 v167, v167, v18
    v_mul_f32 v168, v168, v18
    v_mul_f32 v169, v169, v18
    v_mul_f32 v170, v170, v18
    v_mul_f32 v171, v171, v18
    v_mul_f32 v172, v172, v18
    v_mul_f32 v173, v173, v18
    v_mul_f32 v174, v174, v18
    v_mul_f32 v175, v175, v18
    s_nop 1
    s_setpc_b64 s[60:61]
L_proj:
    s_add_u32 s48, s50, s59
    s_and_b32 s48, s48, 3
    s_lshl_b32 s48, s48, 2
    s_add_u32 s48, s48, s58
    s_add_u32 s51, s50, 0
    s_and_b32 s51, s51, 3
    s_add_u32 s51, s51, s45
    s_and_b32 s51, s51, 3
    s_add_u32 s48, s48, s51
    s_add_u32 s54, s50, s59
    s_add_u32 s54, s54, 1
    s_and_b32 s54, s54, 3
    s_lshl_b32 s54, s54, 2
    s_add_u32 s54, s54, s58
    s_add_u32 s51, s50, 1
    s_and_b32 s51, s51, 3
    s_add_u32 s51, s51, s45
    s_and_b32 s51, s51, 3
    s_add_u32 s54, s54, s51
    s_lshl_b32 s48, s48, 8
    s_lshl_b32 s54, s54, 8
    v_lshlrev_b32 v32, 2, v28
    v_xor_b32 v35, v32, v27
    s_lshl_b32 s51, s47, 3
    v_add_u32 v31, s51, v28
    v_lshlrev_b32 v31, 13, v31
    v_lshl_add_u32 v8, v35, 4, v31
    v_lshrrev_b32 v31, 3, v2
    v_mul_u32_u24 v31, 1280, v31
    v_and_b32 v33, 7, v2
    v_xor_b32 v34, v28, v33
    v_lshl_add_u32 v10, v34, 4, v31
    v_xor_b32 v11, 64, v10
    s_mul_i32 s49, s44, 143360
    s_mul_i32 s51, s47, 40960
    s_add_u32 s49, s49, s51
    s_mul_i32 s52, s47, 2080
    s_add_u32 s52, s52, 67584
    s_mov_b32 s56, 0x3e0293ee
    v_mul_u32_u24 v31, 2080, v28
    v_lshl_add_u32 v31, v29, 8, v31
    v_lshl_add_u32 v31, v30, 3, v31
    v_add_u32 v31, 67584, v31
    v_xor_b32 v32, 0, v29
    v_lshl_add_u32 v4, v32, 6, v31
    v_xor_b32 v32, 1, v29
    v_lshl_add_u32 v5, v32, 6, v31
    v_xor_b32 v32, 2, v29
    v_lshl_add_u32 v6, v32, 6, v31
    v_xor_b32 v32, 3, v29
    v_lshl_add_u32 v7, v32, 6, v31
    v_lshrrev_b32 v32, 1, v27
    v_xor_b32 v32, v32, v28
    v_lshlrev_b32 v32, 4, v32
    v_lshl_add_u32 v32, v27, 7, v32
    v_add_u32 v254, s53, v32
    v_xor_b32 v255, 64, v254
    v_lshrrev_b32 v32, 1, v28
    v_lshlrev_b32 v32, 8, v32
    v_lshl_add_u32 v32, v27, 4, v32
    v_and_b32 v33, 1, v28
    v_lshl_add_u32 v32, v33, 3, v32
    v_add_u32 v9, s53, v32
    v_lshlrev_b32 v0, 4, v2
    v_add_u32 v1, s53, v0
    v_lshlrev_b32 v31, 8, v28
    s_lshl_b32 s51, s47, 12
    v_add_u32 v31, s51, v31
    v_lshl_add_u32 v2, v35, 4, v31
    s_cmp_eq_u32 s3, 7
    s_cbranch_scc1 L_proj1
    s_mul_i32 s67, s47, 4160
    s_mul_i32 s68, s47, 4224
    s_mov_b32 s62, -1
    s_add_u32 s60, s62, s59
    s_and_b32 s60, s60, 3
    s_lshl_b32 s60, s60, 2
    s_add_u32 s60, s60, s58
    s_add_u32 s51, s62, 0
    s_and_b32 s51, s51, 3
    s_add_u32 s51, s51, s45
    s_and_b32 s51, s51, 3
    s_add_u32 s60, s60, s51
    s_lshl_b32 s63, s44, 5
    s_add_u32 s60, s60, s63
    s_lshl_b32 s60, s60, 17
    s_add_u32 s61, s62, s59
    s_add_u32 s61, s61, 1
    s_and_b32 s61, s61, 3
    s_lshl_b32 s61, s61, 2
    s_add_u32 s61, s61, s58
    s_add_u32 s51, s62, 1
    s_and_b32 s51, s51, 3
    s_add_u32 s51, s51, s45
    s_and_b32 s51, s51, 3
    s_add_u32 s61, s61, s51
    s_add_u32 s61, s61, s63
    s_lshl_b32 s61, s61, 17
    s_cmp_eq_u32 s62, 3
    s_cselect_b32 s61, 1073741824, s61
    s_waitcnt vmcnt(0)
    s_add_u32 m0, s52, 0
    s_add_u32 s51, s48, 0
    buffer_load_dwordx4 v8, s[32:35], s51 offen lds
    s_add_u32 m0, s52, 1024
    s_add_u32 s51, s48, 32768
    buffer_load_dwordx4 v8, s[32:35], s51 offen lds
    s_add_u32 m0, s52, 8320
    s_add_u32 s51, s48, 262144
    buffer_load_dwordx4 v8, s[32:35], s51 offen lds
    s_add_u32 m0, s52, 9344
    s_add_u32 s51, s48, 294912
    buffer_load_dwordx4 v8, s[32:35], s51 offen lds
    s_add_u32 m0, s53, 0
    s_add_u32 s51, s49, 0
    buffer_load_dwordx4 v10, s[28:31], s51 offen lds
    s_add_u32 m0, s53, 1024
    s_add_u32 s51, s49, 10240
    buffer_load_dwordx4 v11, s[28:31], s51 offen lds
    s_add_u32 m0, s53, 2048
    s_add_u32 s51, s49, 20480
    buffer_load_dwordx4 v10, s[28:31], s51 offen lds
    s_add_u32 m0, s53, 3072
    s_add_u32 s51, s49, 30720
    buffer_load_dwordx4 v11, s[28:31], s51 offen lds
    s_add_u32 m0, s52, 16640
    s_add_u32 s51, s48, 524288
    buffer_load_dwordx4 v8, s[32:35], s51 offen lds
    s_add_u32 m0, s52, 17664
    s_add_u32 s51, s48, 557056
    buffer_load_dwordx4 v8, s[32:35], s51 offen lds
    s_add_u32 m0, s52, 24960
    s_add_u32 s51, s48, 786432
    buffer_load_dwordx4 v8, s[32:35], s51 offen lds
    s_add_u32 m0, s52, 25984
    s_add_u32 s51, s48, 819200
    buffer_load_dwordx4 v8, s[32:35], s51 offen lds
    s_add_u32 m0, s53, 4096
    s_add_u32 s51, s49, 128
    buffer_load_dwordx4 v10, s[28:31], s51 offen lds
    s_add_u32 m0, s53, 5120
    s_add_u32 s51, s49, 10368
    buffer_load_dwordx4 v11, s[28:31], s51 offen lds
    s_add_u32 m0, s53, 6144
    s_add_u32 s51, s49, 20608
    buffer_load_dwordx4 v10, s[28:31], s51 offen lds
    s_add_u32 m0, s53, 7168
    s_add_u32 s51, s49, 30848
    buffer_load_dwordx4 v11, s[28:31], s51 offen lds
    s_waitcnt vmcnt(8)
    s_barrier
    ds_read_b128 v[96:99], v254 offset:0
    ds_read_b128 v[100:103], v254 offset:2048
    ds_read_b128 v[104:107], v255 offset:0
    ds_read_b128 v[108:111], v255 offset:2048
    ds_read_b64_tr_b16 v[12:13], v4 offset:0
    ds_read_b64_tr_b16 v[14:15], v4 offset:1024
    ds_read_b64_tr_b16 v[16:17], v4 offset:32
    ds_read_b64_tr_b16 v[18:19], v4 offset:1056
    ds_read_b64_tr_b16 v[20:21], v5 offset:0
    ds_read_b64_tr_b16 v[22:23], v5 offset:1024
    ds_read_b64_tr_b16 v[24:25], v5 offset:32
    ds_read_b64_tr_b16 v[26:27], v5 offset:1056
    s_waitcnt lgkmcnt(8)
    s_waitcnt lgkmcnt(6)
    v_mfma_f32_16x16x32_bf16 v[32:35], v[12:15], v[96:99], 0
    ds_read_b64_tr_b16 v[28:29], v6 offset:0
    v_mfma_f32_16x16x32_bf16 v[36:39], v[12:15], v[100:103], 0
    ds_read_b64_tr_b16 v[30:31], v6 offset:1024
    s_add_u32 m0, s52, 33280
    s_add_u32 s51, s48, 1048576
    buffer_load_dwordx4 v8, s[32:35], s51 offen lds
    s_waitcnt lgkmcnt(6)
    v_mfma_f32_16x16x32_bf16 v[40:43], v[16:19], v[96:99], 0
    ds_read_b64_tr_b16 v[12:13], v6 offset:32
    v_mfma_f32_16x16x32_bf16 v[44:47], v[16:19], v[100:103], 0
    ds_read_b64_tr_b16 v[14:15], v6 offset:1056
    s_waitcnt lgkmcnt(6)
    v_mfma_f32_16x16x32_bf16 v[48:51], v[20:23], v[96:99], 0
    ds_read_b64_tr_b16 v[16:17], v7 offset:0
    v_mfma_f32_16x16x32_bf16 v[52:55], v[20:23], v[100:103], 0
    ds_read_b64_tr_b16 v[18:19], v7 offset:1024
    s_waitcnt lgkmcnt(6)
    v_mfma_f32_16x16x32_bf16 v[56:59], v[24:27], v[96:99], 0
    ds_read_b64_tr_b16 v[20:21], v7 offset:32
    v_mfma_f32_16x16x32_bf16 v[60:63], v[24:27], v[100:103], 0
    ds_read_b64_tr_b16 v[22:23], v7 offset:1056
    s_add_u32 m0, s52, 34304
    s_add_u32 s51, s48, 1081344
    buffer_load_dwordx4 v8, s[32:35], s51 offen lds
    s_waitcnt lgkmcnt(6)
    v_mfma_f32_16x16x32_bf16 v[64:67], v[28:31], v[96:99], 0
    ds_read_b64_tr_b16 v[24:25], v4 offset:8320
    v_mfma_f32_16x16x32_bf16 v[68:71], v[28:31], v[100:103], 0
    ds_read_b64_tr_b16 v[26:27], v4 offset:9344
    s_waitcnt lgkmcnt(6)
    v_mfma_f32_16x16x32_bf16 v[72:75], v[12:15], v[96:99], 0
    ds_read_b64_tr_b16 v[28:29], v4 offset:8352
    v_mfma_f32_16x16x32_bf16 v[76:79], v[12:15], v[100:103], 0
    ds_read_b64_tr_b16 v[30:31], v4 offset:9376
    s_add_u32 m0, s53, 0
    s_add_u32 s51, s49, 256
    buffer_load_dwordx4 v10, s[28:31], s51 offen lds
    s_waitcnt lgkmcnt(6)
    v_mfma_f32_16x16x32_bf16 v[80:83], v[16:19], v[96:99], 0
    ds_read_b64_tr_b16 v[12:13], v5 offset:8320
    v_mfma_f32_16x16x32_bf16 v[84:87], v[16:19], v[100:103], 0
    ds_read_b64_tr_b16 v[14:15], v5 offset:9344
    s_waitcnt lgkmcnt(6)
    v_mfma_f32_16x16x32_bf16 v[88:91], v[20:23], v[96:99], 0
    ds_read_b64_tr_b16 v[16:17], v5 offset:8352
    v_mfma_f32_16x16x32_bf16 v[92:95], v[20:23], v[100:103], 0
    ds_read_b64_tr_b16 v[18:19], v5 offset:9376
    s_add_u32 m0, s53, 1024
    s_add_u32 s51, s49, 10496
    buffer_load_dwordx4 v11, s[28:31], s51 offen lds
    s_waitcnt lgkmcnt(6)
    v_mfma_f32_16x16x32_bf16 v[32:35], v[24:27], v[104:107], v[32:35]
    ds_read_b64_tr_b16 v[20:21], v6 offset:8320
    v_mfma_f32_16x16x32_bf16 v[36:39], v[24:27], v[108:111], v[36:39]
    ds_read_b64_tr_b16 v[22:23], v6 offset:9344
    s_waitcnt lgkmcnt(6)
    v_mfma_f32_16x16x32_bf16 v[40:43], v[28:31], v[104:107], v[40:43]
    ds_read_b64_tr_b16 v[24:25], v6 offset:8352
    v_mfma_f32_16x16x32_bf16 v[44:47], v[28:31], v[108:111], v[44:47]
    ds_read_b64_tr_b16 v[26:27], v6 offset:9376
    s_add_u32 m0, s53, 2048
    s_add_u32 s51, s49, 20736
    buffer_load_dwordx4 v10, s[28:31], s51 offen lds
    s_waitcnt lgkmcnt(6)
    v_mfma_f32_16x16x32_bf16 v[48:51], v[12:15], v[104:107], v[48:51]
    ds_read_b64_tr_b16 v[28:29], v7 offset:8320
    v_mfma_f32_16x16x32_bf16 v[52:55], v[12:15], v[108:111], v[52:55]
    ds_read_b64_tr_b16 v[30:31], v7 offset:9344
    s_waitcnt lgkmcnt(6)
    v_mfma_f32_16x16x32_bf16 v[56:59], v[16:19], v[104:107], v[56:59]
    ds_read_b64_tr_b16 v[12:13], v7 offset:8352
    v_mfma_f32_16x16x32_bf16 v[60:63], v[16:19], v[108:111], v[60:63]
    ds_read_b64_tr_b16 v[14:15], v7 offset:9376
    s_add_u32 m0, s53, 3072
    s_add_u32 s51, s49, 30976
    buffer_load_dwordx4 v11, s[28:31], s51 offen lds
    s_waitcnt lgkmcnt(6)
    v_mfma_f32_16x16x32_bf16 v[64:67], v[20:23], v[104:107], v[64:67]
    v_mfma_f32_16x16x32_bf16 v[68:71], v[20:23], v[108:111], v[68:71]
    s_waitcnt lgkmcnt(4)
    v_mfma_f32_16x16x32_bf16 v[72:75], v[24:27], v[104:107], v[72:75]
    v_mfma_f32_16x16x32_bf16 v[76:79], v[24:27], v[108:111], v[76:79]
    s_waitcnt lgkmcnt(2)
    v_mfma_f32_16x16x32_bf16 v[80:83], v[28:31], v[104:107], v[80:83]
    v_mfma_f32_16x16x32_bf16 v[84:87], v[28:31], v[108:111], v[84:87]
    s_waitcnt lgkmcnt(0)
    v_mfma_f32_16x16x32_bf16 v[88:91], v[12:15], v[104:107], v[88:91]
    v_mfma_f32_16x16x32_bf16 v[92:95], v[12:15], v[108:111], v[92:95]
    s_waitcnt vmcnt(6)
    s_barrier
    ds_read_b128 v[112:115], v254 offset:4096
    ds_read_b128 v[116:119], v254 offset:6144
    ds_read_b128 v[120:123], v255 offset:4096
    ds_read_b128 v[124:127], v255 offset:6144
    ds_read_b64_tr_b16 v[12:13], v4 offset:16640
    ds_read_b64_tr_b16 v[14:15], v4 offset:17664
    ds_read_b64_tr_b16 v[16:17], v4 offset:16672
    ds_read_b64_tr_b16 v[18:19], v4 offset:17696
    ds_read_b64_tr_b16 v[20:21], v5 offset:16640
    ds_read_b64_tr_b16 v[22:23], v5 offset:17664
    ds_read_b64_tr_b16 v[24:25], v5 offset:16672
    ds_read_b64_tr_b16 v[26:27], v5 offset:17696
    s_waitcnt lgkmcnt(8)
    s_waitcnt lgkmcnt(6)
    v_mfma_f32_16x16x32_bf16 v[32:35], v[12:15], v[112:115], v[32:35]
    ds_read_b64_tr_b16 v[28:29], v6 offset:16640
    v_mfma_f32_16x16x32_bf16 v[36:39], v[12:15], v[116:119], v[36:39]
    ds_read_b64_tr_b16 v[30:31], v6 offset:17664
    s_add_u32 m0, s52, 0
    s_add_u32 s51, s48, 1310720
    buffer_load_dwordx4 v8, s[32:35], s51 offen lds
    s_waitcnt lgkmcnt(6)
    v_mfma_f32_16x16x32_bf16 v[40:43], v[16:19], v[112:115], v[40:43]
    ds_read_b64_tr_b16 v[12:13], v6 offset:16672
    v_mfma_f32_16x16x32_bf16 v[44:47], v[16:19], v[116:119], v[44:47]
    ds_read_b64_tr_b16 v[14:15], v6 offset:17696
    s_waitcnt lgkmcnt(6)
    v_mfma_f32_16x16x32_bf16 v[48:51], v[20:23], v[112:115], v[48:51]
    ds_read_b64_tr_b16 v[16:17], v7 offset:16640
    v_mfma_f32_16x16x32_bf16 v[52:55], v[20:23], v[116:119], v[52:55]
    ds_read_b64_tr_b16 v[18:19], v7 offset:17664
    s_add_u32 m0, s52, 1024
    s_add_u32 s51, s48, 1343488
    buffer_load_dwordx4 v8, s[32:35], s51 offen lds
    s_waitcnt lgkmcnt(6)
    v_mfma_f32_16x16x32_bf16 v[56:59], v[24:27], v[112:115], v[56:59]
    ds_read_b64_tr_b16 v[20:21], v7 offset:16672
    v_mfma_f32_16x16x32_bf16 v[60:63], v[24:27], v[116:119], v[60:63]
    ds_read_b64_tr_b16 v[22:23], v7 offset:17696
    s_waitcnt lgkmcnt(6)
    v_mfma_f32_16x16x32_bf16 v[64:67], v[28:31], v[112:115], v[64:67]
    ds_read_b64_tr_b16 v[24:25], v4 offset:24960
    v_mfma_f32_16x16x32_bf16 v[68:71], v[28:31], v[116:119], v[68:71]
    ds_read_b64_tr_b16 v[26:27], v4 offset:25984
    s_add_u32 m0, s52, 8320
    s_add_u32 s51, s48, 1572864
    buffer_load_dwordx4 v8, s[32:35], s51 offen lds
    s_waitcnt lgkmcnt(6)
    v_mfma_f32_16x16x32_bf16 v[72:75], v[12:15], v[112:115], v[72:75]
    ds_read_b64_tr_b16 v[28:29], v4 offset:24992
    v_mfma_f32_16x16x32_bf16 v[76:79], v[12:15], v[116:119], v[76:79]
    ds_read_b64_tr_b16 v[30:31], v4 offset:26016
    s_add_u32 m0, s52, 9344
    s_add_u32 s51, s48, 1605632
    buffer_load_dwordx4 v8, s[32:35], s51 offen lds
    s_waitcnt lgkmcnt(6)
    v_mfma_f32_16x16x32_bf16 v[80:83], v[16:19], v[112:115], v[80:83]
    ds_read_b64_tr_b16 v[12:13], v5 offset:24960
    v_mfma_f32_16x16x32_bf16 v[84:87], v[16:19], v[116:119], v[84:87]
    ds_read_b64_tr_b16 v[14:15], v5 offset:25984
    s_waitcnt lgkmcnt(6)
    v_mfma_f32_16x16x32_bf16 v[88:91], v[20:23], v[112:115], v[88:91]
    ds_read_b64_tr_b16 v[16:17], v5 offset:24992
    v_mfma_f32_16x16x32_bf16 v[92:95], v[20:23], v[116:119], v[92:95]
    ds_read_b64_tr_b16 v[18:19], v5 offset:26016
    s_add_u32 m0, s53, 4096
    s_add_u32 s51, s49, 384
    buffer_load_dwordx4 v10, s[28:31], s51 offen lds
    s_waitcnt lgkmcnt(6)
    v_mfma_f32_16x16x32_bf16 v[32:35], v[24:27], v[120:123], v[32:35]
    ds_read_b64_tr_b16 v[20:21], v6 offset:24960
    v_mfma_f32_16x16x32_bf16 v[36:39], v[24:27], v[124:127], v[36:39]
    ds_read_b64_tr_b16 v[22:23], v6 offset:25984
    s_add_u32 m0, s53, 5120
    s_add_u32 s51, s49, 10624
    buffer_load_dwordx4 v11, s[28:31], s51 offen lds
    s_waitcnt lgkmcnt(6)
    v_mfma_f32_16x16x32_bf16 v[40:43], v[28:31], v[120:123], v[40:43]
    ds_read_b64_tr_b16 v[24:25], v6 offset:24992
    v_mfma_f32_16x16x32_bf16 v[44:47], v[28:31], v[124:127], v[44:47]
    ds_read_b64_tr_b16 v[26:27], v6 offset:26016
    s_waitcnt lgkmcnt(6)
    v_mfma_f32_16x16x32_bf16 v[48:51], v[12:15], v[120:123], v[48:51]
    ds_read_b64_tr_b16 v[28:29], v7 offset:24960
    v_mfma_f32_16x16x32_bf16 v[52:55], v[12:15], v[124:127], v[52:55]
    ds_read_b64_tr_b16 v[30:31], v7 offset:25984
    s_add_u32 m0, s53, 6144
    s_add_u32 s51, s49, 20864
    buffer_load_dwordx4 v10, s[28:31], s51 offen lds
    s_waitcnt lgkmcnt(6)
    v_mfma_f32_16x16x32_bf16 v[56:59], v[16:19], v[120:123], v[56:59]
    ds_read_b64_tr_b16 v[12:13], v7 offset:24992
    v_mfma_f32_16x16x32_bf16 v[60:63], v[16:19], v[124:127], v[60:63]
    ds_read_b64_tr_b16 v[14:15], v7 offset:26016
    s_waitcnt lgkmcnt(6)
    v_mfma_f32_16x16x32_bf16 v[64:67], v[20:23], v[120:123], v[64:67]
    v_mfma_f32_16x16x32_bf16 v[68:71], v[20:23], v[124:127], v[68:71]
    s_add_u32 m0, s53, 7168
    s_add_u32 s51, s49, 31104
    buffer_load_dwordx4 v11, s[28:31], s51 offen lds
    s_waitcnt lgkmcnt(4)
    v_mfma_f32_16x16x32_bf16 v[72:75], v[24:27], v[120:123], v[72:75]
    v_mfma_f32_16x16x32_bf16 v[76:79], v[24:27], v[124:127], v[76:79]
    s_waitcnt lgkmcnt(2)
    v_mfma_f32_16x16x32_bf16 v[80:83], v[28:31], v[120:123], v[80:83]
    v_mfma_f32_16x16x32_bf16 v[84:87], v[28:31], v[124:127], v[84:87]
    s_waitcnt lgkmcnt(0)
    v_mfma_f32_16x16x32_bf16 v[88:91], v[12:15], v[120:123], v[88:91]
    v_mfma_f32_16x16x32_bf16 v[92:95], v[12:15], v[124:127], v[92:95]
    s_waitcnt vmcnt(6)
    s_barrier
    ds_read_b128 v[128:131], v254 offset:0
    ds_read_b128 v[132:135], v254 offset:2048
    ds_read_b128 v[136:139], v255 offset:0
    ds_read_b128 v[140:143], v255 offset:2048
    ds_read_b64_tr_b16 v[12:13], v4 offset:33280
    ds_read_b64_tr_b16 v[14:15], v4 offset:34304
    ds_read_b64_tr_b16 v[16:17], v4 offset:33312
    ds_read_b64_tr_b16 v[18:19], v4 offset:34336
    ds_read_b64_tr_b16 v[20:21], v5 offset:33280
    ds_read_b64_tr_b16 v[22:23], v5 offset:34304
    ds_read_b64_tr_b16 v[24:25], v5 offset:33312
    ds_read_b64_tr_b16 v[26:27], v5 offset:34336
    s_waitcnt lgkmcnt(8)
    s_waitcnt lgkmcnt(6)
    v_mfma_f32_16x16x32_bf16 v[32:35], v[12:15], v[128:131], v[32:35]
    ds_read_b64_tr_b16 v[28:29], v6 offset:33280
    v_mfma_f32_16x16x32_bf16 v[36:39], v[12:15], v[132:135], v[36:39]
    ds_read_b64_tr_b16 v[30:31], v6 offset:34304
    s_add_u32 m0, s52, 16640
    s_add_u32 s51, s48, 1835008
    buffer_load_dwordx4 v8, s[32:35], s51 offen lds
    s_waitcnt lgkmcnt(6)
    v_mfma_f32_16x16x32_bf16 v[40:43], v[16:19], v[128:131], v[40:43]
    ds_read_b64_tr_b16 v[12:13], v6 offset:33312
    v_mfma_f32_16x16x32_bf16 v[44:47], v[16:19], v[132:135], v[44:47]
    ds_read_b64_tr_b16 v[14:15], v6 offset:34336
    s_waitcnt lgkmcnt(6)
    v_mfma_f32_16x16x32_bf16 v[48:51], v[20:23], v[128:131], v[48:51]
    ds_read_b64_tr_b16 v[16:17], v7 offset:33280
    v_mfma_f32_16x16x32_bf16 v[52:55], v[20:23], v[132:135], v[52:55]
    ds_read_b64_tr_b16 v[18:19], v7 offset:34304
    s_add_u32 m0, s52, 17664
    s_add_u32 s51, s48, 1867776
    buffer_load_dwordx4 v8, s[32:35], s51 offen lds
    s_waitcnt lgkmcnt(6)
    v_mfma_f32_16x16x32_bf16 v[56:59], v[24:27], v[128:131], v[56:59]
    ds_read_b64_tr_b16 v[20:21], v7 offset:33312
    v_mfma_f32_16x16x32_bf16 v[60:63], v[24:27], v[132:135], v[60:63]
    ds_read_b64_tr_b16 v[22:23], v7 offset:34336
    s_waitcnt lgkmcnt(6)
    v_mfma_f32_16x16x32_bf16 v[64:67], v[28:31], v[128:131], v[64:67]
    ds_read_b64_tr_b16 v[24:25], v4 offset:0
    v_mfma_f32_16x16x32_bf16 v[68:71], v[28:31], v[132:135], v[68:71]
    ds_read_b64_tr_b16 v[26:27], v4 offset:1024
    s_add_u32 m0, s52, 24960
    s_add_u32 s51, s48, 2097152
    buffer_load_dwordx4 v8, s[32:35], s51 offen lds
    s_waitcnt lgkmcnt(6)
    v_mfma_f32_16x16x32_bf16 v[72:75], v[12:15], v[128:131], v[72:75]
    ds_read_b64_tr_b16 v[28:29], v4 offset:32
    v_mfma_f32_16x16x32_bf16 v[76:79], v[12:15], v[132:135], v[76:79]
    ds_read_b64_tr_b16 v[30:31], v4 offset:1056
    s_add_u32 m0, s52, 25984
    s_add_u32 s51, s48, 2129920
    buffer_load_dwordx4 v8, s[32:35], s51 offen lds
    s_waitcnt lgkmcnt(6)
    v_mfma_f32_16x16x32_bf16 v[80:83], v[16:19], v[128:131], v[80:83]
    ds_read_b64_tr_b16 v[12:13], v5 offset:0
    v_mfma_f32_16x16x32_bf16 v[84:87], v[16:19], v[132:135], v[84:87]
    ds_read_b64_tr_b16 v[14:15], v5 offset:1024
    s_waitcnt lgkmcnt(6)
    v_mfma_f32_16x16x32_bf16 v[88:91], v[20:23], v[128:131], v[88:91]
    ds_read_b64_tr_b16 v[16:17], v5 offset:32
    v_mfma_f32_16x16x32_bf16 v[92:95], v[20:23], v[132:135], v[92:95]
    ds_read_b64_tr_b16 v[18:19], v5 offset:1056
    s_add_u32 m0, s53, 0
    s_add_u32 s51, s49, 512
    buffer_load_dwordx4 v10, s[28:31], s51 offen lds
    s_waitcnt lgkmcnt(6)
    v_mfma_f32_16x16x32_bf16 v[32:35], v[24:27], v[136:139], v[32:35]
    ds_read_b64_tr_b16 v[20:21], v6 offset:0
    v_mfma_f32_16x16x32_bf16 v[36:39], v[24:27], v[140:143], v[36:39]
    ds_read_b64_tr_b16 v[22:23], v6 offset:1024
    s_add_u32 m0, s53, 1024
    s_add_u32 s51, s49, 10752
    buffer_load_dwordx4 v11, s[28:31], s51 offen lds
    s_waitcnt lgkmcnt(6)
    v_mfma_f32_16x16x32_bf16 v[40:43], v[28:31], v[136:139], v[40:43]
    ds_read_b64_tr_b16 v[24:25], v6 offset:32
    v_mfma_f32_16x16x32_bf16 v[44:47], v[28:31], v[140:143], v[44:47]
    ds_read_b64_tr_b16 v[26:27], v6 offset:1056
    s_waitcnt lgkmcnt(6)
    v_mfma_f32_16x16x32_bf16 v[48:51], v[12:15], v[136:139], v[48:51]
    ds_read_b64_tr_b16 v[28:29], v7 offset:0
    v_mfma_f32_16x16x32_bf16 v[52:55], v[12:15], v[140:143], v[52:55]
    ds_read_b64_tr_b16 v[30:31], v7 offset:1024
    s_add_u32 m0, s53, 2048
    s_add_u32 s51, s49, 20992
    buffer_load_dwordx4 v10, s[28:31], s51 offen lds
    s_waitcnt lgkmcnt(6)
    v_mfma_f32_16x16x32_bf16 v[56:59], v[16:19], v[136:139], v[56:59]
    ds_read_b64_tr_b16 v[12:13], v7 offset:32
    v_mfma_f32_16x16x32_bf16 v[60:63], v[16:19], v[140:143], v[60:63]
    ds_read_b64_tr_b16 v[14:15], v7 offset:1056
    s_waitcnt lgkmcnt(6)
    v_mfma_f32_16x16x32_bf16 v[64:67], v[20:23], v[136:139], v[64:67]
    v_mfma_f32_16x16x32_bf16 v[68:71], v[20:23], v[140:143], v[68:71]
    s_add_u32 m0, s53, 3072
    s_add_u32 s51, s49, 31232
    buffer_load_dwordx4 v11, s[28:31], s51 offen lds
    s_waitcnt lgkmcnt(4)
    v_mfma_f32_16x16x32_bf16 v[72:75], v[24:27], v[136:139], v[72:75]
    v_mfma_f32_16x16x32_bf16 v[76:79], v[24:27], v[140:143], v[76:79]
    s_waitcnt lgkmcnt(2)
    v_mfma_f32_16x16x32_bf16 v[80:83], v[28:31], v[136:139], v[80:83]
    v_mfma_f32_16x16x32_bf16 v[84:87], v[28:31], v[140:143], v[84:87]
    s_waitcnt lgkmcnt(0)
    v_mfma_f32_16x16x32_bf16 v[88:91], v[12:15], v[136:139], v[88:91]
    v_mfma_f32_16x16x32_bf16 v[92:95], v[12:15], v[140:143], v[92:95]
    s_waitcnt vmcnt(6)
    s_barrier
    ds_read_b128 v[144:147], v254 offset:4096
    ds_read_b128 v[148:151], v254 offset:6144
    ds_read_b128 v[152:155], v255 offset:4096
    ds_read_b128 v[156:159], v255 offset:6144
    ds_read_b64_tr_b16 v[12:13], v4 offset:8320
    ds_read_b64_tr_b16 v[14:15], v4 offset:9344
    ds_read_b64_tr_b16 v[16:17], v4 offset:8352
    ds_read_b64_tr_b16 v[18:19], v4 offset:9376
    ds_read_b64_tr_b16 v[20:21], v5 offset:8320
    ds_read_b64_tr_b16 v[22:23], v5 offset:9344
    ds_read_b64_tr_b16 v[24:25], v5 offset:8352
    ds_read_b64_tr_b16 v[26:27], v5 offset:9376
    s_waitcnt lgkmcnt(8)
    s_waitcnt lgkmcnt(6)
    v_mfma_f32_16x16x32_bf16 v[32:35], v[12:15], v[144:147], v[32:35]
    ds_read_b64_tr_b16 v[28:29], v6 offset:8320
    v_mfma_f32_16x16x32_bf16 v[36:39], v[12:15], v[148:151], v[36:39]
    ds_read_b64_tr_b16 v[30:31], v6 offset:9344
    s_add_u32 m0, s52, 33280
    s_add_u32 s51, s48, 2359296
    buffer_load_dwordx4 v8, s[32:35], s51 offen lds
    s_waitcnt lgkmcnt(6)
    v_mfma_f32_16x16x32_bf16 v[40:43], v[16:19], v[144:147], v[40:43]
    ds_read_b64_tr_b16 v[12:13], v6 offset:8352
    v_mfma_f32_16x16x32_bf16 v[44:47], v[16:19], v[148:151], v[44:47]
    ds_read_b64_tr_b16 v[14:15], v6 offset:9376
    s_waitcnt lgkmcnt(6)
    v_mfma_f32_16x16x32_bf16 v[48:51], v[20:23], v[144:147], v[48:51]
    ds_read_b64_tr_b16 v[16:17], v7 offset:8320
    v_mfma_f32_16x16x32_bf16 v[52:55], v[20:23], v[148:151], v[52:55]
    ds_read_b64_tr_b16 v[18:19], v7 offset:9344
    s_add_u32 m0, s52, 34304
    s_add_u32 s51, s48, 2392064
    buffer_load_dwordx4 v8, s[32:35], s51 offen lds
    s_waitcnt lgkmcnt(6)
    v_mfma_f32_16x16x32_bf16 v[56:59], v[24:27], v[144:147], v[56:59]
    ds_read_b64_tr_b16 v[20:21], v7 offset:8352
    v_mfma_f32_16x16x32_bf16 v[60:63], v[24:27], v[148:151], v[60:63]
    ds_read_b64_tr_b16 v[22:23], v7 offset:9376
    s_add_u32 m0, s52, 0
    s_add_u32 s51, s48, 2621440
    buffer_load_dwordx4 v8, s[32:35], s51 offen lds
    s_waitcnt lgkmcnt(6)
    v_mfma_f32_16x16x32_bf16 v[64:67], v[28:31], v[144:147], v[64:67]
    ds_read_b64_tr_b16 v[24:25], v4 offset:16640
    v_mfma_f32_16x16x32_bf16 v[68:71], v[28:31], v[148:151], v[68:71]
    ds_read_b64_tr_b16 v[26:27], v4 offset:17664
    s_add_u32 m0, s52, 1024
    s_add_u32 s51, s48, 2654208
    buffer_load_dwordx4 v8, s[32:35], s51 offen lds
    s_waitcnt lgkmcnt(6)
    v_mfma_f32_16x16x32_bf16 v[72:75], v[12:15], v[144:147], v[72:75]
    ds_read_b64_tr_b16 v[28:29], v4 offset:16672
    v_mfma_f32_16x16x32_bf16 v[76:79], v[12:15], v[148:151], v[76:79]
    ds_read_b64_tr_b16 v[30:31], v4 offset:17696
    s_add_u32 m0, s53, 4096
    s_add_u32 s51, s49, 640
    buffer_load_dwordx4 v10, s[28:31], s51 offen lds
    s_waitcnt lgkmcnt(6)
    v_mfma_f32_16x16x32_bf16 v[80:83], v[16:19], v[144:147], v[80:83]
    ds_read_b64_tr_b16 v[12:13], v5 offset:16640
    v_mfma_f32_16x16x32_bf16 v[84:87], v[16:19], v[148:151], v[84:87]
    ds_read_b64_tr_b16 v[14:15], v5 offset:17664
    s_add_u32 m0, s53, 5120
    s_add_u32 s51, s49, 10880
    buffer_load_dwordx4 v11, s[28:31], s51 offen lds
    s_waitcnt lgkmcnt(6)
    v_mfma_f32_16x16x32_bf16 v[88:91], v[20:23], v[144:147], v[88:91]
    ds_read_b64_tr_b16 v[16:17], v5 offset:16672
    v_mfma_f32_16x16x32_bf16 v[92:95], v[20:23], v[148:151], v[92:95]
    ds_read_b64_tr_b16 v[18:19], v5 offset:17696
    s_add_u32 m0, s53, 6144
    s_add_u32 s51, s49, 21120
    buffer_load_dwordx4 v10, s[28:31], s51 offen lds
    s_waitcnt lgkmcnt(6)
    v_mfma_f32_16x16x32_bf16 v[32:35], v[24:27], v[152:155], v[32:35]
    ds_read_b64_tr_b16 v[20:21], v6 offset:16640
    v_mfma_f32_16x16x32_bf16 v[36:39], v[24:27], v[156:159], v[36:39]
    ds_read_b64_tr_b16 v[22:23], v6 offset:17664
    s_add_u32 m0, s53, 7168
    s_add_u32 s51, s49, 31360
    buffer_load_dwordx4 v11, s[28:31], s51 offen lds
    s_waitcnt lgkmcnt(6)
    v_mfma_f32_16x16x32_bf16 v[40:43], v[28:31], v[152:155], v[40:43]
    ds_read_b64_tr_b16 v[24:25], v6 offset:16672
    v_mfma_f32_16x16x32_bf16 v[44:47], v[28:31], v[156:159], v[44:47]
    ds_read_b64_tr_b16 v[26:27], v6 offset:17696
    s_add_u32 m0, s67, 50688
    s_add_u32 s63, s61, 0
    buffer_load_dwordx4 v2, s[20:23], s63 offen offset:0 nt lds
    s_waitcnt lgkmcnt(6)
    v_mfma_f32_16x16x32_bf16 v[48:51], v[12:15], v[152:155], v[48:51]
    ds_read_b64_tr_b16 v[28:29], v7 offset:16640
    v_mfma_f32_16x16x32_bf16 v[52:55], v[12:15], v[156:159], v[52:55]
    ds_read_b64_tr_b16 v[30:31], v7 offset:17664
    s_add_u32 m0, s67, 50688
    s_add_u32 s63, s61, 0
    buffer_load_dwordx4 v2, s[20:23], s63 offen offset:1024 nt lds
    s_waitcnt lgkmcnt(6)
    v_mfma_f32_16x16x32_bf16 v[56:59], v[16:19], v[152:155], v[56:59]
    ds_read_b64_tr_b16 v[12:13], v7 offset:16672
    v_mfma_f32_16x16x32_bf16 v[60:63], v[16:19], v[156:159], v[60:63]
    ds_read_b64_tr_b16 v[14:15], v7 offset:17696
    s_add_u32 m0, s67, 50720
    s_add_u32 s63, s61, 0
    buffer_load_dwordx4 v2, s[20:23], s63 offen offset:2048 nt lds
    s_waitcnt lgkmcnt(6)
    v_mfma_f32_16x16x32_bf16 v[64:67], v[20:23], v[152:155], v[64:67]
    v_mfma_f32_16x16x32_bf16 v[68:71], v[20:23], v[156:159], v[68:71]
    s_add_u32 m0, s67, 50720
    s_add_u32 s63, s61, 0
    buffer_load_dwordx4 v2, s[20:23], s63 offen offset:3072 nt lds
    s_waitcnt lgkmcnt(4)
    v_mfma_f32_16x16x32_bf16 v[72:75], v[24:27], v[152:155], v[72:75]
    v_mfma_f32_16x16x32_bf16 v[76:79], v[24:27], v[156:159], v[76:79]
    s_waitcnt lgkmcnt(2)
    v_mfma_f32_16x16x32_bf16 v[80:83], v[28:31], v[152:155], v[80:83]
    v_mfma_f32_16x16x32_bf16 v[84:87], v[28:31], v[156:159], v[84:87]
    s_waitcnt lgkmcnt(0)
    v_mfma_f32_16x16x32_bf16 v[88:91], v[12:15], v[152:155], v[88:91]
    v_mfma_f32_16x16x32_bf16 v[92:95], v[12:15], v[156:159], v[92:95]
    s_waitcnt vmcnt(10)
    s_barrier
    ds_read_b128 v[160:163], v254 offset:0
    ds_read_b128 v[164:167], v254 offset:2048
    ds_read_b128 v[168:171], v255 offset:0
    ds_read_b128 v[172:175], v255 offset:2048
    ds_read_b64_tr_b16 v[12:13], v4 offset:24960
    ds_read_b64_tr_b16 v[14:15], v4 offset:25984
    ds_read_b64_tr_b16 v[16:17], v4 offset:24992
    ds_read_b64_tr_b16 v[18:19], v4 offset:26016
    ds_read_b64_tr_b16 v[20:21], v5 offset:24960
    ds_read_b64_tr_b16 v[22:23], v5 offset:25984
    ds_read_b64_tr_b16 v[24:25], v5 offset:24992
    ds_read_b64_tr_b16 v[26:27], v5 offset:26016
    s_waitcnt lgkmcnt(8)
    s_waitcnt lgkmcnt(6)
    v_mfma_f32_16x16x32_bf16 v[32:35], v[12:15], v[160:163], v[32:35]
    ds_read_b64_tr_b16 v[28:29], v6 offset:24960
    v_mfma_f32_16x16x32_bf16 v[36:39], v[12:15], v[164:167], v[36:39]
    ds_read_b64_tr_b16 v[30:31], v6 offset:25984
    s_add_u32 m0, s52, 8320
    s_add_u32 s51, s48, 2883584
    buffer_load_dwordx4 v8, s[32:35], s51 offen lds
    s_waitcnt lgkmcnt(6)
    v_mfma_f32_16x16x32_bf16 v[40:43], v[16:19], v[160:163], v[40:43]
    ds_read_b64_tr_b16 v[12:13], v6 offset:24992
    v_mfma_f32_16x16x32_bf16 v[44:47], v[16:19], v[164:167], v[44:47]
    ds_read_b64_tr_b16 v[14:15], v6 offset:26016
    s_waitcnt lgkmcnt(6)
    v_mfma_f32_16x16x32_bf16 v[48:51], v[20:23], v[160:163], v[48:51]
    ds_read_b64_tr_b16 v[16:17], v7 offset:24960
    v_mfma_f32_16x16x32_bf16 v[52:55], v[20:23], v[164:167], v[52:55]
    ds_read_b64_tr_b16 v[18:19], v7 offset:25984
    s_add_u32 m0, s52, 9344
    s_add_u32 s51, s48, 2916352
    buffer_load_dwordx4 v8, s[32:35], s51 offen lds
    s_waitcnt lgkmcnt(6)
    v_mfma_f32_16x16x32_bf16 v[56:59], v[24:27], v[160:163], v[56:59]
    ds_read_b64_tr_b16 v[20:21], v7 offset:24992
    v_mfma_f32_16x16x32_bf16 v[60:63], v[24:27], v[164:167], v[60:63]
    ds_read_b64_tr_b16 v[22:23], v7 offset:26016
    s_waitcnt lgkmcnt(6)
    v_mfma_f32_16x16x32_bf16 v[64:67], v[28:31], v[160:163], v[64:67]
    ds_read_b64_tr_b16 v[24:25], v4 offset:33280
    v_mfma_f32_16x16x32_bf16 v[68:71], v[28:31], v[164:167], v[68:71]
    ds_read_b64_tr_b16 v[26:27], v4 offset:34304
    s_add_u32 m0, s52, 16640
    s_add_u32 s51, s48, 3145728
    buffer_load_dwordx4 v8, s[32:35], s51 offen lds
    s_waitcnt lgkmcnt(6)
    v_mfma_f32_16x16x32_bf16 v[72:75], v[12:15], v[160:163], v[72:75]
    ds_read_b64_tr_b16 v[28:29], v4 offset:33312
    v_mfma_f32_16x16x32_bf16 v[76:79], v[12:15], v[164:167], v[76:79]
    ds_read_b64_tr_b16 v[30:31], v4 offset:34336
    s_add_u32 m0, s52, 17664
    s_add_u32 s51, s48, 3178496
    buffer_load_dwordx4 v8, s[32:35], s51 offen lds
    s_waitcnt lgkmcnt(6)
    v_mfma_f32_16x16x32_bf16 v[80:83], v[16:19], v[160:163], v[80:83]
    ds_read_b64_tr_b16 v[12:13], v5 offset:33280
    v_mfma_f32_16x16x32_bf16 v[84:87], v[16:19], v[164:167], v[84:87]
    ds_read_b64_tr_b16 v[14:15], v5 offset:34304
    s_waitcnt lgkmcnt(6)
    v_mfma_f32_16x16x32_bf16 v[88:91], v[20:23], v[160:163], v[88:91]
    ds_read_b64_tr_b16 v[16:17], v5 offset:33312
    v_mfma_f32_16x16x32_bf16 v[92:95], v[20:23], v[164:167], v[92:95]
    ds_read_b64_tr_b16 v[18:19], v5 offset:34336
    s_add_u32 m0, s53, 0
    s_add_u32 s51, s49, 768
    buffer_load_dwordx4 v10, s[28:31], s51 offen lds
    s_waitcnt lgkmcnt(6)
    v_mfma_f32_16x16x32_bf16 v[32:35], v[24:27], v[168:171], v[32:35]
    ds_read_b64_tr_b16 v[20:21], v6 offset:33280
    v_mfma_f32_16x16x32_bf16 v[36:39], v[24:27], v[172:175], v[36:39]
    ds_read_b64_tr_b16 v[22:23], v6 offset:34304
    s_add_u32 m0, s53, 1024
    s_add_u32 s51, s49, 11008
    buffer_load_dwordx4 v11, s[28:31], s51 offen lds
    s_waitcnt lgkmcnt(6)
    v_mfma_f32_16x16x32_bf16 v[40:43], v[28:31], v[168:171], v[40:43]
    ds_read_b64_tr_b16 v[24:25], v6 offset:33312
    v_mfma_f32_16x16x32_bf16 v[44:47], v[28:31], v[172:175], v[44:47]
    ds_read_b64_tr_b16 v[26:27], v6 offset:34336
    s_waitcnt lgkmcnt(6)
    v_mfma_f32_16x16x32_bf16 v[48:51], v[12:15], v[168:171], v[48:51]
    ds_read_b64_tr_b16 v[28:29], v7 offset:33280
    v_mfma_f32_16x16x32_bf16 v[52:55], v[12:15], v[172:175], v[52:55]
    ds_read_b64_tr_b16 v[30:31], v7 offset:34304
    s_add_u32 m0, s53, 2048
    s_add_u32 s51, s49, 21248
    buffer_load_dwordx4 v10, s[28:31], s51 offen lds
    s_waitcnt lgkmcnt(6)
    v_mfma_f32_16x16x32_bf16 v[56:59], v[16:19], v[168:171], v[56:59]
    ds_read_b64_tr_b16 v[12:13], v7 offset:33312
    v_mfma_f32_16x16x32_bf16 v[60:63], v[16:19], v[172:175], v[60:63]
    ds_read_b64_tr_b16 v[14:15], v7 offset:34336
    s_waitcnt lgkmcnt(6)
    v_mfma_f32_16x16x32_bf16 v[64:67], v[20:23], v[168:171], v[64:67]
    v_mfma_f32_16x16x32_bf16 v[68:71], v[20:23], v[172:175], v[68:71]
    s_add_u32 m0, s53, 3072
    s_add_u32 s51, s49, 31488
    buffer_load_dwordx4 v11, s[28:31], s51 offen lds
    s_waitcnt lgkmcnt(4)
    v_mfma_f32_16x16x32_bf16 v[72:75], v[24:27], v[168:171], v[72:75]
    v_mfma_f32_16x16x32_bf16 v[76:79], v[24:27], v[172:175], v[76:79]
    s_waitcnt lgkmcnt(2)
    v_mfma_f32_16x16x32_bf16 v[80:83], v[28:31], v[168:171], v[80:83]
    v_mfma_f32_16x16x32_bf16 v[84:87], v[28:31], v[172:175], v[84:87]
    s_waitcnt lgkmcnt(0)
    v_mfma_f32_16x16x32_bf16 v[88:91], v[12:15], v[168:171], v[88:91]
    v_mfma_f32_16x16x32_bf16 v[92:95], v[12:15], v[172:175], v[92:95]
    s_waitcnt vmcnt(6)
    s_barrier
    ds_read_b128 v[176:179], v254 offset:4096
    ds_read_b128 v[180:183], v254 offset:6144
    ds_read_b128 v[184:187], v255 offset:4096
    ds_read_b128 v[188:191], v255 offset:6144
    ds_read_b64_tr_b16 v[12:13], v4 offset:0
    ds_read_b64_tr_b16 v[14:15], v4 offset:1024
    ds_read_b64_tr_b16 v[16:17], v4 offset:32
    ds_read_b64_tr_b16 v[18:19], v4 offset:1056
    ds_read_b64_tr_b16 v[20:21], v5 offset:0
    ds_read_b64_tr_b16 v[22:23], v5 offset:1024
    ds_read_b64_tr_b16 v[24:25], v5 offset:32
    ds_read_b64_tr_b16 v[26:27], v5 offset:1056
    s_waitcnt lgkmcnt(8)
    s_waitcnt lgkmcnt(6)
    v_mfma_f32_16x16x32_bf16 v[32:35], v[12:15], v[176:179], v[32:35]
    ds_read_b64_tr_b16 v[28:29], v6 offset:0
    v_mfma_f32_16x16x32_bf16 v[36:39], v[12:15], v[180:183], v[36:39]
    ds_read_b64_tr_b16 v[30:31], v6 offset:1024
    s_add_u32 m0, s52, 24960
    s_add_u32 s51, s48, 3407872
    buffer_load_dwordx4 v8, s[32:35], s51 offen lds
    s_waitcnt lgkmcnt(6)
    v_mfma_f32_16x16x32_bf16 v[40:43], v[16:19], v[176:179], v[40:43]
    ds_read_b64_tr_b16 v[12:13], v6 offset:32
    v_mfma_f32_16x16x32_bf16 v[44:47], v[16:19], v[180:183], v[44:47]
    ds_read_b64_tr_b16 v[14:15], v6 offset:1056
    s_waitcnt lgkmcnt(6)
    v_mfma_f32_16x16x32_bf16 v[48:51], v[20:23], v[176:179], v[48:51]
    ds_read_b64_tr_b16 v[16:17], v7 offset:0
    v_mfma_f32_16x16x32_bf16 v[52:55], v[20:23], v[180:183], v[52:55]
    ds_read_b64_tr_b16 v[18:19], v7 offset:1024
    s_add_u32 m0, s52, 25984
    s_add_u32 s51, s48, 3440640
    buffer_load_dwordx4 v8, s[32:35], s51 offen lds
    s_waitcnt lgkmcnt(6)
    v_mfma_f32_16x16x32_bf16 v[56:59], v[24:27], v[176:179], v[56:59]
    ds_read_b64_tr_b16 v[20:21], v7 offset:32
    v_mfma_f32_16x16x32_bf16 v[60:63], v[24:27], v[180:183], v[60:63]
    ds_read_b64_tr_b16 v[22:23], v7 offset:1056
    s_waitcnt lgkmcnt(6)
    v_mfma_f32_16x16x32_bf16 v[64:67], v[28:31], v[176:179], v[64:67]
    ds_read_b64_tr_b16 v[24:25], v4 offset:8320
    v_mfma_f32_16x16x32_bf16 v[68:71], v[28:31], v[180:183], v[68:71]
    ds_read_b64_tr_b16 v[26:27], v4 offset:9344
    s_add_u32 m0, s52, 33280
    s_add_u32 s51, s48, 3670016
    buffer_load_dwordx4 v8, s[32:35], s51 offen lds
    s_waitcnt lgkmcnt(6)
    v_mfma_f32_16x16x32_bf16 v[72:75], v[12:15], v[176:179], v[72:75]
    ds_read_b64_tr_b16 v[28:29], v4 offset:8352
    v_mfma_f32_16x16x32_bf16 v[76:79], v[12:15], v[180:183], v[76:79]
    ds_read_b64_tr_b16 v[30:31], v4 offset:9376
    s_add_u32 m0, s52, 34304
    s_add_u32 s51, s48, 3702784
    buffer_load_dwordx4 v8, s[32:35], s51 offen lds
    s_waitcnt lgkmcnt(6)
    v_mfma_f32_16x16x32_bf16 v[80:83], v[16:19], v[176:179], v[80:83]
    ds_read_b64_tr_b16 v[12:13], v5 offset:8320
    v_mfma_f32_16x16x32_bf16 v[84:87], v[16:19], v[180:183], v[84:87]
    ds_read_b64_tr_b16 v[14:15], v5 offset:9344
    s_waitcnt lgkmcnt(6)
    v_mfma_f32_16x16x32_bf16 v[88:91], v[20:23], v[176:179], v[88:91]
    ds_read_b64_tr_b16 v[16:17], v5 offset:8352
    v_mfma_f32_16x16x32_bf16 v[92:95], v[20:23], v[180:183], v[92:95]
    ds_read_b64_tr_b16 v[18:19], v5 offset:9376
    s_add_u32 m0, s53, 4096
    s_add_u32 s51, s49, 896
    buffer_load_dwordx4 v10, s[28:31], s51 offen lds
    s_waitcnt lgkmcnt(6)
    v_mfma_f32_16x16x32_bf16 v[32:35], v[24:27], v[184:187], v[32:35]
    ds_read_b64_tr_b16 v[20:21], v6 offset:8320
    v_mfma_f32_16x16x32_bf16 v[36:39], v[24:27], v[188:191], v[36:39]
    ds_read_b64_tr_b16 v[22:23], v6 offset:9344
    s_add_u32 m0, s53, 5120
    s_add_u32 s51, s49, 11136
    buffer_load_dwordx4 v11, s[28:31], s51 offen lds
    s_waitcnt lgkmcnt(6)
    v_mfma_f32_16x16x32_bf16 v[40:43], v[28:31], v[184:187], v[40:43]
    ds_read_b64_tr_b16 v[24:25], v6 offset:8352
    v_mfma_f32_16x16x32_bf16 v[44:47], v[28:31], v[188:191], v[44:47]
    ds_read_b64_tr_b16 v[26:27], v6 offset:9376
    s_waitcnt lgkmcnt(6)
    v_mfma_f32_16x16x32_bf16 v[48:51], v[12:15], v[184:187], v[48:51]
    ds_read_b64_tr_b16 v[28:29], v7 offset:8320
    v_mfma_f32_16x16x32_bf16 v[52:55], v[12:15], v[188:191], v[52:55]
    ds_read_b64_tr_b16 v[30:31], v7 offset:9344
    s_add_u32 m0, s53, 6144
    s_add_u32 s51, s49, 21376
    buffer_load_dwordx4 v10, s[28:31], s51 offen lds
    s_waitcnt lgkmcnt(6)
    v_mfma_f32_16x16x32_bf16 v[56:59], v[16:19], v[184:187], v[56:59]
    ds_read_b64_tr_b16 v[12:13], v7 offset:8352
    v_mfma_f32_16x16x32_bf16 v[60:63], v[16:19], v[188:191], v[60:63]
    ds_read_b64_tr_b16 v[14:15], v7 offset:9376
    s_waitcnt lgkmcnt(6)
    v_mfma_f32_16x16x32_bf16 v[64:67], v[20:23], v[184:187], v[64:67]
    v_mfma_f32_16x16x32_bf16 v[68:71], v[20:23], v[188:191], v[68:71]
    s_add_u32 m0, s53, 7168
    s_add_u32 s51, s49, 31616
    buffer_load_dwordx4 v11, s[28:31], s51 offen lds
    s_waitcnt lgkmcnt(4)
    v_mfma_f32_16x16x32_bf16 v[72:75], v[24:27], v[184:187], v[72:75]
    v_mfma_f32_16x16x32_bf16 v[76:79], v[24:27], v[188:191], v[76:79]
    s_waitcnt lgkmcnt(2)
    v_mfma_f32_16x16x32_bf16 v[80:83], v[28:31], v[184:187], v[80:83]
    v_mfma_f32_16x16x32_bf16 v[84:87], v[28:31], v[188:191], v[84:87]
    s_waitcnt lgkmcnt(0)
    v_mfma_f32_16x16x32_bf16 v[88:91], v[12:15], v[184:187], v[88:91]
    v_mfma_f32_16x16x32_bf16 v[92:95], v[12:15], v[188:191], v[92:95]
    s_waitcnt vmcnt(6)
    s_barrier
    ds_read_b128 v[192:195], v254 offset:0
    ds_read_b128 v[196:199], v254 offset:2048
    ds_read_b128 v[200:203], v255 offset:0
    ds_read_b128 v[204:207], v255 offset:2048
    ds_read_b64_tr_b16 v[12:13], v4 offset:16640
    ds_read_b64_tr_b16 v[14:15], v4 offset:17664
    ds_read_b64_tr_b16 v[16:17], v4 offset:16672
    ds_read_b64_tr_b16 v[18:19], v4 offset:17696
    ds_read_b64_tr_b16 v[20:21], v5 offset:16640
    ds_read_b64_tr_b16 v[22:23], v5 offset:17664
    ds_read_b64_tr_b16 v[24:25], v5 offset:16672
    ds_read_b64_tr_b16 v[26:27], v5 offset:17696
    s_waitcnt lgkmcnt(8)
    s_waitcnt lgkmcnt(6)
    v_mfma_f32_16x16x32_bf16 v[32:35], v[12:15], v[192:195], v[32:35]
    ds_read_b64_tr_b16 v[28:29], v6 offset:16640
    v_mfma_f32_16x16x32_bf16 v[36:39], v[12:15], v[196:199], v[36:39]
    ds_read_b64_tr_b16 v[30:31], v6 offset:17664
    s_add_u32 m0, s52, 0
    s_add_u32 s51, s48, 3932160
    buffer_load_dwordx4 v8, s[32:35], s51 offen lds
    s_waitcnt lgkmcnt(6)
    v_mfma_f32_16x16x32_bf16 v[40:43], v[16:19], v[192:195], v[40:43]
    ds_read_b64_tr_b16 v[12:13], v6 offset:16672
    v_mfma_f32_16x16x32_bf16 v[44:47], v[16:19], v[196:199], v[44:47]
    ds_read_b64_tr_b16 v[14:15], v6 offset:17696
    s_waitcnt lgkmcnt(6)
    v_mfma_f32_16x16x32_bf16 v[48:51], v[20:23], v[192:195], v[48:51]
    ds_read_b64_tr_b16 v[16:17], v7 offset:16640
    v_mfma_f32_16x16x32_bf16 v[52:55], v[20:23], v[196:199], v[52:55]
    ds_read_b64_tr_b16 v[18:19], v7 offset:17664
    s_add_u32 m0, s52, 1024
    s_add_u32 s51, s48, 3964928
    buffer_load_dwordx4 v8, s[32:35], s51 offen lds
    s_waitcnt lgkmcnt(6)
    v_mfma_f32_16x16x32_bf16 v[56:59], v[24:27], v[192:195], v[56:59]
    ds_read_b64_tr_b16 v[20:21], v7 offset:16672
    v_mfma_f32_16x16x32_bf16 v[60:63], v[24:27], v[196:199], v[60:63]
    ds_read_b64_tr_b16 v[22:23], v7 offset:17696
    s_waitcnt lgkmcnt(6)
    v_mfma_f32_16x16x32_bf16 v[64:67], v[28:31], v[192:195], v[64:67]
    ds_read_b64_tr_b16 v[24:25], v4 offset:24960
    v_mfma_f32_16x16x32_bf16 v[68:71], v[28:31], v[196:199], v[68:71]
    ds_read_b64_tr_b16 v[26:27], v4 offset:25984
    s_add_u32 m0, s52, 8320
    s_add_u32 s51, s48, 4194304
    buffer_load_dwordx4 v8, s[32:35], s51 offen lds
    s_waitcnt lgkmcnt(6)
    v_mfma_f32_16x16x32_bf16 v[72:75], v[12:15], v[192:195], v[72:75]
    ds_read_b64_tr_b16 v[28:29], v4 offset:24992
    v_mfma_f32_16x16x32_bf16 v[76:79], v[12:15], v[196:199], v[76:79]
    ds_read_b64_tr_b16 v[30:31], v4 offset:26016
    s_add_u32 m0, s52, 9344
    s_add_u32 s51, s48, 4227072
    buffer_load_dwordx4 v8, s[32:35], s51 offen lds
    s_waitcnt lgkmcnt(6)
    v_mfma_f32_16x16x32_bf16 v[80:83], v[16:19], v[192:195], v[80:83]
    ds_read_b64_tr_b16 v[12:13], v5 offset:24960
    v_mfma_f32_16x16x32_bf16 v[84:87], v[16:19], v[196:199], v[84:87]
    ds_read_b64_tr_b16 v[14:15], v5 offset:25984
    s_waitcnt lgkmcnt(6)
    v_mfma_f32_16x16x32_bf16 v[88:91], v[20:23], v[192:195], v[88:91]
    ds_read_b64_tr_b16 v[16:17], v5 offset:24992
    v_mfma_f32_16x16x32_bf16 v[92:95], v[20:23], v[196:199], v[92:95]
    ds_read_b64_tr_b16 v[18:19], v5 offset:26016
    s_add_u32 m0, s53, 0
    s_add_u32 s51, s49, 1024
    buffer_load_dwordx4 v10, s[28:31], s51 offen lds
    s_waitcnt lgkmcnt(6)
    v_mfma_f32_16x16x32_bf16 v[32:35], v[24:27], v[200:203], v[32:35]
    ds_read_b64_tr_b16 v[20:21], v6 offset:24960
    v_mfma_f32_16x16x32_bf16 v[36:39], v[24:27], v[204:207], v[36:39]
    ds_read_b64_tr_b16 v[22:23], v6 offset:25984
    s_add_u32 m0, s53, 1024
    s_add_u32 s51, s49, 11264
    buffer_load_dwordx4 v11, s[28:31], s51 offen lds
    s_waitcnt lgkmcnt(6)
    v_mfma_f32_16x16x32_bf16 v[40:43], v[28:31], v[200:203], v[40:43]
    ds_read_b64_tr_b16 v[24:25], v6 offset:24992
    v_mfma_f32_16x16x32_bf16 v[44:47], v[28:31], v[204:207], v[44:47]
    ds_read_b64_tr_b16 v[26:27], v6 offset:26016
    s_waitcnt lgkmcnt(6)
    v_mfma_f32_16x16x32_bf16 v[48:51], v[12:15], v[200:203], v[48:51]
    ds_read_b64_tr_b16 v[28:29], v7 offset:24960
    v_mfma_f32_16x16x32_bf16 v[52:55], v[12:15], v[204:207], v[52:55]
    ds_read_b64_tr_b16 v[30:31], v7 offset:25984
    s_add_u32 m0, s53, 2048
    s_add_u32 s51, s49, 21504
    buffer_load_dwordx4 v10, s[28:31], s51 offen lds
    s_waitcnt lgkmcnt(6)
    v_mfma_f32_16x16x32_bf16 v[56:59], v[16:19], v[200:203], v[56:59]
    ds_read_b64_tr_b16 v[12:13], v7 offset:24992
    v_mfma_f32_16x16x32_bf16 v[60:63], v[16:19], v[204:207], v[60:63]
    ds_read_b64_tr_b16 v[14:15], v7 offset:26016
    s_waitcnt lgkmcnt(6)
    v_mfma_f32_16x16x32_bf16 v[64:67], v[20:23], v[200:203], v[64:67]
    v_mfma_f32_16x16x32_bf16 v[68:71], v[20:23], v[204:207], v[68:71]
    s_add_u32 m0, s53, 3072
    s_add_u32 s51, s49, 31744
    buffer_load_dwordx4 v11, s[28:31], s51 offen lds
    s_waitcnt lgkmcnt(4)
    v_mfma_f32_16x16x32_bf16 v[72:75], v[24:27], v[200:203], v[72:75]
    v_mfma_f32_16x16x32_bf16 v[76:79], v[24:27], v[204:207], v[76:79]
    s_waitcnt lgkmcnt(2)
    v_mfma_f32_16x16x32_bf16 v[80:83], v[28:31], v[200:203], v[80:83]
    v_mfma_f32_16x16x32_bf16 v[84:87], v[28:31], v[204:207], v[84:87]
    s_waitcnt lgkmcnt(0)
    v_mfma_f32_16x16x32_bf16 v[88:91], v[12:15], v[200:203], v[88:91]
    v_mfma_f32_16x16x32_bf16 v[92:95], v[12:15], v[204:207], v[92:95]
    s_waitcnt vmcnt(6)
    s_barrier
    ds_read_b128 v[208:211], v254 offset:4096
    ds_read_b128 v[212:215], v254 offset:6144
    ds_read_b128 v[216:219], v255 offset:4096
    ds_read_b128 v[220:223], v255 offset:6144
    ds_read_b64_tr_b16 v[12:13], v4 offset:33280
    ds_read_b64_tr_b16 v[14:15], v4 offset:34304
    ds_read_b64_tr_b16 v[16:17], v4 offset:33312
    ds_read_b64_tr_b16 v[18:19], v4 offset:34336
    ds_read_b64_tr_b16 v[20:21], v5 offset:33280
    ds_read_b64_tr_b16 v[22:23], v5 offset:34304
    ds_read_b64_tr_b16 v[24:25], v5 offset:33312
    ds_read_b64_tr_b16 v[26:27], v5 offset:34336
    s_waitcnt lgkmcnt(8)
    s_waitcnt lgkmcnt(6)
    v_mfma_f32_16x16x32_bf16 v[32:35], v[12:15], v[208:211], v[32:35]
    ds_read_b64_tr_b16 v[28:29], v6 offset:33280
    v_mfma_f32_16x16x32_bf16 v[36:39], v[12:15], v[212:215], v[36:39]
    ds_read_b64_tr_b16 v[30:31], v6 offset:34304
    s_add_u32 m0, s52, 16640
    s_add_u32 s51, s48, 4456448
    buffer_load_dwordx4 v8, s[32:35], s51 offen lds
    s_waitcnt lgkmcnt(6)
    v_mfma_f32_16x16x32_bf16 v[40:43], v[16:19], v[208:211], v[40:43]
    ds_read_b64_tr_b16 v[12:13], v6 offset:33312
    v_mfma_f32_16x16x32_bf16 v[44:47], v[16:19], v[212:215], v[44:47]
    ds_read_b64_tr_b16 v[14:15], v6 offset:34336
    s_waitcnt lgkmcnt(6)
    v_mfma_f32_16x16x32_bf16 v[48:51], v[20:23], v[208:211], v[48:51]
    ds_read_b64_tr_b16 v[16:17], v7 offset:33280
    v_mfma_f32_16x16x32_bf16 v[52:55], v[20:23], v[212:215], v[52:55]
    ds_read_b64_tr_b16 v[18:19], v7 offset:34304
    s_add_u32 m0, s52, 17664
    s_add_u32 s51, s48, 4489216
    buffer_load_dwordx4 v8, s[32:35], s51 offen lds
    s_waitcnt lgkmcnt(6)
    v_mfma_f32_16x16x32_bf16 v[56:59], v[24:27], v[208:211], v[56:59]
    ds_read_b64_tr_b16 v[20:21], v7 offset:33312
    v_mfma_f32_16x16x32_bf16 v[60:63], v[24:27], v[212:215], v[60:63]
    ds_read_b64_tr_b16 v[22:23], v7 offset:34336
    s_waitcnt lgkmcnt(6)
    v_mfma_f32_16x16x32_bf16 v[64:67], v[28:31], v[208:211], v[64:67]
    ds_read_b64_tr_b16 v[24:25], v4 offset:0
    v_mfma_f32_16x16x32_bf16 v[68:71], v[28:31], v[212:215], v[68:71]
    ds_read_b64_tr_b16 v[26:27], v4 offset:1024
    s_add_u32 m0, s52, 24960
    s_add_u32 s51, s48, 4718592
    buffer_load_dwordx4 v8, s[32:35], s51 offen lds
    s_waitcnt lgkmcnt(6)
    v_mfma_f32_16x16x32_bf16 v[72:75], v[12:15], v[208:211], v[72:75]
    ds_read_b64_tr_b16 v[28:29], v4 offset:32
    v_mfma_f32_16x16x32_bf16 v[76:79], v[12:15], v[212:215], v[76:79]
    ds_read_b64_tr_b16 v[30:31], v4 offset:1056
    s_add_u32 m0, s52, 25984
    s_add_u32 s51, s48, 4751360
    buffer_load_dwordx4 v8, s[32:35], s51 offen lds
    s_waitcnt lgkmcnt(6)
    v_mfma_f32_16x16x32_bf16 v[80:83], v[16:19], v[208:211], v[80:83]
    ds_read_b64_tr_b16 v[12:13], v5 offset:0
    v_mfma_f32_16x16x32_bf16 v[84:87], v[16:19], v[212:215], v[84:87]
    ds_read_b64_tr_b16 v[14:15], v5 offset:1024
    s_waitcnt lgkmcnt(6)
    v_mfma_f32_16x16x32_bf16 v[88:91], v[20:23], v[208:211], v[88:91]
    ds_read_b64_tr_b16 v[16:17], v5 offset:32
    v_mfma_f32_16x16x32_bf16 v[92:95], v[20:23], v[212:215], v[92:95]
    ds_read_b64_tr_b16 v[18:19], v5 offset:1056
    s_add_u32 m0, s53, 4096
    s_add_u32 s51, s49, 1152
    buffer_load_dwordx4 v10, s[28:31], s51 offen lds
    s_waitcnt lgkmcnt(6)
    v_mfma_f32_16x16x32_bf16 v[32:35], v[24:27], v[216:219], v[32:35]
    ds_read_b64_tr_b16 v[20:21], v6 offset:0
    v_mfma_f32_16x16x32_bf16 v[36:39], v[24:27], v[220:223], v[36:39]
    ds_read_b64_tr_b16 v[22:23], v6 offset:1024
    s_add_u32 m0, s53, 5120
    s_add_u32 s51, s49, 11392
    buffer_load_dwordx4 v11, s[28:31], s51 offen lds
    s_waitcnt lgkmcnt(6)
    v_mfma_f32_16x16x32_bf16 v[40:43], v[28:31], v[216:219], v[40:43]
    ds_read_b64_tr_b16 v[24:25], v6 offset:32
    v_mfma_f32_16x16x32_bf16 v[44:47], v[28:31], v[220:223], v[44:47]
    ds_read_b64_tr_b16 v[26:27], v6 offset:1056
    s_waitcnt lgkmcnt(6)
    v_mfma_f32_16x16x32_bf16 v[48:51], v[12:15], v[216:219], v[48:51]
    ds_read_b64_tr_b16 v[28:29], v7 offset:0
    v_mfma_f32_16x16x32_bf16 v[52:55], v[12:15], v[220:223], v[52:55]
    ds_read_b64_tr_b16 v[30:31], v7 offset:1024
    s_add_u32 m0, s53, 6144
    s_add_u32 s51, s49, 21632
    buffer_load_dwordx4 v10, s[28:31], s51 offen lds
    s_waitcnt lgkmcnt(6)
    v_mfma_f32_16x16x32_bf16 v[56:59], v[16:19], v[216:219], v[56:59]
    ds_read_b64_tr_b16 v[12:13], v7 offset:32
    v_mfma_f32_16x16x32_bf16 v[60:63], v[16:19], v[220:223], v[60:63]
    ds_read_b64_tr_b16 v[14:15], v7 offset:1056
    s_waitcnt lgkmcnt(6)
    v_mfma_f32_16x16x32_bf16 v[64:67], v[20:23], v[216:219], v[64:67]
    v_mfma_f32_16x16x32_bf16 v[68:71], v[20:23], v[220:223], v[68:71]
    s_add_u32 m0, s53, 7168
    s_add_u32 s51, s49, 31872
    buffer_load_dwordx4 v11, s[28:31], s51 offen lds
    s_waitcnt lgkmcnt(4)
    v_mfma_f32_16x16x32_bf16 v[72:75], v[24:27], v[216:219], v[72:75]
    v_mfma_f32_16x16x32_bf16 v[76:79], v[24:27], v[220:223], v[76:79]
    s_waitcnt lgkmcnt(2)
    v_mfma_f32_16x16x32_bf16 v[80:83], v[28:31], v[216:219], v[80:83]
    v_mfma_f32_16x16x32_bf16 v[84:87], v[28:31], v[220:223], v[84:87]
    s_waitcnt lgkmcnt(0)
    v_mfma_f32_16x16x32_bf16 v[88:91], v[12:15], v[216:219], v[88:91]
    v_mfma_f32_16x16x32_bf16 v[92:95], v[12:15], v[220:223], v[92:95]
    s_waitcnt vmcnt(6)
    s_barrier
    ds_read_b128 v[224:227], v254 offset:0
    ds_read_b128 v[228:231], v254 offset:2048
    ds_read_b128 v[232:235], v255 offset:0
    ds_read_b128 v[236:239], v255 offset:2048
    ds_read_b64_tr_b16 v[12:13], v4 offset:8320
    ds_read_b64_tr_b16 v[14:15], v4 offset:9344
    ds_read_b64_tr_b16 v[16:17], v4 offset:8352
    ds_read_b64_tr_b16 v[18:19], v4 offset:9376
    ds_read_b64_tr_b16 v[20:21], v5 offset:8320
    ds_read_b64_tr_b16 v[22:23], v5 offset:9344
    ds_read_b64_tr_b16 v[24:25], v5 offset:8352
    ds_read_b64_tr_b16 v[26:27], v5 offset:9376
    s_waitcnt lgkmcnt(8)
    s_waitcnt lgkmcnt(6)
    v_mfma_f32_16x16x32_bf16 v[32:35], v[12:15], v[224:227], v[32:35]
    ds_read_b64_tr_b16 v[28:29], v6 offset:8320
    v_mfma_f32_16x16x32_bf16 v[36:39], v[12:15], v[228:231], v[36:39]
    ds_read_b64_tr_b16 v[30:31], v6 offset:9344
    s_add_u32 m0, s52, 33280
    s_add_u32 s51, s48, 4980736
    buffer_load_dwordx4 v8, s[32:35], s51 offen lds
    s_waitcnt lgkmcnt(6)
    v_mfma_f32_16x16x32_bf16 v[40:43], v[16:19], v[224:227], v[40:43]
    ds_read_b64_tr_b16 v[12:13], v6 offset:8352
    v_mfma_f32_16x16x32_bf16 v[44:47], v[16:19], v[228:231], v[44:47]
    ds_read_b64_tr_b16 v[14:15], v6 offset:9376
    s_waitcnt lgkmcnt(6)
    v_mfma_f32_16x16x32_bf16 v[48:51], v[20:23], v[224:227], v[48:51]
    ds_read_b64_tr_b16 v[16:17], v7 offset:8320
    v_mfma_f32_16x16x32_bf16 v[52:55], v[20:23], v[228:231], v[52:55]
    ds_read_b64_tr_b16 v[18:19], v7 offset:9344
    s_waitcnt lgkmcnt(6)
    v_mfma_f32_16x16x32_bf16 v[56:59], v[24:27], v[224:227], v[56:59]
    ds_read_b64_tr_b16 v[20:21], v7 offset:8352
    v_mfma_f32_16x16x32_bf16 v[60:63], v[24:27], v[228:231], v[60:63]
    ds_read_b64_tr_b16 v[22:23], v7 offset:9376
    s_waitcnt lgkmcnt(6)
    v_mfma_f32_16x16x32_bf16 v[64:67], v[28:31], v[224:227], v[64:67]
    ds_read_b64_tr_b16 v[24:25], v4 offset:16640
    v_mfma_f32_16x16x32_bf16 v[68:71], v[28:31], v[228:231], v[68:71]
    ds_read_b64_tr_b16 v[26:27], v4 offset:17664
    s_add_u32 m0, s52, 34304
    s_add_u32 s51, s48, 5013504
    buffer_load_dwordx4 v8, s[32:35], s51 offen lds
    s_waitcnt lgkmcnt(6)
    v_mfma_f32_16x16x32_bf16 v[72:75], v[12:15], v[224:227], v[72:75]
    ds_read_b64_tr_b16 v[28:29], v4 offset:16672
    v_mfma_f32_16x16x32_bf16 v[76:79], v[12:15], v[228:231], v[76:79]
    ds_read_b64_tr_b16 v[30:31], v4 offset:17696
    s_waitcnt lgkmcnt(6)
    v_mfma_f32_16x16x32_bf16 v[80:83], v[16:19], v[224:227], v[80:83]
    ds_read_b64_tr_b16 v[12:13], v5 offset:16640
    v_mfma_f32_16x16x32_bf16 v[84:87], v[16:19], v[228:231], v[84:87]
    ds_read_b64_tr_b16 v[14:15], v5 offset:17664
    s_waitcnt lgkmcnt(6)
    v_mfma_f32_16x16x32_bf16 v[88:91], v[20:23], v[224:227], v[88:91]
    ds_read_b64_tr_b16 v[16:17], v5 offset:16672
    v_mfma_f32_16x16x32_bf16 v[92:95], v[20:23], v[228:231], v[92:95]
    ds_read_b64_tr_b16 v[18:19], v5 offset:17696
    s_add_u32 m0, s52, 0
    s_add_u32 s51, s54, 0
    buffer_load_dwordx4 v8, s[32:35], s51 offen lds
    s_waitcnt lgkmcnt(6)
    v_mfma_f32_16x16x32_bf16 v[32:35], v[24:27], v[232:235], v[32:35]
    ds_read_b64_tr_b16 v[20:21], v6 offset:16640
    v_mfma_f32_16x16x32_bf16 v[36:39], v[24:27], v[236:239], v[36:39]
    ds_read_b64_tr_b16 v[22:23], v6 offset:17664
    s_waitcnt lgkmcnt(6)
    v_mfma_f32_16x16x32_bf16 v[40:43], v[28:31], v[232:235], v[40:43]
    ds_read_b64_tr_b16 v[24:25], v6 offset:16672
    v_mfma_f32_16x16x32_bf16 v[44:47], v[28:31], v[236:239], v[44:47]
    ds_read_b64_tr_b16 v[26:27], v6 offset:17696
    s_waitcnt lgkmcnt(6)
    v_mfma_f32_16x16x32_bf16 v[48:51], v[12:15], v[232:235], v[48:51]
    ds_read_b64_tr_b16 v[28:29], v7 offset:16640
    v_mfma_f32_16x16x32_bf16 v[52:55], v[12:15], v[236:239], v[52:55]
    ds_read_b64_tr_b16 v[30:31], v7 offset:17664
    s_add_u32 m0, s52, 1024
    s_add_u32 s51, s54, 32768
    buffer_load_dwordx4 v8, s[32:35], s51 offen lds
    s_waitcnt lgkmcnt(6)
    v_mfma_f32_16x16x32_bf16 v[56:59], v[16:19], v[232:235], v[56:59]
    ds_read_b64_tr_b16 v[12:13], v7 offset:16672
    v_mfma_f32_16x16x32_bf16 v[60:63], v[16:19], v[236:239], v[60:63]
    ds_read_b64_tr_b16 v[14:15], v7 offset:17696
    s_waitcnt lgkmcnt(6)
    v_mfma_f32_16x16x32_bf16 v[64:67], v[20:23], v[232:235], v[64:67]
    v_mfma_f32_16x16x32_bf16 v[68:71], v[20:23], v[236:239], v[68:71]
    s_waitcnt lgkmcnt(4)
    v_mfma_f32_16x16x32_bf16 v[72:75], v[24:27], v[232:235], v[72:75]
    v_mfma_f32_16x16x32_bf16 v[76:79], v[24:27], v[236:239], v[76:79]
    s_waitcnt lgkmcnt(2)
    v_mfma_f32_16x16x32_bf16 v[80:83], v[28:31], v[232:235], v[80:83]
    v_mfma_f32_16x16x32_bf16 v[84:87], v[28:31], v[236:239], v[84:87]
    s_waitcnt lgkmcnt(0)
    v_mfma_f32_16x16x32_bf16 v[88:91], v[12:15], v[232:235], v[88:91]
    v_mfma_f32_16x16x32_bf16 v[92:95], v[12:15], v[236:239], v[92:95]
    s_waitcnt vmcnt(2)
    s_barrier
    ds_read_b128 v[240:243], v254 offset:4096
    ds_read_b128 v[244:247], v254 offset:6144
    ds_read_b128 v[248:251], v255 offset:4096
    ds_read_b128 v[252:255], v255 offset:6144
    ds_read_b64_tr_b16 v[12:13], v4 offset:24960
    ds_read_b64_tr_b16 v[14:15], v4 offset:25984
    ds_read_b64_tr_b16 v[16:17], v4 offset:33280
    ds_read_b64_tr_b16 v[18:19], v4 offset:34304
    ds_read_b64_tr_b16 v[20:21], v4 offset:24992
    ds_read_b64_tr_b16 v[22:23], v4 offset:26016
    ds_read_b64_tr_b16 v[24:25], v4 offset:33312
    ds_read_b64_tr_b16 v[26:27], v4 offset:34336
    s_waitcnt lgkmcnt(8)
    s_waitcnt lgkmcnt(6)
    v_mfma_f32_16x16x32_bf16 v[32:35], v[12:15], v[240:243], v[32:35]
    ds_read_b64_tr_b16 v[28:29], v5 offset:24960
    v_mfma_f32_16x16x32_bf16 v[36:39], v[12:15], v[244:247], v[36:39]
    ds_read_b64_tr_b16 v[30:31], v5 offset:25984
    s_add_u32 m0, s52, 8320
    s_add_u32 s51, s54, 262144
    buffer_load_dwordx4 v8, s[32:35], s51 offen lds
    s_waitcnt lgkmcnt(6)
    v_mfma_f32_16x16x32_bf16 v[32:35], v[16:19], v[248:251], v[32:35]
    ds_read_b64_tr_b16 v[12:13], v5 offset:33280
    v_mfma_f32_16x16x32_bf16 v[36:39], v[16:19], v[252:255], v[36:39]
    ds_read_b64_tr_b16 v[14:15], v5 offset:34304
    s_waitcnt lgkmcnt(6)
    v_mfma_f32_16x16x32_bf16 v[40:43], v[20:23], v[240:243], v[40:43]
    ds_read_b64_tr_b16 v[16:17], v5 offset:24992
    v_mfma_f32_16x16x32_bf16 v[44:47], v[20:23], v[244:247], v[44:47]
    ds_read_b64_tr_b16 v[18:19], v5 offset:26016
    s_add_u32 m0, s52, 9344
    s_add_u32 s51, s54, 294912
    buffer_load_dwordx4 v8, s[32:35], s51 offen lds
    s_waitcnt lgkmcnt(6)
    v_mfma_f32_16x16x32_bf16 v[40:43], v[24:27], v[248:251], v[40:43]
    ds_read_b64_tr_b16 v[20:21], v5 offset:33312
    v_mfma_f32_16x16x32_bf16 v[44:47], v[24:27], v[252:255], v[44:47]
    ds_read_b64_tr_b16 v[22:23], v5 offset:34336
    s_waitcnt lgkmcnt(6)
    v_mfma_f32_16x16x32_bf16 v[48:51], v[28:31], v[240:243], v[48:51]
    ds_read_b64_tr_b16 v[24:25], v6 offset:24960
    v_mfma_f32_16x16x32_bf16 v[52:55], v[28:31], v[244:247], v[52:55]
    ds_read_b64_tr_b16 v[26:27], v6 offset:25984
    s_add_u32 m0, s52, 16640
    s_add_u32 s51, s54, 524288
    buffer_load_dwordx4 v8, s[32:35], s51 offen lds
    v_mul_f32 v32, s56, v32
    v_mul_f32 v33, s56, v33
    v_mul_f32 v34, s56, v34
    v_mul_f32 v35, s56, v35
    v_cvt_pk_bf16_f32 v32, v32, v33
    v_cvt_pk_bf16_f32 v33, v34, v35
    ds_write_b64 v9, v[32:33] offset:0
    v_mul_f32 v36, s56, v36
    v_mul_f32 v37, s56, v37
    v_mul_f32 v38, s56, v38
    v_mul_f32 v39, s56, v39
    v_cvt_pk_bf16_f32 v36, v36, v37
    v_cvt_pk_bf16_f32 v37, v38, v39
    ds_write_b64 v9, v[36:37] offset:4096
    s_waitcnt lgkmcnt(8)
    v_mfma_f32_16x16x32_bf16 v[48:51], v[12:15], v[248:251], v[48:51]
    ds_read_b64_tr_b16 v[28:29], v6 offset:33280
    v_mfma_f32_16x16x32_bf16 v[52:55], v[12:15], v[252:255], v[52:55]
    ds_read_b64_tr_b16 v[30:31], v6 offset:34304
    s_add_u32 m0, s52, 17664
    s_add_u32 s51, s54, 557056
    buffer_load_dwordx4 v8, s[32:35], s51 offen lds
    s_waitcnt lgkmcnt(8)
    v_mfma_f32_16x16x32_bf16 v[56:59], v[16:19], v[240:243], v[56:59]
    ds_read_b64_tr_b16 v[12:13], v6 offset:24992
    v_mfma_f32_16x16x32_bf16 v[60:63], v[16:19], v[244:247], v[60:63]
    ds_read_b64_tr_b16 v[14:15], v6 offset:26016
    v_mul_f32 v40, s56, v40
    v_mul_f32 v41, s56, v41
    v_mul_f32 v42, s56, v42
    v_mul_f32 v43, s56, v43
    v_cvt_pk_bf16_f32 v40, v40, v41
    v_cvt_pk_bf16_f32 v41, v42, v43
    ds_write_b64 v9, v[40:41] offset:512
    v_mul_f32 v44, s56, v44
    v_mul_f32 v45, s56, v45
    v_mul_f32 v46, s56, v46
    v_mul_f32 v47, s56, v47
    v_cvt_pk_bf16_f32 v44, v44, v45
    v_cvt_pk_bf16_f32 v45, v46, v47
    ds_write_b64 v9, v[44:45] offset:4608
    s_waitcnt lgkmcnt(10)
    v_mfma_f32_16x16x32_bf16 v[56:59], v[20:23], v[248:251], v[56:59]
    ds_read_b64_tr_b16 v[16:17], v6 offset:33312
    v_mfma_f32_16x16x32_bf16 v[60:63], v[20:23], v[252:255], v[60:63]
    ds_read_b64_tr_b16 v[18:19], v6 offset:34336
    s_add_u32 m0, s67, 16896
    s_add_u32 s63, s61, 16384
    buffer_load_dwordx4 v2, s[20:23], s63 offen offset:0 nt lds
    s_waitcnt lgkmcnt(10)
    v_mfma_f32_16x16x32_bf16 v[64:67], v[24:27], v[240:243], v[64:67]
    ds_read_b64_tr_b16 v[20:21], v7 offset:24960
    v_mfma_f32_16x16x32_bf16 v[68:71], v[24:27], v[244:247], v[68:71]
    ds_read_b64_tr_b16 v[22:23], v7 offset:25984
    s_add_u32 m0, s67, 16896
    s_add_u32 s63, s61, 16384
    buffer_load_dwordx4 v2, s[20:23], s63 offen offset:1024 nt lds
    v_mul_f32 v48, s56, v48
    v_mul_f32 v49, s56, v49
    v_mul_f32 v50, s56, v50
    v_mul_f32 v51, s56, v51
    v_cvt_pk_bf16_f32 v48, v48, v49
    v_cvt_pk_bf16_f32 v49, v50, v51
    ds_write_b64 v9, v[48:49] offset:1024
    v_mul_f32 v52, s56, v52
    v_mul_f32 v53, s56, v53
    v_mul_f32 v54, s56, v54
    v_mul_f32 v55, s56, v55
    v_cvt_pk_bf16_f32 v52, v52, v53
    v_cvt_pk_bf16_f32 v53, v54, v55
    ds_write_b64 v9, v[52:53] offset:5120
    s_waitcnt lgkmcnt(10)
    v_mfma_f32_16x16x32_bf16 v[64:67], v[28:31], v[248:251], v[64:67]
    ds_read_b64_tr_b16 v[24:25], v7 offset:33280
    v_mfma_f32_16x16x32_bf16 v[68:71], v[28:31], v[252:255], v[68:71]
    ds_read_b64_tr_b16 v[26:27], v7 offset:34304
    s_waitcnt lgkmcnt(10)
    v_mfma_f32_16x16x32_bf16 v[72:75], v[12:15], v[240:243], v[72:75]
    ds_read_b64_tr_b16 v[28:29], v7 offset:24992
    v_mfma_f32_16x16x32_bf16 v[76:79], v[12:15], v[244:247], v[76:79]
    ds_read_b64_tr_b16 v[30:31], v7 offset:26016
    s_add_u32 m0, s67, 16928
    s_add_u32 s63, s61, 16384
    buffer_load_dwordx4 v2, s[20:23], s63 offen offset:2048 nt lds
    v_mul_f32 v56, s56, v56
    v_mul_f32 v57, s56, v57
    v_mul_f32 v58, s56, v58
    v_mul_f32 v59, s56, v59
    v_cvt_pk_bf16_f32 v56, v56, v57
    v_cvt_pk_bf16_f32 v57, v58, v59
    ds_write_b64 v9, v[56:57] offset:1536
    v_mul_f32 v60, s56, v60
    v_mul_f32 v61, s56, v61
    v_mul_f32 v62, s56, v62
    v_mul_f32 v63, s56, v63
    v_cvt_pk_bf16_f32 v60, v60, v61
    v_cvt_pk_bf16_f32 v61, v62, v63
    ds_write_b64 v9, v[60:61] offset:5632
    s_waitcnt lgkmcnt(10)
    v_mfma_f32_16x16x32_bf16 v[72:75], v[16:19], v[248:251], v[72:75]
    ds_read_b64_tr_b16 v[12:13], v7 offset:33312
    v_mfma_f32_16x16x32_bf16 v[76:79], v[16:19], v[252:255], v[76:79]
    ds_read_b64_tr_b16 v[14:15], v7 offset:34336
    s_waitcnt lgkmcnt(10)
    v_mfma_f32_16x16x32_bf16 v[80:83], v[20:23], v[240:243], v[80:83]
    v_mfma_f32_16x16x32_bf16 v[84:87], v[20:23], v[244:247], v[84:87]
    s_add_u32 m0, s67, 16928
    s_add_u32 s63, s61, 16384
    buffer_load_dwordx4 v2, s[20:23], s63 offen offset:3072 nt lds
    v_mul_f32 v64, s56, v64
    v_mul_f32 v65, s56, v65
    v_mul_f32 v66, s56, v66
    v_mul_f32 v67, s56, v67
    v_cvt_pk_bf16_f32 v64, v64, v65
    v_cvt_pk_bf16_f32 v65, v66, v67
    ds_write_b64 v9, v[64:65] offset:2048
    v_mul_f32 v68, s56, v68
    v_mul_f32 v69, s56, v69
    v_mul_f32 v70, s56, v70
    v_mul_f32 v71, s56, v71
    v_cvt_pk_bf16_f32 v68, v68, v69
    v_cvt_pk_bf16_f32 v69, v70, v71
    ds_write_b64 v9, v[68:69] offset:6144
    s_waitcnt lgkmcnt(8)
    v_mfma_f32_16x16x32_bf16 v[80:83], v[24:27], v[248:251], v[80:83]
    v_mfma_f32_16x16x32_bf16 v[84:87], v[24:27], v[252:255], v[84:87]
    s_waitcnt lgkmcnt(6)
    v_mfma_f32_16x16x32_bf16 v[88:91], v[28:31], v[240:243], v[88:91]
    v_mfma_f32_16x16x32_bf16 v[92:95], v[28:31], v[244:247], v[92:95]
    v_mul_f32 v72, s56, v72
    v_mul_f32 v73, s56, v73
    v_mul_f32 v74, s56, v74
    v_mul_f32 v75, s56, v75
    v_cvt_pk_bf16_f32 v72, v72, v73
    v_cvt_pk_bf16_f32 v73, v74, v75
    ds_write_b64 v9, v[72:73] offset:2560
    v_mul_f32 v76, s56, v76
    v_mul_f32 v77, s56, v77
    v_mul_f32 v78, s56, v78
    v_mul_f32 v79, s56, v79
    v_cvt_pk_bf16_f32 v76, v76, v77
    v_cvt_pk_bf16_f32 v77, v78, v79
    ds_write_b64 v9, v[76:77] offset:6656
    s_waitcnt lgkmcnt(4)
    v_mfma_f32_16x16x32_bf16 v[88:91], v[12:15], v[248:251], v[88:91]
    v_mfma_f32_16x16x32_bf16 v[92:95], v[12:15], v[252:255], v[92:95]
    s_nop 7
    v_mul_f32 v80, s56, v80
    v_mul_f32 v81, s56, v81
    v_mul_f32 v82, s56, v82
    v_mul_f32 v83, s56, v83
    v_cvt_pk_bf16_f32 v80, v80, v81
    v_cvt_pk_bf16_f32 v81, v82, v83
    ds_write_b64 v9, v[80:81] offset:3072
    v_mul_f32 v84, s56, v84
    v_mul_f32 v85, s56, v85
    v_mul_f32 v86, s56, v86
    v_mul_f32 v87, s56, v87
    v_cvt_pk_bf16_f32 v84, v84, v85
    v_cvt_pk_bf16_f32 v85, v86, v87
    ds_write_b64 v9, v[84:85] offset:7168
    v_mul_f32 v88, s56, v88
    v_mul_f32 v89, s56, v89
    v_mul_f32 v90, s56, v90
    v_mul_f32 v91, s56, v91
    v_cvt_pk_bf16_f32 v88, v88, v89
    v_cvt_pk_bf16_f32 v89, v90, v91
    ds_write_b64 v9, v[88:89] offset:3584
    v_mul_f32 v92, s56, v92
    v_mul_f32 v93, s56, v93
    v_mul_f32 v94, s56, v94
    v_mul_f32 v95, s56, v95
    v_cvt_pk_bf16_f32 v92, v92, v93
    v_cvt_pk_bf16_f32 v93, v94, v95
    ds_write_b64 v9, v[92:93] offset:7680
    s_waitcnt lgkmcnt(0)
    s_add_u32 s50, s50, 1
    s_mov_b32 s48, s54
    s_add_u32 s54, s50, s59
    s_add_u32 s54, s54, 1
    s_and_b32 s54, s54, 3
    s_lshl_b32 s54, s54, 2
    s_add_u32 s54, s54, s58
    s_add_u32 s51, s50, 1
    s_and_b32 s51, s51, 3
    s_add_u32 s51, s51, s45
    s_and_b32 s51, s51, 3
    s_add_u32 s54, s54, s51
    s_lshl_b32 s54, s54, 8
    s_cmp_ge_u32 s50, 3
    s_cselect_b32 s54, 1073741824, s54
    s_waitcnt vmcnt(6)
L_rounda:
    s_waitcnt vmcnt(10)
    s_barrier
    ds_read_b64_tr_b16 v[12:13], v4 offset:0
    ds_read_b64_tr_b16 v[14:15], v4 offset:1024
    ds_read_b64_tr_b16 v[16:17], v4 offset:32
    ds_read_b64_tr_b16 v[18:19], v4 offset:1056
    ds_read_b64_tr_b16 v[20:21], v5 offset:0
    ds_read_b64_tr_b16 v[22:23], v5 offset:1024
    ds_read_b64_tr_b16 v[24:25], v5 offset:32
    ds_read_b64_tr_b16 v[26:27], v5 offset:1056
    s_waitcnt lgkmcnt(6)
    v_mfma_f32_16x16x32_bf16 v[32:35], v[12:15], v[96:99], 0
    ds_read_b64_tr_b16 v[28:29], v6 offset:0
    v_mfma_f32_16x16x32_bf16 v[36:39], v[12:15], v[100:103], 0
    ds_read_b64_tr_b16 v[30:31], v6 offset:1024
    s_add_u32 m0, s52, 24960
    s_add_u32 s51, s48, 786432
    buffer_load_dwordx4 v8, s[32:35], s51 offen lds
    s_waitcnt lgkmcnt(6)
    v_mfma_f32_16x16x32_bf16 v[40:43], v[16:19], v[96:99], 0
    ds_read_b64_tr_b16 v[12:13], v6 offset:32
    v_mfma_f32_16x16x32_bf16 v[44:47], v[16:19], v[100:103], 0
    ds_read_b64_tr_b16 v[14:15], v6 offset:1056
    s_add_u32 m0, s52, 25984
    s_add_u32 s51, s48, 819200
    buffer_load_dwordx4 v8, s[32:35], s51 offen lds
    s_waitcnt lgkmcnt(6)
    v_mfma_f32_16x16x32_bf16 v[48:51], v[20:23], v[96:99], 0
    ds_read_b64_tr_b16 v[16:17], v7 offset:0
    v_mfma_f32_16x16x32_bf16 v[52:55], v[20:23], v[100:103], 0
    ds_read_b64_tr_b16 v[18:19], v7 offset:1024
    s_add_u32 m0, s52, 33280
    s_add_u32 s51, s48, 1048576
    buffer_load_dwordx4 v8, s[32:35], s51 offen lds
    s_waitcnt lgkmcnt(6)
    v_mfma_f32_16x16x32_bf16 v[56:59], v[24:27], v[96:99], 0
    ds_read_b64_tr_b16 v[20:21], v7 offset:32
    v_mfma_f32_16x16x32_bf16 v[60:63], v[24:27], v[100:103], 0
    ds_read_b64_tr_b16 v[22:23], v7 offset:1056
    s_add_u32 m0, s52, 34304
    s_add_u32 s51, s48, 1081344
    buffer_load_dwordx4 v8, s[32:35], s51 offen lds
    s_waitcnt lgkmcnt(6)
    v_mfma_f32_16x16x32_bf16 v[64:67], v[28:31], v[96:99], 0
    ds_read_b64_tr_b16 v[24:25], v4 offset:8320
    v_mfma_f32_16x16x32_bf16 v[68:71], v[28:31], v[100:103], 0
    ds_read_b64_tr_b16 v[26:27], v4 offset:9344
    s_add_u32 m0, s68, 33792
    s_add_u32 s63, s61, 0
    buffer_load_dwordx4 v2, s[24:27], s63 offen offset:0 nt lds
    s_waitcnt lgkmcnt(6)
    v_mfma_f32_16x16x32_bf16 v[72:75], v[12:15], v[96:99], 0
    ds_read_b64_tr_b16 v[28:29], v4 offset:8352
    v_mfma_f32_16x16x32_bf16 v[76:79], v[12:15], v[100:103], 0
    ds_read_b64_tr_b16 v[30:31], v4 offset:9376
    s_add_u32 m0, s68, 33824
    s_add_u32 s63, s61, 0
    buffer_load_dwordx4 v2, s[24:27], s63 offen offset:1024 nt lds
    s_waitcnt lgkmcnt(6)
    v_mfma_f32_16x16x32_bf16 v[80:83], v[16:19], v[96:99], 0
    v_mfma_f32_16x16x32_bf16 v[84:87], v[16:19], v[100:103], 0
    s_add_u32 m0, s68, 33856
    s_add_u32 s63, s61, 0
    buffer_load_dwordx4 v2, s[24:27], s63 offen offset:2048 nt lds
    s_waitcnt lgkmcnt(4)
    v_mfma_f32_16x16x32_bf16 v[88:91], v[20:23], v[96:99], 0
    v_mfma_f32_16x16x32_bf16 v[92:95], v[20:23], v[100:103], 0
    s_add_u32 m0, s68, 33888
    s_add_u32 s63, s61, 0
    buffer_load_dwordx4 v2, s[24:27], s63 offen offset:3072 nt lds
    s_waitcnt lgkmcnt(2)
    v_mfma_f32_16x16x32_bf16 v[32:35], v[24:27], v[104:107], v[32:35]
    v_mfma_f32_16x16x32_bf16 v[36:39], v[24:27], v[108:111], v[36:39]
    s_waitcnt lgkmcnt(0)
    v_mfma_f32_16x16x32_bf16 v[40:43], v[28:31], v[104:107], v[40:43]
    v_mfma_f32_16x16x32_bf16 v[44:47], v[28:31], v[108:111], v[44:47]
    s_waitcnt vmcnt(12)
    s_barrier
    ds_read_b64_tr_b16 v[12:13], v5 offset:8320
    ds_read_b64_tr_b16 v[14:15], v5 offset:9344
    ds_read_b64_tr_b16 v[16:17], v5 offset:8352
    ds_read_b64_tr_b16 v[18:19], v5 offset:9376
    ds_read_b64_tr_b16 v[20:21], v6 offset:8320
    ds_read_b64_tr_b16 v[22:23], v6 offset:9344
    ds_read_b64_tr_b16 v[24:25], v6 offset:8352
    ds_read_b64_tr_b16 v[26:27], v6 offset:9376
    s_waitcnt lgkmcnt(6)
    v_mfma_f32_16x16x32_bf16 v[48:51], v[12:15], v[104:107], v[48:51]
    ds_read_b64_tr_b16 v[28:29], v7 offset:8320
    v_mfma_f32_16x16x32_bf16 v[52:55], v[12:15], v[108:111], v[52:55]
    ds_read_b64_tr_b16 v[30:31], v7 offset:9344
    s_add_u32 m0, s52, 0
    s_add_u32 s51, s48, 1310720
    buffer_load_dwordx4 v8, s[32:35], s51 offen lds
    s_waitcnt lgkmcnt(6)
    v_mfma_f32_16x16x32_bf16 v[56:59], v[16:19], v[104:107], v[56:59]
    ds_read_b64_tr_b16 v[12:13], v7 offset:8352
    v_mfma_f32_16x16x32_bf16 v[60:63], v[16:19], v[108:111], v[60:63]
    ds_read_b64_tr_b16 v[14:15], v7 offset:9376
    s_waitcnt lgkmcnt(6)
    v_mfma_f32_16x16x32_bf16 v[64:67], v[20:23], v[104:107], v[64:67]
    ds_read_b64_tr_b16 v[16:17], v4 offset:16640
    v_mfma_f32_16x16x32_bf16 v[68:71], v[20:23], v[108:111], v[68:71]
    ds_read_b64_tr_b16 v[18:19], v4 offset:17664
    s_add_u32 m0, s52, 1024
    s_add_u32 s51, s48, 1343488
    buffer_load_dwordx4 v8, s[32:35], s51 offen lds
    s_waitcnt lgkmcnt(6)
    v_mfma_f32_16x16x32_bf16 v[72:75], v[24:27], v[104:107], v[72:75]
    ds_read_b64_tr_b16 v[20:21], v4 offset:16672
    v_mfma_f32_16x16x32_bf16 v[76:79], v[24:27], v[108:111], v[76:79]
    ds_read_b64_tr_b16 v[22:23], v4 offset:17696
    s_add_u32 m0, s67, 50688
    s_add_u32 s63, s61, 32768
    buffer_load_dwordx4 v2, s[20:23], s63 offen offset:0 nt lds
    s_waitcnt lgkmcnt(6)
    v_mfma_f32_16x16x32_bf16 v[80:83], v[28:31], v[104:107], v[80:83]
    ds_read_b64_tr_b16 v[24:25], v5 offset:16640
    v_mfma_f32_16x16x32_bf16 v[84:87], v[28:31], v[108:111], v[84:87]
    ds_read_b64_tr_b16 v[26:27], v5 offset:17664
    s_add_u32 m0, s67, 50688
    s_add_u32 s63, s61, 32768
    buffer_load_dwordx4 v2, s[20:23], s63 offen offset:1024 nt lds
    s_waitcnt lgkmcnt(6)
    v_mfma_f32_16x16x32_bf16 v[88:91], v[12:15], v[104:107], v[88:91]
    ds_read_b64_tr_b16 v[28:29], v5 offset:16672
    v_mfma_f32_16x16x32_bf16 v[92:95], v[12:15], v[108:111], v[92:95]
    ds_read_b64_tr_b16 v[30:31], v5 offset:17696
    s_waitcnt lgkmcnt(6)
    v_mfma_f32_16x16x32_bf16 v[32:35], v[16:19], v[112:115], v[32:35]
    v_mfma_f32_16x16x32_bf16 v[36:39], v[16:19], v[116:119], v[36:39]
    s_add_u32 m0, s67, 50720
    s_add_u32 s63, s61, 32768
    buffer_load_dwordx4 v2, s[20:23], s63 offen offset:2048 nt lds
    s_waitcnt lgkmcnt(4)
    v_mfma_f32_16x16x32_bf16 v[40:43], v[20:23], v[112:115], v[40:43]
    v_mfma_f32_16x16x32_bf16 v[44:47], v[20:23], v[116:119], v[44:47]
    s_add_u32 m0, s67, 50720
    s_add_u32 s63, s61, 32768
    buffer_load_dwordx4 v2, s[20:23], s63 offen offset:3072 nt lds
    s_waitcnt lgkmcnt(2)
    v_mfma_f32_16x16x32_bf16 v[48:51], v[24:27], v[112:115], v[48:51]
    v_mfma_f32_16x16x32_bf16 v[52:55], v[24:27], v[116:119], v[52:55]
    s_waitcnt lgkmcnt(0)
    v_mfma_f32_16x16x32_bf16 v[56:59], v[28:31], v[112:115], v[56:59]
    v_mfma_f32_16x16x32_bf16 v[60:63], v[28:31], v[116:119], v[60:63]
    s_waitcnt vmcnt(12)
    s_barrier
    s_add_u32 s62, s62, 1
    s_add_u32 s60, s62, s59
    s_and_b32 s60, s60, 3
    s_lshl_b32 s60, s60, 2
    s_add_u32 s60, s60, s58
    s_add_u32 s51, s62, 0
    s_and_b32 s51, s51, 3
    s_add_u32 s51, s51, s45
    s_and_b32 s51, s51, 3
    s_add_u32 s60, s60, s51
    s_lshl_b32 s63, s44, 5
    s_add_u32 s60, s60, s63
    s_lshl_b32 s60, s60, 17
    s_add_u32 s61, s62, s59
    s_add_u32 s61, s61, 1
    s_and_b32 s61, s61, 3
    s_lshl_b32 s61, s61, 2
    s_add_u32 s61, s61, s58
    s_add_u32 s51, s62, 1
    s_and_b32 s51, s51, 3
    s_add_u32 s51, s51, s45
    s_and_b32 s51, s51, 3
    s_add_u32 s61, s61, s51
    s_add_u32 s61, s61, s63
    s_lshl_b32 s61, s61, 17
    s_cmp_eq_u32 s62, 3
    s_cselect_b32 s61, 1073741824, s61
    ds_read_b64_tr_b16 v[12:13], v6 offset:16640
    ds_read_b64_tr_b16 v[14:15], v6 offset:17664
    ds_read_b64_tr_b16 v[16:17], v6 offset:16672
    ds_read_b64_tr_b16 v[18:19], v6 offset:17696
    ds_read_b64_tr_b16 v[20:21], v7 offset:16640
    ds_read_b64_tr_b16 v[22:23], v7 offset:17664
    ds_read_b64_tr_b16 v[24:25], v7 offset:16672
    ds_read_b64_tr_b16 v[26:27], v7 offset:17696
    s_waitcnt lgkmcnt(6)
    v_mfma_f32_16x16x32_bf16 v[64:67], v[12:15], v[112:115], v[64:67]
    ds_read_b64_tr_b16 v[28:29], v4 offset:24960
    v_mfma_f32_16x16x32_bf16 v[68:71], v[12:15], v[116:119], v[68:71]
    ds_read_b64_tr_b16 v[30:31], v4 offset:25984
    s_add_u32 m0, s52, 8320
    s_add_u32 s51, s48, 1572864
    buffer_load_dwordx4 v8, s[32:35], s51 offen lds
    s_waitcnt lgkmcnt(6)
    v_mfma_f32_16x16x32_bf16 v[72:75], v[16:19], v[112:115], v[72:75]
    ds_read_b64_tr_b16 v[12:13], v4 offset:24992
    v_mfma_f32_16x16x32_bf16 v[76:79], v[16:19], v[116:119], v[76:79]
    ds_read_b64_tr_b16 v[14:15], v4 offset:26016
    s_waitcnt lgkmcnt(6)
    v_mfma_f32_16x16x32_bf16 v[80:83], v[20:23], v[112:115], v[80:83]
    ds_read_b64_tr_b16 v[16:17], v5 offset:24960
    v_mfma_f32_16x16x32_bf16 v[84:87], v[20:23], v[116:119], v[84:87]
    ds_read_b64_tr_b16 v[18:19], v5 offset:25984
    s_add_u32 m0, s52, 9344
    s_add_u32 s51, s48, 1605632
    buffer_load_dwordx4 v8, s[32:35], s51 offen lds
    s_waitcnt lgkmcnt(6)
    v_mfma_f32_16x16x32_bf16 v[88:91], v[24:27], v[112:115], v[88:91]
    ds_read_b64_tr_b16 v[20:21], v5 offset:24992
    v_mfma_f32_16x16x32_bf16 v[92:95], v[24:27], v[116:119], v[92:95]
    ds_read_b64_tr_b16 v[22:23], v5 offset:26016
    s_add_u32 m0, s68, 0
    s_add_u32 s63, s60, 16384
    buffer_load_dwordx4 v2, s[24:27], s63 offen offset:0 nt lds
    s_waitcnt lgkmcnt(6)
    v_mfma_f32_16x16x32_bf16 v[32:35], v[28:31], v[120:123], v[32:35]
    ds_read_b64_tr_b16 v[24:25], v6 offset:24960
    v_mfma_f32_16x16x32_bf16 v[36:39], v[28:31], v[124:127], v[36:39]
    ds_read_b64_tr_b16 v[26:27], v6 offset:25984
    s_add_u32 m0, s68, 32
    s_add_u32 s63, s60, 16384
    buffer_load_dwordx4 v2, s[24:27], s63 offen offset:1024 nt lds
    s_waitcnt lgkmcnt(6)
    v_mfma_f32_16x16x32_bf16 v[40:43], v[12:15], v[120:123], v[40:43]
    ds_read_b64_tr_b16 v[28:29], v6 offset:24992
    v_mfma_f32_16x16x32_bf16 v[44:47], v[12:15], v[124:127], v[44:47]
    ds_read_b64_tr_b16 v[30:31], v6 offset:26016
    s_waitcnt lgkmcnt(6)
    v_mfma_f32_16x16x32_bf16 v[48:51], v[16:19], v[120:123], v[48:51]
    v_mfma_f32_16x16x32_bf16 v[52:55], v[16:19], v[124:127], v[52:55]
    s_add_u32 m0, s68, 64
    s_add_u32 s63, s60, 16384
    buffer_load_dwordx4 v2, s[24:27], s63 offen offset:2048 nt lds
    s_waitcnt lgkmcnt(4)
    v_mfma_f32_16x16x32_bf16 v[56:59], v[20:23], v[120:123], v[56:59]
    v_mfma_f32_16x16x32_bf16 v[60:63], v[20:23], v[124:127], v[60:63]
    s_add_u32 m0, s68, 96
    s_add_u32 s63, s60, 16384
    buffer_load_dwordx4 v2, s[24:27], s63 offen offset:3072 nt lds
    s_waitcnt lgkmcnt(2)
    v_mfma_f32_16x16x32_bf16 v[64:67], v[24:27], v[120:123], v[64:67]
    v_mfma_f32_16x16x32_bf16 v[68:71], v[24:27], v[124:127], v[68:71]
    s_waitcnt lgkmcnt(0)
    v_mfma_f32_16x16x32_bf16 v[72:75], v[28:31], v[120:123], v[72:75]
    v_mfma_f32_16x16x32_bf16 v[76:79], v[28:31], v[124:127], v[76:79]
    s_waitcnt vmcnt(12)
    s_barrier
    ds_read_b64_tr_b16 v[12:13], v7 offset:24960
    ds_read_b64_tr_b16 v[14:15], v7 offset:25984
    ds_read_b64_tr_b16 v[16:17], v7 offset:24992
    ds_read_b64_tr_b16 v[18:19], v7 offset:26016
    ds_read_b64_tr_b16 v[20:21], v4 offset:33280
    ds_read_b64_tr_b16 v[22:23], v4 offset:34304
    ds_read_b64_tr_b16 v[24:25], v4 offset:33312
    ds_read_b64_tr_b16 v[26:27], v4 offset:34336
    s_waitcnt lgkmcnt(6)
    v_mfma_f32_16x16x32_bf16 v[80:83], v[12:15], v[120:123], v[80:83]
    ds_read_b64_tr_b16 v[28:29], v5 offset:33280
    v_mfma_f32_16x16x32_bf16 v[84:87], v[12:15], v[124:127], v[84:87]
    ds_read_b64_tr_b16 v[30:31], v5 offset:34304
    s_add_u32 m0, s52, 16640
    s_add_u32 s51, s48, 1835008
    buffer_load_dwordx4 v8, s[32:35], s51 offen lds
    s_waitcnt lgkmcnt(6)
    v_mfma_f32_16x16x32_bf16 v[88:91], v[16:19], v[120:123], v[88:91]
    ds_read_b64_tr_b16 v[12:13], v5 offset:33312
    v_mfma_f32_16x16x32_bf16 v[92:95], v[16:19], v[124:127], v[92:95]
    ds_read_b64_tr_b16 v[14:15], v5 offset:34336
    s_waitcnt lgkmcnt(6)
    v_mfma_f32_16x16x32_bf16 v[32:35], v[20:23], v[128:131], v[32:35]
    ds_read_b64_tr_b16 v[16:17], v6 offset:33280
    v_mfma_f32_16x16x32_bf16 v[36:39], v[20:23], v[132:135], v[36:39]
    ds_read_b64_tr_b16 v[18:19], v6 offset:34304
    s_add_u32 m0, s52, 17664
    s_add_u32 s51, s48, 1867776
    buffer_load_dwordx4 v8, s[32:35], s51 offen lds
    s_waitcnt lgkmcnt(6)
    v_mfma_f32_16x16x32_bf16 v[40:43], v[24:27], v[128:131], v[40:43]
    ds_read_b64_tr_b16 v[20:21], v6 offset:33312
    v_mfma_f32_16x16x32_bf16 v[44:47], v[24:27], v[132:135], v[44:47]
    ds_read_b64_tr_b16 v[22:23], v6 offset:34336
    s_add_u32 m0, s67, 16896
    s_add_u32 s63, s60, 49152
    buffer_load_dwordx4 v2, s[20:23], s63 offen offset:0 nt lds
    s_waitcnt lgkmcnt(6)
    v_mfma_f32_16x16x32_bf16 v[48:51], v[28:31], v[128:131], v[48:51]
    ds_read_b64_tr_b16 v[24:25], v7 offset:33280
    v_mfma_f32_16x16x32_bf16 v[52:55], v[28:31], v[132:135], v[52:55]
    ds_read_b64_tr_b16 v[26:27], v7 offset:34304
    s_add_u32 m0, s67, 16896
    s_add_u32 s63, s60, 49152
    buffer_load_dwordx4 v2, s[20:23], s63 offen offset:1024 nt lds
    s_waitcnt lgkmcnt(6)
    v_mfma_f32_16x16x32_bf16 v[56:59], v[12:15], v[128:131], v[56:59]
    ds_read_b64_tr_b16 v[28:29], v7 offset:33312
    v_mfma_f32_16x16x32_bf16 v[60:63], v[12:15], v[132:135], v[60:63]
    ds_read_b64_tr_b16 v[30:31], v7 offset:34336
    s_waitcnt lgkmcnt(6)
    v_mfma_f32_16x16x32_bf16 v[64:67], v[16:19], v[128:131], v[64:67]
    v_mfma_f32_16x16x32_bf16 v[68:71], v[16:19], v[132:135], v[68:71]
    s_add_u32 m0, s67, 16928
    s_add_u32 s63, s60, 49152
    buffer_load_dwordx4 v2, s[20:23], s63 offen offset:2048 nt lds
    s_waitcnt lgkmcnt(4)
    v_mfma_f32_16x16x32_bf16 v[72:75], v[20:23], v[128:131], v[72:75]
    v_mfma_f32_16x16x32_bf16 v[76:79], v[20:23], v[132:135], v[76:79]
    s_add_u32 m0, s67, 16928
    s_add_u32 s63, s60, 49152
    buffer_load_dwordx4 v2, s[20:23], s63 offen offset:3072 nt lds
    s_waitcnt lgkmcnt(2)
    v_mfma_f32_16x16x32_bf16 v[80:83], v[24:27], v[128:131], v[80:83]
    v_mfma_f32_16x16x32_bf16 v[84:87], v[24:27], v[132:135], v[84:87]
    s_waitcnt lgkmcnt(0)
    v_mfma_f32_16x16x32_bf16 v[88:91], v[28:31], v[128:131], v[88:91]
    v_mfma_f32_16x16x32_bf16 v[92:95], v[28:31], v[132:135], v[92:95]
    s_waitcnt vmcnt(10)
    s_barrier
    ds_read_b64_tr_b16 v[12:13], v4 offset:0
    ds_read_b64_tr_b16 v[14:15], v4 offset:1024
    ds_read_b64_tr_b16 v[16:17], v4 offset:32
    ds_read_b64_tr_b16 v[18:19], v4 offset:1056
    ds_read_b64_tr_b16 v[20:21], v5 offset:0
    ds_read_b64_tr_b16 v[22:23], v5 offset:1024
    ds_read_b64_tr_b16 v[24:25], v5 offset:32
    ds_read_b64_tr_b16 v[26:27], v5 offset:1056
    s_waitcnt lgkmcnt(6)
    v_mfma_f32_16x16x32_bf16 v[32:35], v[12:15], v[136:139], v[32:35]
    ds_read_b64_tr_b16 v[28:29], v6 offset:0
    v_mfma_f32_16x16x32_bf16 v[36:39], v[12:15], v[140:143], v[36:39]
    ds_read_b64_tr_b16 v[30:31], v6 offset:1024
    s_add_u32 m0, s52, 24960
    s_add_u32 s51, s48, 2097152
    buffer_load_dwordx4 v8, s[32:35], s51 offen lds
    s_waitcnt lgkmcnt(6)
    v_mfma_f32_16x16x32_bf16 v[40:43], v[16:19], v[136:139], v[40:43]
    ds_read_b64_tr_b16 v[12:13], v6 offset:32
    v_mfma_f32_16x16x32_bf16 v[44:47], v[16:19], v[140:143], v[44:47]
    ds_read_b64_tr_b16 v[14:15], v6 offset:1056
    s_add_u32 m0, s52, 25984
    s_add_u32 s51, s48, 2129920
    buffer_load_dwordx4 v8, s[32:35], s51 offen lds
    s_waitcnt lgkmcnt(6)
    v_mfma_f32_16x16x32_bf16 v[48:51], v[20:23], v[136:139], v[48:51]
    ds_read_b64_tr_b16 v[16:17], v7 offset:0
    v_mfma_f32_16x16x32_bf16 v[52:55], v[20:23], v[140:143], v[52:55]
    ds_read_b64_tr_b16 v[18:19], v7 offset:1024
    s_add_u32 m0, s52, 33280
    s_add_u32 s51, s48, 2359296
    buffer_load_dwordx4 v8, s[32:35], s51 offen lds
    s_waitcnt lgkmcnt(6)
    v_mfma_f32_16x16x32_bf16 v[56:59], v[24:27], v[136:139], v[56:59]
    ds_read_b64_tr_b16 v[20:21], v7 offset:32
    v_mfma_f32_16x16x32_bf16 v[60:63], v[24:27], v[140:143], v[60:63]
    ds_read_b64_tr_b16 v[22:23], v7 offset:1056
    s_add_u32 m0, s52, 34304
    s_add_u32 s51, s48, 2392064
    buffer_load_dwordx4 v8, s[32:35], s51 offen lds
    s_waitcnt lgkmcnt(6)
    v_mfma_f32_16x16x32_bf16 v[64:67], v[28:31], v[136:139], v[64:67]
    ds_read_b64_tr_b16 v[24:25], v4 offset:8320
    v_mfma_f32_16x16x32_bf16 v[68:71], v[28:31], v[140:143], v[68:71]
    ds_read_b64_tr_b16 v[26:27], v4 offset:9344
    s_add_u32 m0, s68, 33792
    s_add_u32 s63, s60, 32768
    buffer_load_dwordx4 v2, s[24:27], s63 offen offset:0 nt lds
    s_waitcnt lgkmcnt(6)
    v_mfma_f32_16x16x32_bf16 v[72:75], v[12:15], v[136:139], v[72:75]
    ds_read_b64_tr_b16 v[28:29], v4 offset:8352
    v_mfma_f32_16x16x32_bf16 v[76:79], v[12:15], v[140:143], v[76:79]
    ds_read_b64_tr_b16 v[30:31], v4 offset:9376
    s_add_u32 m0, s68, 33824
    s_add_u32 s63, s60, 32768
    buffer_load_dwordx4 v2, s[24:27], s63 offen offset:1024 nt lds
    s_waitcnt lgkmcnt(6)
    v_mfma_f32_16x16x32_bf16 v[80:83], v[16:19], v[136:139], v[80:83]
    v_mfma_f32_16x16x32_bf16 v[84:87], v[16:19], v[140:143], v[84:87]
    s_add_u32 m0, s68, 33856
    s_add_u32 s63, s60, 32768
    buffer_load_dwordx4 v2, s[24:27], s63 offen offset:2048 nt lds
    s_waitcnt lgkmcnt(4)
    v_mfma_f32_16x16x32_bf16 v[88:91], v[20:23], v[136:139], v[88:91]
    v_mfma_f32_16x16x32_bf16 v[92:95], v[20:23], v[140:143], v[92:95]
    s_add_u32 m0, s68, 33888
    s_add_u32 s63, s60, 32768
    buffer_load_dwordx4 v2, s[24:27], s63 offen offset:3072 nt lds
    s_waitcnt lgkmcnt(2)
    v_mfma_f32_16x16x32_bf16 v[32:35], v[24:27], v[144:147], v[32:35]
    v_mfma_f32_16x16x32_bf16 v[36:39], v[24:27], v[148:151], v[36:39]
    s_waitcnt lgkmcnt(0)
    v_mfma_f32_16x16x32_bf16 v[40:43], v[28:31], v[144:147], v[40:43]
    v_mfma_f32_16x16x32_bf16 v[44:47], v[28:31], v[148:151], v[44:47]
    s_cmp_lg_u32 s50, 3
    s_cbranch_scc1 L_o1_35
    ds_read_b128 v[96:99], v1 offset:0
L_o1_35:
    s_waitcnt lgkmcnt(0)
    s_waitcnt vmcnt(12)
    s_barrier
    ds_read_b64_tr_b16 v[12:13], v5 offset:8320
    ds_read_b64_tr_b16 v[14:15], v5 offset:9344
    ds_read_b64_tr_b16 v[16:17], v5 offset:8352
    ds_read_b64_tr_b16 v[18:19], v5 offset:9376
    ds_read_b64_tr_b16 v[20:21], v6 offset:8320
    ds_read_b64_tr_b16 v[22:23], v6 offset:9344
    ds_read_b64_tr_b16 v[24:25], v6 offset:8352
    ds_read_b64_tr_b16 v[26:27], v6 offset:9376
    s_waitcnt lgkmcnt(6)
    v_mfma_f32_16x16x32_bf16 v[48:51], v[12:15], v[144:147], v[48:51]
    ds_read_b64_tr_b16 v[28:29], v7 offset:8320
    v_mfma_f32_16x16x32_bf16 v[52:55], v[12:15], v[148:151], v[52:55]
    ds_read_b64_tr_b16 v[30:31], v7 offset:9344
    s_add_u32 m0, s52, 0
    s_add_u32 s51, s48, 2621440
    buffer_load_dwordx4 v8, s[32:35], s51 offen lds
    s_waitcnt lgkmcnt(6)
    v_mfma_f32_16x16x32_bf16 v[56:59], v[16:19], v[144:147], v[56:59]
    ds_read_b64_tr_b16 v[12:13], v7 offset:8352
    v_mfma_f32_16x16x32_bf16 v[60:63], v[16:19], v[148:151], v[60:63]
    ds_read_b64_tr_b16 v[14:15], v7 offset:9376
    s_waitcnt lgkmcnt(6)
    v_mfma_f32_16x16x32_bf16 v[64:67], v[20:23], v[144:147], v[64:67]
    ds_read_b64_tr_b16 v[16:17], v4 offset:16640
    v_mfma_f32_16x16x32_bf16 v[68:71], v[20:23], v[148:151], v[68:71]
    ds_read_b64_tr_b16 v[18:19], v4 offset:17664
    s_add_u32 m0, s52, 1024
    s_add_u32 s51, s48, 2654208
    buffer_load_dwordx4 v8, s[32:35], s51 offen lds
    s_waitcnt lgkmcnt(6)
    v_mfma_f32_16x16x32_bf16 v[72:75], v[24:27], v[144:147], v[72:75]
    ds_read_b64_tr_b16 v[20:21], v4 offset:16672
    v_mfma_f32_16x16x32_bf16 v[76:79], v[24:27], v[148:151], v[76:79]
    ds_read_b64_tr_b16 v[22:23], v4 offset:17696
    s_add_u32 m0, s67, 50688
    s_add_u32 s63, s60, 65536
    buffer_load_dwordx4 v2, s[20:23], s63 offen offset:0 nt lds
    s_waitcnt lgkmcnt(6)
    v_mfma_f32_16x16x32_bf16 v[80:83], v[28:31], v[144:147], v[80:83]
    ds_read_b64_tr_b16 v[24:25], v5 offset:16640
    v_mfma_f32_16x16x32_bf16 v[84:87], v[28:31], v[148:151], v[84:87]
    ds_read_b64_tr_b16 v[26:27], v5 offset:17664
    s_add_u32 m0, s67, 50688
    s_add_u32 s63, s60, 65536
    buffer_load_dwordx4 v2, s[20:23], s63 offen offset:1024 nt lds
    s_waitcnt lgkmcnt(6)
    v_mfma_f32_16x16x32_bf16 v[88:91], v[12:15], v[144:147], v[88:91]
    ds_read_b64_tr_b16 v[28:29], v5 offset:16672
    v_mfma_f32_16x16x32_bf16 v[92:95], v[12:15], v[148:151], v[92:95]
    ds_read_b64_tr_b16 v[30:31], v5 offset:17696
    s_waitcnt lgkmcnt(6)
    v_mfma_f32_16x16x32_bf16 v[32:35], v[16:19], v[152:155], v[32:35]
    v_mfma_f32_16x16x32_bf16 v[36:39], v[16:19], v[156:159], v[36:39]
    s_add_u32 m0, s67, 50720
    s_add_u32 s63, s60, 65536
    buffer_load_dwordx4 v2, s[20:23], s63 offen offset:2048 nt lds
    s_waitcnt lgkmcnt(4)
    v_mfma_f32_16x16x32_bf16 v[40:43], v[20:23], v[152:155], v[40:43]
    v_mfma_f32_16x16x32_bf16 v[44:47], v[20:23], v[156:159], v[44:47]
    s_add_u32 m0, s67, 50720
    s_add_u32 s63, s60, 65536
    buffer_load_dwordx4 v2, s[20:23], s63 offen offset:3072 nt lds
    s_waitcnt lgkmcnt(2)
    v_mfma_f32_16x16x32_bf16 v[48:51], v[24:27], v[152:155], v[48:51]
    v_mfma_f32_16x16x32_bf16 v[52:55], v[24:27], v[156:159], v[52:55]
    s_waitcnt lgkmcnt(0)
    v_mfma_f32_16x16x32_bf16 v[56:59], v[28:31], v[152:155], v[56:59]
    v_mfma_f32_16x16x32_bf16 v[60:63], v[28:31], v[156:159], v[60:63]
    s_cmp_lg_u32 s50, 3
    s_cbranch_scc1 L_o1_36
    ds_read_b128 v[100:103], v1 offset:1024
L_o1_36:
    s_waitcnt lgkmcnt(0)
    s_waitcnt vmcnt(12)
    s_barrier
    ds_read_b64_tr_b16 v[12:13], v6 offset:16640
    ds_read_b64_tr_b16 v[14:15], v6 offset:17664
    ds_read_b64_tr_b16 v[16:17], v6 offset:16672
    ds_read_b64_tr_b16 v[18:19], v6 offset:17696
    ds_read_b64_tr_b16 v[20:21], v7 offset:16640
    ds_read_b64_tr_b16 v[22:23], v7 offset:17664
    ds_read_b64_tr_b16 v[24:25], v7 offset:16672
    ds_read_b64_tr_b16 v[26:27], v7 offset:17696
    s_waitcnt lgkmcnt(6)
    v_mfma_f32_16x16x32_bf16 v[64:67], v[12:15], v[152:155], v[64:67]
    ds_read_b64_tr_b16 v[28:29], v4 offset:24960
    v_mfma_f32_16x16x32_bf16 v[68:71], v[12:15], v[156:159], v[68:71]
    ds_read_b64_tr_b16 v[30:31], v4 offset:25984
    s_add_u32 m0, s52, 8320
    s_add_u32 s51, s48, 2883584
    buffer_load_dwordx4 v8, s[32:35], s51 offen lds
    s_waitcnt lgkmcnt(6)
    v_mfma_f32_16x16x32_bf16 v[72:75], v[16:19], v[152:155], v[72:75]
    ds_read_b64_tr_b16 v[12:13], v4 offset:24992
    v_mfma_f32_16x16x32_bf16 v[76:79], v[16:19], v[156:159], v[76:79]
    ds_read_b64_tr_b16 v[14:15], v4 offset:26016
    s_waitcnt lgkmcnt(6)
    v_mfma_f32_16x16x32_bf16 v[80:83], v[20:23], v[152:155], v[80:83]
    ds_read_b64_tr_b16 v[16:17], v5 offset:24960
    v_mfma_f32_16x16x32_bf16 v[84:87], v[20:23], v[156:159], v[84:87]
    ds_read_b64_tr_b16 v[18:19], v5 offset:25984
    s_add_u32 m0, s52, 9344
    s_add_u32 s51, s48, 2916352
    buffer_load_dwordx4 v8, s[32:35], s51 offen lds
    s_waitcnt lgkmcnt(6)
    v_mfma_f32_16x16x32_bf16 v[88:91], v[24:27], v[152:155], v[88:91]
    ds_read_b64_tr_b16 v[20:21], v5 offset:24992
    v_mfma_f32_16x16x32_bf16 v[92:95], v[24:27], v[156:159], v[92:95]
    ds_read_b64_tr_b16 v[22:23], v5 offset:26016
    s_add_u32 m0, s68, 0
    s_add_u32 s63, s60, 49152
    buffer_load_dwordx4 v2, s[24:27], s63 offen offset:0 nt lds
    s_waitcnt lgkmcnt(6)
    v_mfma_f32_16x16x32_bf16 v[32:35], v[28:31], v[160:163], v[32:35]
    ds_read_b64_tr_b16 v[24:25], v6 offset:24960
    v_mfma_f32_16x16x32_bf16 v[36:39], v[28:31], v[164:167], v[36:39]
    ds_read_b64_tr_b16 v[26:27], v6 offset:25984
    s_add_u32 m0, s68, 32
    s_add_u32 s63, s60, 49152
    buffer_load_dwordx4 v2, s[24:27], s63 offen offset:1024 nt lds
    s_waitcnt lgkmcnt(6)
    v_mfma_f32_16x16x32_bf16 v[40:43], v[12:15], v[160:163], v[40:43]
    ds_read_b64_tr_b16 v[28:29], v6 offset:24992
    v_mfma_f32_16x16x32_bf16 v[44:47], v[12:15], v[164:167], v[44:47]
    ds_read_b64_tr_b16 v[30:31], v6 offset:26016
    s_waitcnt lgkmcnt(6)
    v_mfma_f32_16x16x32_bf16 v[48:51], v[16:19], v[160:163], v[48:51]
    v_mfma_f32_16x16x32_bf16 v[52:55], v[16:19], v[164:167], v[52:55]
    s_add_u32 m0, s68, 64
    s_add_u32 s63, s60, 49152
    buffer_load_dwordx4 v2, s[24:27], s63 offen offset:2048 nt lds
    s_waitcnt lgkmcnt(4)
    v_mfma_f32_16x16x32_bf16 v[56:59], v[20:23], v[160:163], v[56:59]
    v_mfma_f32_16x16x32_bf16 v[60:63], v[20:23], v[164:167], v[60:63]
    s_add_u32 m0, s68, 96
    s_add_u32 s63, s60, 49152
    buffer_load_dwordx4 v2, s[24:27], s63 offen offset:3072 nt lds
    s_waitcnt lgkmcnt(2)
    v_mfma_f32_16x16x32_bf16 v[64:67], v[24:27], v[160:163], v[64:67]
    v_mfma_f32_16x16x32_bf16 v[68:71], v[24:27], v[164:167], v[68:71]
    s_waitcnt lgkmcnt(0)
    v_mfma_f32_16x16x32_bf16 v[72:75], v[28:31], v[160:163], v[72:75]
    v_mfma_f32_16x16x32_bf16 v[76:79], v[28:31], v[164:167], v[76:79]
    s_cmp_lg_u32 s50, 3
    s_cbranch_scc1 L_o1_37
    ds_read_b128 v[104:107], v1 offset:2048
L_o1_37:
    s_waitcnt lgkmcnt(0)
    s_waitcnt vmcnt(12)
    s_barrier
    ds_read_b64_tr_b16 v[12:13], v7 offset:24960
    ds_read_b64_tr_b16 v[14:15], v7 offset:25984
    ds_read_b64_tr_b16 v[16:17], v7 offset:24992
    ds_read_b64_tr_b16 v[18:19], v7 offset:26016
    ds_read_b64_tr_b16 v[20:21], v4 offset:33280
    ds_read_b64_tr_b16 v[22:23], v4 offset:34304
    ds_read_b64_tr_b16 v[24:25], v4 offset:33312
    ds_read_b64_tr_b16 v[26:27], v4 offset:34336
    s_waitcnt lgkmcnt(6)
    v_mfma_f32_16x16x32_bf16 v[80:83], v[12:15], v[160:163], v[80:83]
    ds_read_b64_tr_b16 v[28:29], v5 offset:33280
    v_mfma_f32_16x16x32_bf16 v[84:87], v[12:15], v[164:167], v[84:87]
    ds_read_b64_tr_b16 v[30:31], v5 offset:34304
    s_add_u32 m0, s52, 16640
    s_add_u32 s51, s48, 3145728
    buffer_load_dwordx4 v8, s[32:35], s51 offen lds
    s_waitcnt lgkmcnt(6)
    v_mfma_f32_16x16x32_bf16 v[88:91], v[16:19], v[160:163], v[88:91]
    ds_read_b64_tr_b16 v[12:13], v5 offset:33312
    v_mfma_f32_16x16x32_bf16 v[92:95], v[16:19], v[164:167], v[92:95]
    ds_read_b64_tr_b16 v[14:15], v5 offset:34336
    s_waitcnt lgkmcnt(6)
    v_mfma_f32_16x16x32_bf16 v[32:35], v[20:23], v[168:171], v[32:35]
    ds_read_b64_tr_b16 v[16:17], v6 offset:33280
    v_mfma_f32_16x16x32_bf16 v[36:39], v[20:23], v[172:175], v[36:39]
    ds_read_b64_tr_b16 v[18:19], v6 offset:34304
    s_add_u32 m0, s52, 17664
    s_add_u32 s51, s48, 3178496
    buffer_load_dwordx4 v8, s[32:35], s51 offen lds
    s_waitcnt lgkmcnt(6)
    v_mfma_f32_16x16x32_bf16 v[40:43], v[24:27], v[168:171], v[40:43]
    ds_read_b64_tr_b16 v[20:21], v6 offset:33312
    v_mfma_f32_16x16x32_bf16 v[44:47], v[24:27], v[172:175], v[44:47]
    ds_read_b64_tr_b16 v[22:23], v6 offset:34336
    s_add_u32 m0, s67, 16896
    s_add_u32 s63, s60, 81920
    buffer_load_dwordx4 v2, s[20:23], s63 offen offset:0 nt lds
    s_waitcnt lgkmcnt(6)
    v_mfma_f32_16x16x32_bf16 v[48:51], v[28:31], v[168:171], v[48:51]
    ds_read_b64_tr_b16 v[24:25], v7 offset:33280
    v_mfma_f32_16x16x32_bf16 v[52:55], v[28:31], v[172:175], v[52:55]
    ds_read_b64_tr_b16 v[26:27], v7 offset:34304
    s_add_u32 m0, s67, 16896
    s_add_u32 s63, s60, 81920
    buffer_load_dwordx4 v2, s[20:23], s63 offen offset:1024 nt lds
    s_waitcnt lgkmcnt(6)
    v_mfma_f32_16x16x32_bf16 v[56:59], v[12:15], v[168:171], v[56:59]
    ds_read_b64_tr_b16 v[28:29], v7 offset:33312
    v_mfma_f32_16x16x32_bf16 v[60:63], v[12:15], v[172:175], v[60:63]
    ds_read_b64_tr_b16 v[30:31], v7 offset:34336
    s_waitcnt lgkmcnt(6)
    v_mfma_f32_16x16x32_bf16 v[64:67], v[16:19], v[168:171], v[64:67]
    v_mfma_f32_16x16x32_bf16 v[68:71], v[16:19], v[172:175], v[68:71]
    s_add_u32 m0, s67, 16928
    s_add_u32 s63, s60, 81920
    buffer_load_dwordx4 v2, s[20:23], s63 offen offset:2048 nt lds
    s_waitcnt lgkmcnt(4)
    v_mfma_f32_16x16x32_bf16 v[72:75], v[20:23], v[168:171], v[72:75]
    v_mfma_f32_16x16x32_bf16 v[76:79], v[20:23], v[172:175], v[76:79]
    s_add_u32 m0, s67, 16928
    s_add_u32 s63, s60, 81920
    buffer_load_dwordx4 v2, s[20:23], s63 offen offset:3072 nt lds
    s_waitcnt lgkmcnt(2)
    v_mfma_f32_16x16x32_bf16 v[80:83], v[24:27], v[168:171], v[80:83]
    v_mfma_f32_16x16x32_bf16 v[84:87], v[24:27], v[172:175], v[84:87]
    s_waitcnt lgkmcnt(0)
    v_mfma_f32_16x16x32_bf16 v[88:91], v[28:31], v[168:171], v[88:91]
    v_mfma_f32_16x16x32_bf16 v[92:95], v[28:31], v[172:175], v[92:95]
    s_cmp_lg_u32 s50, 3
    s_cbranch_scc1 L_o1_38
    ds_read_b128 v[108:111], v1 offset:3072
L_o1_38:
    s_waitcnt lgkmcnt(0)
    s_waitcnt vmcnt(10)
    s_barrier
    ds_read_b64_tr_b16 v[12:13], v4 offset:0
    ds_read_b64_tr_b16 v[14:15], v4 offset:1024
    ds_read_b64_tr_b16 v[16:17], v4 offset:32
    ds_read_b64_tr_b16 v[18:19], v4 offset:1056
    ds_read_b64_tr_b16 v[20:21], v5 offset:0
    ds_read_b64_tr_b16 v[22:23], v5 offset:1024
    ds_read_b64_tr_b16 v[24:25], v5 offset:32
    ds_read_b64_tr_b16 v[26:27], v5 offset:1056
    s_waitcnt lgkmcnt(6)
    v_mfma_f32_16x16x32_bf16 v[32:35], v[12:15], v[176:179], v[32:35]
    ds_read_b64_tr_b16 v[28:29], v6 offset:0
    v_mfma_f32_16x16x32_bf16 v[36:39], v[12:15], v[180:183], v[36:39]
    ds_read_b64_tr_b16 v[30:31], v6 offset:1024
    s_add_u32 m0, s52, 24960
    s_add_u32 s51, s48, 3407872
    buffer_load_dwordx4 v8, s[32:35], s51 offen lds
    s_waitcnt lgkmcnt(6)
    v_mfma_f32_16x16x32_bf16 v[40:43], v[16:19], v[176:179], v[40:43]
    ds_read_b64_tr_b16 v[12:13], v6 offset:32
    v_mfma_f32_16x16x32_bf16 v[44:47], v[16:19], v[180:183], v[44:47]
    ds_read_b64_tr_b16 v[14:15], v6 offset:1056
    s_add_u32 m0, s52, 25984
    s_add_u32 s51, s48, 3440640
    buffer_load_dwordx4 v8, s[32:35], s51 offen lds
    s_waitcnt lgkmcnt(6)
    v_mfma_f32_16x16x32_bf16 v[48:51], v[20:23], v[176:179], v[48:51]
    ds_read_b64_tr_b16 v[16:17], v7 offset:0
    v_mfma_f32_16x16x32_bf16 v[52:55], v[20:23], v[180:183], v[52:55]
    ds_read_b64_tr_b16 v[18:19], v7 offset:1024
    s_add_u32 m0, s52, 33280
    s_add_u32 s51, s48, 3670016
    buffer_load_dwordx4 v8, s[32:35], s51 offen lds
    s_waitcnt lgkmcnt(6)
    v_mfma_f32_16x16x32_bf16 v[56:59], v[24:27], v[176:179], v[56:59]
    ds_read_b64_tr_b16 v[20:21], v7 offset:32
    v_mfma_f32_16x16x32_bf16 v[60:63], v[24:27], v[180:183], v[60:63]
    ds_read_b64_tr_b16 v[22:23], v7 offset:1056
    s_add_u32 m0, s52, 34304
    s_add_u32 s51, s48, 3702784
    buffer_load_dwordx4 v8, s[32:35], s51 offen lds
    s_waitcnt lgkmcnt(6)
    v_mfma_f32_16x16x32_bf16 v[64:67], v[28:31], v[176:179], v[64:67]
    ds_read_b64_tr_b16 v[24:25], v4 offset:8320
    v_mfma_f32_16x16x32_bf16 v[68:71], v[28:31], v[180:183], v[68:71]
    ds_read_b64_tr_b16 v[26:27], v4 offset:9344
    s_add_u32 m0, s68, 33792
    s_add_u32 s63, s60, 65536
    buffer_load_dwordx4 v2, s[24:27], s63 offen offset:0 nt lds
    s_waitcnt lgkmcnt(6)
    v_mfma_f32_16x16x32_bf16 v[72:75], v[12:15], v[176:179], v[72:75]
    ds_read_b64_tr_b16 v[28:29], v4 offset:8352
    v_mfma_f32_16x16x32_bf16 v[76:79], v[12:15], v[180:183], v[76:79]
    ds_read_b64_tr_b16 v[30:31], v4 offset:9376
    s_add_u32 m0, s68, 33824
    s_add_u32 s63, s60, 65536
    buffer_load_dwordx4 v2, s[24:27], s63 offen offset:1024 nt lds
    s_waitcnt lgkmcnt(6)
    v_mfma_f32_16x16x32_bf16 v[80:83], v[16:19], v[176:179], v[80:83]
    v_mfma_f32_16x16x32_bf16 v[84:87], v[16:19], v[180:183], v[84:87]
    s_add_u32 m0, s68, 33856
    s_add_u32 s63, s60, 65536
    buffer_load_dwordx4 v2, s[24:27], s63 offen offset:2048 nt lds
    s_waitcnt lgkmcnt(4)
    v_mfma_f32_16x16x32_bf16 v[88:91], v[20:23], v[176:179], v[88:91]
    v_mfma_f32_16x16x32_bf16 v[92:95], v[20:23], v[180:183], v[92:95]
    s_add_u32 m0, s68, 33888
    s_add_u32 s63, s60, 65536
    buffer_load_dwordx4 v2, s[24:27], s63 offen offset:3072 nt lds
    s_waitcnt lgkmcnt(2)
    v_mfma_f32_16x16x32_bf16 v[32:35], v[24:27], v[184:187], v[32:35]
    v_mfma_f32_16x16x32_bf16 v[36:39], v[24:27], v[188:191], v[36:39]
    s_waitcnt lgkmcnt(0)
    v_mfma_f32_16x16x32_bf16 v[40:43], v[28:31], v[184:187], v[40:43]
    v_mfma_f32_16x16x32_bf16 v[44:47], v[28:31], v[188:191], v[44:47]
    s_cmp_lg_u32 s50, 3
    s_cbranch_scc1 L_o1_39
    ds_read_b128 v[112:115], v1 offset:4096
L_o1_39:
    s_waitcnt lgkmcnt(0)
    s_waitcnt vmcnt(12)
    s_barrier
    ds_read_b64_tr_b16 v[12:13], v5 offset:8320
    ds_read_b64_tr_b16 v[14:15], v5 offset:9344
    ds_read_b64_tr_b16 v[16:17], v5 offset:8352
    ds_read_b64_tr_b16 v[18:19], v5 offset:9376
    ds_read_b64_tr_b16 v[20:21], v6 offset:8320
    ds_read_b64_tr_b16 v[22:23], v6 offset:9344
    ds_read_b64_tr_b16 v[24:25], v6 offset:8352
    ds_read_b64_tr_b16 v[26:27], v6 offset:9376
    s_waitcnt lgkmcnt(6)
    v_mfma_f32_16x16x32_bf16 v[48:51], v[12:15], v[184:187], v[48:51]
    ds_read_b64_tr_b16 v[28:29], v7 offset:8320
    v_mfma_f32_16x16x32_bf16 v[52:55], v[12:15], v[188:191], v[52:55]
    ds_read_b64_tr_b16 v[30:31], v7 offset:9344
    s_add_u32 m0, s52, 0
    s_add_u32 s51, s48, 3932160
    buffer_load_dwordx4 v8, s[32:35], s51 offen lds
    s_waitcnt lgkmcnt(6)
    v_mfma_f32_16x16x32_bf16 v[56:59], v[16:19], v[184:187], v[56:59]
    ds_read_b64_tr_b16 v[12:13], v7 offset:8352
    v_mfma_f32_16x16x32_bf16 v[60:63], v[16:19], v[188:191], v[60:63]
    ds_read_b64_tr_b16 v[14:15], v7 offset:9376
    s_waitcnt lgkmcnt(6)
    v_mfma_f32_16x16x32_bf16 v[64:67], v[20:23], v[184:187], v[64:67]
    ds_read_b64_tr_b16 v[16:17], v4 offset:16640
    v_mfma_f32_16x16x32_bf16 v[68:71], v[20:23], v[188:191], v[68:71]
    ds_read_b64_tr_b16 v[18:19], v4 offset:17664
    s_add_u32 m0, s52, 1024
    s_add_u32 s51, s48, 3964928
    buffer_load_dwordx4 v8, s[32:35], s51 offen lds
    s_waitcnt lgkmcnt(6)
    v_mfma_f32_16x16x32_bf16 v[72:75], v[24:27], v[184:187], v[72:75]
    ds_read_b64_tr_b16 v[20:21], v4 offset:16672
    v_mfma_f32_16x16x32_bf16 v[76:79], v[24:27], v[188:191], v[76:79]
    ds_read_b64_tr_b16 v[22:23], v4 offset:17696
    s_add_u32 m0, s67, 50688
    s_add_u32 s63, s60, 98304
    buffer_load_dwordx4 v2, s[20:23], s63 offen offset:0 nt lds
    s_waitcnt lgkmcnt(6)
    v_mfma_f32_16x16x32_bf16 v[80:83], v[28:31], v[184:187], v[80:83]
    ds_read_b64_tr_b16 v[24:25], v5 offset:16640
    v_mfma_f32_16x16x32_bf16 v[84:87], v[28:31], v[188:191], v[84:87]
    ds_read_b64_tr_b16 v[26:27], v5 offset:17664
    s_add_u32 m0, s67, 50688
    s_add_u32 s63, s60, 98304
    buffer_load_dwordx4 v2, s[20:23], s63 offen offset:1024 nt lds
    s_waitcnt lgkmcnt(6)
    v_mfma_f32_16x16x32_bf16 v[88:91], v[12:15], v[184:187], v[88:91]
    ds_read_b64_tr_b16 v[28:29], v5 offset:16672
    v_mfma_f32_16x16x32_bf16 v[92:95], v[12:15], v[188:191], v[92:95]
    ds_read_b64_tr_b16 v[30:31], v5 offset:17696
    s_waitcnt lgkmcnt(6)
    v_mfma_f32_16x16x32_bf16 v[32:35], v[16:19], v[192:195], v[32:35]
    v_mfma_f32_16x16x32_bf16 v[36:39], v[16:19], v[196:199], v[36:39]
    s_add_u32 m0, s67, 50720
    s_add_u32 s63, s60, 98304
    buffer_load_dwordx4 v2, s[20:23], s63 offen offset:2048 nt lds
    s_waitcnt lgkmcnt(4)
    v_mfma_f32_16x16x32_bf16 v[40:43], v[20:23], v[192:195], v[40:43]
    v_mfma_f32_16x16x32_bf16 v[44:47], v[20:23], v[196:199], v[44:47]
    s_add_u32 m0, s67, 50720
    s_add_u32 s63, s60, 98304
    buffer_load_dwordx4 v2, s[20:23], s63 offen offset:3072 nt lds
    s_waitcnt lgkmcnt(2)
    v_mfma_f32_16x16x32_bf16 v[48:51], v[24:27], v[192:195], v[48:51]
    v_mfma_f32_16x16x32_bf16 v[52:55], v[24:27], v[196:199], v[52:55]
    s_waitcnt lgkmcnt(0)
    v_mfma_f32_16x16x32_bf16 v[56:59], v[28:31], v[192:195], v[56:59]
    v_mfma_f32_16x16x32_bf16 v[60:63], v[28:31], v[196:199], v[60:63]
    s_cmp_lg_u32 s50, 3
    s_cbranch_scc1 L_o1_40
    ds_read_b128 v[116:119], v1 offset:5120
L_o1_40:
    s_waitcnt lgkmcnt(0)
    s_waitcnt vmcnt(12)
    s_barrier
    ds_read_b64_tr_b16 v[12:13], v6 offset:16640
    ds_read_b64_tr_b16 v[14:15], v6 offset:17664
    ds_read_b64_tr_b16 v[16:17], v6 offset:16672
    ds_read_b64_tr_b16 v[18:19], v6 offset:17696
    ds_read_b64_tr_b16 v[20:21], v7 offset:16640
    ds_read_b64_tr_b16 v[22:23], v7 offset:17664
    ds_read_b64_tr_b16 v[24:25], v7 offset:16672
    ds_read_b64_tr_b16 v[26:27], v7 offset:17696
    s_waitcnt lgkmcnt(6)
    v_mfma_f32_16x16x32_bf16 v[64:67], v[12:15], v[192:195], v[64:67]
    ds_read_b64_tr_b16 v[28:29], v4 offset:24960
    v_mfma_f32_16x16x32_bf16 v[68:71], v[12:15], v[196:199], v[68:71]
    ds_read_b64_tr_b16 v[30:31], v4 offset:25984
    s_add_u32 m0, s52, 8320
    s_add_u32 s51, s48, 4194304
    buffer_load_dwordx4 v8, s[32:35], s51 offen lds
    s_waitcnt lgkmcnt(6)
    v_mfma_f32_16x16x32_bf16 v[72:75], v[16:19], v[192:195], v[72:75]
    ds_read_b64_tr_b16 v[12:13], v4 offset:24992
    v_mfma_f32_16x16x32_bf16 v[76:79], v[16:19], v[196:199], v[76:79]
    ds_read_b64_tr_b16 v[14:15], v4 offset:26016
    s_waitcnt lgkmcnt(6)
    v_mfma_f32_16x16x32_bf16 v[80:83], v[20:23], v[192:195], v[80:83]
    ds_read_b64_tr_b16 v[16:17], v5 offset:24960
    v_mfma_f32_16x16x32_bf16 v[84:87], v[20:23], v[196:199], v[84:87]
    ds_read_b64_tr_b16 v[18:19], v5 offset:25984
    s_add_u32 m0, s52, 9344
    s_add_u32 s51, s48, 4227072
    buffer_load_dwordx4 v8, s[32:35], s51 offen lds
    s_waitcnt lgkmcnt(6)
    v_mfma_f32_16x16x32_bf16 v[88:91], v[24:27], v[192:195], v[88:91]
    ds_read_b64_tr_b16 v[20:21], v5 offset:24992
    v_mfma_f32_16x16x32_bf16 v[92:95], v[24:27], v[196:199], v[92:95]
    ds_read_b64_tr_b16 v[22:23], v5 offset:26016
    s_add_u32 m0, s68, 0
    s_add_u32 s63, s60, 81920
    buffer_load_dwordx4 v2, s[24:27], s63 offen offset:0 nt lds
    s_waitcnt lgkmcnt(6)
    v_mfma_f32_16x16x32_bf16 v[32:35], v[28:31], v[200:203], v[32:35]
    ds_read_b64_tr_b16 v[24:25], v6 offset:24960
    v_mfma_f32_16x16x32_bf16 v[36:39], v[28:31], v[204:207], v[36:39]
    ds_read_b64_tr_b16 v[26:27], v6 offset:25984
    s_add_u32 m0, s68, 32
    s_add_u32 s63, s60, 81920
    buffer_load_dwordx4 v2, s[24:27], s63 offen offset:1024 nt lds
    s_waitcnt lgkmcnt(6)
    v_mfma_f32_16x16x32_bf16 v[40:43], v[12:15], v[200:203], v[40:43]
    ds_read_b64_tr_b16 v[28:29], v6 offset:24992
    v_mfma_f32_16x16x32_bf16 v[44:47], v[12:15], v[204:207], v[44:47]
    ds_read_b64_tr_b16 v[30:31], v6 offset:26016
    s_waitcnt lgkmcnt(6)
    v_mfma_f32_16x16x32_bf16 v[48:51], v[16:19], v[200:203], v[48:51]
    v_mfma_f32_16x16x32_bf16 v[52:55], v[16:19], v[204:207], v[52:55]
    s_add_u32 m0, s68, 64
    s_add_u32 s63, s60, 81920
    buffer_load_dwordx4 v2, s[24:27], s63 offen offset:2048 nt lds
    s_waitcnt lgkmcnt(4)
    v_mfma_f32_16x16x32_bf16 v[56:59], v[20:23], v[200:203], v[56:59]
    v_mfma_f32_16x16x32_bf16 v[60:63], v[20:23], v[204:207], v[60:63]
    s_add_u32 m0, s68, 96
    s_add_u32 s63, s60, 81920
    buffer_load_dwordx4 v2, s[24:27], s63 offen offset:3072 nt lds
    s_waitcnt lgkmcnt(2)
    v_mfma_f32_16x16x32_bf16 v[64:67], v[24:27], v[200:203], v[64:67]
    v_mfma_f32_16x16x32_bf16 v[68:71], v[24:27], v[204:207], v[68:71]
    s_waitcnt lgkmcnt(0)
    v_mfma_f32_16x16x32_bf16 v[72:75], v[28:31], v[200:203], v[72:75]
    v_mfma_f32_16x16x32_bf16 v[76:79], v[28:31], v[204:207], v[76:79]
    s_cmp_lg_u32 s50, 3
    s_cbranch_scc1 L_o1_41
    ds_read_b128 v[120:123], v1 offset:6144
L_o1_41:
    s_waitcnt lgkmcnt(0)
    s_waitcnt vmcnt(12)
    s_barrier
    ds_read_b64_tr_b16 v[12:13], v7 offset:24960
    ds_read_b64_tr_b16 v[14:15], v7 offset:25984
    ds_read_b64_tr_b16 v[16:17], v7 offset:24992
    ds_read_b64_tr_b16 v[18:19], v7 offset:26016
    ds_read_b64_tr_b16 v[20:21], v4 offset:33280
    ds_read_b64_tr_b16 v[22:23], v4 offset:34304
    ds_read_b64_tr_b16 v[24:25], v4 offset:33312
    ds_read_b64_tr_b16 v[26:27], v4 offset:34336
    s_waitcnt lgkmcnt(6)
    v_mfma_f32_16x16x32_bf16 v[80:83], v[12:15], v[200:203], v[80:83]
    ds_read_b64_tr_b16 v[28:29], v5 offset:33280
    v_mfma_f32_16x16x32_bf16 v[84:87], v[12:15], v[204:207], v[84:87]
    ds_read_b64_tr_b16 v[30:31], v5 offset:34304
    s_add_u32 m0, s52, 16640
    s_add_u32 s51, s48, 4456448
    buffer_load_dwordx4 v8, s[32:35], s51 offen lds
    s_waitcnt lgkmcnt(6)
    v_mfma_f32_16x16x32_bf16 v[88:91], v[16:19], v[200:203], v[88:91]
    ds_read_b64_tr_b16 v[12:13], v5 offset:33312
    v_mfma_f32_16x16x32_bf16 v[92:95], v[16:19], v[204:207], v[92:95]
    ds_read_b64_tr_b16 v[14:15], v5 offset:34336
    s_waitcnt lgkmcnt(6)
    v_mfma_f32_16x16x32_bf16 v[32:35], v[20:23], v[208:211], v[32:35]
    ds_read_b64_tr_b16 v[16:17], v6 offset:33280
    v_mfma_f32_16x16x32_bf16 v[36:39], v[20:23], v[212:215], v[36:39]
    ds_read_b64_tr_b16 v[18:19], v6 offset:34304
    s_add_u32 m0, s52, 17664
    s_add_u32 s51, s48, 4489216
    buffer_load_dwordx4 v8, s[32:35], s51 offen lds
    s_waitcnt lgkmcnt(6)
    v_mfma_f32_16x16x32_bf16 v[40:43], v[24:27], v[208:211], v[40:43]
    ds_read_b64_tr_b16 v[20:21], v6 offset:33312
    v_mfma_f32_16x16x32_bf16 v[44:47], v[24:27], v[212:215], v[44:47]
    ds_read_b64_tr_b16 v[22:23], v6 offset:34336
    s_add_u32 m0, s67, 16896
    s_add_u32 s63, s60, 114688
    buffer_load_dwordx4 v2, s[20:23], s63 offen offset:0 nt lds
    s_waitcnt lgkmcnt(6)
    v_mfma_f32_16x16x32_bf16 v[48:51], v[28:31], v[208:211], v[48:51]
    ds_read_b64_tr_b16 v[24:25], v7 offset:33280
    v_mfma_f32_16x16x32_bf16 v[52:55], v[28:31], v[212:215], v[52:55]
    ds_read_b64_tr_b16 v[26:27], v7 offset:34304
    s_add_u32 m0, s67, 16896
    s_add_u32 s63, s60, 114688
    buffer_load_dwordx4 v2, s[20:23], s63 offen offset:1024 nt lds
    s_waitcnt lgkmcnt(6)
    v_mfma_f32_16x16x32_bf16 v[56:59], v[12:15], v[208:211], v[56:59]
    ds_read_b64_tr_b16 v[28:29], v7 offset:33312
    v_mfma_f32_16x16x32_bf16 v[60:63], v[12:15], v[212:215], v[60:63]
    ds_read_b64_tr_b16 v[30:31], v7 offset:34336
    s_waitcnt lgkmcnt(6)
    v_mfma_f32_16x16x32_bf16 v[64:67], v[16:19], v[208:211], v[64:67]
    v_mfma_f32_16x16x32_bf16 v[68:71], v[16:19], v[212:215], v[68:71]
    s_add_u32 m0, s67, 16928
    s_add_u32 s63, s60, 114688
    buffer_load_dwordx4 v2, s[20:23], s63 offen offset:2048 nt lds
    s_waitcnt lgkmcnt(4)
    v_mfma_f32_16x16x32_bf16 v[72:75], v[20:23], v[208:211], v[72:75]
    v_mfma_f32_16x16x32_bf16 v[76:79], v[20:23], v[212:215], v[76:79]
    s_add_u32 m0, s67, 16928
    s_add_u32 s63, s60, 114688
    buffer_load_dwordx4 v2, s[20:23], s63 offen offset:3072 nt lds
    s_waitcnt lgkmcnt(2)
    v_mfma_f32_16x16x32_bf16 v[80:83], v[24:27], v[208:211], v[80:83]
    v_mfma_f32_16x16x32_bf16 v[84:87], v[24:27], v[212:215], v[84:87]
    s_waitcnt lgkmcnt(0)
    v_mfma_f32_16x16x32_bf16 v[88:91], v[28:31], v[208:211], v[88:91]
    v_mfma_f32_16x16x32_bf16 v[92:95], v[28:31], v[212:215], v[92:95]
    s_cmp_lg_u32 s50, 3
    s_cbranch_scc1 L_o1_42
    ds_read_b128 v[124:127], v1 offset:7168
L_o1_42:
    s_waitcnt lgkmcnt(0)
    s_waitcnt vmcnt(10)
    s_barrier
    ds_read_b64_tr_b16 v[12:13], v4 offset:0
    ds_read_b64_tr_b16 v[14:15], v4 offset:1024
    ds_read_b64_tr_b16 v[16:17], v4 offset:32
    ds_read_b64_tr_b16 v[18:19], v4 offset:1056
    ds_read_b64_tr_b16 v[20:21], v5 offset:0
    ds_read_b64_tr_b16 v[22:23], v5 offset:1024
    ds_read_b64_tr_b16 v[24:25], v5 offset:32
    ds_read_b64_tr_b16 v[26:27], v5 offset:1056
    s_waitcnt lgkmcnt(6)
    v_mfma_f32_16x16x32_bf16 v[32:35], v[12:15], v[216:219], v[32:35]
    ds_read_b64_tr_b16 v[28:29], v6 offset:0
    v_mfma_f32_16x16x32_bf16 v[36:39], v[12:15], v[220:223], v[36:39]
    ds_read_b64_tr_b16 v[30:31], v6 offset:1024
    s_add_u32 m0, s52, 24960
    s_add_u32 s51, s48, 4718592
    buffer_load_dwordx4 v8, s[32:35], s51 offen lds
    s_waitcnt lgkmcnt(6)
    v_mfma_f32_16x16x32_bf16 v[40:43], v[16:19], v[216:219], v[40:43]
    ds_read_b64_tr_b16 v[12:13], v6 offset:32
    v_mfma_f32_16x16x32_bf16 v[44:47], v[16:19], v[220:223], v[44:47]
    ds_read_b64_tr_b16 v[14:15], v6 offset:1056
    s_add_u32 m0, s52, 25984
    s_add_u32 s51, s48, 4751360
    buffer_load_dwordx4 v8, s[32:35], s51 offen lds
    s_waitcnt lgkmcnt(6)
    v_mfma_f32_16x16x32_bf16 v[48:51], v[20:23], v[216:219], v[48:51]
    ds_read_b64_tr_b16 v[16:17], v7 offset:0
    v_mfma_f32_16x16x32_bf16 v[52:55], v[20:23], v[220:223], v[52:55]
    ds_read_b64_tr_b16 v[18:19], v7 offset:1024
    s_add_u32 m0, s52, 33280
    s_add_u32 s51, s48, 4980736
    buffer_load_dwordx4 v8, s[32:35], s51 offen lds
    s_waitcnt lgkmcnt(6)
    v_mfma_f32_16x16x32_bf16 v[56:59], v[24:27], v[216:219], v[56:59]
    ds_read_b64_tr_b16 v[20:21], v7 offset:32
    v_mfma_f32_16x16x32_bf16 v[60:63], v[24:27], v[220:223], v[60:63]
    ds_read_b64_tr_b16 v[22:23], v7 offset:1056
    s_add_u32 m0, s52, 34304
    s_add_u32 s51, s48, 5013504
    buffer_load_dwordx4 v8, s[32:35], s51 offen lds
    s_waitcnt lgkmcnt(6)
    v_mfma_f32_16x16x32_bf16 v[64:67], v[28:31], v[216:219], v[64:67]
    ds_read_b64_tr_b16 v[24:25], v4 offset:8320
    v_mfma_f32_16x16x32_bf16 v[68:71], v[28:31], v[220:223], v[68:71]
    ds_read_b64_tr_b16 v[26:27], v4 offset:9344
    s_add_u32 m0, s68, 33792
    s_add_u32 s63, s60, 98304
    buffer_load_dwordx4 v2, s[24:27], s63 offen offset:0 nt lds
    s_waitcnt lgkmcnt(6)
    v_mfma_f32_16x16x32_bf16 v[72:75], v[12:15], v[216:219], v[72:75]
    ds_read_b64_tr_b16 v[28:29], v4 offset:8352
    v_mfma_f32_16x16x32_bf16 v[76:79], v[12:15], v[220:223], v[76:79]
    ds_read_b64_tr_b16 v[30:31], v4 offset:9376
    s_add_u32 m0, s68, 33824
    s_add_u32 s63, s60, 98304
    buffer_load_dwordx4 v2, s[24:27], s63 offen offset:1024 nt lds
    s_waitcnt lgkmcnt(6)
    v_mfma_f32_16x16x32_bf16 v[80:83], v[16:19], v[216:219], v[80:83]
    v_mfma_f32_16x16x32_bf16 v[84:87], v[16:19], v[220:223], v[84:87]
    s_add_u32 m0, s68, 33856
    s_add_u32 s63, s60, 98304
    buffer_load_dwordx4 v2, s[24:27], s63 offen offset:2048 nt lds
    s_waitcnt lgkmcnt(4)
    v_mfma_f32_16x16x32_bf16 v[88:91], v[20:23], v[216:219], v[88:91]
    v_mfma_f32_16x16x32_bf16 v[92:95], v[20:23], v[220:223], v[92:95]
    s_add_u32 m0, s68, 33888
    s_add_u32 s63, s60, 98304
    buffer_load_dwordx4 v2, s[24:27], s63 offen offset:3072 nt lds
    s_waitcnt lgkmcnt(2)
    v_mfma_f32_16x16x32_bf16 v[32:35], v[24:27], v[224:227], v[32:35]
    v_mfma_f32_16x16x32_bf16 v[36:39], v[24:27], v[228:231], v[36:39]
    s_waitcnt lgkmcnt(0)
    v_mfma_f32_16x16x32_bf16 v[40:43], v[28:31], v[224:227], v[40:43]
    v_mfma_f32_16x16x32_bf16 v[44:47], v[28:31], v[228:231], v[44:47]
    s_waitcnt vmcnt(12)
    s_barrier
    ds_read_b64_tr_b16 v[12:13], v5 offset:8320
    ds_read_b64_tr_b16 v[14:15], v5 offset:9344
    ds_read_b64_tr_b16 v[16:17], v5 offset:8352
    ds_read_b64_tr_b16 v[18:19], v5 offset:9376
    ds_read_b64_tr_b16 v[20:21], v6 offset:8320
    ds_read_b64_tr_b16 v[22:23], v6 offset:9344
    ds_read_b64_tr_b16 v[24:25], v6 offset:8352
    ds_read_b64_tr_b16 v[26:27], v6 offset:9376
    s_waitcnt lgkmcnt(6)
    v_mfma_f32_16x16x32_bf16 v[48:51], v[12:15], v[224:227], v[48:51]
    ds_read_b64_tr_b16 v[28:29], v7 offset:8320
    v_mfma_f32_16x16x32_bf16 v[52:55], v[12:15], v[228:231], v[52:55]
    ds_read_b64_tr_b16 v[30:31], v7 offset:9344
    s_add_u32 m0, s52, 0
    s_add_u32 s51, s54, 0
    buffer_load_dwordx4 v8, s[32:35], s51 offen lds
    s_waitcnt lgkmcnt(6)
    v_mfma_f32_16x16x32_bf16 v[56:59], v[16:19], v[224:227], v[56:59]
    ds_read_b64_tr_b16 v[12:13], v7 offset:8352
    v_mfma_f32_16x16x32_bf16 v[60:63], v[16:19], v[228:231], v[60:63]
    ds_read_b64_tr_b16 v[14:15], v7 offset:9376
    s_waitcnt lgkmcnt(6)
    v_mfma_f32_16x16x32_bf16 v[64:67], v[20:23], v[224:227], v[64:67]
    ds_read_b64_tr_b16 v[16:17], v4 offset:16640
    v_mfma_f32_16x16x32_bf16 v[68:71], v[20:23], v[228:231], v[68:71]
    ds_read_b64_tr_b16 v[18:19], v4 offset:17664
    s_add_u32 m0, s52, 1024
    s_add_u32 s51, s54, 32768
    buffer_load_dwordx4 v8, s[32:35], s51 offen lds
    s_waitcnt lgkmcnt(6)
    v_mfma_f32_16x16x32_bf16 v[72:75], v[24:27], v[224:227], v[72:75]
    ds_read_b64_tr_b16 v[20:21], v4 offset:16672
    v_mfma_f32_16x16x32_bf16 v[76:79], v[24:27], v[228:231], v[76:79]
    ds_read_b64_tr_b16 v[22:23], v4 offset:17696
    s_add_u32 m0, s67, 50688
    s_add_u32 s63, s61, 0
    buffer_load_dwordx4 v2, s[20:23], s63 offen offset:0 nt lds
    s_waitcnt lgkmcnt(6)
    v_mfma_f32_16x16x32_bf16 v[80:83], v[28:31], v[224:227], v[80:83]
    ds_read_b64_tr_b16 v[24:25], v5 offset:16640
    v_mfma_f32_16x16x32_bf16 v[84:87], v[28:31], v[228:231], v[84:87]
    ds_read_b64_tr_b16 v[26:27], v5 offset:17664
    s_add_u32 m0, s67, 50688
    s_add_u32 s63, s61, 0
    buffer_load_dwordx4 v2, s[20:23], s63 offen offset:1024 nt lds
    s_waitcnt lgkmcnt(6)
    v_mfma_f32_16x16x32_bf16 v[88:91], v[12:15], v[224:227], v[88:91]
    ds_read_b64_tr_b16 v[28:29], v5 offset:16672
    v_mfma_f32_16x16x32_bf16 v[92:95], v[12:15], v[228:231], v[92:95]
    ds_read_b64_tr_b16 v[30:31], v5 offset:17696
    s_waitcnt lgkmcnt(6)
    v_mfma_f32_16x16x32_bf16 v[32:35], v[16:19], v[232:235], v[32:35]
    v_mfma_f32_16x16x32_bf16 v[36:39], v[16:19], v[236:239], v[36:39]
    s_add_u32 m0, s67, 50720
    s_add_u32 s63, s61, 0
    buffer_load_dwordx4 v2, s[20:23], s63 offen offset:2048 nt lds
    s_waitcnt lgkmcnt(4)
    v_mfma_f32_16x16x32_bf16 v[40:43], v[20:23], v[232:235], v[40:43]
    v_mfma_f32_16x16x32_bf16 v[44:47], v[20:23], v[236:239], v[44:47]
    s_add_u32 m0, s67, 50720
    s_add_u32 s63, s61, 0
    buffer_load_dwordx4 v2, s[20:23], s63 offen offset:3072 nt lds
    s_waitcnt lgkmcnt(2)
    v_mfma_f32_16x16x32_bf16 v[48:51], v[24:27], v[232:235], v[48:51]
    v_mfma_f32_16x16x32_bf16 v[52:55], v[24:27], v[236:239], v[52:55]
    s_waitcnt lgkmcnt(0)
    v_mfma_f32_16x16x32_bf16 v[56:59], v[28:31], v[232:235], v[56:59]
    v_mfma_f32_16x16x32_bf16 v[60:63], v[28:31], v[236:239], v[60:63]
    s_waitcnt vmcnt(10)
    s_barrier
    ds_read_b64_tr_b16 v[12:13], v6 offset:16640
    ds_read_b64_tr_b16 v[14:15], v6 offset:17664
    ds_read_b64_tr_b16 v[16:17], v6 offset:16672
    ds_read_b64_tr_b16 v[18:19], v6 offset:17696
    ds_read_b64_tr_b16 v[20:21], v7 offset:16640
    ds_read_b64_tr_b16 v[22:23], v7 offset:17664
    ds_read_b64_tr_b16 v[24:25], v7 offset:16672
    ds_read_b64_tr_b16 v[26:27], v7 offset:17696
    s_waitcnt lgkmcnt(6)
    v_mfma_f32_16x16x32_bf16 v[64:67], v[12:15], v[232:235], v[64:67]
    ds_read_b64_tr_b16 v[28:29], v4 offset:24960
    v_mfma_f32_16x16x32_bf16 v[68:71], v[12:15], v[236:239], v[68:71]
    ds_read_b64_tr_b16 v[30:31], v4 offset:25984
    s_add_u32 m0, s52, 8320
    s_add_u32 s51, s54, 262144
    buffer_load_dwordx4 v8, s[32:35], s51 offen lds
    s_waitcnt lgkmcnt(6)
    v_mfma_f32_16x16x32_bf16 v[72:75], v[16:19], v[232:235], v[72:75]
    ds_read_b64_tr_b16 v[12:13], v4 offset:33280
    v_mfma_f32_16x16x32_bf16 v[76:79], v[16:19], v[236:239], v[76:79]
    ds_read_b64_tr_b16 v[14:15], v4 offset:34304
    s_waitcnt lgkmcnt(6)
    v_mfma_f32_16x16x32_bf16 v[80:83], v[20:23], v[232:235], v[80:83]
    ds_read_b64_tr_b16 v[16:17], v4 offset:24992
    v_mfma_f32_16x16x32_bf16 v[84:87], v[20:23], v[236:239], v[84:87]
    ds_read_b64_tr_b16 v[18:19], v4 offset:26016
    s_add_u32 m0, s52, 9344
    s_add_u32 s51, s54, 294912
    buffer_load_dwordx4 v8, s[32:35], s51 offen lds
    s_waitcnt lgkmcnt(6)
    v_mfma_f32_16x16x32_bf16 v[88:91], v[24:27], v[232:235], v[88:91]
    ds_read_b64_tr_b16 v[20:21], v4 offset:33312
    v_mfma_f32_16x16x32_bf16 v[92:95], v[24:27], v[236:239], v[92:95]
    ds_read_b64_tr_b16 v[22:23], v4 offset:34336
    s_add_u32 m0, s68, 0
    s_add_u32 s63, s60, 114688
    buffer_load_dwordx4 v2, s[24:27], s63 offen offset:0 nt lds
    s_waitcnt lgkmcnt(6)
    v_mfma_f32_16x16x32_bf16 v[32:35], v[28:31], v[240:243], v[32:35]
    ds_read_b64_tr_b16 v[24:25], v5 offset:24960
    v_mfma_f32_16x16x32_bf16 v[36:39], v[28:31], v[244:247], v[36:39]
    ds_read_b64_tr_b16 v[26:27], v5 offset:25984
    s_add_u32 m0, s68, 32
    s_add_u32 s63, s60, 114688
    buffer_load_dwordx4 v2, s[24:27], s63 offen offset:1024 nt lds
    s_waitcnt lgkmcnt(6)
    v_mfma_f32_16x16x32_bf16 v[32:35], v[12:15], v[248:251], v[32:35]
    ds_read_b64_tr_b16 v[28:29], v5 offset:33280
    v_mfma_f32_16x16x32_bf16 v[36:39], v[12:15], v[252:255], v[36:39]
    ds_read_b64_tr_b16 v[30:31], v5 offset:34304
    s_waitcnt lgkmcnt(6)
    v_mfma_f32_16x16x32_bf16 v[40:43], v[16:19], v[240:243], v[40:43]
    v_mfma_f32_16x16x32_bf16 v[44:47], v[16:19], v[244:247], v[44:47]
    s_add_u32 m0, s68, 64
    s_add_u32 s63, s60, 114688
    buffer_load_dwordx4 v2, s[24:27], s63 offen offset:2048 nt lds
    s_waitcnt lgkmcnt(4)
    v_mfma_f32_16x16x32_bf16 v[40:43], v[20:23], v[248:251], v[40:43]
    v_mfma_f32_16x16x32_bf16 v[44:47], v[20:23], v[252:255], v[44:47]
    s_add_u32 m0, s68, 96
    s_add_u32 s63, s60, 114688
    buffer_load_dwordx4 v2, s[24:27], s63 offen offset:3072 nt lds
    s_waitcnt lgkmcnt(2)
    v_mfma_f32_16x16x32_bf16 v[48:51], v[24:27], v[240:243], v[48:51]
    v_mfma_f32_16x16x32_bf16 v[52:55], v[24:27], v[244:247], v[52:55]
    v_mul_f32 v32, s56, v32
    v_mul_f32 v33, s56, v33
    v_mul_f32 v34, s56, v34
    v_mul_f32 v35, s56, v35
    v_cvt_pk_bf16_f32 v32, v32, v33
    v_cvt_pk_bf16_f32 v33, v34, v35
    ds_write_b64 v9, v[32:33] offset:0
    v_mul_f32 v36, s56, v36
    v_mul_f32 v37, s56, v37
    v_mul_f32 v38, s56, v38
    v_mul_f32 v39, s56, v39
    v_cvt_pk_bf16_f32 v36, v36, v37
    v_cvt_pk_bf16_f32 v37, v38, v39
    ds_write_b64 v9, v[36:37] offset:4096
    s_waitcnt lgkmcnt(2)
    v_mfma_f32_16x16x32_bf16 v[48:51], v[28:31], v[248:251], v[48:51]
    v_mfma_f32_16x16x32_bf16 v[52:55], v[28:31], v[252:255], v[52:55]
    s_nop 7
    v_mul_f32 v40, s56, v40
    v_mul_f32 v41, s56, v41
    v_mul_f32 v42, s56, v42
    v_mul_f32 v43, s56, v43
    v_cvt_pk_bf16_f32 v40, v40, v41
    v_cvt_pk_bf16_f32 v41, v42, v43
    ds_write_b64 v9, v[40:41] offset:512
    v_mul_f32 v44, s56, v44
    v_mul_f32 v45, s56, v45
    v_mul_f32 v46, s56, v46
    v_mul_f32 v47, s56, v47
    v_cvt_pk_bf16_f32 v44, v44, v45
    v_cvt_pk_bf16_f32 v45, v46, v47
    ds_write_b64 v9, v[44:45] offset:4608
    v_mul_f32 v48, s56, v48
    v_mul_f32 v49, s56, v49
    v_mul_f32 v50, s56, v50
    v_mul_f32 v51, s56, v51
    v_cvt_pk_bf16_f32 v48, v48, v49
    v_cvt_pk_bf16_f32 v49, v50, v51
    ds_write_b64 v9, v[48:49] offset:1024
    v_mul_f32 v52, s56, v52
    v_mul_f32 v53, s56, v53
    v_mul_f32 v54, s56, v54
    v_mul_f32 v55, s56, v55
    v_cvt_pk_bf16_f32 v52, v52, v53
    v_cvt_pk_bf16_f32 v53, v54, v55
    ds_write_b64 v9, v[52:53] offset:5120
    s_waitcnt lgkmcnt(0)
    s_waitcnt vmcnt(12)
    s_barrier
    ds_read_b64_tr_b16 v[12:13], v5 offset:24992
    ds_read_b64_tr_b16 v[14:15], v5 offset:26016
    ds_read_b64_tr_b16 v[16:17], v5 offset:33312
    ds_read_b64_tr_b16 v[18:19], v5 offset:34336
    ds_read_b64_tr_b16 v[20:21], v6 offset:24960
    ds_read_b64_tr_b16 v[22:23], v6 offset:25984
    ds_read_b64_tr_b16 v[24:25], v6 offset:33280
    ds_read_b64_tr_b16 v[26:27], v6 offset:34304
    s_waitcnt lgkmcnt(6)
    v_mfma_f32_16x16x32_bf16 v[56:59], v[12:15], v[240:243], v[56:59]
    ds_read_b64_tr_b16 v[28:29], v6 offset:24992
    v_mfma_f32_16x16x32_bf16 v[60:63], v[12:15], v[244:247], v[60:63]
    ds_read_b64_tr_b16 v[30:31], v6 offset:26016
    s_add_u32 m0, s52, 16640
    s_add_u32 s51, s54, 524288
    buffer_load_dwordx4 v8, s[32:35], s51 offen lds
    s_waitcnt lgkmcnt(6)
    v_mfma_f32_16x16x32_bf16 v[56:59], v[16:19], v[248:251], v[56:59]
    ds_read_b64_tr_b16 v[12:13], v6 offset:33312
    v_mfma_f32_16x16x32_bf16 v[60:63], v[16:19], v[252:255], v[60:63]
    ds_read_b64_tr_b16 v[14:15], v6 offset:34336
    s_waitcnt lgkmcnt(6)
    v_mfma_f32_16x16x32_bf16 v[64:67], v[20:23], v[240:243], v[64:67]
    ds_read_b64_tr_b16 v[16:17], v7 offset:24960
    v_mfma_f32_16x16x32_bf16 v[68:71], v[20:23], v[244:247], v[68:71]
    ds_read_b64_tr_b16 v[18:19], v7 offset:25984
    s_add_u32 m0, s52, 17664
    s_add_u32 s51, s54, 557056
    buffer_load_dwordx4 v8, s[32:35], s51 offen lds
    s_waitcnt lgkmcnt(6)
    v_mfma_f32_16x16x32_bf16 v[64:67], v[24:27], v[248:251], v[64:67]
    ds_read_b64_tr_b16 v[20:21], v7 offset:33280
    v_mfma_f32_16x16x32_bf16 v[68:71], v[24:27], v[252:255], v[68:71]
    ds_read_b64_tr_b16 v[22:23], v7 offset:34304
    s_add_u32 m0, s67, 16896
    s_add_u32 s63, s61, 16384
    buffer_load_dwordx4 v2, s[20:23], s63 offen offset:0 nt lds
    s_waitcnt lgkmcnt(6)
    v_mfma_f32_16x16x32_bf16 v[72:75], v[28:31], v[240:243], v[72:75]
    ds_read_b64_tr_b16 v[24:25], v7 offset:24992
    v_mfma_f32_16x16x32_bf16 v[76:79], v[28:31], v[244:247], v[76:79]
    ds_read_b64_tr_b16 v[26:27], v7 offset:26016
    s_add_u32 m0, s67, 16896
    s_add_u32 s63, s61, 16384
    buffer_load_dwordx4 v2, s[20:23], s63 offen offset:1024 nt lds
    v_mul_f32 v56, s56, v56
    v_mul_f32 v57, s56, v57
    v_mul_f32 v58, s56, v58
    v_mul_f32 v59, s56, v59
    v_cvt_pk_bf16_f32 v56, v56, v57
    v_cvt_pk_bf16_f32 v57, v58, v59
    ds_write_b64 v9, v[56:57] offset:1536
    v_mul_f32 v60, s56, v60
    v_mul_f32 v61, s56, v61
    v_mul_f32 v62, s56, v62
    v_mul_f32 v63, s56, v63
    v_cvt_pk_bf16_f32 v60, v60, v61
    v_cvt_pk_bf16_f32 v61, v62, v63
    ds_write_b64 v9, v[60:61] offset:5632
    s_waitcnt lgkmcnt(8)
    v_mfma_f32_16x16x32_bf16 v[72:75], v[12:15], v[248:251], v[72:75]
    ds_read_b64_tr_b16 v[28:29], v7 offset:33312
    v_mfma_f32_16x16x32_bf16 v[76:79], v[12:15], v[252:255], v[76:79]
    ds_read_b64_tr_b16 v[30:31], v7 offset:34336
    s_waitcnt lgkmcnt(8)
    v_mfma_f32_16x16x32_bf16 v[80:83], v[16:19], v[240:243], v[80:83]
    v_mfma_f32_16x16x32_bf16 v[84:87], v[16:19], v[244:247], v[84:87]
    s_add_u32 m0, s67, 16928
    s_add_u32 s63, s61, 16384
    buffer_load_dwordx4 v2, s[20:23], s63 offen offset:2048 nt lds
    v_mul_f32 v64, s56, v64
    v_mul_f32 v65, s56, v65
    v_mul_f32 v66, s56, v66
    v_mul_f32 v67, s56, v67
    v_cvt_pk_bf16_f32 v64, v64, v65
    v_cvt_pk_bf16_f32 v65, v66, v67
    ds_write_b64 v9, v[64:65] offset:2048
    v_mul_f32 v68, s56, v68
    v_mul_f32 v69, s56, v69
    v_mul_f32 v70, s56, v70
    v_mul_f32 v71, s56, v71
    v_cvt_pk_bf16_f32 v68, v68, v69
    v_cvt_pk_bf16_f32 v69, v70, v71
    ds_write_b64 v9, v[68:69] offset:6144
    s_waitcnt lgkmcnt(8)
    v_mfma_f32_16x16x32_bf16 v[80:83], v[20:23], v[248:251], v[80:83]
    v_mfma_f32_16x16x32_bf16 v[84:87], v[20:23], v[252:255], v[84:87]
    s_add_u32 m0, s67, 16928
    s_add_u32 s63, s61, 16384
    buffer_load_dwordx4 v2, s[20:23], s63 offen offset:3072 nt lds
    s_waitcnt lgkmcnt(6)
    v_mfma_f32_16x16x32_bf16 v[88:91], v[24:27], v[240:243], v[88:91]
    v_mfma_f32_16x16x32_bf16 v[92:95], v[24:27], v[244:247], v[92:95]
    v_mul_f32 v72, s56, v72
    v_mul_f32 v73, s56, v73
    v_mul_f32 v74, s56, v74
    v_mul_f32 v75, s56, v75
    v_cvt_pk_bf16_f32 v72, v72, v73
    v_cvt_pk_bf16_f32 v73, v74, v75
    ds_write_b64 v9, v[72:73] offset:2560
    v_mul_f32 v76, s56, v76
    v_mul_f32 v77, s56, v77
    v_mul_f32 v78, s56, v78
    v_mul_f32 v79, s56, v79
    v_cvt_pk_bf16_f32 v76, v76, v77
    v_cvt_pk_bf16_f32 v77, v78, v79
    ds_write_b64 v9, v[76:77] offset:6656
    s_waitcnt lgkmcnt(4)
    v_mfma_f32_16x16x32_bf16 v[88:91], v[28:31], v[248:251], v[88:91]
    v_mfma_f32_16x16x32_bf16 v[92:95], v[28:31], v[252:255], v[92:95]
    s_nop 7
    v_mul_f32 v80, s56, v80
    v_mul_f32 v81, s56, v81
    v_mul_f32 v82, s56, v82
    v_mul_f32 v83, s56, v83
    v_cvt_pk_bf16_f32 v80, v80, v81
    v_cvt_pk_bf16_f32 v81, v82, v83
    ds_write_b64 v9, v[80:81] offset:3072
    v_mul_f32 v84, s56, v84
    v_mul_f32 v85, s56, v85
    v_mul_f32 v86, s56, v86
    v_mul_f32 v87, s56, v87
    v_cvt_pk_bf16_f32 v84, v84, v85
    v_cvt_pk_bf16_f32 v85, v86, v87
    ds_write_b64 v9, v[84:85] offset:7168
    v_mul_f32 v88, s56, v88
    v_mul_f32 v89, s56, v89
    v_mul_f32 v90, s56, v90
    v_mul_f32 v91, s56, v91
    v_cvt_pk_bf16_f32 v88, v88, v89
    v_cvt_pk_bf16_f32 v89, v90, v91
    ds_write_b64 v9, v[88:89] offset:3584
    v_mul_f32 v92, s56, v92
    v_mul_f32 v93, s56, v93
    v_mul_f32 v94, s56, v94
    v_mul_f32 v95, s56, v95
    v_cvt_pk_bf16_f32 v92, v92, v93
    v_cvt_pk_bf16_f32 v93, v94, v95
    ds_write_b64 v9, v[92:93] offset:7680
    s_waitcnt lgkmcnt(0)
    s_add_u32 s50, s50, 1
    s_mov_b32 s48, s54
    s_add_u32 s54, s50, s59
    s_add_u32 s54, s54, 1
    s_and_b32 s54, s54, 3
    s_lshl_b32 s54, s54, 2
    s_add_u32 s54, s54, s58
    s_add_u32 s51, s50, 1
    s_and_b32 s51, s51, 3
    s_add_u32 s51, s51, s45
    s_and_b32 s51, s51, 3
    s_add_u32 s54, s54, s51
    s_lshl_b32 s54, s54, 8
    s_cmp_ge_u32 s50, 3
    s_cselect_b32 s54, 1073741824, s54
    s_cmp_lt_u32 s50, 4
    s_cbranch_scc1 L_rounda
    s_waitcnt vmcnt(12)
    s_barrier
    s_add_u32 m0, s68, 33792
    s_add_u32 s63, s61, 0
    buffer_load_dwordx4 v2, s[24:27], s63 offen offset:0 nt lds
    s_add_u32 m0, s68, 33824
    s_add_u32 s63, s61, 0
    buffer_load_dwordx4 v2, s[24:27], s63 offen offset:1024 nt lds
    s_add_u32 m0, s68, 33856
    s_add_u32 s63, s61, 0
    buffer_load_dwordx4 v2, s[24:27], s63 offen offset:2048 nt lds
    s_add_u32 m0, s68, 33888
    s_add_u32 s63, s61, 0
    buffer_load_dwordx4 v2, s[24:27], s63 offen offset:3072 nt lds
    s_waitcnt vmcnt(10)
    s_barrier
    s_add_u32 m0, s67, 50688
    s_add_u32 s63, s61, 32768
    buffer_load_dwordx4 v2, s[20:23], s63 offen offset:0 nt lds
    s_add_u32 m0, s67, 50688
    s_add_u32 s63, s61, 32768
    buffer_load_dwordx4 v2, s[20:23], s63 offen offset:1024 nt lds
    s_add_u32 m0, s67, 50720
    s_add_u32 s63, s61, 32768
    buffer_load_dwordx4 v2, s[20:23], s63 offen offset:2048 nt lds
    s_add_u32 m0, s67, 50720
    s_add_u32 s63, s61, 32768
    buffer_load_dwordx4 v2, s[20:23], s63 offen offset:3072 nt lds
    s_waitcnt vmcnt(8)
    s_barrier
    s_add_u32 s62, s62, 1
    s_add_u32 s60, s62, s59
    s_and_b32 s60, s60, 3
    s_lshl_b32 s60, s60, 2
    s_add_u32 s60, s60, s58
    s_add_u32 s51, s62, 0
    s_and_b32 s51, s51, 3
    s_add_u32 s51, s51, s45
    s_and_b32 s51, s51, 3
    s_add_u32 s60, s60, s51
    s_lshl_b32 s63, s44, 5
    s_add_u32 s60, s60, s63
    s_lshl_b32 s60, s60, 17
    s_add_u32 s61, s62, s59
    s_add_u32 s61, s61, 1
    s_and_b32 s61, s61, 3
    s_lshl_b32 s61, s61, 2
    s_add_u32 s61, s61, s58
    s_add_u32 s51, s62, 1
    s_and_b32 s51, s51, 3
    s_add_u32 s51, s51, s45
    s_and_b32 s51, s51, 3
    s_add_u32 s61, s61, s51
    s_add_u32 s61, s61, s63
    s_lshl_b32 s61, s61, 17
    s_cmp_eq_u32 s62, 3
    s_cselect_b32 s61, 1073741824, s61
    s_add_u32 m0, s68, 0
    s_add_u32 s63, s60, 16384
    buffer_load_dwordx4 v2, s[24:27], s63 offen offset:0 nt lds
    s_add_u32 m0, s68, 32
    s_add_u32 s63, s60, 16384
    buffer_load_dwordx4 v2, s[24:27], s63 offen offset:1024 nt lds
    s_add_u32 m0, s68, 64
    s_add_u32 s63, s60, 16384
    buffer_load_dwordx4 v2, s[24:27], s63 offen offset:2048 nt lds
    s_add_u32 m0, s68, 96
    s_add_u32 s63, s60, 16384
    buffer_load_dwordx4 v2, s[24:27], s63 offen offset:3072 nt lds
    s_waitcnt vmcnt(8)
    s_barrier
    s_add_u32 m0, s67, 16896
    s_add_u32 s63, s60, 49152
    buffer_load_dwordx4 v2, s[20:23], s63 offen offset:0 nt lds
    s_add_u32 m0, s67, 16896
    s_add_u32 s63, s60, 49152
    buffer_load_dwordx4 v2, s[20:23], s63 offen offset:1024 nt lds
    s_add_u32 m0, s67, 16928
    s_add_u32 s63, s60, 49152
    buffer_load_dwordx4 v2, s[20:23], s63 offen offset:2048 nt lds
    s_add_u32 m0, s67, 16928
    s_add_u32 s63, s60, 49152
    buffer_load_dwordx4 v2, s[20:23], s63 offen offset:3072 nt lds
    s_waitcnt vmcnt(8)
    s_barrier
    s_add_u32 m0, s68, 33792
    s_add_u32 s63, s60, 32768
    buffer_load_dwordx4 v2, s[24:27], s63 offen offset:0 nt lds
    s_add_u32 m0, s68, 33824
    s_add_u32 s63, s60, 32768
    buffer_load_dwordx4 v2, s[24:27], s63 offen offset:1024 nt lds
    s_add_u32 m0, s68, 33856
    s_add_u32 s63, s60, 32768
    buffer_load_dwordx4 v2, s[24:27], s63 offen offset:2048 nt lds
    s_add_u32 m0, s68, 33888
    s_add_u32 s63, s60, 32768
    buffer_load_dwordx4 v2, s[24:27], s63 offen offset:3072 nt lds
    s_waitcnt vmcnt(8)
    s_barrier
    s_add_u32 m0, s67, 50688
    s_add_u32 s63, s60, 65536
    buffer_load_dwordx4 v2, s[20:23], s63 offen offset:0 nt lds
    s_add_u32 m0, s67, 50688
    s_add_u32 s63, s60, 65536
    buffer_load_dwordx4 v2, s[20:23], s63 offen offset:1024 nt lds
    s_add_u32 m0, s67, 50720
    s_add_u32 s63, s60, 65536
    buffer_load_dwordx4 v2, s[20:23], s63 offen offset:2048 nt lds
    s_add_u32 m0, s67, 50720
    s_add_u32 s63, s60, 65536
    buffer_load_dwordx4 v2, s[20:23], s63 offen offset:3072 nt lds
    s_waitcnt vmcnt(8)
    s_barrier
    s_add_u32 m0, s68, 0
    s_add_u32 s63, s60, 49152
    buffer_load_dwordx4 v2, s[24:27], s63 offen offset:0 nt lds
    s_add_u32 m0, s68, 32
    s_add_u32 s63, s60, 49152
    buffer_load_dwordx4 v2, s[24:27], s63 offen offset:1024 nt lds
    s_add_u32 m0, s68, 64
    s_add_u32 s63, s60, 49152
    buffer_load_dwordx4 v2, s[24:27], s63 offen offset:2048 nt lds
    s_add_u32 m0, s68, 96
    s_add_u32 s63, s60, 49152
    buffer_load_dwordx4 v2, s[24:27], s63 offen offset:3072 nt lds
    s_mul_i32 s51, s47, 6144
    s_add_u32 s51, s51, 137984
    v_add_u32 v4, s51, v0
    ds_read_b128 v[128:131], v1 offset:0
    ds_read_b128 v[132:135], v1 offset:1024
    ds_read_b128 v[136:139], v1 offset:2048
    ds_read_b128 v[140:143], v1 offset:3072
    ds_read_b128 v[144:147], v1 offset:4096
    ds_read_b128 v[148:151], v1 offset:5120
    ds_read_b128 v[152:155], v1 offset:6144
    ds_read_b128 v[156:159], v1 offset:7168
    ds_read_b128 v[160:163], v4 offset:0
    ds_read_b128 v[164:167], v4 offset:1024
    ds_read_b128 v[168:171], v4 offset:2048
    ds_read_b128 v[172:175], v4 offset:3072
    ds_read_b128 v[176:179], v4 offset:4096
    ds_read_b128 v[180:183], v4 offset:5120
    s_waitcnt lgkmcnt(0)
    s_waitcnt vmcnt(8)
    s_barrier
    s_add_u32 m0, s67, 16896
    s_add_u32 s63, s60, 81920
    buffer_load_dwordx4 v2, s[20:23], s63 offen offset:0 nt lds
    s_add_u32 m0, s67, 16896
    s_add_u32 s63, s60, 81920
    buffer_load_dwordx4 v2, s[20:23], s63 offen offset:1024 nt lds
    s_add_u32 m0, s67, 16928
    s_add_u32 s63, s60, 81920
    buffer_load_dwordx4 v2, s[20:23], s63 offen offset:2048 nt lds
    s_add_u32 m0, s67, 16928
    s_add_u32 s63, s60, 81920
    buffer_load_dwordx4 v2, s[20:23], s63 offen offset:3072 nt lds
    s_waitcnt vmcnt(8)
    s_barrier
    s_add_u32 m0, s68, 33792
    s_add_u32 s63, s60, 65536
    buffer_load_dwordx4 v2, s[24:27], s63 offen offset:0 nt lds
    s_add_u32 m0, s68, 33824
    s_add_u32 s63, s60, 65536
    buffer_load_dwordx4 v2, s[24:27], s63 offen offset:1024 nt lds
    s_add_u32 m0, s68, 33856
    s_add_u32 s63, s60, 65536
    buffer_load_dwordx4 v2, s[24:27], s63 offen offset:2048 nt lds
    s_add_u32 m0, s68, 33888
    s_add_u32 s63, s60, 65536
    buffer_load_dwordx4 v2, s[24:27], s63 offen offset:3072 nt lds
    s_waitcnt vmcnt(8)
    s_barrier
    s_add_u32 m0, s67, 50688
    s_add_u32 s63, s60, 98304
    buffer_load_dwordx4 v2, s[20:23], s63 offen offset:0 nt lds
    s_add_u32 m0, s67, 50688
    s_add_u32 s63, s60, 98304
    buffer_load_dwordx4 v2, s[20:23], s63 offen offset:1024 nt lds
    s_add_u32 m0, s67, 50720
    s_add_u32 s63, s60, 98304
    buffer_load_dwordx4 v2, s[20:23], s63 offen offset:2048 nt lds
    s_add_u32 m0, s67, 50720
    s_add_u32 s63, s60, 98304
    buffer_load_dwordx4 v2, s[20:23], s63 offen offset:3072 nt lds
    s_waitcnt vmcnt(8)
    s_barrier
    s_add_u32 m0, s68, 0
    s_add_u32 s63, s60, 81920
    buffer_load_dwordx4 v2, s[24:27], s63 offen offset:0 nt lds
    s_add_u32 m0, s68, 32
    s_add_u32 s63, s60, 81920
    buffer_load_dwordx4 v2, s[24:27], s63 offen offset:1024 nt lds
    s_add_u32 m0, s68, 64
    s_add_u32 s63, s60, 81920
    buffer_load_dwordx4 v2, s[24:27], s63 offen offset:2048 nt lds
    s_add_u32 m0, s68, 96
    s_add_u32 s63, s60, 81920
    buffer_load_dwordx4 v2, s[24:27], s63 offen offset:3072 nt lds
    s_waitcnt vmcnt(8)
    s_barrier
    s_add_u32 m0, s67, 16896
    s_add_u32 s63, s60, 114688
    buffer_load_dwordx4 v2, s[20:23], s63 offen offset:0 nt lds
    s_add_u32 m0, s67, 16896
    s_add_u32 s63, s60, 114688
    buffer_load_dwordx4 v2, s[20:23], s63 offen offset:1024 nt lds
    s_add_u32 m0, s67, 16928
    s_add_u32 s63, s60, 114688
    buffer_load_dwordx4 v2, s[20:23], s63 offen offset:2048 nt lds
    s_add_u32 m0, s67, 16928
    s_add_u32 s63, s60, 114688
    buffer_load_dwordx4 v2, s[20:23], s63 offen offset:3072 nt lds
    s_waitcnt vmcnt(8)
    s_barrier
    s_add_u32 m0, s68, 33792
    s_add_u32 s63, s60, 98304
    buffer_load_dwordx4 v2, s[24:27], s63 offen offset:0 nt lds
    s_add_u32 m0, s68, 33824
    s_add_u32 s63, s60, 98304
    buffer_load_dwordx4 v2, s[24:27], s63 offen offset:1024 nt lds
    s_add_u32 m0, s68, 33856
    s_add_u32 s63, s60, 98304
    buffer_load_dwordx4 v2, s[24:27], s63 offen offset:2048 nt lds
    s_add_u32 m0, s68, 33888
    s_add_u32 s63, s60, 98304
    buffer_load_dwordx4 v2, s[24:27], s63 offen offset:3072 nt lds
    s_waitcnt vmcnt(8)
    s_barrier
    s_add_u32 m0, s67, 50688
    s_add_u32 s63, s61, 0
    buffer_load_dwordx4 v2, s[20:23], s63 offen offset:0 nt lds
    s_add_u32 m0, s67, 50688
    s_add_u32 s63, s61, 0
    buffer_load_dwordx4 v2, s[20:23], s63 offen offset:1024 nt lds
    s_add_u32 m0, s67, 50720
    s_add_u32 s63, s61, 0
    buffer_load_dwordx4 v2, s[20:23], s63 offen offset:2048 nt lds
    s_add_u32 m0, s67, 50720
    s_add_u32 s63, s61, 0
    buffer_load_dwordx4 v2, s[20:23], s63 offen offset:3072 nt lds
    s_waitcnt vmcnt(8)
    s_barrier
    s_add_u32 m0, s68, 0
    s_add_u32 s63, s60, 114688
    buffer_load_dwordx4 v2, s[24:27], s63 offen offset:0 nt lds
    s_add_u32 m0, s68, 32
    s_add_u32 s63, s60, 114688
    buffer_load_dwordx4 v2, s[24:27], s63 offen offset:1024 nt lds
    s_add_u32 m0, s68, 64
    s_add_u32 s63, s60, 114688
    buffer_load_dwordx4 v2, s[24:27], s63 offen offset:2048 nt lds
    s_add_u32 m0, s68, 96
    s_add_u32 s63, s60, 114688
    buffer_load_dwordx4 v2, s[24:27], s63 offen offset:3072 nt lds
    s_waitcnt vmcnt(8)
    s_barrier
    s_add_u32 m0, s67, 16896
    s_add_u32 s63, s61, 16384
    buffer_load_dwordx4 v2, s[20:23], s63 offen offset:0 nt lds
    s_add_u32 m0, s67, 16896
    s_add_u32 s63, s61, 16384
    buffer_load_dwordx4 v2, s[20:23], s63 offen offset:1024 nt lds
    s_add_u32 m0, s67, 16928
    s_add_u32 s63, s61, 16384
    buffer_load_dwordx4 v2, s[20:23], s63 offen offset:2048 nt lds
    s_add_u32 m0, s67, 16928
    s_add_u32 s63, s61, 16384
    buffer_load_dwordx4 v2, s[20:23], s63 offen offset:3072 nt lds
    s_waitcnt vmcnt(8)
    s_barrier
    s_waitcnt vmcnt(4)
    s_barrier
    s_add_u32 s55, s50, s59
    s_add_u32 s55, s55, 1
    s_and_b32 s55, s55, 3
    s_lshl_b32 s55, s55, 2
    s_add_u32 s55, s55, s58
    s_add_u32 s51, s50, 1
    s_and_b32 s51, s51, 3
    s_add_u32 s51, s51, s45
    s_and_b32 s51, s51, 3
    s_add_u32 s55, s55, s51
    s_lshl_b32 s51, s44, 5
    s_add_u32 s55, s55, s51
    s_mul_i32 s55, s55, 28672
    s_lshl_b32 s51, s47, 11
    s_add_u32 s55, s55, s51
    s_add_u32 s51, s55, 0
    buffer_store_dwordx4 v[96:99], v0, s[40:43], s51 offen offset:0
    buffer_store_dwordx4 v[100:103], v0, s[40:43], s51 offen offset:1024
    s_add_u32 s51, s55, 7168
    buffer_store_dwordx4 v[104:107], v0, s[40:43], s51 offen offset:0
    buffer_store_dwordx4 v[108:111], v0, s[40:43], s51 offen offset:1024
    s_add_u32 s51, s55, 14336
    buffer_store_dwordx4 v[112:115], v0, s[40:43], s51 offen offset:0
    buffer_store_dwordx4 v[116:119], v0, s[40:43], s51 offen offset:1024
    s_add_u32 s51, s55, 21504
    buffer_store_dwordx4 v[120:123], v0, s[40:43], s51 offen offset:0
    buffer_store_dwordx4 v[124:127], v0, s[40:43], s51 offen offset:1024
    s_add_u32 s55, s50, s59
    s_add_u32 s55, s55, 2
    s_and_b32 s55, s55, 3
    s_lshl_b32 s55, s55, 2
    s_add_u32 s55, s55, s58
    s_add_u32 s51, s50, 2
    s_and_b32 s51, s51, 3
    s_add_u32 s51, s51, s45
    s_and_b32 s51, s51, 3
    s_add_u32 s55, s55, s51
    s_lshl_b32 s51, s44, 5
    s_add_u32 s55, s55, s51
    s_mul_i32 s55, s55, 28672
    s_lshl_b32 s51, s47, 11
    s_add_u32 s55, s55, s51
    s_add_u32 s51, s55, 0
    buffer_store_dwordx4 v[128:131], v0, s[40:43], s51 offen offset:0
    buffer_store_dwordx4 v[132:135], v0, s[40:43], s51 offen offset:1024
    s_add_u32 s51, s55, 7168
    buffer_store_dwordx4 v[136:139], v0, s[40:43], s51 offen offset:0
    buffer_store_dwordx4 v[140:143], v0, s[40:43], s51 offen offset:1024
    s_add_u32 s51, s55, 14336
    buffer_store_dwordx4 v[144:147], v0, s[40:43], s51 offen offset:0
    buffer_store_dwordx4 v[148:151], v0, s[40:43], s51 offen offset:1024
    s_add_u32 s51, s55, 21504
    buffer_store_dwordx4 v[152:155], v0, s[40:43], s51 offen offset:0
    buffer_store_dwordx4 v[156:159], v0, s[40:43], s51 offen offset:1024
    s_add_u32 s55, s50, s59
    s_and_b32 s55, s55, 3
    s_lshl_b32 s55, s55, 2
    s_add_u32 s55, s55, s58
    s_add_u32 s51, s50, 0
    s_and_b32 s51, s51, 3
    s_add_u32 s51, s51, s45
    s_and_b32 s51, s51, 3
    s_add_u32 s55, s55, s51
    s_lshl_b32 s51, s44, 5
    s_add_u32 s55, s55, s51
    s_mul_i32 s55, s55, 28672
    s_lshl_b32 s51, s47, 11
    s_add_u32 s55, s55, s51
    s_add_u32 s51, s55, 0
    buffer_store_dwordx4 v[160:163], v0, s[40:43], s51 offen offset:0
    buffer_store_dwordx4 v[164:167], v0, s[40:43], s51 offen offset:1024
    s_add_u32 s51, s55, 7168
    buffer_store_dwordx4 v[168:171], v0, s[40:43], s51 offen offset:0
    buffer_store_dwordx4 v[172:175], v0, s[40:43], s51 offen offset:1024
    s_add_u32 s51, s55, 14336
    buffer_store_dwordx4 v[176:179], v0, s[40:43], s51 offen offset:0
    buffer_store_dwordx4 v[180:183], v0, s[40:43], s51 offen offset:1024
    s_endpgm
L_proj1:
    s_mul_i32 s67, s47, 4160
    s_mul_i32 s68, s47, 4224
    s_mov_b32 s62, -1
    s_add_u32 s60, s62, s59
    s_and_b32 s60, s60, 3
    s_lshl_b32 s60, s60, 2
    s_add_u32 s60, s60, s58
    s_add_u32 s51, s62, 0
    s_and_b32 s51, s51, 3
    s_add_u32 s51, s51, s45
    s_and_b32 s51, s51, 3
    s_add_u32 s60, s60, s51
    s_lshl_b32 s63, s44, 5
    s_add_u32 s60, s60, s63
    s_lshl_b32 s60, s60, 17
    s_add_u32 s61, s62, s59
    s_add_u32 s61, s61, 1
    s_and_b32 s61, s61, 3
    s_lshl_b32 s61, s61, 2
    s_add_u32 s61, s61, s58
    s_add_u32 s51, s62, 1
    s_and_b32 s51, s51, 3
    s_add_u32 s51, s51, s45
    s_and_b32 s51, s51, 3
    s_add_u32 s61, s61, s51
    s_add_u32 s61, s61, s63
    s_lshl_b32 s61, s61, 17
    s_cmp_eq_u32 s62, 3
    s_cselect_b32 s61, 1073741824, s61
    s_waitcnt vmcnt(0)
    s_add_u32 m0, s52, 0
    s_add_u32 s51, s48, 0
    buffer_load_dwordx4 v8, s[32:35], s51 offen lds
    s_add_u32 m0, s52, 1024
    s_add_u32 s51, s48, 32768
    buffer_load_dwordx4 v8, s[32:35], s51 offen lds
    s_add_u32 m0, s52, 8320
    s_add_u32 s51, s48, 262144
    buffer_load_dwordx4 v8, s[32:35], s51 offen lds
    s_add_u32 m0, s52, 9344
    s_add_u32 s51, s48, 294912
    buffer_load_dwordx4 v8, s[32:35], s51 offen lds
    s_add_u32 m0, s53, 0
    s_add_u32 s51, s49, 0
    buffer_load_dwordx4 v10, s[28:31], s51 offen lds
    s_add_u32 m0, s53, 1024
    s_add_u32 s51, s49, 10240
    buffer_load_dwordx4 v11, s[28:31], s51 offen lds
    s_add_u32 m0, s52, 16640
    s_add_u32 s51, s48, 524288
    buffer_load_dwordx4 v8, s[32:35], s51 offen lds
    s_add_u32 m0, s52, 17664
    s_add_u32 s51, s48, 557056
    buffer_load_dwordx4 v8, s[32:35], s51 offen lds
    s_add_u32 m0, s52, 24960
    s_add_u32 s51, s48, 786432
    buffer_load_dwordx4 v8, s[32:35], s51 offen lds
    s_add_u32 m0, s52, 25984
    s_add_u32 s51, s48, 819200
    buffer_load_dwordx4 v8, s[32:35], s51 offen lds
    s_add_u32 m0, s53, 4096
    s_add_u32 s51, s49, 128
    buffer_load_dwordx4 v10, s[28:31], s51 offen lds
    s_add_u32 m0, s53, 5120
    s_add_u32 s51, s49, 10368
    buffer_load_dwordx4 v11, s[28:31], s51 offen lds
    s_waitcnt vmcnt(6)
    s_barrier
    ds_read_b128 v[96:99], v254 offset:0
    ds_read_b128 v[104:107], v255 offset:0
    ds_read_b64_tr_b16 v[12:13], v4 offset:0
    ds_read_b64_tr_b16 v[14:15], v4 offset:1024
    ds_read_b64_tr_b16 v[16:17], v4 offset:32
    ds_read_b64_tr_b16 v[18:19], v4 offset:1056
    ds_read_b64_tr_b16 v[20:21], v5 offset:0
    ds_read_b64_tr_b16 v[22:23], v5 offset:1024
    ds_read_b64_tr_b16 v[24:25], v5 offset:32
    ds_read_b64_tr_b16 v[26:27], v5 offset:1056
    s_waitcnt lgkmcnt(8)
    s_waitcnt lgkmcnt(6)
    v_mfma_f32_16x16x32_bf16 v[32:35], v[12:15], v[96:99], 0
    ds_read_b64_tr_b16 v[28:29], v6 offset:0
    ds_read_b64_tr_b16 v[30:31], v6 offset:1024
    s_add_u32 m0, s52, 33280
    s_add_u32 s51, s48, 1048576
    buffer_load_dwordx4 v8, s[32:35], s51 offen lds
    s_waitcnt lgkmcnt(6)
    v_mfma_f32_16x16x32_bf16 v[40:43], v[16:19], v[96:99], 0
    ds_read_b64_tr_b16 v[12:13], v6 offset:32
    ds_read_b64_tr_b16 v[14:15], v6 offset:1056
    s_waitcnt lgkmcnt(6)
    v_mfma_f32_16x16x32_bf16 v[48:51], v[20:23], v[96:99], 0
    ds_read_b64_tr_b16 v[16:17], v7 offset:0
    ds_read_b64_tr_b16 v[18:19], v7 offset:1024
    s_waitcnt lgkmcnt(6)
    v_mfma_f32_16x16x32_bf16 v[56:59], v[24:27], v[96:99], 0
    ds_read_b64_tr_b16 v[20:21], v7 offset:32
    ds_read_b64_tr_b16 v[22:23], v7 offset:1056
    s_waitcnt lgkmcnt(6)
    v_mfma_f32_16x16x32_bf16 v[64:67], v[28:31], v[96:99], 0
    ds_read_b64_tr_b16 v[24:25], v4 offset:8320
    ds_read_b64_tr_b16 v[26:27], v4 offset:9344
    s_add_u32 m0, s52, 34304
    s_add_u32 s51, s48, 1081344
    buffer_load_dwordx4 v8, s[32:35], s51 offen lds
    s_waitcnt lgkmcnt(6)
    v_mfma_f32_16x16x32_bf16 v[72:75], v[12:15], v[96:99], 0
    ds_read_b64_tr_b16 v[28:29], v4 offset:8352
    ds_read_b64_tr_b16 v[30:31], v4 offset:9376
    s_waitcnt lgkmcnt(6)
    v_mfma_f32_16x16x32_bf16 v[80:83], v[16:19], v[96:99], 0
    ds_read_b64_tr_b16 v[12:13], v5 offset:8320
    ds_read_b64_tr_b16 v[14:15], v5 offset:9344
    s_waitcnt lgkmcnt(6)
    v_mfma_f32_16x16x32_bf16 v[88:91], v[20:23], v[96:99], 0
    ds_read_b64_tr_b16 v[16:17], v5 offset:8352
    ds_read_b64_tr_b16 v[18:19], v5 offset:9376
    s_add_u32 m0, s53, 0
    s_add_u32 s51, s49, 256
    buffer_load_dwordx4 v10, s[28:31], s51 offen lds
    s_waitcnt lgkmcnt(6)
    v_mfma_f32_16x16x32_bf16 v[32:35], v[24:27], v[104:107], v[32:35]
    ds_read_b64_tr_b16 v[20:21], v6 offset:8320
    ds_read_b64_tr_b16 v[22:23], v6 offset:9344
    s_waitcnt lgkmcnt(6)
    v_mfma_f32_16x16x32_bf16 v[40:43], v[28:31], v[104:107], v[40:43]
    ds_read_b64_tr_b16 v[24:25], v6 offset:8352
    ds_read_b64_tr_b16 v[26:27], v6 offset:9376
    s_waitcnt lgkmcnt(6)
    v_mfma_f32_16x16x32_bf16 v[48:51], v[12:15], v[104:107], v[48:51]
    ds_read_b64_tr_b16 v[28:29], v7 offset:8320
    ds_read_b64_tr_b16 v[30:31], v7 offset:9344
    s_add_u32 m0, s53, 1024
    s_add_u32 s51, s49, 10496
    buffer_load_dwordx4 v11, s[28:31], s51 offen lds
    s_waitcnt lgkmcnt(6)
    v_mfma_f32_16x16x32_bf16 v[56:59], v[16:19], v[104:107], v[56:59]
    ds_read_b64_tr_b16 v[12:13], v7 offset:8352
    ds_read_b64_tr_b16 v[14:15], v7 offset:9376
    s_waitcnt lgkmcnt(6)
    v_mfma_f32_16x16x32_bf16 v[64:67], v[20:23], v[104:107], v[64:67]
    s_waitcnt lgkmcnt(4)
    v_mfma_f32_16x16x32_bf16 v[72:75], v[24:27], v[104:107], v[72:75]
    s_waitcnt lgkmcnt(2)
    v_mfma_f32_16x16x32_bf16 v[80:83], v[28:31], v[104:107], v[80:83]
    s_waitcnt lgkmcnt(0)
    v_mfma_f32_16x16x32_bf16 v[88:91], v[12:15], v[104:107], v[88:91]
    s_waitcnt vmcnt(4)
    s_barrier
    ds_read_b128 v[112:115], v254 offset:4096
    ds_read_b128 v[120:123], v255 offset:4096
    ds_read_b64_tr_b16 v[12:13], v4 offset:16640
    ds_read_b64_tr_b16 v[14:15], v4 offset:17664
    ds_read_b64_tr_b16 v[16:17], v4 offset:16672
    ds_read_b64_tr_b16 v[18:19], v4 offset:17696
    ds_read_b64_tr_b16 v[20:21], v5 offset:16640
    ds_read_b64_tr_b16 v[22:23], v5 offset:17664
    ds_read_b64_tr_b16 v[24:25], v5 offset:16672
    ds_read_b64_tr_b16 v[26:27], v5 offset:17696
    s_waitcnt lgkmcnt(8)
    s_waitcnt lgkmcnt(6)
    v_mfma_f32_16x16x32_bf16 v[32:35], v[12:15], v[112:115], v[32:35]
    ds_read_b64_tr_b16 v[28:29], v6 offset:16640
    ds_read_b64_tr_b16 v[30:31], v6 offset:17664
    s_add_u32 m0, s52, 0
    s_add_u32 s51, s48, 1310720
    buffer_load_dwordx4 v8, s[32:35], s51 offen lds
    s_waitcnt lgkmcnt(6)
    v_mfma_f32_16x16x32_bf16 v[40:43], v[16:19], v[112:115], v[40:43]
    ds_read_b64_tr_b16 v[12:13], v6 offset:16672
    ds_read_b64_tr_b16 v[14:15], v6 offset:17696
    s_waitcnt lgkmcnt(6)
    v_mfma_f32_16x16x32_bf16 v[48:51], v[20:23], v[112:115], v[48:51]
    ds_read_b64_tr_b16 v[16:17], v7 offset:16640
    ds_read_b64_tr_b16 v[18:19], v7 offset:17664
    s_waitcnt lgkmcnt(6)
    v_mfma_f32_16x16x32_bf16 v[56:59], v[24:27], v[112:115], v[56:59]
    ds_read_b64_tr_b16 v[20:21], v7 offset:16672
    ds_read_b64_tr_b16 v[22:23], v7 offset:17696
    s_add_u32 m0, s52, 1024
    s_add_u32 s51, s48, 1343488
    buffer_load_dwordx4 v8, s[32:35], s51 offen lds
    s_waitcnt lgkmcnt(6)
    v_mfma_f32_16x16x32_bf16 v[64:67], v[28:31], v[112:115], v[64:67]
    ds_read_b64_tr_b16 v[24:25], v4 offset:24960
    ds_read_b64_tr_b16 v[26:27], v4 offset:25984
    s_waitcnt lgkmcnt(6)
    v_mfma_f32_16x16x32_bf16 v[72:75], v[12:15], v[112:115], v[72:75]
    ds_read_b64_tr_b16 v[28:29], v4 offset:24992
    ds_read_b64_tr_b16 v[30:31], v4 offset:26016
    s_add_u32 m0, s52, 8320
    s_add_u32 s51, s48, 1572864
    buffer_load_dwordx4 v8, s[32:35], s51 offen lds
    s_waitcnt lgkmcnt(6)
    v_mfma_f32_16x16x32_bf16 v[80:83], v[16:19], v[112:115], v[80:83]
    ds_read_b64_tr_b16 v[12:13], v5 offset:24960
    ds_read_b64_tr_b16 v[14:15], v5 offset:25984
    s_waitcnt lgkmcnt(6)
    v_mfma_f32_16x16x32_bf16 v[88:91], v[20:23], v[112:115], v[88:91]
    ds_read_b64_tr_b16 v[16:17], v5 offset:24992
    ds_read_b64_tr_b16 v[18:19], v5 offset:26016
    s_add_u32 m0, s52, 9344
    s_add_u32 s51, s48, 1605632
    buffer_load_dwordx4 v8, s[32:35], s51 offen lds
    s_waitcnt lgkmcnt(6)
    v_mfma_f32_16x16x32_bf16 v[32:35], v[24:27], v[120:123], v[32:35]
    ds_read_b64_tr_b16 v[20:21], v6 offset:24960
    ds_read_b64_tr_b16 v[22:23], v6 offset:25984
    s_waitcnt lgkmcnt(6)
    v_mfma_f32_16x16x32_bf16 v[40:43], v[28:31], v[120:123], v[40:43]
    ds_read_b64_tr_b16 v[24:25], v6 offset:24992
    ds_read_b64_tr_b16 v[26:27], v6 offset:26016
    s_add_u32 m0, s53, 4096
    s_add_u32 s51, s49, 384
    buffer_load_dwordx4 v10, s[28:31], s51 offen lds
    s_waitcnt lgkmcnt(6)
    v_mfma_f32_16x16x32_bf16 v[48:51], v[12:15], v[120:123], v[48:51]
    ds_read_b64_tr_b16 v[28:29], v7 offset:24960
    ds_read_b64_tr_b16 v[30:31], v7 offset:25984
    s_waitcnt lgkmcnt(6)
    v_mfma_f32_16x16x32_bf16 v[56:59], v[16:19], v[120:123], v[56:59]
    ds_read_b64_tr_b16 v[12:13], v7 offset:24992
    ds_read_b64_tr_b16 v[14:15], v7 offset:26016
    s_add_u32 m0, s53, 5120
    s_add_u32 s51, s49, 10624
    buffer_load_dwordx4 v11, s[28:31], s51 offen lds
    s_waitcnt lgkmcnt(6)
    v_mfma_f32_16x16x32_bf16 v[64:67], v[20:23], v[120:123], v[64:67]
    s_waitcnt lgkmcnt(4)
    v_mfma_f32_16x16x32_bf16 v[72:75], v[24:27], v[120:123], v[72:75]
    s_waitcnt lgkmcnt(2)
    v_mfma_f32_16x16x32_bf16 v[80:83], v[28:31], v[120:123], v[80:83]
    s_waitcnt lgkmcnt(0)
    v_mfma_f32_16x16x32_bf16 v[88:91], v[12:15], v[120:123], v[88:91]
    s_waitcnt vmcnt(4)
    s_barrier
    ds_read_b128 v[128:131], v254 offset:0
    ds_read_b128 v[136:139], v255 offset:0
    ds_read_b64_tr_b16 v[12:13], v4 offset:33280
    ds_read_b64_tr_b16 v[14:15], v4 offset:34304
    ds_read_b64_tr_b16 v[16:17], v4 offset:33312
    ds_read_b64_tr_b16 v[18:19], v4 offset:34336
    ds_read_b64_tr_b16 v[20:21], v5 offset:33280
    ds_read_b64_tr_b16 v[22:23], v5 offset:34304
    ds_read_b64_tr_b16 v[24:25], v5 offset:33312
    ds_read_b64_tr_b16 v[26:27], v5 offset:34336
    s_waitcnt lgkmcnt(8)
    s_waitcnt lgkmcnt(6)
    v_mfma_f32_16x16x32_bf16 v[32:35], v[12:15], v[128:131], v[32:35]
    ds_read_b64_tr_b16 v[28:29], v6 offset:33280
    ds_read_b64_tr_b16 v[30:31], v6 offset:34304
    s_add_u32 m0, s52, 16640
    s_add_u32 s51, s48, 1835008
    buffer_load_dwordx4 v8, s[32:35], s51 offen lds
    s_waitcnt lgkmcnt(6)
    v_mfma_f32_16x16x32_bf16 v[40:43], v[16:19], v[128:131], v[40:43]
    ds_read_b64_tr_b16 v[12:13], v6 offset:33312
    ds_read_b64_tr_b16 v[14:15], v6 offset:34336
    s_waitcnt lgkmcnt(6)
    v_mfma_f32_16x16x32_bf16 v[48:51], v[20:23], v[128:131], v[48:51]
    ds_read_b64_tr_b16 v[16:17], v7 offset:33280
    ds_read_b64_tr_b16 v[18:19], v7 offset:34304
    s_waitcnt lgkmcnt(6)
    v_mfma_f32_16x16x32_bf16 v[56:59], v[24:27], v[128:131], v[56:59]
    ds_read_b64_tr_b16 v[20:21], v7 offset:33312
    ds_read_b64_tr_b16 v[22:23], v7 offset:34336
    s_add_u32 m0, s52, 17664
    s_add_u32 s51, s48, 1867776
    buffer_load_dwordx4 v8, s[32:35], s51 offen lds
    s_waitcnt lgkmcnt(6)
    v_mfma_f32_16x16x32_bf16 v[64:67], v[28:31], v[128:131], v[64:67]
    ds_read_b64_tr_b16 v[24:25], v4 offset:0
    ds_read_b64_tr_b16 v[26:27], v4 offset:1024
    s_waitcnt lgkmcnt(6)
    v_mfma_f32_16x16x32_bf16 v[72:75], v[12:15], v[128:131], v[72:75]
    ds_read_b64_tr_b16 v[28:29], v4 offset:32
    ds_read_b64_tr_b16 v[30:31], v4 offset:1056
    s_add_u32 m0, s52, 24960
    s_add_u32 s51, s48, 2097152
    buffer_load_dwordx4 v8, s[32:35], s51 offen lds
    s_waitcnt lgkmcnt(6)
    v_mfma_f32_16x16x32_bf16 v[80:83], v[16:19], v[128:131], v[80:83]
    ds_read_b64_tr_b16 v[12:13], v5 offset:0
    ds_read_b64_tr_b16 v[14:15], v5 offset:1024
    s_waitcnt lgkmcnt(6)
    v_mfma_f32_16x16x32_bf16 v[88:91], v[20:23], v[128:131], v[88:91]
    ds_read_b64_tr_b16 v[16:17], v5 offset:32
    ds_read_b64_tr_b16 v[18:19], v5 offset:1056
    s_add_u32 m0, s52, 25984
    s_add_u32 s51, s48, 2129920
    buffer_load_dwordx4 v8, s[32:35], s51 offen lds
    s_waitcnt lgkmcnt(6)
    v_mfma_f32_16x16x32_bf16 v[32:35], v[24:27], v[136:139], v[32:35]
    ds_read_b64_tr_b16 v[20:21], v6 offset:0
    ds_read_b64_tr_b16 v[22:23], v6 offset:1024
    s_waitcnt lgkmcnt(6)
    v_mfma_f32_16x16x32_bf16 v[40:43], v[28:31], v[136:139], v[40:43]
    ds_read_b64_tr_b16 v[24:25], v6 offset:32
    ds_read_b64_tr_b16 v[26:27], v6 offset:1056
    s_add_u32 m0, s53, 0
    s_add_u32 s51, s49, 512
    buffer_load_dwordx4 v10, s[28:31], s51 offen lds
    s_waitcnt lgkmcnt(6)
    v_mfma_f32_16x16x32_bf16 v[48:51], v[12:15], v[136:139], v[48:51]
    ds_read_b64_tr_b16 v[28:29], v7 offset:0
    ds_read_b64_tr_b16 v[30:31], v7 offset:1024
    s_waitcnt lgkmcnt(6)
    v_mfma_f32_16x16x32_bf16 v[56:59], v[16:19], v[136:139], v[56:59]
    ds_read_b64_tr_b16 v[12:13], v7 offset:32
    ds_read_b64_tr_b16 v[14:15], v7 offset:1056
    s_add_u32 m0, s53, 1024
    s_add_u32 s51, s49, 10752
    buffer_load_dwordx4 v11, s[28:31], s51 offen lds
    s_waitcnt lgkmcnt(6)
    v_mfma_f32_16x16x32_bf16 v[64:67], v[20:23], v[136:139], v[64:67]
    s_waitcnt lgkmcnt(4)
    v_mfma_f32_16x16x32_bf16 v[72:75], v[24:27], v[136:139], v[72:75]
    s_waitcnt lgkmcnt(2)
    v_mfma_f32_16x16x32_bf16 v[80:83], v[28:31], v[136:139], v[80:83]
    s_waitcnt lgkmcnt(0)
    v_mfma_f32_16x16x32_bf16 v[88:91], v[12:15], v[136:139], v[88:91]
    s_waitcnt vmcnt(4)
    s_barrier
    ds_read_b128 v[144:147], v254 offset:4096
    ds_read_b128 v[152:155], v255 offset:4096
    ds_read_b64_tr_b16 v[12:13], v4 offset:8320
    ds_read_b64_tr_b16 v[14:15], v4 offset:9344
    ds_read_b64_tr_b16 v[16:17], v4 offset:8352
    ds_read_b64_tr_b16 v[18:19], v4 offset:9376
    ds_read_b64_tr_b16 v[20:21], v5 offset:8320
    ds_read_b64_tr_b16 v[22:23], v5 offset:9344
    ds_read_b64_tr_b16 v[24:25], v5 offset:8352
    ds_read_b64_tr_b16 v[26:27], v5 offset:9376
    s_waitcnt lgkmcnt(8)
    s_waitcnt lgkmcnt(6)
    v_mfma_f32_16x16x32_bf16 v[32:35], v[12:15], v[144:147], v[32:35]
    ds_read_b64_tr_b16 v[28:29], v6 offset:8320
    ds_read_b64_tr_b16 v[30:31], v6 offset:9344
    s_add_u32 m0, s52, 33280
    s_add_u32 s51, s48, 2359296
    buffer_load_dwordx4 v8, s[32:35], s51 offen lds
    s_waitcnt lgkmcnt(6)
    v_mfma_f32_16x16x32_bf16 v[40:43], v[16:19], v[144:147], v[40:43]
    ds_read_b64_tr_b16 v[12:13], v6 offset:8352
    ds_read_b64_tr_b16 v[14:15], v6 offset:9376
    s_waitcnt lgkmcnt(6)
    v_mfma_f32_16x16x32_bf16 v[48:51], v[20:23], v[144:147], v[48:51]
    ds_read_b64_tr_b16 v[16:17], v7 offset:8320
    ds_read_b64_tr_b16 v[18:19], v7 offset:9344
    s_add_u32 m0, s52, 34304
    s_add_u32 s51, s48, 2392064
    buffer_load_dwordx4 v8, s[32:35], s51 offen lds
    s_waitcnt lgkmcnt(6)
    v_mfma_f32_16x16x32_bf16 v[56:59], v[24:27], v[144:147], v[56:59]
    ds_read_b64_tr_b16 v[20:21], v7 offset:8352
    ds_read_b64_tr_b16 v[22:23], v7 offset:9376
    s_add_u32 m0, s52, 0
    s_add_u32 s51, s48, 2621440
    buffer_load_dwordx4 v8, s[32:35], s51 offen lds
    s_waitcnt lgkmcnt(6)
    v_mfma_f32_16x16x32_bf16 v[64:67], v[28:31], v[144:147], v[64:67]
    ds_read_b64_tr_b16 v[24:25], v4 offset:16640
    ds_read_b64_tr_b16 v[26:27], v4 offset:17664
    s_add_u32 m0, s52, 1024
    s_add_u32 s51, s48, 2654208
    buffer_load_dwordx4 v8, s[32:35], s51 offen lds
    s_waitcnt lgkmcnt(6)
    v_mfma_f32_16x16x32_bf16 v[72:75], v[12:15], v[144:147], v[72:75]
    ds_read_b64_tr_b16 v[28:29], v4 offset:16672
    ds_read_b64_tr_b16 v[30:31], v4 offset:17696
    s_waitcnt lgkmcnt(6)
    v_mfma_f32_16x16x32_bf16 v[80:83], v[16:19], v[144:147], v[80:83]
    ds_read_b64_tr_b16 v[12:13], v5 offset:16640
    ds_read_b64_tr_b16 v[14:15], v5 offset:17664
    s_add_u32 m0, s53, 4096
    s_add_u32 s51, s49, 640
    buffer_load_dwordx4 v10, s[28:31], s51 offen lds
    s_waitcnt lgkmcnt(6)
    v_mfma_f32_16x16x32_bf16 v[88:91], v[20:23], v[144:147], v[88:91]
    ds_read_b64_tr_b16 v[16:17], v5 offset:16672
    ds_read_b64_tr_b16 v[18:19], v5 offset:17696
    s_add_u32 m0, s53, 5120
    s_add_u32 s51, s49, 10880
    buffer_load_dwordx4 v11, s[28:31], s51 offen lds
    s_waitcnt lgkmcnt(6)
    v_mfma_f32_16x16x32_bf16 v[32:35], v[24:27], v[152:155], v[32:35]
    ds_read_b64_tr_b16 v[20:21], v6 offset:16640
    ds_read_b64_tr_b16 v[22:23], v6 offset:17664
    s_add_u32 m0, s67, 50688
    s_add_u32 s63, s61, 0
    buffer_load_dwordx4 v2, s[20:23], s63 offen offset:0 nt lds
    s_waitcnt lgkmcnt(6)
    v_mfma_f32_16x16x32_bf16 v[40:43], v[28:31], v[152:155], v[40:43]
    ds_read_b64_tr_b16 v[24:25], v6 offset:16672
    ds_read_b64_tr_b16 v[26:27], v6 offset:17696
    s_add_u32 m0, s67, 50688
    s_add_u32 s63, s61, 0
    buffer_load_dwordx4 v2, s[20:23], s63 offen offset:1024 nt lds
    s_waitcnt lgkmcnt(6)
    v_mfma_f32_16x16x32_bf16 v[48:51], v[12:15], v[152:155], v[48:51]
    ds_read_b64_tr_b16 v[28:29], v7 offset:16640
    ds_read_b64_tr_b16 v[30:31], v7 offset:17664
    s_waitcnt lgkmcnt(6)
    v_mfma_f32_16x16x32_bf16 v[56:59], v[16:19], v[152:155], v[56:59]
    ds_read_b64_tr_b16 v[12:13], v7 offset:16672
    ds_read_b64_tr_b16 v[14:15], v7 offset:17696
    s_add_u32 m0, s67, 50720
    s_add_u32 s63, s61, 0
    buffer_load_dwordx4 v2, s[20:23], s63 offen offset:2048 nt lds
    s_waitcnt lgkmcnt(6)
    v_mfma_f32_16x16x32_bf16 v[64:67], v[20:23], v[152:155], v[64:67]
    s_add_u32 m0, s67, 50720
    s_add_u32 s63, s61, 0
    buffer_load_dwordx4 v2, s[20:23], s63 offen offset:3072 nt lds
    s_waitcnt lgkmcnt(4)
    v_mfma_f32_16x16x32_bf16 v[72:75], v[24:27], v[152:155], v[72:75]
    s_waitcnt lgkmcnt(2)
    v_mfma_f32_16x16x32_bf16 v[80:83], v[28:31], v[152:155], v[80:83]
    s_waitcnt lgkmcnt(0)
    v_mfma_f32_16x16x32_bf16 v[88:91], v[12:15], v[152:155], v[88:91]
    s_waitcnt vmcnt(8)
    s_barrier
    ds_read_b128 v[160:163], v254 offset:0
    ds_read_b128 v[168:171], v255 offset:0
    ds_read_b64_tr_b16 v[12:13], v4 offset:24960
    ds_read_b64_tr_b16 v[14:15], v4 offset:25984
    ds_read_b64_tr_b16 v[16:17], v4 offset:24992
    ds_read_b64_tr_b16 v[18:19], v4 offset:26016
    ds_read_b64_tr_b16 v[20:21], v5 offset:24960
    ds_read_b64_tr_b16 v[22:23], v5 offset:25984
    ds_read_b64_tr_b16 v[24:25], v5 offset:24992
    ds_read_b64_tr_b16 v[26:27], v5 offset:26016
    s_waitcnt lgkmcnt(8)
    s_waitcnt lgkmcnt(6)
    v_mfma_f32_16x16x32_bf16 v[32:35], v[12:15], v[160:163], v[32:35]
    ds_read_b64_tr_b16 v[28:29], v6 offset:24960
    ds_read_b64_tr_b16 v[30:31], v6 offset:25984
    s_add_u32 m0, s52, 8320
    s_add_u32 s51, s48, 2883584
    buffer_load_dwordx4 v8, s[32:35], s51 offen lds
    s_waitcnt lgkmcnt(6)
    v_mfma_f32_16x16x32_bf16 v[40:43], v[16:19], v[160:163], v[40:43]
    ds_read_b64_tr_b16 v[12:13], v6 offset:24992
    ds_read_b64_tr_b16 v[14:15], v6 offset:26016
    s_waitcnt lgkmcnt(6)
    v_mfma_f32_16x16x32_bf16 v[48:51], v[20:23], v[160:163], v[48:51]
    ds_read_b64_tr_b16 v[16:17], v7 offset:24960
    ds_read_b64_tr_b16 v[18:19], v7 offset:25984
    s_waitcnt lgkmcnt(6)
    v_mfma_f32_16x16x32_bf16 v[56:59], v[24:27], v[160:163], v[56:59]
    ds_read_b64_tr_b16 v[20:21], v7 offset:24992
    ds_read_b64_tr_b16 v[22:23], v7 offset:26016
    s_add_u32 m0, s52, 9344
    s_add_u32 s51, s48, 2916352
    buffer_load_dwordx4 v8, s[32:35], s51 offen lds
    s_waitcnt lgkmcnt(6)
    v_mfma_f32_16x16x32_bf16 v[64:67], v[28:31], v[160:163], v[64:67]
    ds_read_b64_tr_b16 v[24:25], v4 offset:33280
    ds_read_b64_tr_b16 v[26:27], v4 offset:34304
    s_waitcnt lgkmcnt(6)
    v_mfma_f32_16x16x32_bf16 v[72:75], v[12:15], v[160:163], v[72:75]
    ds_read_b64_tr_b16 v[28:29], v4 offset:33312
    ds_read_b64_tr_b16 v[30:31], v4 offset:34336
    s_add_u32 m0, s52, 16640
    s_add_u32 s51, s48, 3145728
    buffer_load_dwordx4 v8, s[32:35], s51 offen lds
    s_waitcnt lgkmcnt(6)
    v_mfma_f32_16x16x32_bf16 v[80:83], v[16:19], v[160:163], v[80:83]
    ds_read_b64_tr_b16 v[12:13], v5 offset:33280
    ds_read_b64_tr_b16 v[14:15], v5 offset:34304
    s_waitcnt lgkmcnt(6)
    v_mfma_f32_16x16x32_bf16 v[88:91], v[20:23], v[160:163], v[88:91]
    ds_read_b64_tr_b16 v[16:17], v5 offset:33312
    ds_read_b64_tr_b16 v[18:19], v5 offset:34336
    s_add_u32 m0, s52, 17664
    s_add_u32 s51, s48, 3178496
    buffer_load_dwordx4 v8, s[32:35], s51 offen lds
    s_waitcnt lgkmcnt(6)
    v_mfma_f32_16x16x32_bf16 v[32:35], v[24:27], v[168:171], v[32:35]
    ds_read_b64_tr_b16 v[20:21], v6 offset:33280
    ds_read_b64_tr_b16 v[22:23], v6 offset:34304
    s_waitcnt lgkmcnt(6)
    v_mfma_f32_16x16x32_bf16 v[40:43], v[28:31], v[168:171], v[40:43]
    ds_read_b64_tr_b16 v[24:25], v6 offset:33312
    ds_read_b64_tr_b16 v[26:27], v6 offset:34336
    s_add_u32 m0, s53, 0
    s_add_u32 s51, s49, 768
    buffer_load_dwordx4 v10, s[28:31], s51 offen lds
    s_waitcnt lgkmcnt(6)
    v_mfma_f32_16x16x32_bf16 v[48:51], v[12:15], v[168:171], v[48:51]
    ds_read_b64_tr_b16 v[28:29], v7 offset:33280
    ds_read_b64_tr_b16 v[30:31], v7 offset:34304
    s_waitcnt lgkmcnt(6)
    v_mfma_f32_16x16x32_bf16 v[56:59], v[16:19], v[168:171], v[56:59]
    ds_read_b64_tr_b16 v[12:13], v7 offset:33312
    ds_read_b64_tr_b16 v[14:15], v7 offset:34336
    s_add_u32 m0, s53, 1024
    s_add_u32 s51, s49, 11008
    buffer_load_dwordx4 v11, s[28:31], s51 offen lds
    s_waitcnt lgkmcnt(6)
    v_mfma_f32_16x16x32_bf16 v[64:67], v[20:23], v[168:171], v[64:67]
    s_waitcnt lgkmcnt(4)
    v_mfma_f32_16x16x32_bf16 v[72:75], v[24:27], v[168:171], v[72:75]
    s_waitcnt lgkmcnt(2)
    v_mfma_f32_16x16x32_bf16 v[80:83], v[28:31], v[168:171], v[80:83]
    s_waitcnt lgkmcnt(0)
    v_mfma_f32_16x16x32_bf16 v[88:91], v[12:15], v[168:171], v[88:91]
    s_waitcnt vmcnt(4)
    s_barrier
    ds_read_b128 v[176:179], v254 offset:4096
    ds_read_b128 v[184:187], v255 offset:4096
    ds_read_b64_tr_b16 v[12:13], v4 offset:0
    ds_read_b64_tr_b16 v[14:15], v4 offset:1024
    ds_read_b64_tr_b16 v[16:17], v4 offset:32
    ds_read_b64_tr_b16 v[18:19], v4 offset:1056
    ds_read_b64_tr_b16 v[20:21], v5 offset:0
    ds_read_b64_tr_b16 v[22:23], v5 offset:1024
    ds_read_b64_tr_b16 v[24:25], v5 offset:32
    ds_read_b64_tr_b16 v[26:27], v5 offset:1056
    s_waitcnt lgkmcnt(8)
    s_waitcnt lgkmcnt(6)
    v_mfma_f32_16x16x32_bf16 v[32:35], v[12:15], v[176:179], v[32:35]
    ds_read_b64_tr_b16 v[28:29], v6 offset:0
    ds_read_b64_tr_b16 v[30:31], v6 offset:1024
    s_add_u32 m0, s52, 24960
    s_add_u32 s51, s48, 3407872
    buffer_load_dwordx4 v8, s[32:35], s51 offen lds
    s_waitcnt lgkmcnt(6)
    v_mfma_f32_16x16x32_bf16 v[40:43], v[16:19], v[176:179], v[40:43]
    ds_read_b64_tr_b16 v[12:13], v6 offset:32
    ds_read_b64_tr_b16 v[14:15], v6 offset:1056
    s_waitcnt lgkmcnt(6)
    v_mfma_f32_16x16x32_bf16 v[48:51], v[20:23], v[176:179], v[48:51]
    ds_read_b64_tr_b16 v[16:17], v7 offset:0
    ds_read_b64_tr_b16 v[18:19], v7 offset:1024
    s_waitcnt lgkmcnt(6)
    v_mfma_f32_16x16x32_bf16 v[56:59], v[24:27], v[176:179], v[56:59]
    ds_read_b64_tr_b16 v[20:21], v7 offset:32
    ds_read_b64_tr_b16 v[22:23], v7 offset:1056
    s_add_u32 m0, s52, 25984
    s_add_u32 s51, s48, 3440640
    buffer_load_dwordx4 v8, s[32:35], s51 offen lds
    s_waitcnt lgkmcnt(6)
    v_mfma_f32_16x16x32_bf16 v[64:67], v[28:31], v[176:179], v[64:67]
    ds_read_b64_tr_b16 v[24:25], v4 offset:8320
    ds_read_b64_tr_b16 v[26:27], v4 offset:9344
    s_waitcnt lgkmcnt(6)
    v_mfma_f32_16x16x32_bf16 v[72:75], v[12:15], v[176:179], v[72:75]
    ds_read_b64_tr_b16 v[28:29], v4 offset:8352
    ds_read_b64_tr_b16 v[30:31], v4 offset:9376
    s_add_u32 m0, s52, 33280
    s_add_u32 s51, s48, 3670016
    buffer_load_dwordx4 v8, s[32:35], s51 offen lds
    s_waitcnt lgkmcnt(6)
    v_mfma_f32_16x16x32_bf16 v[80:83], v[16:19], v[176:179], v[80:83]
    ds_read_b64_tr_b16 v[12:13], v5 offset:8320
    ds_read_b64_tr_b16 v[14:15], v5 offset:9344
    s_waitcnt lgkmcnt(6)
    v_mfma_f32_16x16x32_bf16 v[88:91], v[20:23], v[176:179], v[88:91]
    ds_read_b64_tr_b16 v[16:17], v5 offset:8352
    ds_read_b64_tr_b16 v[18:19], v5 offset:9376
    s_add_u32 m0, s52, 34304
    s_add_u32 s51, s48, 3702784
    buffer_load_dwordx4 v8, s[32:35], s51 offen lds
    s_waitcnt lgkmcnt(6)
    v_mfma_f32_16x16x32_bf16 v[32:35], v[24:27], v[184:187], v[32:35]
    ds_read_b64_tr_b16 v[20:21], v6 offset:8320
    ds_read_b64_tr_b16 v[22:23], v6 offset:9344
    s_waitcnt lgkmcnt(6)
    v_mfma_f32_16x16x32_bf16 v[40:43], v[28:31], v[184:187], v[40:43]
    ds_read_b64_tr_b16 v[24:25], v6 offset:8352
    ds_read_b64_tr_b16 v[26:27], v6 offset:9376
    s_add_u32 m0, s53, 4096
    s_add_u32 s51, s49, 896
    buffer_load_dwordx4 v10, s[28:31], s51 offen lds
    s_waitcnt lgkmcnt(6)
    v_mfma_f32_16x16x32_bf16 v[48:51], v[12:15], v[184:187], v[48:51]
    ds_read_b64_tr_b16 v[28:29], v7 offset:8320
    ds_read_b64_tr_b16 v[30:31], v7 offset:9344
    s_waitcnt lgkmcnt(6)
    v_mfma_f32_16x16x32_bf16 v[56:59], v[16:19], v[184:187], v[56:59]
    ds_read_b64_tr_b16 v[12:13], v7 offset:8352
    ds_read_b64_tr_b16 v[14:15], v7 offset:9376
    s_add_u32 m0, s53, 5120
    s_add_u32 s51, s49, 11136
    buffer_load_dwordx4 v11, s[28:31], s51 offen lds
    s_waitcnt lgkmcnt(6)
    v_mfma_f32_16x16x32_bf16 v[64:67], v[20:23], v[184:187], v[64:67]
    s_waitcnt lgkmcnt(4)
    v_mfma_f32_16x16x32_bf16 v[72:75], v[24:27], v[184:187], v[72:75]
    s_waitcnt lgkmcnt(2)
    v_mfma_f32_16x16x32_bf16 v[80:83], v[28:31], v[184:187], v[80:83]
    s_waitcnt lgkmcnt(0)
    v_mfma_f32_16x16x32_bf16 v[88:91], v[12:15], v[184:187], v[88:91]
    s_waitcnt vmcnt(4)
    s_barrier
    ds_read_b128 v[192:195], v254 offset:0
    ds_read_b128 v[200:203], v255 offset:0
    ds_read_b64_tr_b16 v[12:13], v4 offset:16640
    ds_read_b64_tr_b16 v[14:15], v4 offset:17664
    ds_read_b64_tr_b16 v[16:17], v4 offset:16672
    ds_read_b64_tr_b16 v[18:19], v4 offset:17696
    ds_read_b64_tr_b16 v[20:21], v5 offset:16640
    ds_read_b64_tr_b16 v[22:23], v5 offset:17664
    ds_read_b64_tr_b16 v[24:25], v5 offset:16672
    ds_read_b64_tr_b16 v[26:27], v5 offset:17696
    s_waitcnt lgkmcnt(8)
    s_waitcnt lgkmcnt(6)
    v_mfma_f32_16x16x32_bf16 v[32:35], v[12:15], v[192:195], v[32:35]
    ds_read_b64_tr_b16 v[28:29], v6 offset:16640
    ds_read_b64_tr_b16 v[30:31], v6 offset:17664
    s_add_u32 m0, s52, 0
    s_add_u32 s51, s48, 3932160
    buffer_load_dwordx4 v8, s[32:35], s51 offen lds
    s_waitcnt lgkmcnt(6)
    v_mfma_f32_16x16x32_bf16 v[40:43], v[16:19], v[192:195], v[40:43]
    ds_read_b64_tr_b16 v[12:13], v6 offset:16672
    ds_read_b64_tr_b16 v[14:15], v6 offset:17696
    s_waitcnt lgkmcnt(6)
    v_mfma_f32_16x16x32_bf16 v[48:51], v[20:23], v[192:195], v[48:51]
    ds_read_b64_tr_b16 v[16:17], v7 offset:16640
    ds_read_b64_tr_b16 v[18:19], v7 offset:17664
    s_waitcnt lgkmcnt(6)
    v_mfma_f32_16x16x32_bf16 v[56:59], v[24:27], v[192:195], v[56:59]
    ds_read_b64_tr_b16 v[20:21], v7 offset:16672
    ds_read_b64_tr_b16 v[22:23], v7 offset:17696
    s_add_u32 m0, s52, 1024
    s_add_u32 s51, s48, 3964928
    buffer_load_dwordx4 v8, s[32:35], s51 offen lds
    s_waitcnt lgkmcnt(6)
    v_mfma_f32_16x16x32_bf16 v[64:67], v[28:31], v[192:195], v[64:67]
    ds_read_b64_tr_b16 v[24:25], v4 offset:24960
    ds_read_b64_tr_b16 v[26:27], v4 offset:25984
    s_waitcnt lgkmcnt(6)
    v_mfma_f32_16x16x32_bf16 v[72:75], v[12:15], v[192:195], v[72:75]
    ds_read_b64_tr_b16 v[28:29], v4 offset:24992
    ds_read_b64_tr_b16 v[30:31], v4 offset:26016
    s_add_u32 m0, s52, 8320
    s_add_u32 s51, s48, 4194304
    buffer_load_dwordx4 v8, s[32:35], s51 offen lds
    s_waitcnt lgkmcnt(6)
    v_mfma_f32_16x16x32_bf16 v[80:83], v[16:19], v[192:195], v[80:83]
    ds_read_b64_tr_b16 v[12:13], v5 offset:24960
    ds_read_b64_tr_b16 v[14:15], v5 offset:25984
    s_waitcnt lgkmcnt(6)
    v_mfma_f32_16x16x32_bf16 v[88:91], v[20:23], v[192:195], v[88:91]
    ds_read_b64_tr_b16 v[16:17], v5 offset:24992
    ds_read_b64_tr_b16 v[18:19], v5 offset:26016
    s_add_u32 m0, s52, 9344
    s_add_u32 s51, s48, 4227072
    buffer_load_dwordx4 v8, s[32:35], s51 offen lds
    s_waitcnt lgkmcnt(6)
    v_mfma_f32_16x16x32_bf16 v[32:35], v[24:27], v[200:203], v[32:35]
    ds_read_b64_tr_b16 v[20:21], v6 offset:24960
    ds_read_b64_tr_b16 v[22:23], v6 offset:25984
    s_waitcnt lgkmcnt(6)
    v_mfma_f32_16x16x32_bf16 v[40:43], v[28:31], v[200:203], v[40:43]
    ds_read_b64_tr_b16 v[24:25], v6 offset:24992
    ds_read_b64_tr_b16 v[26:27], v6 offset:26016
    s_add_u32 m0, s53, 0
    s_add_u32 s51, s49, 1024
    buffer_load_dwordx4 v10, s[28:31], s51 offen lds
    s_waitcnt lgkmcnt(6)
    v_mfma_f32_16x16x32_bf16 v[48:51], v[12:15], v[200:203], v[48:51]
    ds_read_b64_tr_b16 v[28:29], v7 offset:24960
    ds_read_b64_tr_b16 v[30:31], v7 offset:25984
    s_waitcnt lgkmcnt(6)
    v_mfma_f32_16x16x32_bf16 v[56:59], v[16:19], v[200:203], v[56:59]
    ds_read_b64_tr_b16 v[12:13], v7 offset:24992
    ds_read_b64_tr_b16 v[14:15], v7 offset:26016
    s_add_u32 m0, s53, 1024
    s_add_u32 s51, s49, 11264
    buffer_load_dwordx4 v11, s[28:31], s51 offen lds
    s_waitcnt lgkmcnt(6)
    v_mfma_f32_16x16x32_bf16 v[64:67], v[20:23], v[200:203], v[64:67]
    s_waitcnt lgkmcnt(4)
    v_mfma_f32_16x16x32_bf16 v[72:75], v[24:27], v[200:203], v[72:75]
    s_waitcnt lgkmcnt(2)
    v_mfma_f32_16x16x32_bf16 v[80:83], v[28:31], v[200:203], v[80:83]
    s_waitcnt lgkmcnt(0)
    v_mfma_f32_16x16x32_bf16 v[88:91], v[12:15], v[200:203], v[88:91]
    s_waitcnt vmcnt(4)
    s_barrier
    ds_read_b128 v[208:211], v254 offset:4096
    ds_read_b128 v[216:219], v255 offset:4096
    ds_read_b64_tr_b16 v[12:13], v4 offset:33280
    ds_read_b64_tr_b16 v[14:15], v4 offset:34304
    ds_read_b64_tr_b16 v[16:17], v4 offset:33312
    ds_read_b64_tr_b16 v[18:19], v4 offset:34336
    ds_read_b64_tr_b16 v[20:21], v5 offset:33280
    ds_read_b64_tr_b16 v[22:23], v5 offset:34304
    ds_read_b64_tr_b16 v[24:25], v5 offset:33312
    ds_read_b64_tr_b16 v[26:27], v5 offset:34336
    s_waitcnt lgkmcnt(8)
    s_waitcnt lgkmcnt(6)
    v_mfma_f32_16x16x32_bf16 v[32:35], v[12:15], v[208:211], v[32:35]
    ds_read_b64_tr_b16 v[28:29], v6 offset:33280
    ds_read_b64_tr_b16 v[30:31], v6 offset:34304
    s_add_u32 m0, s52, 16640
    s_add_u32 s51, s48, 4456448
    buffer_load_dwordx4 v8, s[32:35], s51 offen lds
    s_waitcnt lgkmcnt(6)
    v_mfma_f32_16x16x32_bf16 v[40:43], v[16:19], v[208:211], v[40:43]
    ds_read_b64_tr_b16 v[12:13], v6 offset:33312
    ds_read_b64_tr_b16 v[14:15], v6 offset:34336
    s_waitcnt lgkmcnt(6)
    v_mfma_f32_16x16x32_bf16 v[48:51], v[20:23], v[208:211], v[48:51]
    ds_read_b64_tr_b16 v[16:17], v7 offset:33280
    ds_read_b64_tr_b16 v[18:19], v7 offset:34304
    s_waitcnt lgkmcnt(6)
    v_mfma_f32_16x16x32_bf16 v[56:59], v[24:27], v[208:211], v[56:59]
    ds_read_b64_tr_b16 v[20:21], v7 offset:33312
    ds_read_b64_tr_b16 v[22:23], v7 offset:34336
    s_add_u32 m0, s52, 17664
    s_add_u32 s51, s48, 4489216
    buffer_load_dwordx4 v8, s[32:35], s51 offen lds
    s_waitcnt lgkmcnt(6)
    v_mfma_f32_16x16x32_bf16 v[64:67], v[28:31], v[208:211], v[64:67]
    ds_read_b64_tr_b16 v[24:25], v4 offset:0
    ds_read_b64_tr_b16 v[26:27], v4 offset:1024
    s_waitcnt lgkmcnt(6)
    v_mfma_f32_16x16x32_bf16 v[72:75], v[12:15], v[208:211], v[72:75]
    ds_read_b64_tr_b16 v[28:29], v4 offset:32
    ds_read_b64_tr_b16 v[30:31], v4 offset:1056
    s_add_u32 m0, s52, 24960
    s_add_u32 s51, s48, 4718592
    buffer_load_dwordx4 v8, s[32:35], s51 offen lds
    s_waitcnt lgkmcnt(6)
    v_mfma_f32_16x16x32_bf16 v[80:83], v[16:19], v[208:211], v[80:83]
    ds_read_b64_tr_b16 v[12:13], v5 offset:0
    ds_read_b64_tr_b16 v[14:15], v5 offset:1024
    s_waitcnt lgkmcnt(6)
    v_mfma_f32_16x16x32_bf16 v[88:91], v[20:23], v[208:211], v[88:91]
    ds_read_b64_tr_b16 v[16:17], v5 offset:32
    ds_read_b64_tr_b16 v[18:19], v5 offset:1056
    s_add_u32 m0, s52, 25984
    s_add_u32 s51, s48, 4751360
    buffer_load_dwordx4 v8, s[32:35], s51 offen lds
    s_waitcnt lgkmcnt(6)
    v_mfma_f32_16x16x32_bf16 v[32:35], v[24:27], v[216:219], v[32:35]
    ds_read_b64_tr_b16 v[20:21], v6 offset:0
    ds_read_b64_tr_b16 v[22:23], v6 offset:1024
    s_waitcnt lgkmcnt(6)
    v_mfma_f32_16x16x32_bf16 v[40:43], v[28:31], v[216:219], v[40:43]
    ds_read_b64_tr_b16 v[24:25], v6 offset:32
    ds_read_b64_tr_b16 v[26:27], v6 offset:1056
    s_add_u32 m0, s53, 4096
    s_add_u32 s51, s49, 1152
    buffer_load_dwordx4 v10, s[28:31], s51 offen lds
    s_waitcnt lgkmcnt(6)
    v_mfma_f32_16x16x32_bf16 v[48:51], v[12:15], v[216:219], v[48:51]
    ds_read_b64_tr_b16 v[28:29], v7 offset:0
    ds_read_b64_tr_b16 v[30:31], v7 offset:1024
    s_waitcnt lgkmcnt(6)
    v_mfma_f32_16x16x32_bf16 v[56:59], v[16:19], v[216:219], v[56:59]
    ds_read_b64_tr_b16 v[12:13], v7 offset:32
    ds_read_b64_tr_b16 v[14:15], v7 offset:1056
    s_add_u32 m0, s53, 5120
    s_add_u32 s51, s49, 11392
    buffer_load_dwordx4 v11, s[28:31], s51 offen lds
    s_waitcnt lgkmcnt(6)
    v_mfma_f32_16x16x32_bf16 v[64:67], v[20:23], v[216:219], v[64:67]
    s_waitcnt lgkmcnt(4)
    v_mfma_f32_16x16x32_bf16 v[72:75], v[24:27], v[216:219], v[72:75]
    s_waitcnt lgkmcnt(2)
    v_mfma_f32_16x16x32_bf16 v[80:83], v[28:31], v[216:219], v[80:83]
    s_waitcnt lgkmcnt(0)
    v_mfma_f32_16x16x32_bf16 v[88:91], v[12:15], v[216:219], v[88:91]
    s_waitcnt vmcnt(4)
    s_barrier
    ds_read_b128 v[224:227], v254 offset:0
    ds_read_b128 v[232:235], v255 offset:0
    ds_read_b64_tr_b16 v[12:13], v4 offset:8320
    ds_read_b64_tr_b16 v[14:15], v4 offset:9344
    ds_read_b64_tr_b16 v[16:17], v4 offset:8352
    ds_read_b64_tr_b16 v[18:19], v4 offset:9376
    ds_read_b64_tr_b16 v[20:21], v5 offset:8320
    ds_read_b64_tr_b16 v[22:23], v5 offset:9344
    ds_read_b64_tr_b16 v[24:25], v5 offset:8352
    ds_read_b64_tr_b16 v[26:27], v5 offset:9376
    s_waitcnt lgkmcnt(8)
    s_waitcnt lgkmcnt(6)
    v_mfma_f32_16x16x32_bf16 v[32:35], v[12:15], v[224:227], v[32:35]
    ds_read_b64_tr_b16 v[28:29], v6 offset:8320
    ds_read_b64_tr_b16 v[30:31], v6 offset:9344
    s_add_u32 m0, s52, 33280
    s_add_u32 s51, s48, 4980736
    buffer_load_dwordx4 v8, s[32:35], s51 offen lds
    s_waitcnt lgkmcnt(6)
    v_mfma_f32_16x16x32_bf16 v[40:43], v[16:19], v[224:227], v[40:43]
    ds_read_b64_tr_b16 v[12:13], v6 offset:8352
    ds_read_b64_tr_b16 v[14:15], v6 offset:9376
    s_waitcnt lgkmcnt(6)
    v_mfma_f32_16x16x32_bf16 v[48:51], v[20:23], v[224:227], v[48:51]
    ds_read_b64_tr_b16 v[16:17], v7 offset:8320
    ds_read_b64_tr_b16 v[18:19], v7 offset:9344
    s_waitcnt lgkmcnt(6)
    v_mfma_f32_16x16x32_bf16 v[56:59], v[24:27], v[224:227], v[56:59]
    ds_read_b64_tr_b16 v[20:21], v7 offset:8352
    ds_read_b64_tr_b16 v[22:23], v7 offset:9376
    s_waitcnt lgkmcnt(6)
    v_mfma_f32_16x16x32_bf16 v[64:67], v[28:31], v[224:227], v[64:67]
    ds_read_b64_tr_b16 v[24:25], v4 offset:16640
    ds_read_b64_tr_b16 v[26:27], v4 offset:17664
    s_add_u32 m0, s52, 34304
    s_add_u32 s51, s48, 5013504
    buffer_load_dwordx4 v8, s[32:35], s51 offen lds
    s_waitcnt lgkmcnt(6)
    v_mfma_f32_16x16x32_bf16 v[72:75], v[12:15], v[224:227], v[72:75]
    ds_read_b64_tr_b16 v[28:29], v4 offset:16672
    ds_read_b64_tr_b16 v[30:31], v4 offset:17696
    s_waitcnt lgkmcnt(6)
    v_mfma_f32_16x16x32_bf16 v[80:83], v[16:19], v[224:227], v[80:83]
    ds_read_b64_tr_b16 v[12:13], v5 offset:16640
    ds_read_b64_tr_b16 v[14:15], v5 offset:17664
    s_waitcnt lgkmcnt(6)
    v_mfma_f32_16x16x32_bf16 v[88:91], v[20:23], v[224:227], v[88:91]
    ds_read_b64_tr_b16 v[16:17], v5 offset:16672
    ds_read_b64_tr_b16 v[18:19], v5 offset:17696
    s_add_u32 m0, s52, 0
    s_add_u32 s51, s54, 0
    buffer_load_dwordx4 v8, s[32:35], s51 offen lds
    s_waitcnt lgkmcnt(6)
    v_mfma_f32_16x16x32_bf16 v[32:35], v[24:27], v[232:235], v[32:35]
    ds_read_b64_tr_b16 v[20:21], v6 offset:16640
    ds_read_b64_tr_b16 v[22:23], v6 offset:17664
    s_waitcnt lgkmcnt(6)
    v_mfma_f32_16x16x32_bf16 v[40:43], v[28:31], v[232:235], v[40:43]
    ds_read_b64_tr_b16 v[24:25], v6 offset:16672
    ds_read_b64_tr_b16 v[26:27], v6 offset:17696
    s_waitcnt lgkmcnt(6)
    v_mfma_f32_16x16x32_bf16 v[48:51], v[12:15], v[232:235], v[48:51]
    ds_read_b64_tr_b16 v[28:29], v7 offset:16640
    ds_read_b64_tr_b16 v[30:31], v7 offset:17664
    s_add_u32 m0, s52, 1024
    s_add_u32 s51, s54, 32768
    buffer_load_dwordx4 v8, s[32:35], s51 offen lds
    s_waitcnt lgkmcnt(6)
    v_mfma_f32_16x16x32_bf16 v[56:59], v[16:19], v[232:235], v[56:59]
    ds_read_b64_tr_b16 v[12:13], v7 offset:16672
    ds_read_b64_tr_b16 v[14:15], v7 offset:17696
    s_waitcnt lgkmcnt(6)
    v_mfma_f32_16x16x32_bf16 v[64:67], v[20:23], v[232:235], v[64:67]
    s_waitcnt lgkmcnt(4)
    v_mfma_f32_16x16x32_bf16 v[72:75], v[24:27], v[232:235], v[72:75]
    s_waitcnt lgkmcnt(2)
    v_mfma_f32_16x16x32_bf16 v[80:83], v[28:31], v[232:235], v[80:83]
    s_waitcnt lgkmcnt(0)
    v_mfma_f32_16x16x32_bf16 v[88:91], v[12:15], v[232:235], v[88:91]
    s_waitcnt vmcnt(2)
    s_barrier
    ds_read_b128 v[240:243], v254 offset:4096
    ds_read_b128 v[248:251], v255 offset:4096
    ds_read_b64_tr_b16 v[12:13], v4 offset:24960
    ds_read_b64_tr_b16 v[14:15], v4 offset:25984
    ds_read_b64_tr_b16 v[16:17], v4 offset:33280
    ds_read_b64_tr_b16 v[18:19], v4 offset:34304
    ds_read_b64_tr_b16 v[20:21], v4 offset:24992
    ds_read_b64_tr_b16 v[22:23], v4 offset:26016
    ds_read_b64_tr_b16 v[24:25], v4 offset:33312
    ds_read_b64_tr_b16 v[26:27], v4 offset:34336
    s_waitcnt lgkmcnt(8)
    s_waitcnt lgkmcnt(6)
    v_mfma_f32_16x16x32_bf16 v[32:35], v[12:15], v[240:243], v[32:35]
    ds_read_b64_tr_b16 v[28:29], v5 offset:24960
    ds_read_b64_tr_b16 v[30:31], v5 offset:25984
    s_add_u32 m0, s52, 8320
    s_add_u32 s51, s54, 262144
    buffer_load_dwordx4 v8, s[32:35], s51 offen lds
    s_waitcnt lgkmcnt(6)
    v_mfma_f32_16x16x32_bf16 v[32:35], v[16:19], v[248:251], v[32:35]
    ds_read_b64_tr_b16 v[12:13], v5 offset:33280
    ds_read_b64_tr_b16 v[14:15], v5 offset:34304
    s_waitcnt lgkmcnt(6)
    v_mfma_f32_16x16x32_bf16 v[40:43], v[20:23], v[240:243], v[40:43]
    ds_read_b64_tr_b16 v[16:17], v5 offset:24992
    ds_read_b64_tr_b16 v[18:19], v5 offset:26016
    s_add_u32 m0, s52, 9344
    s_add_u32 s51, s54, 294912
    buffer_load_dwordx4 v8, s[32:35], s51 offen lds
    s_waitcnt lgkmcnt(6)
    v_mfma_f32_16x16x32_bf16 v[40:43], v[24:27], v[248:251], v[40:43]
    ds_read_b64_tr_b16 v[20:21], v5 offset:33312
    ds_read_b64_tr_b16 v[22:23], v5 offset:34336
    s_waitcnt lgkmcnt(6)
    v_mfma_f32_16x16x32_bf16 v[48:51], v[28:31], v[240:243], v[48:51]
    ds_read_b64_tr_b16 v[24:25], v6 offset:24960
    ds_read_b64_tr_b16 v[26:27], v6 offset:25984
    s_add_u32 m0, s52, 16640
    s_add_u32 s51, s54, 524288
    buffer_load_dwordx4 v8, s[32:35], s51 offen lds
    v_mul_f32 v32, s56, v32
    v_mul_f32 v33, s56, v33
    v_mul_f32 v34, s56, v34
    v_mul_f32 v35, s56, v35
    v_cvt_pk_bf16_f32 v32, v32, v33
    v_cvt_pk_bf16_f32 v33, v34, v35
    ds_write_b64 v9, v[32:33] offset:0
    s_waitcnt lgkmcnt(7)
    v_mfma_f32_16x16x32_bf16 v[48:51], v[12:15], v[248:251], v[48:51]
    ds_read_b64_tr_b16 v[28:29], v6 offset:33280
    ds_read_b64_tr_b16 v[30:31], v6 offset:34304
    s_add_u32 m0, s52, 17664
    s_add_u32 s51, s54, 557056
    buffer_load_dwordx4 v8, s[32:35], s51 offen lds
    s_waitcnt lgkmcnt(7)
    v_mfma_f32_16x16x32_bf16 v[56:59], v[16:19], v[240:243], v[56:59]
    ds_read_b64_tr_b16 v[12:13], v6 offset:24992
    ds_read_b64_tr_b16 v[14:15], v6 offset:26016
    v_mul_f32 v40, s56, v40
    v_mul_f32 v41, s56, v41
    v_mul_f32 v42, s56, v42
    v_mul_f32 v43, s56, v43
    v_cvt_pk_bf16_f32 v40, v40, v41
    v_cvt_pk_bf16_f32 v41, v42, v43
    ds_write_b64 v9, v[40:41] offset:512
    s_waitcnt lgkmcnt(8)
    v_mfma_f32_16x16x32_bf16 v[56:59], v[20:23], v[248:251], v[56:59]
    ds_read_b64_tr_b16 v[16:17], v6 offset:33312
    ds_read_b64_tr_b16 v[18:19], v6 offset:34336
    s_add_u32 m0, s67, 16896
    s_add_u32 s63, s61, 16384
    buffer_load_dwordx4 v2, s[20:23], s63 offen offset:0 nt lds
    s_waitcnt lgkmcnt(8)
    v_mfma_f32_16x16x32_bf16 v[64:67], v[24:27], v[240:243], v[64:67]
    ds_read_b64_tr_b16 v[20:21], v7 offset:24960
    ds_read_b64_tr_b16 v[22:23], v7 offset:25984
    s_add_u32 m0, s67, 16896
    s_add_u32 s63, s61, 16384
    buffer_load_dwordx4 v2, s[20:23], s63 offen offset:1024 nt lds
    v_mul_f32 v48, s56, v48
    v_mul_f32 v49, s56, v49
    v_mul_f32 v50, s56, v50
    v_mul_f32 v51, s56, v51
    v_cvt_pk_bf16_f32 v48, v48, v49
    v_cvt_pk_bf16_f32 v49, v50, v51
    ds_write_b64 v9, v[48:49] offset:1024
    s_waitcnt lgkmcnt(8)
    v_mfma_f32_16x16x32_bf16 v[64:67], v[28:31], v[248:251], v[64:67]
    ds_read_b64_tr_b16 v[24:25], v7 offset:33280
    ds_read_b64_tr_b16 v[26:27], v7 offset:34304
    s_waitcnt lgkmcnt(8)
    v_mfma_f32_16x16x32_bf16 v[72:75], v[12:15], v[240:243], v[72:75]
    ds_read_b64_tr_b16 v[28:29], v7 offset:24992
    ds_read_b64_tr_b16 v[30:31], v7 offset:26016
    s_add_u32 m0, s67, 16928
    s_add_u32 s63, s61, 16384
    buffer_load_dwordx4 v2, s[20:23], s63 offen offset:2048 nt lds
    v_mul_f32 v56, s56, v56
    v_mul_f32 v57, s56, v57
    v_mul_f32 v58, s56, v58
    v_mul_f32 v59, s56, v59
    v_cvt_pk_bf16_f32 v56, v56, v57
    v_cvt_pk_bf16_f32 v57, v58, v59
    ds_write_b64 v9, v[56:57] offset:1536
    s_waitcnt lgkmcnt(8)
    v_mfma_f32_16x16x32_bf16 v[72:75], v[16:19], v[248:251], v[72:75]
    ds_read_b64_tr_b16 v[12:13], v7 offset:33312
    ds_read_b64_tr_b16 v[14:15], v7 offset:34336
    s_waitcnt lgkmcnt(8)
    v_mfma_f32_16x16x32_bf16 v[80:83], v[20:23], v[240:243], v[80:83]
    s_add_u32 m0, s67, 16928
    s_add_u32 s63, s61, 16384
    buffer_load_dwordx4 v2, s[20:23], s63 offen offset:3072 nt lds
    v_mul_f32 v64, s56, v64
    v_mul_f32 v65, s56, v65
    v_mul_f32 v66, s56, v66
    v_mul_f32 v67, s56, v67
    v_cvt_pk_bf16_f32 v64, v64, v65
    v_cvt_pk_bf16_f32 v65, v66, v67
    ds_write_b64 v9, v[64:65] offset:2048
    s_waitcnt lgkmcnt(6)
    v_mfma_f32_16x16x32_bf16 v[80:83], v[24:27], v[248:251], v[80:83]
    s_waitcnt lgkmcnt(4)
    v_mfma_f32_16x16x32_bf16 v[88:91], v[28:31], v[240:243], v[88:91]
    v_mul_f32 v72, s56, v72
    v_mul_f32 v73, s56, v73
    v_mul_f32 v74, s56, v74
    v_mul_f32 v75, s56, v75
    v_cvt_pk_bf16_f32 v72, v72, v73
    v_cvt_pk_bf16_f32 v73, v74, v75
    ds_write_b64 v9, v[72:73] offset:2560
    s_waitcnt lgkmcnt(2)
    v_mfma_f32_16x16x32_bf16 v[88:91], v[12:15], v[248:251], v[88:91]
    s_nop 7
    v_mul_f32 v80, s56, v80
    v_mul_f32 v81, s56, v81
    v_mul_f32 v82, s56, v82
    v_mul_f32 v83, s56, v83
    v_cvt_pk_bf16_f32 v80, v80, v81
    v_cvt_pk_bf16_f32 v81, v82, v83
    ds_write_b64 v9, v[80:81] offset:3072
    v_mul_f32 v88, s56, v88
    v_mul_f32 v89, s56, v89
    v_mul_f32 v90, s56, v90
    v_mul_f32 v91, s56, v91
    v_cvt_pk_bf16_f32 v88, v88, v89
    v_cvt_pk_bf16_f32 v89, v90, v91
    ds_write_b64 v9, v[88:89] offset:3584
    s_waitcnt lgkmcnt(0)
    s_add_u32 s50, s50, 1
    s_mov_b32 s48, s54
    s_add_u32 s54, s50, s59
    s_add_u32 s54, s54, 1
    s_and_b32 s54, s54, 3
    s_lshl_b32 s54, s54, 2
    s_add_u32 s54, s54, s58
    s_add_u32 s51, s50, 1
    s_and_b32 s51, s51, 3
    s_add_u32 s51, s51, s45
    s_and_b32 s51, s51, 3
    s_add_u32 s54, s54, s51
    s_lshl_b32 s54, s54, 8
    s_cmp_ge_u32 s50, 3
    s_cselect_b32 s54, 1073741824, s54
    s_waitcnt vmcnt(6)
L_roundb:
    s_waitcnt vmcnt(10)
    s_barrier
    ds_read_b64_tr_b16 v[12:13], v4 offset:0
    ds_read_b64_tr_b16 v[14:15], v4 offset:1024
    ds_read_b64_tr_b16 v[16:17], v4 offset:32
    ds_read_b64_tr_b16 v[18:19], v4 offset:1056
    ds_read_b64_tr_b16 v[20:21], v5 offset:0
    ds_read_b64_tr_b16 v[22:23], v5 offset:1024
    ds_read_b64_tr_b16 v[24:25], v5 offset:32
    ds_read_b64_tr_b16 v[26:27], v5 offset:1056
    s_waitcnt lgkmcnt(6)
    v_mfma_f32_16x16x32_bf16 v[32:35], v[12:15], v[96:99], 0
    ds_read_b64_tr_b16 v[28:29], v6 offset:0
    ds_read_b64_tr_b16 v[30:31], v6 offset:1024
    s_add_u32 m0, s52, 24960
    s_add_u32 s51, s48, 786432
    buffer_load_dwordx4 v8, s[32:35], s51 offen lds
    s_waitcnt lgkmcnt(6)
    v_mfma_f32_16x16x32_bf16 v[40:43], v[16:19], v[96:99], 0
    ds_read_b64_tr_b16 v[12:13], v6 offset:32
    ds_read_b64_tr_b16 v[14:15], v6 offset:1056
    s_add_u32 m0, s52, 25984
    s_add_u32 s51, s48, 819200
    buffer_load_dwordx4 v8, s[32:35], s51 offen lds
    s_waitcnt lgkmcnt(6)
    v_mfma_f32_16x16x32_bf16 v[48:51], v[20:23], v[96:99], 0
    ds_read_b64_tr_b16 v[16:17], v7 offset:0
    ds_read_b64_tr_b16 v[18:19], v7 offset:1024
    s_add_u32 m0, s52, 33280
    s_add_u32 s51, s48, 1048576
    buffer_load_dwordx4 v8, s[32:35], s51 offen lds
    s_waitcnt lgkmcnt(6)
    v_mfma_f32_16x16x32_bf16 v[56:59], v[24:27], v[96:99], 0
    ds_read_b64_tr_b16 v[20:21], v7 offset:32
    ds_read_b64_tr_b16 v[22:23], v7 offset:1056
    s_add_u32 m0, s52, 34304
    s_add_u32 s51, s48, 1081344
    buffer_load_dwordx4 v8, s[32:35], s51 offen lds
    s_waitcnt lgkmcnt(6)
    v_mfma_f32_16x16x32_bf16 v[64:67], v[28:31], v[96:99], 0
    ds_read_b64_tr_b16 v[24:25], v4 offset:8320
    ds_read_b64_tr_b16 v[26:27], v4 offset:9344
    s_add_u32 m0, s68, 33792
    s_add_u32 s63, s61, 0
    buffer_load_dwordx4 v2, s[24:27], s63 offen offset:0 nt lds
    s_waitcnt lgkmcnt(6)
    v_mfma_f32_16x16x32_bf16 v[72:75], v[12:15], v[96:99], 0
    ds_read_b64_tr_b16 v[28:29], v4 offset:8352
    ds_read_b64_tr_b16 v[30:31], v4 offset:9376
    s_add_u32 m0, s68, 33824
    s_add_u32 s63, s61, 0
    buffer_load_dwordx4 v2, s[24:27], s63 offen offset:1024 nt lds
    s_waitcnt lgkmcnt(6)
    v_mfma_f32_16x16x32_bf16 v[80:83], v[16:19], v[96:99], 0
    s_add_u32 m0, s68, 33856
    s_add_u32 s63, s61, 0
    buffer_load_dwordx4 v2, s[24:27], s63 offen offset:2048 nt lds
    s_waitcnt lgkmcnt(4)
    v_mfma_f32_16x16x32_bf16 v[88:91], v[20:23], v[96:99], 0
    s_add_u32 m0, s68, 33888
    s_add_u32 s63, s61, 0
    buffer_load_dwordx4 v2, s[24:27], s63 offen offset:3072 nt lds
    s_waitcnt lgkmcnt(2)
    v_mfma_f32_16x16x32_bf16 v[32:35], v[24:27], v[104:107], v[32:35]
    s_waitcnt lgkmcnt(0)
    v_mfma_f32_16x16x32_bf16 v[40:43], v[28:31], v[104:107], v[40:43]
    s_waitcnt vmcnt(12)
    s_barrier
    ds_read_b64_tr_b16 v[12:13], v5 offset:8320
    ds_read_b64_tr_b16 v[14:15], v5 offset:9344
    ds_read_b64_tr_b16 v[16:17], v5 offset:8352
    ds_read_b64_tr_b16 v[18:19], v5 offset:9376
    ds_read_b64_tr_b16 v[20:21], v6 offset:8320
    ds_read_b64_tr_b16 v[22:23], v6 offset:9344
    ds_read_b64_tr_b16 v[24:25], v6 offset:8352
    ds_read_b64_tr_b16 v[26:27], v6 offset:9376
    s_waitcnt lgkmcnt(6)
    v_mfma_f32_16x16x32_bf16 v[48:51], v[12:15], v[104:107], v[48:51]
    ds_read_b64_tr_b16 v[28:29], v7 offset:8320
    ds_read_b64_tr_b16 v[30:31], v7 offset:9344
    s_add_u32 m0, s52, 0
    s_add_u32 s51, s48, 1310720
    buffer_load_dwordx4 v8, s[32:35], s51 offen lds
    s_waitcnt lgkmcnt(6)
    v_mfma_f32_16x16x32_bf16 v[56:59], v[16:19], v[104:107], v[56:59]
    ds_read_b64_tr_b16 v[12:13], v7 offset:8352
    ds_read_b64_tr_b16 v[14:15], v7 offset:9376
    s_waitcnt lgkmcnt(6)
    v_mfma_f32_16x16x32_bf16 v[64:67], v[20:23], v[104:107], v[64:67]
    ds_read_b64_tr_b16 v[16:17], v4 offset:16640
    ds_read_b64_tr_b16 v[18:19], v4 offset:17664
    s_add_u32 m0, s52, 1024
    s_add_u32 s51, s48, 1343488
    buffer_load_dwordx4 v8, s[32:35], s51 offen lds
    s_waitcnt lgkmcnt(6)
    v_mfma_f32_16x16x32_bf16 v[72:75], v[24:27], v[104:107], v[72:75]
    ds_read_b64_tr_b16 v[20:21], v4 offset:16672
    ds_read_b64_tr_b16 v[22:23], v4 offset:17696
    s_add_u32 m0, s67, 50688
    s_add_u32 s63, s61, 32768
    buffer_load_dwordx4 v2, s[20:23], s63 offen offset:0 nt lds
    s_waitcnt lgkmcnt(6)
    v_mfma_f32_16x16x32_bf16 v[80:83], v[28:31], v[104:107], v[80:83]
    ds_read_b64_tr_b16 v[24:25], v5 offset:16640
    ds_read_b64_tr_b16 v[26:27], v5 offset:17664
    s_add_u32 m0, s67, 50688
    s_add_u32 s63, s61, 32768
    buffer_load_dwordx4 v2, s[20:23], s63 offen offset:1024 nt lds
    s_waitcnt lgkmcnt(6)
    v_mfma_f32_16x16x32_bf16 v[88:91], v[12:15], v[104:107], v[88:91]
    ds_read_b64_tr_b16 v[28:29], v5 offset:16672
    ds_read_b64_tr_b16 v[30:31], v5 offset:17696
    s_waitcnt lgkmcnt(6)
    v_mfma_f32_16x16x32_bf16 v[32:35], v[16:19], v[112:115], v[32:35]
    s_add_u32 m0, s67, 50720
    s_add_u32 s63, s61, 32768
    buffer_load_dwordx4 v2, s[20:23], s63 offen offset:2048 nt lds
    s_waitcnt lgkmcnt(4)
    v_mfma_f32_16x16x32_bf16 v[40:43], v[20:23], v[112:115], v[40:43]
    s_add_u32 m0, s67, 50720
    s_add_u32 s63, s61, 32768
    buffer_load_dwordx4 v2, s[20:23], s63 offen offset:3072 nt lds
    s_waitcnt lgkmcnt(2)
    v_mfma_f32_16x16x32_bf16 v[48:51], v[24:27], v[112:115], v[48:51]
    s_waitcnt lgkmcnt(0)
    v_mfma_f32_16x16x32_bf16 v[56:59], v[28:31], v[112:115], v[56:59]
    s_waitcnt vmcnt(12)
    s_barrier
    s_add_u32 s62, s62, 1
    s_add_u32 s60, s62, s59
    s_and_b32 s60, s60, 3
    s_lshl_b32 s60, s60, 2
    s_add_u32 s60, s60, s58
    s_add_u32 s51, s62, 0
    s_and_b32 s51, s51, 3
    s_add_u32 s51, s51, s45
    s_and_b32 s51, s51, 3
    s_add_u32 s60, s60, s51
    s_lshl_b32 s63, s44, 5
    s_add_u32 s60, s60, s63
    s_lshl_b32 s60, s60, 17
    s_add_u32 s61, s62, s59
    s_add_u32 s61, s61, 1
    s_and_b32 s61, s61, 3
    s_lshl_b32 s61, s61, 2
    s_add_u32 s61, s61, s58
    s_add_u32 s51, s62, 1
    s_and_b32 s51, s51, 3
    s_add_u32 s51, s51, s45
    s_and_b32 s51, s51, 3
    s_add_u32 s61, s61, s51
    s_add_u32 s61, s61, s63
    s_lshl_b32 s61, s61, 17
    s_cmp_eq_u32 s62, 3
    s_cselect_b32 s61, 1073741824, s61
    ds_read_b64_tr_b16 v[12:13], v6 offset:16640
    ds_read_b64_tr_b16 v[14:15], v6 offset:17664
    ds_read_b64_tr_b16 v[16:17], v6 offset:16672
    ds_read_b64_tr_b16 v[18:19], v6 offset:17696
    ds_read_b64_tr_b16 v[20:21], v7 offset:16640
    ds_read_b64_tr_b16 v[22:23], v7 offset:17664
    ds_read_b64_tr_b16 v[24:25], v7 offset:16672
    ds_read_b64_tr_b16 v[26:27], v7 offset:17696
    s_waitcnt lgkmcnt(6)
    v_mfma_f32_16x16x32_bf16 v[64:67], v[12:15], v[112:115], v[64:67]
    ds_read_b64_tr_b16 v[28:29], v4 offset:24960
    ds_read_b64_tr_b16 v[30:31], v4 offset:25984
    s_add_u32 m0, s52, 8320
    s_add_u32 s51, s48, 1572864
    buffer_load_dwordx4 v8, s[32:35], s51 offen lds
    s_waitcnt lgkmcnt(6)
    v_mfma_f32_16x16x32_bf16 v[72:75], v[16:19], v[112:115], v[72:75]
    ds_read_b64_tr_b16 v[12:13], v4 offset:24992
    ds_read_b64_tr_b16 v[14:15], v4 offset:26016
    s_waitcnt lgkmcnt(6)
    v_mfma_f32_16x16x32_bf16 v[80:83], v[20:23], v[112:115], v[80:83]
    ds_read_b64_tr_b16 v[16:17], v5 offset:24960
    ds_read_b64_tr_b16 v[18:19], v5 offset:25984
    s_add_u32 m0, s52, 9344
    s_add_u32 s51, s48, 1605632
    buffer_load_dwordx4 v8, s[32:35], s51 offen lds
    s_waitcnt lgkmcnt(6)
    v_mfma_f32_16x16x32_bf16 v[88:91], v[24:27], v[112:115], v[88:91]
    ds_read_b64_tr_b16 v[20:21], v5 offset:24992
    ds_read_b64_tr_b16 v[22:23], v5 offset:26016
    s_add_u32 m0, s68, 0
    s_add_u32 s63, s60, 16384
    buffer_load_dwordx4 v2, s[24:27], s63 offen offset:0 nt lds
    s_waitcnt lgkmcnt(6)
    v_mfma_f32_16x16x32_bf16 v[32:35], v[28:31], v[120:123], v[32:35]
    ds_read_b64_tr_b16 v[24:25], v6 offset:24960
    ds_read_b64_tr_b16 v[26:27], v6 offset:25984
    s_add_u32 m0, s68, 32
    s_add_u32 s63, s60, 16384
    buffer_load_dwordx4 v2, s[24:27], s63 offen offset:1024 nt lds
    s_waitcnt lgkmcnt(6)
    v_mfma_f32_16x16x32_bf16 v[40:43], v[12:15], v[120:123], v[40:43]
    ds_read_b64_tr_b16 v[28:29], v6 offset:24992
    ds_read_b64_tr_b16 v[30:31], v6 offset:26016
    s_waitcnt lgkmcnt(6)
    v_mfma_f32_16x16x32_bf16 v[48:51], v[16:19], v[120:123], v[48:51]
    s_add_u32 m0, s68, 64
    s_add_u32 s63, s60, 16384
    buffer_load_dwordx4 v2, s[24:27], s63 offen offset:2048 nt lds
    s_waitcnt lgkmcnt(4)
    v_mfma_f32_16x16x32_bf16 v[56:59], v[20:23], v[120:123], v[56:59]
    s_add_u32 m0, s68, 96
    s_add_u32 s63, s60, 16384
    buffer_load_dwordx4 v2, s[24:27], s63 offen offset:3072 nt lds
    s_waitcnt lgkmcnt(2)
    v_mfma_f32_16x16x32_bf16 v[64:67], v[24:27], v[120:123], v[64:67]
    s_waitcnt lgkmcnt(0)
    v_mfma_f32_16x16x32_bf16 v[72:75], v[28:31], v[120:123], v[72:75]
    s_waitcnt vmcnt(12)
    s_barrier
    ds_read_b64_tr_b16 v[12:13], v7 offset:24960
    ds_read_b64_tr_b16 v[14:15], v7 offset:25984
    ds_read_b64_tr_b16 v[16:17], v7 offset:24992
    ds_read_b64_tr_b16 v[18:19], v7 offset:26016
    ds_read_b64_tr_b16 v[20:21], v4 offset:33280
    ds_read_b64_tr_b16 v[22:23], v4 offset:34304
    ds_read_b64_tr_b16 v[24:25], v4 offset:33312
    ds_read_b64_tr_b16 v[26:27], v4 offset:34336
    s_waitcnt lgkmcnt(6)
    v_mfma_f32_16x16x32_bf16 v[80:83], v[12:15], v[120:123], v[80:83]
    ds_read_b64_tr_b16 v[28:29], v5 offset:33280
    ds_read_b64_tr_b16 v[30:31], v5 offset:34304
    s_add_u32 m0, s52, 16640
    s_add_u32 s51, s48, 1835008
    buffer_load_dwordx4 v8, s[32:35], s51 offen lds
    s_waitcnt lgkmcnt(6)
    v_mfma_f32_16x16x32_bf16 v[88:91], v[16:19], v[120:123], v[88:91]
    ds_read_b64_tr_b16 v[12:13], v5 offset:33312
    ds_read_b64_tr_b16 v[14:15], v5 offset:34336
    s_waitcnt lgkmcnt(6)
    v_mfma_f32_16x16x32_bf16 v[32:35], v[20:23], v[128:131], v[32:35]
    ds_read_b64_tr_b16 v[16:17], v6 offset:33280
    ds_read_b64_tr_b16 v[18:19], v6 offset:34304
    s_add_u32 m0, s52, 17664
    s_add_u32 s51, s48, 1867776
    buffer_load_dwordx4 v8, s[32:35], s51 offen lds
    s_waitcnt lgkmcnt(6)
    v_mfma_f32_16x16x32_bf16 v[40:43], v[24:27], v[128:131], v[40:43]
    ds_read_b64_tr_b16 v[20:21], v6 offset:33312
    ds_read_b64_tr_b16 v[22:23], v6 offset:34336
    s_add_u32 m0, s67, 16896
    s_add_u32 s63, s60, 49152
    buffer_load_dwordx4 v2, s[20:23], s63 offen offset:0 nt lds
    s_waitcnt lgkmcnt(6)
    v_mfma_f32_16x16x32_bf16 v[48:51], v[28:31], v[128:131], v[48:51]
    ds_read_b64_tr_b16 v[24:25], v7 offset:33280
    ds_read_b64_tr_b16 v[26:27], v7 offset:34304
    s_add_u32 m0, s67, 16896
    s_add_u32 s63, s60, 49152
    buffer_load_dwordx4 v2, s[20:23], s63 offen offset:1024 nt lds
    s_waitcnt lgkmcnt(6)
    v_mfma_f32_16x16x32_bf16 v[56:59], v[12:15], v[128:131], v[56:59]
    ds_read_b64_tr_b16 v[28:29], v7 offset:33312
    ds_read_b64_tr_b16 v[30:31], v7 offset:34336
    s_waitcnt lgkmcnt(6)
    v_mfma_f32_16x16x32_bf16 v[64:67], v[16:19], v[128:131], v[64:67]
    s_add_u32 m0, s67, 16928
    s_add_u32 s63, s60, 49152
    buffer_load_dwordx4 v2, s[20:23], s63 offen offset:2048 nt lds
    s_waitcnt lgkmcnt(4)
    v_mfma_f32_16x16x32_bf16 v[72:75], v[20:23], v[128:131], v[72:75]
    s_add_u32 m0, s67, 16928
    s_add_u32 s63, s60, 49152
    buffer_load_dwordx4 v2, s[20:23], s63 offen offset:3072 nt lds
    s_waitcnt lgkmcnt(2)
    v_mfma_f32_16x16x32_bf16 v[80:83], v[24:27], v[128:131], v[80:83]
    s_waitcnt lgkmcnt(0)
    v_mfma_f32_16x16x32_bf16 v[88:91], v[28:31], v[128:131], v[88:91]
    s_waitcnt vmcnt(10)
    s_barrier
    ds_read_b64_tr_b16 v[12:13], v4 offset:0
    ds_read_b64_tr_b16 v[14:15], v4 offset:1024
    ds_read_b64_tr_b16 v[16:17], v4 offset:32
    ds_read_b64_tr_b16 v[18:19], v4 offset:1056
    ds_read_b64_tr_b16 v[20:21], v5 offset:0
    ds_read_b64_tr_b16 v[22:23], v5 offset:1024
    ds_read_b64_tr_b16 v[24:25], v5 offset:32
    ds_read_b64_tr_b16 v[26:27], v5 offset:1056
    s_waitcnt lgkmcnt(6)
    v_mfma_f32_16x16x32_bf16 v[32:35], v[12:15], v[136:139], v[32:35]
    ds_read_b64_tr_b16 v[28:29], v6 offset:0
    ds_read_b64_tr_b16 v[30:31], v6 offset:1024
    s_add_u32 m0, s52, 24960
    s_add_u32 s51, s48, 2097152
    buffer_load_dwordx4 v8, s[32:35], s51 offen lds
    s_waitcnt lgkmcnt(6)
    v_mfma_f32_16x16x32_bf16 v[40:43], v[16:19], v[136:139], v[40:43]
    ds_read_b64_tr_b16 v[12:13], v6 offset:32
    ds_read_b64_tr_b16 v[14:15], v6 offset:1056
    s_add_u32 m0, s52, 25984
    s_add_u32 s51, s48, 2129920
    buffer_load_dwordx4 v8, s[32:35], s51 offen lds
    s_waitcnt lgkmcnt(6)
    v_mfma_f32_16x16x32_bf16 v[48:51], v[20:23], v[136:139], v[48:51]
    ds_read_b64_tr_b16 v[16:17], v7 offset:0
    ds_read_b64_tr_b16 v[18:19], v7 offset:1024
    s_add_u32 m0, s52, 33280
    s_add_u32 s51, s48, 2359296
    buffer_load_dwordx4 v8, s[32:35], s51 offen lds
    s_waitcnt lgkmcnt(6)
    v_mfma_f32_16x16x32_bf16 v[56:59], v[24:27], v[136:139], v[56:59]
    ds_read_b64_tr_b16 v[20:21], v7 offset:32
    ds_read_b64_tr_b16 v[22:23], v7 offset:1056
    s_add_u32 m0, s52, 34304
    s_add_u32 s51, s48, 2392064
    buffer_load_dwordx4 v8, s[32:35], s51 offen lds
    s_waitcnt lgkmcnt(6)
    v_mfma_f32_16x16x32_bf16 v[64:67], v[28:31], v[136:139], v[64:67]
    ds_read_b64_tr_b16 v[24:25], v4 offset:8320
    ds_read_b64_tr_b16 v[26:27], v4 offset:9344
    s_add_u32 m0, s68, 33792
    s_add_u32 s63, s60, 32768
    buffer_load_dwordx4 v2, s[24:27], s63 offen offset:0 nt lds
    s_waitcnt lgkmcnt(6)
    v_mfma_f32_16x16x32_bf16 v[72:75], v[12:15], v[136:139], v[72:75]
    ds_read_b64_tr_b16 v[28:29], v4 offset:8352
    ds_read_b64_tr_b16 v[30:31], v4 offset:9376
    s_add_u32 m0, s68, 33824
    s_add_u32 s63, s60, 32768
    buffer_load_dwordx4 v2, s[24:27], s63 offen offset:1024 nt lds
    s_waitcnt lgkmcnt(6)
    v_mfma_f32_16x16x32_bf16 v[80:83], v[16:19], v[136:139], v[80:83]
    s_add_u32 m0, s68, 33856
    s_add_u32 s63, s60, 32768
    buffer_load_dwordx4 v2, s[24:27], s63 offen offset:2048 nt lds
    s_waitcnt lgkmcnt(4)
    v_mfma_f32_16x16x32_bf16 v[88:91], v[20:23], v[136:139], v[88:91]
    s_add_u32 m0, s68, 33888
    s_add_u32 s63, s60, 32768
    buffer_load_dwordx4 v2, s[24:27], s63 offen offset:3072 nt lds
    s_waitcnt lgkmcnt(2)
    v_mfma_f32_16x16x32_bf16 v[32:35], v[24:27], v[144:147], v[32:35]
    s_waitcnt lgkmcnt(0)
    v_mfma_f32_16x16x32_bf16 v[40:43], v[28:31], v[144:147], v[40:43]
    s_waitcnt vmcnt(12)
    s_barrier
    ds_read_b64_tr_b16 v[12:13], v5 offset:8320
    ds_read_b64_tr_b16 v[14:15], v5 offset:9344
    ds_read_b64_tr_b16 v[16:17], v5 offset:8352
    ds_read_b64_tr_b16 v[18:19], v5 offset:9376
    ds_read_b64_tr_b16 v[20:21], v6 offset:8320
    ds_read_b64_tr_b16 v[22:23], v6 offset:9344
    ds_read_b64_tr_b16 v[24:25], v6 offset:8352
    ds_read_b64_tr_b16 v[26:27], v6 offset:9376
    s_waitcnt lgkmcnt(6)
    v_mfma_f32_16x16x32_bf16 v[48:51], v[12:15], v[144:147], v[48:51]
    ds_read_b64_tr_b16 v[28:29], v7 offset:8320
    ds_read_b64_tr_b16 v[30:31], v7 offset:9344
    s_add_u32 m0, s52, 0
    s_add_u32 s51, s48, 2621440
    buffer_load_dwordx4 v8, s[32:35], s51 offen lds
    s_waitcnt lgkmcnt(6)
    v_mfma_f32_16x16x32_bf16 v[56:59], v[16:19], v[144:147], v[56:59]
    ds_read_b64_tr_b16 v[12:13], v7 offset:8352
    ds_read_b64_tr_b16 v[14:15], v7 offset:9376
    s_waitcnt lgkmcnt(6)
    v_mfma_f32_16x16x32_bf16 v[64:67], v[20:23], v[144:147], v[64:67]
    ds_read_b64_tr_b16 v[16:17], v4 offset:16640
    ds_read_b64_tr_b16 v[18:19], v4 offset:17664
    s_add_u32 m0, s52, 1024
    s_add_u32 s51, s48, 2654208
    buffer_load_dwordx4 v8, s[32:35], s51 offen lds
    s_waitcnt lgkmcnt(6)
    v_mfma_f32_16x16x32_bf16 v[72:75], v[24:27], v[144:147], v[72:75]
    ds_read_b64_tr_b16 v[20:21], v4 offset:16672
    ds_read_b64_tr_b16 v[22:23], v4 offset:17696
    s_add_u32 m0, s67, 50688
    s_add_u32 s63, s60, 65536
    buffer_load_dwordx4 v2, s[20:23], s63 offen offset:0 nt lds
    s_waitcnt lgkmcnt(6)
    v_mfma_f32_16x16x32_bf16 v[80:83], v[28:31], v[144:147], v[80:83]
    ds_read_b64_tr_b16 v[24:25], v5 offset:16640
    ds_read_b64_tr_b16 v[26:27], v5 offset:17664
    s_add_u32 m0, s67, 50688
    s_add_u32 s63, s60, 65536
    buffer_load_dwordx4 v2, s[20:23], s63 offen offset:1024 nt lds
    s_waitcnt lgkmcnt(6)
    v_mfma_f32_16x16x32_bf16 v[88:91], v[12:15], v[144:147], v[88:91]
    ds_read_b64_tr_b16 v[28:29], v5 offset:16672
    ds_read_b64_tr_b16 v[30:31], v5 offset:17696
    s_waitcnt lgkmcnt(6)
    v_mfma_f32_16x16x32_bf16 v[32:35], v[16:19], v[152:155], v[32:35]
    s_add_u32 m0, s67, 50720
    s_add_u32 s63, s60, 65536
    buffer_load_dwordx4 v2, s[20:23], s63 offen offset:2048 nt lds
    s_waitcnt lgkmcnt(4)
    v_mfma_f32_16x16x32_bf16 v[40:43], v[20:23], v[152:155], v[40:43]
    s_add_u32 m0, s67, 50720
    s_add_u32 s63, s60, 65536
    buffer_load_dwordx4 v2, s[20:23], s63 offen offset:3072 nt lds
    s_waitcnt lgkmcnt(2)
    v_mfma_f32_16x16x32_bf16 v[48:51], v[24:27], v[152:155], v[48:51]
    s_waitcnt lgkmcnt(0)
    v_mfma_f32_16x16x32_bf16 v[56:59], v[28:31], v[152:155], v[56:59]
    s_waitcnt vmcnt(12)
    s_barrier
    ds_read_b64_tr_b16 v[12:13], v6 offset:16640
    ds_read_b64_tr_b16 v[14:15], v6 offset:17664
    ds_read_b64_tr_b16 v[16:17], v6 offset:16672
    ds_read_b64_tr_b16 v[18:19], v6 offset:17696
    ds_read_b64_tr_b16 v[20:21], v7 offset:16640
    ds_read_b64_tr_b16 v[22:23], v7 offset:17664
    ds_read_b64_tr_b16 v[24:25], v7 offset:16672
    ds_read_b64_tr_b16 v[26:27], v7 offset:17696
    s_waitcnt lgkmcnt(6)
    v_mfma_f32_16x16x32_bf16 v[64:67], v[12:15], v[152:155], v[64:67]
    ds_read_b64_tr_b16 v[28:29], v4 offset:24960
    ds_read_b64_tr_b16 v[30:31], v4 offset:25984
    s_add_u32 m0, s52, 8320
    s_add_u32 s51, s48, 2883584
    buffer_load_dwordx4 v8, s[32:35], s51 offen lds
    s_waitcnt lgkmcnt(6)
    v_mfma_f32_16x16x32_bf16 v[72:75], v[16:19], v[152:155], v[72:75]
    ds_read_b64_tr_b16 v[12:13], v4 offset:24992
    ds_read_b64_tr_b16 v[14:15], v4 offset:26016
    s_waitcnt lgkmcnt(6)
    v_mfma_f32_16x16x32_bf16 v[80:83], v[20:23], v[152:155], v[80:83]
    ds_read_b64_tr_b16 v[16:17], v5 offset:24960
    ds_read_b64_tr_b16 v[18:19], v5 offset:25984
    s_add_u32 m0, s52, 9344
    s_add_u32 s51, s48, 2916352
    buffer_load_dwordx4 v8, s[32:35], s51 offen lds
    s_waitcnt lgkmcnt(6)
    v_mfma_f32_16x16x32_bf16 v[88:91], v[24:27], v[152:155], v[88:91]
    ds_read_b64_tr_b16 v[20:21], v5 offset:24992
    ds_read_b64_tr_b16 v[22:23], v5 offset:26016
    s_add_u32 m0, s68, 0
    s_add_u32 s63, s60, 49152
    buffer_load_dwordx4 v2, s[24:27], s63 offen offset:0 nt lds
    s_waitcnt lgkmcnt(6)
    v_mfma_f32_16x16x32_bf16 v[32:35], v[28:31], v[160:163], v[32:35]
    ds_read_b64_tr_b16 v[24:25], v6 offset:24960
    ds_read_b64_tr_b16 v[26:27], v6 offset:25984
    s_add_u32 m0, s68, 32
    s_add_u32 s63, s60, 49152
    buffer_load_dwordx4 v2, s[24:27], s63 offen offset:1024 nt lds
    s_waitcnt lgkmcnt(6)
    v_mfma_f32_16x16x32_bf16 v[40:43], v[12:15], v[160:163], v[40:43]
    ds_read_b64_tr_b16 v[28:29], v6 offset:24992
    ds_read_b64_tr_b16 v[30:31], v6 offset:26016
    s_waitcnt lgkmcnt(6)
    v_mfma_f32_16x16x32_bf16 v[48:51], v[16:19], v[160:163], v[48:51]
    s_add_u32 m0, s68, 64
    s_add_u32 s63, s60, 49152
    buffer_load_dwordx4 v2, s[24:27], s63 offen offset:2048 nt lds
    s_waitcnt lgkmcnt(4)
    v_mfma_f32_16x16x32_bf16 v[56:59], v[20:23], v[160:163], v[56:59]
    s_add_u32 m0, s68, 96
    s_add_u32 s63, s60, 49152
    buffer_load_dwordx4 v2, s[24:27], s63 offen offset:3072 nt lds
    s_waitcnt lgkmcnt(2)
    v_mfma_f32_16x16x32_bf16 v[64:67], v[24:27], v[160:163], v[64:67]
    s_waitcnt lgkmcnt(0)
    v_mfma_f32_16x16x32_bf16 v[72:75], v[28:31], v[160:163], v[72:75]
    s_waitcnt vmcnt(12)
    s_barrier
    ds_read_b64_tr_b16 v[12:13], v7 offset:24960
    ds_read_b64_tr_b16 v[14:15], v7 offset:25984
    ds_read_b64_tr_b16 v[16:17], v7 offset:24992
    ds_read_b64_tr_b16 v[18:19], v7 offset:26016
    ds_read_b64_tr_b16 v[20:21], v4 offset:33280
    ds_read_b64_tr_b16 v[22:23], v4 offset:34304
    ds_read_b64_tr_b16 v[24:25], v4 offset:33312
    ds_read_b64_tr_b16 v[26:27], v4 offset:34336
    s_waitcnt lgkmcnt(6)
    v_mfma_f32_16x16x32_bf16 v[80:83], v[12:15], v[160:163], v[80:83]
    ds_read_b64_tr_b16 v[28:29], v5 offset:33280
    ds_read_b64_tr_b16 v[30:31], v5 offset:34304
    s_add_u32 m0, s52, 16640
    s_add_u32 s51, s48, 3145728
    buffer_load_dwordx4 v8, s[32:35], s51 offen lds
    s_waitcnt lgkmcnt(6)
    v_mfma_f32_16x16x32_bf16 v[88:91], v[16:19], v[160:163], v[88:91]
    ds_read_b64_tr_b16 v[12:13], v5 offset:33312
    ds_read_b64_tr_b16 v[14:15], v5 offset:34336
    s_waitcnt lgkmcnt(6)
    v_mfma_f32_16x16x32_bf16 v[32:35], v[20:23], v[168:171], v[32:35]
    ds_read_b64_tr_b16 v[16:17], v6 offset:33280
    ds_read_b64_tr_b16 v[18:19], v6 offset:34304
    s_add_u32 m0, s52, 17664
    s_add_u32 s51, s48, 3178496
    buffer_load_dwordx4 v8, s[32:35], s51 offen lds
    s_waitcnt lgkmcnt(6)
    v_mfma_f32_16x16x32_bf16 v[40:43], v[24:27], v[168:171], v[40:43]
    ds_read_b64_tr_b16 v[20:21], v6 offset:33312
    ds_read_b64_tr_b16 v[22:23], v6 offset:34336
    s_add_u32 m0, s67, 16896
    s_add_u32 s63, s60, 81920
    buffer_load_dwordx4 v2, s[20:23], s63 offen offset:0 nt lds
    s_waitcnt lgkmcnt(6)
    v_mfma_f32_16x16x32_bf16 v[48:51], v[28:31], v[168:171], v[48:51]
    ds_read_b64_tr_b16 v[24:25], v7 offset:33280
    ds_read_b64_tr_b16 v[26:27], v7 offset:34304
    s_add_u32 m0, s67, 16896
    s_add_u32 s63, s60, 81920
    buffer_load_dwordx4 v2, s[20:23], s63 offen offset:1024 nt lds
    s_waitcnt lgkmcnt(6)
    v_mfma_f32_16x16x32_bf16 v[56:59], v[12:15], v[168:171], v[56:59]
    ds_read_b64_tr_b16 v[28:29], v7 offset:33312
    ds_read_b64_tr_b16 v[30:31], v7 offset:34336
    s_waitcnt lgkmcnt(6)
    v_mfma_f32_16x16x32_bf16 v[64:67], v[16:19], v[168:171], v[64:67]
    s_add_u32 m0, s67, 16928
    s_add_u32 s63, s60, 81920
    buffer_load_dwordx4 v2, s[20:23], s63 offen offset:2048 nt lds
    s_waitcnt lgkmcnt(4)
    v_mfma_f32_16x16x32_bf16 v[72:75], v[20:23], v[168:171], v[72:75]
    s_add_u32 m0, s67, 16928
    s_add_u32 s63, s60, 81920
    buffer_load_dwordx4 v2, s[20:23], s63 offen offset:3072 nt lds
    s_waitcnt lgkmcnt(2)
    v_mfma_f32_16x16x32_bf16 v[80:83], v[24:27], v[168:171], v[80:83]
    s_waitcnt lgkmcnt(0)
    v_mfma_f32_16x16x32_bf16 v[88:91], v[28:31], v[168:171], v[88:91]
    s_waitcnt vmcnt(10)
    s_barrier
    ds_read_b64_tr_b16 v[12:13], v4 offset:0
    ds_read_b64_tr_b16 v[14:15], v4 offset:1024
    ds_read_b64_tr_b16 v[16:17], v4 offset:32
    ds_read_b64_tr_b16 v[18:19], v4 offset:1056
    ds_read_b64_tr_b16 v[20:21], v5 offset:0
    ds_read_b64_tr_b16 v[22:23], v5 offset:1024
    ds_read_b64_tr_b16 v[24:25], v5 offset:32
    ds_read_b64_tr_b16 v[26:27], v5 offset:1056
    s_waitcnt lgkmcnt(6)
    v_mfma_f32_16x16x32_bf16 v[32:35], v[12:15], v[176:179], v[32:35]
    ds_read_b64_tr_b16 v[28:29], v6 offset:0
    ds_read_b64_tr_b16 v[30:31], v6 offset:1024
    s_add_u32 m0, s52, 24960
    s_add_u32 s51, s48, 3407872
    buffer_load_dwordx4 v8, s[32:35], s51 offen lds
    s_waitcnt lgkmcnt(6)
    v_mfma_f32_16x16x32_bf16 v[40:43], v[16:19], v[176:179], v[40:43]
    ds_read_b64_tr_b16 v[12:13], v6 offset:32
    ds_read_b64_tr_b16 v[14:15], v6 offset:1056
    s_add_u32 m0, s52, 25984
    s_add_u32 s51, s48, 3440640
    buffer_load_dwordx4 v8, s[32:35], s51 offen lds
    s_waitcnt lgkmcnt(6)
    v_mfma_f32_16x16x32_bf16 v[48:51], v[20:23], v[176:179], v[48:51]
    ds_read_b64_tr_b16 v[16:17], v7 offset:0
    ds_read_b64_tr_b16 v[18:19], v7 offset:1024
    s_add_u32 m0, s52, 33280
    s_add_u32 s51, s48, 3670016
    buffer_load_dwordx4 v8, s[32:35], s51 offen lds
    s_waitcnt lgkmcnt(6)
    v_mfma_f32_16x16x32_bf16 v[56:59], v[24:27], v[176:179], v[56:59]
    ds_read_b64_tr_b16 v[20:21], v7 offset:32
    ds_read_b64_tr_b16 v[22:23], v7 offset:1056
    s_add_u32 m0, s52, 34304
    s_add_u32 s51, s48, 3702784
    buffer_load_dwordx4 v8, s[32:35], s51 offen lds
    s_waitcnt lgkmcnt(6)
    v_mfma_f32_16x16x32_bf16 v[64:67], v[28:31], v[176:179], v[64:67]
    ds_read_b64_tr_b16 v[24:25], v4 offset:8320
    ds_read_b64_tr_b16 v[26:27], v4 offset:9344
    s_add_u32 m0, s68, 33792
    s_add_u32 s63, s60, 65536
    buffer_load_dwordx4 v2, s[24:27], s63 offen offset:0 nt lds
    s_waitcnt lgkmcnt(6)
    v_mfma_f32_16x16x32_bf16 v[72:75], v[12:15], v[176:179], v[72:75]
    ds_read_b64_tr_b16 v[28:29], v4 offset:8352
    ds_read_b64_tr_b16 v[30:31], v4 offset:9376
    s_add_u32 m0, s68, 33824
    s_add_u32 s63, s60, 65536
    buffer_load_dwordx4 v2, s[24:27], s63 offen offset:1024 nt lds
    s_waitcnt lgkmcnt(6)
    v_mfma_f32_16x16x32_bf16 v[80:83], v[16:19], v[176:179], v[80:83]
    s_add_u32 m0, s68, 33856
    s_add_u32 s63, s60, 65536
    buffer_load_dwordx4 v2, s[24:27], s63 offen offset:2048 nt lds
    s_waitcnt lgkmcnt(4)
    v_mfma_f32_16x16x32_bf16 v[88:91], v[20:23], v[176:179], v[88:91]
    s_add_u32 m0, s68, 33888
    s_add_u32 s63, s60, 65536
    buffer_load_dwordx4 v2, s[24:27], s63 offen offset:3072 nt lds
    s_waitcnt lgkmcnt(2)
    v_mfma_f32_16x16x32_bf16 v[32:35], v[24:27], v[184:187], v[32:35]
    s_waitcnt lgkmcnt(0)
    v_mfma_f32_16x16x32_bf16 v[40:43], v[28:31], v[184:187], v[40:43]
    s_waitcnt vmcnt(12)
    s_barrier
    ds_read_b64_tr_b16 v[12:13], v5 offset:8320
    ds_read_b64_tr_b16 v[14:15], v5 offset:9344
    ds_read_b64_tr_b16 v[16:17], v5 offset:8352
    ds_read_b64_tr_b16 v[18:19], v5 offset:9376
    ds_read_b64_tr_b16 v[20:21], v6 offset:8320
    ds_read_b64_tr_b16 v[22:23], v6 offset:9344
    ds_read_b64_tr_b16 v[24:25], v6 offset:8352
    ds_read_b64_tr_b16 v[26:27], v6 offset:9376
    s_waitcnt lgkmcnt(6)
    v_mfma_f32_16x16x32_bf16 v[48:51], v[12:15], v[184:187], v[48:51]
    ds_read_b64_tr_b16 v[28:29], v7 offset:8320
    ds_read_b64_tr_b16 v[30:31], v7 offset:9344
    s_add_u32 m0, s52, 0
    s_add_u32 s51, s48, 3932160
    buffer_load_dwordx4 v8, s[32:35], s51 offen lds
    s_waitcnt lgkmcnt(6)
    v_mfma_f32_16x16x32_bf16 v[56:59], v[16:19], v[184:187], v[56:59]
    ds_read_b64_tr_b16 v[12:13], v7 offset:8352
    ds_read_b64_tr_b16 v[14:15], v7 offset:9376
    s_waitcnt lgkmcnt(6)
    v_mfma_f32_16x16x32_bf16 v[64:67], v[20:23], v[184:187], v[64:67]
    ds_read_b64_tr_b16 v[16:17], v4 offset:16640
    ds_read_b64_tr_b16 v[18:19], v4 offset:17664
    s_add_u32 m0, s52, 1024
    s_add_u32 s51, s48, 3964928
    buffer_load_dwordx4 v8, s[32:35], s51 offen lds
    s_waitcnt lgkmcnt(6)
    v_mfma_f32_16x16x32_bf16 v[72:75], v[24:27], v[184:187], v[72:75]
    ds_read_b64_tr_b16 v[20:21], v4 offset:16672
    ds_read_b64_tr_b16 v[22:23], v4 offset:17696
    s_add_u32 m0, s67, 50688
    s_add_u32 s63, s60, 98304
    buffer_load_dwordx4 v2, s[20:23], s63 offen offset:0 nt lds
    s_waitcnt lgkmcnt(6)
    v_mfma_f32_16x16x32_bf16 v[80:83], v[28:31], v[184:187], v[80:83]
    ds_read_b64_tr_b16 v[24:25], v5 offset:16640
    ds_read_b64_tr_b16 v[26:27], v5 offset:17664
    s_add_u32 m0, s67, 50688
    s_add_u32 s63, s60, 98304
    buffer_load_dwordx4 v2, s[20:23], s63 offen offset:1024 nt lds
    s_waitcnt lgkmcnt(6)
    v_mfma_f32_16x16x32_bf16 v[88:91], v[12:15], v[184:187], v[88:91]
    ds_read_b64_tr_b16 v[28:29], v5 offset:16672
    ds_read_b64_tr_b16 v[30:31], v5 offset:17696
    s_waitcnt lgkmcnt(6)
    v_mfma_f32_16x16x32_bf16 v[32:35], v[16:19], v[192:195], v[32:35]
    s_add_u32 m0, s67, 50720
    s_add_u32 s63, s60, 98304
    buffer_load_dwordx4 v2, s[20:23], s63 offen offset:2048 nt lds
    s_waitcnt lgkmcnt(4)
    v_mfma_f32_16x16x32_bf16 v[40:43], v[20:23], v[192:195], v[40:43]
    s_add_u32 m0, s67, 50720
    s_add_u32 s63, s60, 98304
    buffer_load_dwordx4 v2, s[20:23], s63 offen offset:3072 nt lds
    s_waitcnt lgkmcnt(2)
    v_mfma_f32_16x16x32_bf16 v[48:51], v[24:27], v[192:195], v[48:51]
    s_waitcnt lgkmcnt(0)
    v_mfma_f32_16x16x32_bf16 v[56:59], v[28:31], v[192:195], v[56:59]
    s_waitcnt vmcnt(12)
    s_barrier
    ds_read_b64_tr_b16 v[12:13], v6 offset:16640
    ds_read_b64_tr_b16 v[14:15], v6 offset:17664
    ds_read_b64_tr_b16 v[16:17], v6 offset:16672
    ds_read_b64_tr_b16 v[18:19], v6 offset:17696
    ds_read_b64_tr_b16 v[20:21], v7 offset:16640
    ds_read_b64_tr_b16 v[22:23], v7 offset:17664
    ds_read_b64_tr_b16 v[24:25], v7 offset:16672
    ds_read_b64_tr_b16 v[26:27], v7 offset:17696
    s_waitcnt lgkmcnt(6)
    v_mfma_f32_16x16x32_bf16 v[64:67], v[12:15], v[192:195], v[64:67]
    ds_read_b64_tr_b16 v[28:29], v4 offset:24960
    ds_read_b64_tr_b16 v[30:31], v4 offset:25984
    s_add_u32 m0, s52, 8320
    s_add_u32 s51, s48, 4194304
    buffer_load_dwordx4 v8, s[32:35], s51 offen lds
    s_waitcnt lgkmcnt(6)
    v_mfma_f32_16x16x32_bf16 v[72:75], v[16:19], v[192:195], v[72:75]
    ds_read_b64_tr_b16 v[12:13], v4 offset:24992
    ds_read_b64_tr_b16 v[14:15], v4 offset:26016
    s_waitcnt lgkmcnt(6)
    v_mfma_f32_16x16x32_bf16 v[80:83], v[20:23], v[192:195], v[80:83]
    ds_read_b64_tr_b16 v[16:17], v5 offset:24960
    ds_read_b64_tr_b16 v[18:19], v5 offset:25984
    s_add_u32 m0, s52, 9344
    s_add_u32 s51, s48, 4227072
    buffer_load_dwordx4 v8, s[32:35], s51 offen lds
    s_waitcnt lgkmcnt(6)
    v_mfma_f32_16x16x32_bf16 v[88:91], v[24:27], v[192:195], v[88:91]
    ds_read_b64_tr_b16 v[20:21], v5 offset:24992
    ds_read_b64_tr_b16 v[22:23], v5 offset:26016
    s_add_u32 m0, s68, 0
    s_add_u32 s63, s60, 81920
    buffer_load_dwordx4 v2, s[24:27], s63 offen offset:0 nt lds
    s_waitcnt lgkmcnt(6)
    v_mfma_f32_16x16x32_bf16 v[32:35], v[28:31], v[200:203], v[32:35]
    ds_read_b64_tr_b16 v[24:25], v6 offset:24960
    ds_read_b64_tr_b16 v[26:27], v6 offset:25984
    s_add_u32 m0, s68, 32
    s_add_u32 s63, s60, 81920
    buffer_load_dwordx4 v2, s[24:27], s63 offen offset:1024 nt lds
    s_waitcnt lgkmcnt(6)
    v_mfma_f32_16x16x32_bf16 v[40:43], v[12:15], v[200:203], v[40:43]
    ds_read_b64_tr_b16 v[28:29], v6 offset:24992
    ds_read_b64_tr_b16 v[30:31], v6 offset:26016
    s_waitcnt lgkmcnt(6)
    v_mfma_f32_16x16x32_bf16 v[48:51], v[16:19], v[200:203], v[48:51]
    s_add_u32 m0, s68, 64
    s_add_u32 s63, s60, 81920
    buffer_load_dwordx4 v2, s[24:27], s63 offen offset:2048 nt lds
    s_waitcnt lgkmcnt(4)
    v_mfma_f32_16x16x32_bf16 v[56:59], v[20:23], v[200:203], v[56:59]
    s_add_u32 m0, s68, 96
    s_add_u32 s63, s60, 81920
    buffer_load_dwordx4 v2, s[24:27], s63 offen offset:3072 nt lds
    s_waitcnt lgkmcnt(2)
    v_mfma_f32_16x16x32_bf16 v[64:67], v[24:27], v[200:203], v[64:67]
    s_waitcnt lgkmcnt(0)
    v_mfma_f32_16x16x32_bf16 v[72:75], v[28:31], v[200:203], v[72:75]
    s_waitcnt vmcnt(12)
    s_barrier
    ds_read_b64_tr_b16 v[12:13], v7 offset:24960
    ds_read_b64_tr_b16 v[14:15], v7 offset:25984
    ds_read_b64_tr_b16 v[16:17], v7 offset:24992
    ds_read_b64_tr_b16 v[18:19], v7 offset:26016
    ds_read_b64_tr_b16 v[20:21], v4 offset:33280
    ds_read_b64_tr_b16 v[22:23], v4 offset:34304
    ds_read_b64_tr_b16 v[24:25], v4 offset:33312
    ds_read_b64_tr_b16 v[26:27], v4 offset:34336
    s_waitcnt lgkmcnt(6)
    v_mfma_f32_16x16x32_bf16 v[80:83], v[12:15], v[200:203], v[80:83]
    ds_read_b64_tr_b16 v[28:29], v5 offset:33280
    ds_read_b64_tr_b16 v[30:31], v5 offset:34304
    s_add_u32 m0, s52, 16640
    s_add_u32 s51, s48, 4456448
    buffer_load_dwordx4 v8, s[32:35], s51 offen lds
    s_waitcnt lgkmcnt(6)
    v_mfma_f32_16x16x32_bf16 v[88:91], v[16:19], v[200:203], v[88:91]
    ds_read_b64_tr_b16 v[12:13], v5 offset:33312
    ds_read_b64_tr_b16 v[14:15], v5 offset:34336
    s_waitcnt lgkmcnt(6)
    v_mfma_f32_16x16x32_bf16 v[32:35], v[20:23], v[208:211], v[32:35]
    ds_read_b64_tr_b16 v[16:17], v6 offset:33280
    ds_read_b64_tr_b16 v[18:19], v6 offset:34304
    s_add_u32 m0, s52, 17664
    s_add_u32 s51, s48, 4489216
    buffer_load_dwordx4 v8, s[32:35], s51 offen lds
    s_waitcnt lgkmcnt(6)
    v_mfma_f32_16x16x32_bf16 v[40:43], v[24:27], v[208:211], v[40:43]
    ds_read_b64_tr_b16 v[20:21], v6 offset:33312
    ds_read_b64_tr_b16 v[22:23], v6 offset:34336
    s_add_u32 m0, s67, 16896
    s_add_u32 s63, s60, 114688
    buffer_load_dwordx4 v2, s[20:23], s63 offen offset:0 nt lds
    s_waitcnt lgkmcnt(6)
    v_mfma_f32_16x16x32_bf16 v[48:51], v[28:31], v[208:211], v[48:51]
    ds_read_b64_tr_b16 v[24:25], v7 offset:33280
    ds_read_b64_tr_b16 v[26:27], v7 offset:34304
    s_add_u32 m0, s67, 16896
    s_add_u32 s63, s60, 114688
    buffer_load_dwordx4 v2, s[20:23], s63 offen offset:1024 nt lds
    s_waitcnt lgkmcnt(6)
    v_mfma_f32_16x16x32_bf16 v[56:59], v[12:15], v[208:211], v[56:59]
    ds_read_b64_tr_b16 v[28:29], v7 offset:33312
    ds_read_b64_tr_b16 v[30:31], v7 offset:34336
    s_waitcnt lgkmcnt(6)
    v_mfma_f32_16x16x32_bf16 v[64:67], v[16:19], v[208:211], v[64:67]
    s_add_u32 m0, s67, 16928
    s_add_u32 s63, s60, 114688
    buffer_load_dwordx4 v2, s[20:23], s63 offen offset:2048 nt lds
    s_waitcnt lgkmcnt(4)
    v_mfma_f32_16x16x32_bf16 v[72:75], v[20:23], v[208:211], v[72:75]
    s_add_u32 m0, s67, 16928
    s_add_u32 s63, s60, 114688
    buffer_load_dwordx4 v2, s[20:23], s63 offen offset:3072 nt lds
    s_waitcnt lgkmcnt(2)
    v_mfma_f32_16x16x32_bf16 v[80:83], v[24:27], v[208:211], v[80:83]
    s_waitcnt lgkmcnt(0)
    v_mfma_f32_16x16x32_bf16 v[88:91], v[28:31], v[208:211], v[88:91]
    s_waitcnt vmcnt(10)
    s_barrier
    ds_read_b64_tr_b16 v[12:13], v4 offset:0
    ds_read_b64_tr_b16 v[14:15], v4 offset:1024
    ds_read_b64_tr_b16 v[16:17], v4 offset:32
    ds_read_b64_tr_b16 v[18:19], v4 offset:1056
    ds_read_b64_tr_b16 v[20:21], v5 offset:0
    ds_read_b64_tr_b16 v[22:23], v5 offset:1024
    ds_read_b64_tr_b16 v[24:25], v5 offset:32
    ds_read_b64_tr_b16 v[26:27], v5 offset:1056
    s_waitcnt lgkmcnt(6)
    v_mfma_f32_16x16x32_bf16 v[32:35], v[12:15], v[216:219], v[32:35]
    ds_read_b64_tr_b16 v[28:29], v6 offset:0
    ds_read_b64_tr_b16 v[30:31], v6 offset:1024
    s_add_u32 m0, s52, 24960
    s_add_u32 s51, s48, 4718592
    buffer_load_dwordx4 v8, s[32:35], s51 offen lds
    s_waitcnt lgkmcnt(6)
    v_mfma_f32_16x16x32_bf16 v[40:43], v[16:19], v[216:219], v[40:43]
    ds_read_b64_tr_b16 v[12:13], v6 offset:32
    ds_read_b64_tr_b16 v[14:15], v6 offset:1056
    s_add_u32 m0, s52, 25984
    s_add_u32 s51, s48, 4751360
    buffer_load_dwordx4 v8, s[32:35], s51 offen lds
    s_waitcnt lgkmcnt(6)
    v_mfma_f32_16x16x32_bf16 v[48:51], v[20:23], v[216:219], v[48:51]
    ds_read_b64_tr_b16 v[16:17], v7 offset:0
    ds_read_b64_tr_b16 v[18:19], v7 offset:1024
    s_add_u32 m0, s52, 33280
    s_add_u32 s51, s48, 4980736
    buffer_load_dwordx4 v8, s[32:35], s51 offen lds
    s_waitcnt lgkmcnt(6)
    v_mfma_f32_16x16x32_bf16 v[56:59], v[24:27], v[216:219], v[56:59]
    ds_read_b64_tr_b16 v[20:21], v7 offset:32
    ds_read_b64_tr_b16 v[22:23], v7 offset:1056
    s_add_u32 m0, s52, 34304
    s_add_u32 s51, s48, 5013504
    buffer_load_dwordx4 v8, s[32:35], s51 offen lds
    s_waitcnt lgkmcnt(6)
    v_mfma_f32_16x16x32_bf16 v[64:67], v[28:31], v[216:219], v[64:67]
    ds_read_b64_tr_b16 v[24:25], v4 offset:8320
    ds_read_b64_tr_b16 v[26:27], v4 offset:9344
    s_add_u32 m0, s68, 33792
    s_add_u32 s63, s60, 98304
    buffer_load_dwordx4 v2, s[24:27], s63 offen offset:0 nt lds
    s_waitcnt lgkmcnt(6)
    v_mfma_f32_16x16x32_bf16 v[72:75], v[12:15], v[216:219], v[72:75]
    ds_read_b64_tr_b16 v[28:29], v4 offset:8352
    ds_read_b64_tr_b16 v[30:31], v4 offset:9376
    s_add_u32 m0, s68, 33824
    s_add_u32 s63, s60, 98304
    buffer_load_dwordx4 v2, s[24:27], s63 offen offset:1024 nt lds
    s_waitcnt lgkmcnt(6)
    v_mfma_f32_16x16x32_bf16 v[80:83], v[16:19], v[216:219], v[80:83]
    s_add_u32 m0, s68, 33856
    s_add_u32 s63, s60, 98304
    buffer_load_dwordx4 v2, s[24:27], s63 offen offset:2048 nt lds
    s_waitcnt lgkmcnt(4)
    v_mfma_f32_16x16x32_bf16 v[88:91], v[20:23], v[216:219], v[88:91]
    s_add_u32 m0, s68, 33888
    s_add_u32 s63, s60, 98304
    buffer_load_dwordx4 v2, s[24:27], s63 offen offset:3072 nt lds
    s_waitcnt lgkmcnt(2)
    v_mfma_f32_16x16x32_bf16 v[32:35], v[24:27], v[224:227], v[32:35]
    s_waitcnt lgkmcnt(0)
    v_mfma_f32_16x16x32_bf16 v[40:43], v[28:31], v[224:227], v[40:43]
    s_waitcnt vmcnt(12)
    s_barrier
    ds_read_b64_tr_b16 v[12:13], v5 offset:8320
    ds_read_b64_tr_b16 v[14:15], v5 offset:9344
    ds_read_b64_tr_b16 v[16:17], v5 offset:8352
    ds_read_b64_tr_b16 v[18:19], v5 offset:9376
    ds_read_b64_tr_b16 v[20:21], v6 offset:8320
    ds_read_b64_tr_b16 v[22:23], v6 offset:9344
    ds_read_b64_tr_b16 v[24:25], v6 offset:8352
    ds_read_b64_tr_b16 v[26:27], v6 offset:9376
    s_waitcnt lgkmcnt(6)
    v_mfma_f32_16x16x32_bf16 v[48:51], v[12:15], v[224:227], v[48:51]
    ds_read_b64_tr_b16 v[28:29], v7 offset:8320
    ds_read_b64_tr_b16 v[30:31], v7 offset:9344
    s_add_u32 m0, s52, 0
    s_add_u32 s51, s54, 0
    buffer_load_dwordx4 v8, s[32:35], s51 offen lds
    s_waitcnt lgkmcnt(6)
    v_mfma_f32_16x16x32_bf16 v[56:59], v[16:19], v[224:227], v[56:59]
    ds_read_b64_tr_b16 v[12:13], v7 offset:8352
    ds_read_b64_tr_b16 v[14:15], v7 offset:9376
    s_waitcnt lgkmcnt(6)
    v_mfma_f32_16x16x32_bf16 v[64:67], v[20:23], v[224:227], v[64:67]
    ds_read_b64_tr_b16 v[16:17], v4 offset:16640
    ds_read_b64_tr_b16 v[18:19], v4 offset:17664
    s_add_u32 m0, s52, 1024
    s_add_u32 s51, s54, 32768
    buffer_load_dwordx4 v8, s[32:35], s51 offen lds
    s_waitcnt lgkmcnt(6)
    v_mfma_f32_16x16x32_bf16 v[72:75], v[24:27], v[224:227], v[72:75]
    ds_read_b64_tr_b16 v[20:21], v4 offset:16672
    ds_read_b64_tr_b16 v[22:23], v4 offset:17696
    s_add_u32 m0, s67, 50688
    s_add_u32 s63, s61, 0
    buffer_load_dwordx4 v2, s[20:23], s63 offen offset:0 nt lds
    s_waitcnt lgkmcnt(6)
    v_mfma_f32_16x16x32_bf16 v[80:83], v[28:31], v[224:227], v[80:83]
    ds_read_b64_tr_b16 v[24:25], v5 offset:16640
    ds_read_b64_tr_b16 v[26:27], v5 offset:17664
    s_add_u32 m0, s67, 50688
    s_add_u32 s63, s61, 0
    buffer_load_dwordx4 v2, s[20:23], s63 offen offset:1024 nt lds
    s_waitcnt lgkmcnt(6)
    v_mfma_f32_16x16x32_bf16 v[88:91], v[12:15], v[224:227], v[88:91]
    ds_read_b64_tr_b16 v[28:29], v5 offset:16672
    ds_read_b64_tr_b16 v[30:31], v5 offset:17696
    s_waitcnt lgkmcnt(6)
    v_mfma_f32_16x16x32_bf16 v[32:35], v[16:19], v[232:235], v[32:35]
    s_add_u32 m0, s67, 50720
    s_add_u32 s63, s61, 0
    buffer_load_dwordx4 v2, s[20:23], s63 offen offset:2048 nt lds
    s_waitcnt lgkmcnt(4)
    v_mfma_f32_16x16x32_bf16 v[40:43], v[20:23], v[232:235], v[40:43]
    s_add_u32 m0, s67, 50720
    s_add_u32 s63, s61, 0
    buffer_load_dwordx4 v2, s[20:23], s63 offen offset:3072 nt lds
    s_waitcnt lgkmcnt(2)
    v_mfma_f32_16x16x32_bf16 v[48:51], v[24:27], v[232:235], v[48:51]
    s_waitcnt lgkmcnt(0)
    v_mfma_f32_16x16x32_bf16 v[56:59], v[28:31], v[232:235], v[56:59]
    s_waitcnt vmcnt(10)
    s_barrier
    ds_read_b64_tr_b16 v[12:13], v6 offset:16640
    ds_read_b64_tr_b16 v[14:15], v6 offset:17664
    ds_read_b64_tr_b16 v[16:17], v6 offset:16672
    ds_read_b64_tr_b16 v[18:19], v6 offset:17696
    ds_read_b64_tr_b16 v[20:21], v7 offset:16640
    ds_read_b64_tr_b16 v[22:23], v7 offset:17664
    ds_read_b64_tr_b16 v[24:25], v7 offset:16672
    ds_read_b64_tr_b16 v[26:27], v7 offset:17696
    s_waitcnt lgkmcnt(6)
    v_mfma_f32_16x16x32_bf16 v[64:67], v[12:15], v[232:235], v[64:67]
    ds_read_b64_tr_b16 v[28:29], v4 offset:24960
    ds_read_b64_tr_b16 v[30:31], v4 offset:25984
    s_add_u32 m0, s52, 8320
    s_add_u32 s51, s54, 262144
    buffer_load_dwordx4 v8, s[32:35], s51 offen lds
    s_waitcnt lgkmcnt(6)
    v_mfma_f32_16x16x32_bf16 v[72:75], v[16:19], v[232:235], v[72:75]
    ds_read_b64_tr_b16 v[12:13], v4 offset:33280
    ds_read_b64_tr_b16 v[14:15], v4 offset:34304
    s_waitcnt lgkmcnt(6)
    v_mfma_f32_16x16x32_bf16 v[80:83], v[20:23], v[232:235], v[80:83]
    ds_read_b64_tr_b16 v[16:17], v4 offset:24992
    ds_read_b64_tr_b16 v[18:19], v4 offset:26016
    s_add_u32 m0, s52, 9344
    s_add_u32 s51, s54, 294912
    buffer_load_dwordx4 v8, s[32:35], s51 offen lds
    s_waitcnt lgkmcnt(6)
    v_mfma_f32_16x16x32_bf16 v[88:91], v[24:27], v[232:235], v[88:91]
    ds_read_b64_tr_b16 v[20:21], v4 offset:33312
    ds_read_b64_tr_b16 v[22:23], v4 offset:34336
    s_add_u32 m0, s68, 0
    s_add_u32 s63, s60, 114688
    buffer_load_dwordx4 v2, s[24:27], s63 offen offset:0 nt lds
    s_waitcnt lgkmcnt(6)
    v_mfma_f32_16x16x32_bf16 v[32:35], v[28:31], v[240:243], v[32:35]
    ds_read_b64_tr_b16 v[24:25], v5 offset:24960
    ds_read_b64_tr_b16 v[26:27], v5 offset:25984
    s_add_u32 m0, s68, 32
    s_add_u32 s63, s60, 114688
    buffer_load_dwordx4 v2, s[24:27], s63 offen offset:1024 nt lds
    s_waitcnt lgkmcnt(6)
    v_mfma_f32_16x16x32_bf16 v[32:35], v[12:15], v[248:251], v[32:35]
    ds_read_b64_tr_b16 v[28:29], v5 offset:33280
    ds_read_b64_tr_b16 v[30:31], v5 offset:34304
    s_waitcnt lgkmcnt(6)
    v_mfma_f32_16x16x32_bf16 v[40:43], v[16:19], v[240:243], v[40:43]
    s_add_u32 m0, s68, 64
    s_add_u32 s63, s60, 114688
    buffer_load_dwordx4 v2, s[24:27], s63 offen offset:2048 nt lds
    s_waitcnt lgkmcnt(4)
    v_mfma_f32_16x16x32_bf16 v[40:43], v[20:23], v[248:251], v[40:43]
    s_add_u32 m0, s68, 96
    s_add_u32 s63, s60, 114688
    buffer_load_dwordx4 v2, s[24:27], s63 offen offset:3072 nt lds
    s_waitcnt lgkmcnt(2)
    v_mfma_f32_16x16x32_bf16 v[48:51], v[24:27], v[240:243], v[48:51]
    v_mul_f32 v32, s56, v32
    v_mul_f32 v33, s56, v33
    v_mul_f32 v34, s56, v34
    v_mul_f32 v35, s56, v35
    v_cvt_pk_bf16_f32 v32, v32, v33
    v_cvt_pk_bf16_f32 v33, v34, v35
    ds_write_b64 v9, v[32:33] offset:0
    s_waitcnt lgkmcnt(1)
    v_mfma_f32_16x16x32_bf16 v[48:51], v[28:31], v[248:251], v[48:51]
    s_nop 7
    v_mul_f32 v40, s56, v40
    v_mul_f32 v41, s56, v41
    v_mul_f32 v42, s56, v42
    v_mul_f32 v43, s56, v43
    v_cvt_pk_bf16_f32 v40, v40, v41
    v_cvt_pk_bf16_f32 v41, v42, v43
    ds_write_b64 v9, v[40:41] offset:512
    v_mul_f32 v48, s56, v48
    v_mul_f32 v49, s56, v49
    v_mul_f32 v50, s56, v50
    v_mul_f32 v51, s56, v51
    v_cvt_pk_bf16_f32 v48, v48, v49
    v_cvt_pk_bf16_f32 v49, v50, v51
    ds_write_b64 v9, v[48:49] offset:1024
    s_waitcnt lgkmcnt(0)
    s_waitcnt vmcnt(12)
    s_barrier
    ds_read_b64_tr_b16 v[12:13], v5 offset:24992
    ds_read_b64_tr_b16 v[14:15], v5 offset:26016
    ds_read_b64_tr_b16 v[16:17], v5 offset:33312
    ds_read_b64_tr_b16 v[18:19], v5 offset:34336
    ds_read_b64_tr_b16 v[20:21], v6 offset:24960
    ds_read_b64_tr_b16 v[22:23], v6 offset:25984
    ds_read_b64_tr_b16 v[24:25], v6 offset:33280
    ds_read_b64_tr_b16 v[26:27], v6 offset:34304
    s_waitcnt lgkmcnt(6)
    v_mfma_f32_16x16x32_bf16 v[56:59], v[12:15], v[240:243], v[56:59]
    ds_read_b64_tr_b16 v[28:29], v6 offset:24992
    ds_read_b64_tr_b16 v[30:31], v6 offset:26016
    s_add_u32 m0, s52, 16640
    s_add_u32 s51, s54, 524288
    buffer_load_dwordx4 v8, s[32:35], s51 offen lds
    s_waitcnt lgkmcnt(6)
    v_mfma_f32_16x16x32_bf16 v[56:59], v[16:19], v[248:251], v[56:59]
    ds_read_b64_tr_b16 v[12:13], v6 offset:33312
    ds_read_b64_tr_b16 v[14:15], v6 offset:34336
    s_waitcnt lgkmcnt(6)
    v_mfma_f32_16x16x32_bf16 v[64:67], v[20:23], v[240:243], v[64:67]
    ds_read_b64_tr_b16 v[16:17], v7 offset:24960
    ds_read_b64_tr_b16 v[18:19], v7 offset:25984
    s_add_u32 m0, s52, 17664
    s_add_u32 s51, s54, 557056
    buffer_load_dwordx4 v8, s[32:35], s51 offen lds
    s_waitcnt lgkmcnt(6)
    v_mfma_f32_16x16x32_bf16 v[64:67], v[24:27], v[248:251], v[64:67]
    ds_read_b64_tr_b16 v[20:21], v7 offset:33280
    ds_read_b64_tr_b16 v[22:23], v7 offset:34304
    s_add_u32 m0, s67, 16896
    s_add_u32 s63, s61, 16384
    buffer_load_dwordx4 v2, s[20:23], s63 offen offset:0 nt lds
    s_waitcnt lgkmcnt(6)
    v_mfma_f32_16x16x32_bf16 v[72:75], v[28:31], v[240:243], v[72:75]
    ds_read_b64_tr_b16 v[24:25], v7 offset:24992
    ds_read_b64_tr_b16 v[26:27], v7 offset:26016
    s_add_u32 m0, s67, 16896
    s_add_u32 s63, s61, 16384
    buffer_load_dwordx4 v2, s[20:23], s63 offen offset:1024 nt lds
    v_mul_f32 v56, s56, v56
    v_mul_f32 v57, s56, v57
    v_mul_f32 v58, s56, v58
    v_mul_f32 v59, s56, v59
    v_cvt_pk_bf16_f32 v56, v56, v57
    v_cvt_pk_bf16_f32 v57, v58, v59
    ds_write_b64 v9, v[56:57] offset:1536
    s_waitcnt lgkmcnt(7)
    v_mfma_f32_16x16x32_bf16 v[72:75], v[12:15], v[248:251], v[72:75]
    ds_read_b64_tr_b16 v[28:29], v7 offset:33312
    ds_read_b64_tr_b16 v[30:31], v7 offset:34336
    s_waitcnt lgkmcnt(7)
    v_mfma_f32_16x16x32_bf16 v[80:83], v[16:19], v[240:243], v[80:83]
    s_add_u32 m0, s67, 16928
    s_add_u32 s63, s61, 16384
    buffer_load_dwordx4 v2, s[20:23], s63 offen offset:2048 nt lds
    v_mul_f32 v64, s56, v64
    v_mul_f32 v65, s56, v65
    v_mul_f32 v66, s56, v66
    v_mul_f32 v67, s56, v67
    v_cvt_pk_bf16_f32 v64, v64, v65
    v_cvt_pk_bf16_f32 v65, v66, v67
    ds_write_b64 v9, v[64:65] offset:2048
    s_waitcnt lgkmcnt(6)
    v_mfma_f32_16x16x32_bf16 v[80:83], v[20:23], v[248:251], v[80:83]
    s_add_u32 m0, s67, 16928
    s_add_u32 s63, s61, 16384
    buffer_load_dwordx4 v2, s[20:23], s63 offen offset:3072 nt lds
    s_waitcnt lgkmcnt(4)
    v_mfma_f32_16x16x32_bf16 v[88:91], v[24:27], v[240:243], v[88:91]
    v_mul_f32 v72, s56, v72
    v_mul_f32 v73, s56, v73
    v_mul_f32 v74, s56, v74
    v_mul_f32 v75, s56, v75
    v_cvt_pk_bf16_f32 v72, v72, v73
    v_cvt_pk_bf16_f32 v73, v74, v75
    ds_write_b64 v9, v[72:73] offset:2560
    s_waitcnt lgkmcnt(2)
    v_mfma_f32_16x16x32_bf16 v[88:91], v[28:31], v[248:251], v[88:91]
    s_nop 7
    v_mul_f32 v80, s56, v80
    v_mul_f32 v81, s56, v81
    v_mul_f32 v82, s56, v82
    v_mul_f32 v83, s56, v83
    v_cvt_pk_bf16_f32 v80, v80, v81
    v_cvt_pk_bf16_f32 v81, v82, v83
    ds_write_b64 v9, v[80:81] offset:3072
    v_mul_f32 v88, s56, v88
    v_mul_f32 v89, s56, v89
    v_mul_f32 v90, s56, v90
    v_mul_f32 v91, s56, v91
    v_cvt_pk_bf16_f32 v88, v88, v89
    v_cvt_pk_bf16_f32 v89, v90, v91
    ds_write_b64 v9, v[88:89] offset:3584
    s_waitcnt lgkmcnt(0)
    s_add_u32 s50, s50, 1
    s_mov_b32 s48, s54
    s_add_u32 s54, s50, s59
    s_add_u32 s54, s54, 1
    s_and_b32 s54, s54, 3
    s_lshl_b32 s54, s54, 2
    s_add_u32 s54, s54, s58
    s_add_u32 s51, s50, 1
    s_and_b32 s51, s51, 3
    s_add_u32 s51, s51, s45
    s_and_b32 s51, s51, 3
    s_add_u32 s54, s54, s51
    s_lshl_b32 s54, s54, 8
    s_cmp_ge_u32 s50, 3
    s_cselect_b32 s54, 1073741824, s54
    s_cmp_lt_u32 s50, 4
    s_cbranch_scc1 L_roundb
    s_waitcnt vmcnt(12)
    s_barrier
    s_add_u32 m0, s68, 33792
    s_add_u32 s63, s61, 0
    buffer_load_dwordx4 v2, s[24:27], s63 offen offset:0 nt lds
    s_add_u32 m0, s68, 33824
    s_add_u32 s63, s61, 0
    buffer_load_dwordx4 v2, s[24:27], s63 offen offset:1024 nt lds
    s_add_u32 m0, s68, 33856
    s_add_u32 s63, s61, 0
    buffer_load_dwordx4 v2, s[24:27], s63 offen offset:2048 nt lds
    s_add_u32 m0, s68, 33888
    s_add_u32 s63, s61, 0
    buffer_load_dwordx4 v2, s[24:27], s63 offen offset:3072 nt lds
    s_waitcnt vmcnt(10)
    s_barrier
    s_add_u32 m0, s67, 50688
    s_add_u32 s63, s61, 32768
    buffer_load_dwordx4 v2, s[20:23], s63 offen offset:0 nt lds
    s_add_u32 m0, s67, 50688
    s_add_u32 s63, s61, 32768
    buffer_load_dwordx4 v2, s[20:23], s63 offen offset:1024 nt lds
    s_add_u32 m0, s67, 50720
    s_add_u32 s63, s61, 32768
    buffer_load_dwordx4 v2, s[20:23], s63 offen offset:2048 nt lds
    s_add_u32 m0, s67, 50720
    s_add_u32 s63, s61, 32768
    buffer_load_dwordx4 v2, s[20:23], s63 offen offset:3072 nt lds
    s_waitcnt vmcnt(8)
    s_barrier
    s_add_u32 s62, s62, 1
    s_add_u32 s60, s62, s59
    s_and_b32 s60, s60, 3
    s_lshl_b32 s60, s60, 2
    s_add_u32 s60, s60, s58
    s_add_u32 s51, s62, 0
    s_and_b32 s51, s51, 3
    s_add_u32 s51, s51, s45
    s_and_b32 s51, s51, 3
    s_add_u32 s60, s60, s51
    s_lshl_b32 s63, s44, 5
    s_add_u32 s60, s60, s63
    s_lshl_b32 s60, s60, 17
    s_add_u32 s61, s62, s59
    s_add_u32 s61, s61, 1
    s_and_b32 s61, s61, 3
    s_lshl_b32 s61, s61, 2
    s_add_u32 s61, s61, s58
    s_add_u32 s51, s62, 1
    s_and_b32 s51, s51, 3
    s_add_u32 s51, s51, s45
    s_and_b32 s51, s51, 3
    s_add_u32 s61, s61, s51
    s_add_u32 s61, s61, s63
    s_lshl_b32 s61, s61, 17
    s_cmp_eq_u32 s62, 3
    s_cselect_b32 s61, 1073741824, s61
    s_add_u32 m0, s68, 0
    s_add_u32 s63, s60, 16384
    buffer_load_dwordx4 v2, s[24:27], s63 offen offset:0 nt lds
    s_add_u32 m0, s68, 32
    s_add_u32 s63, s60, 16384
    buffer_load_dwordx4 v2, s[24:27], s63 offen offset:1024 nt lds
    s_add_u32 m0, s68, 64
    s_add_u32 s63, s60, 16384
    buffer_load_dwordx4 v2, s[24:27], s63 offen offset:2048 nt lds
    s_add_u32 m0, s68, 96
    s_add_u32 s63, s60, 16384
    buffer_load_dwordx4 v2, s[24:27], s63 offen offset:3072 nt lds
    s_waitcnt vmcnt(8)
    s_barrier
    s_add_u32 m0, s67, 16896
    s_add_u32 s63, s60, 49152
    buffer_load_dwordx4 v2, s[20:23], s63 offen offset:0 nt lds
    s_add_u32 m0, s67, 16896
    s_add_u32 s63, s60, 49152
    buffer_load_dwordx4 v2, s[20:23], s63 offen offset:1024 nt lds
    s_add_u32 m0, s67, 16928
    s_add_u32 s63, s60, 49152
    buffer_load_dwordx4 v2, s[20:23], s63 offen offset:2048 nt lds
    s_add_u32 m0, s67, 16928
    s_add_u32 s63, s60, 49152
    buffer_load_dwordx4 v2, s[20:23], s63 offen offset:3072 nt lds
    s_waitcnt vmcnt(8)
    s_barrier
    s_add_u32 m0, s68, 33792
    s_add_u32 s63, s60, 32768
    buffer_load_dwordx4 v2, s[24:27], s63 offen offset:0 nt lds
    s_add_u32 m0, s68, 33824
    s_add_u32 s63, s60, 32768
    buffer_load_dwordx4 v2, s[24:27], s63 offen offset:1024 nt lds
    s_add_u32 m0, s68, 33856
    s_add_u32 s63, s60, 32768
    buffer_load_dwordx4 v2, s[24:27], s63 offen offset:2048 nt lds
    s_add_u32 m0, s68, 33888
    s_add_u32 s63, s60, 32768
    buffer_load_dwordx4 v2, s[24:27], s63 offen offset:3072 nt lds
    s_waitcnt vmcnt(8)
    s_barrier
    s_add_u32 m0, s67, 50688
    s_add_u32 s63, s60, 65536
    buffer_load_dwordx4 v2, s[20:23], s63 offen offset:0 nt lds
    s_add_u32 m0, s67, 50688
    s_add_u32 s63, s60, 65536
    buffer_load_dwordx4 v2, s[20:23], s63 offen offset:1024 nt lds
    s_add_u32 m0, s67, 50720
    s_add_u32 s63, s60, 65536
    buffer_load_dwordx4 v2, s[20:23], s63 offen offset:2048 nt lds
    s_add_u32 m0, s67, 50720
    s_add_u32 s63, s60, 65536
    buffer_load_dwordx4 v2, s[20:23], s63 offen offset:3072 nt lds
    s_waitcnt vmcnt(8)
    s_barrier
    s_add_u32 m0, s68, 0
    s_add_u32 s63, s60, 49152
    buffer_load_dwordx4 v2, s[24:27], s63 offen offset:0 nt lds
    s_add_u32 m0, s68, 32
    s_add_u32 s63, s60, 49152
    buffer_load_dwordx4 v2, s[24:27], s63 offen offset:1024 nt lds
    s_add_u32 m0, s68, 64
    s_add_u32 s63, s60, 49152
    buffer_load_dwordx4 v2, s[24:27], s63 offen offset:2048 nt lds
    s_add_u32 m0, s68, 96
    s_add_u32 s63, s60, 49152
    buffer_load_dwordx4 v2, s[24:27], s63 offen offset:3072 nt lds
    s_waitcnt vmcnt(8)
    s_barrier
    s_add_u32 m0, s67, 16896
    s_add_u32 s63, s60, 81920
    buffer_load_dwordx4 v2, s[20:23], s63 offen offset:0 nt lds
    s_add_u32 m0, s67, 16896
    s_add_u32 s63, s60, 81920
    buffer_load_dwordx4 v2, s[20:23], s63 offen offset:1024 nt lds
    s_add_u32 m0, s67, 16928
    s_add_u32 s63, s60, 81920
    buffer_load_dwordx4 v2, s[20:23], s63 offen offset:2048 nt lds
    s_add_u32 m0, s67, 16928
    s_add_u32 s63, s60, 81920
    buffer_load_dwordx4 v2, s[20:23], s63 offen offset:3072 nt lds
    s_waitcnt vmcnt(8)
    s_barrier
    s_add_u32 m0, s68, 33792
    s_add_u32 s63, s60, 65536
    buffer_load_dwordx4 v2, s[24:27], s63 offen offset:0 nt lds
    s_add_u32 m0, s68, 33824
    s_add_u32 s63, s60, 65536
    buffer_load_dwordx4 v2, s[24:27], s63 offen offset:1024 nt lds
    s_add_u32 m0, s68, 33856
    s_add_u32 s63, s60, 65536
    buffer_load_dwordx4 v2, s[24:27], s63 offen offset:2048 nt lds
    s_add_u32 m0, s68, 33888
    s_add_u32 s63, s60, 65536
    buffer_load_dwordx4 v2, s[24:27], s63 offen offset:3072 nt lds
    s_waitcnt vmcnt(8)
    s_barrier
    s_add_u32 m0, s67, 50688
    s_add_u32 s63, s60, 98304
    buffer_load_dwordx4 v2, s[20:23], s63 offen offset:0 nt lds
    s_add_u32 m0, s67, 50688
    s_add_u32 s63, s60, 98304
    buffer_load_dwordx4 v2, s[20:23], s63 offen offset:1024 nt lds
    s_add_u32 m0, s67, 50720
    s_add_u32 s63, s60, 98304
    buffer_load_dwordx4 v2, s[20:23], s63 offen offset:2048 nt lds
    s_add_u32 m0, s67, 50720
    s_add_u32 s63, s60, 98304
    buffer_load_dwordx4 v2, s[20:23], s63 offen offset:3072 nt lds
    s_waitcnt vmcnt(8)
    s_barrier
    s_add_u32 m0, s68, 0
    s_add_u32 s63, s60, 81920
    buffer_load_dwordx4 v2, s[24:27], s63 offen offset:0 nt lds
    s_add_u32 m0, s68, 32
    s_add_u32 s63, s60, 81920
    buffer_load_dwordx4 v2, s[24:27], s63 offen offset:1024 nt lds
    s_add_u32 m0, s68, 64
    s_add_u32 s63, s60, 81920
    buffer_load_dwordx4 v2, s[24:27], s63 offen offset:2048 nt lds
    s_add_u32 m0, s68, 96
    s_add_u32 s63, s60, 81920
    buffer_load_dwordx4 v2, s[24:27], s63 offen offset:3072 nt lds
    s_waitcnt vmcnt(8)
    s_barrier
    s_add_u32 m0, s67, 16896
    s_add_u32 s63, s60, 114688
    buffer_load_dwordx4 v2, s[20:23], s63 offen offset:0 nt lds
    s_add_u32 m0, s67, 16896
    s_add_u32 s63, s60, 114688
    buffer_load_dwordx4 v2, s[20:23], s63 offen offset:1024 nt lds
    s_add_u32 m0, s67, 16928
    s_add_u32 s63, s60, 114688
    buffer_load_dwordx4 v2, s[20:23], s63 offen offset:2048 nt lds
    s_add_u32 m0, s67, 16928
    s_add_u32 s63, s60, 114688
    buffer_load_dwordx4 v2, s[20:23], s63 offen offset:3072 nt lds
    s_waitcnt vmcnt(8)
    s_barrier
    s_add_u32 m0, s68, 33792
    s_add_u32 s63, s60, 98304
    buffer_load_dwordx4 v2, s[24:27], s63 offen offset:0 nt lds
    s_add_u32 m0, s68, 33824
    s_add_u32 s63, s60, 98304
    buffer_load_dwordx4 v2, s[24:27], s63 offen offset:1024 nt lds
    s_add_u32 m0, s68, 33856
    s_add_u32 s63, s60, 98304
    buffer_load_dwordx4 v2, s[24:27], s63 offen offset:2048 nt lds
    s_add_u32 m0, s68, 33888
    s_add_u32 s63, s60, 98304
    buffer_load_dwordx4 v2, s[24:27], s63 offen offset:3072 nt lds
    s_waitcnt vmcnt(8)
    s_barrier
    s_add_u32 m0, s67, 50688
    s_add_u32 s63, s61, 0
    buffer_load_dwordx4 v2, s[20:23], s63 offen offset:0 nt lds
    s_add_u32 m0, s67, 50688
    s_add_u32 s63, s61, 0
    buffer_load_dwordx4 v2, s[20:23], s63 offen offset:1024 nt lds
    s_add_u32 m0, s67, 50720
    s_add_u32 s63, s61, 0
    buffer_load_dwordx4 v2, s[20:23], s63 offen offset:2048 nt lds
    s_add_u32 m0, s67, 50720
    s_add_u32 s63, s61, 0
    buffer_load_dwordx4 v2, s[20:23], s63 offen offset:3072 nt lds
    s_waitcnt vmcnt(8)
    s_barrier
    s_add_u32 m0, s68, 0
    s_add_u32 s63, s60, 114688
    buffer_load_dwordx4 v2, s[24:27], s63 offen offset:0 nt lds
    s_add_u32 m0, s68, 32
    s_add_u32 s63, s60, 114688
    buffer_load_dwordx4 v2, s[24:27], s63 offen offset:1024 nt lds
    s_add_u32 m0, s68, 64
    s_add_u32 s63, s60, 114688
    buffer_load_dwordx4 v2, s[24:27], s63 offen offset:2048 nt lds
    s_add_u32 m0, s68, 96
    s_add_u32 s63, s60, 114688
    buffer_load_dwordx4 v2, s[24:27], s63 offen offset:3072 nt lds
    s_waitcnt vmcnt(8)
    s_barrier
    s_add_u32 m0, s67, 16896
    s_add_u32 s63, s61, 16384
    buffer_load_dwordx4 v2, s[20:23], s63 offen offset:0 nt lds
    s_add_u32 m0, s67, 16896
    s_add_u32 s63, s61, 16384
    buffer_load_dwordx4 v2, s[20:23], s63 offen offset:1024 nt lds
    s_add_u32 m0, s67, 16928
    s_add_u32 s63, s61, 16384
    buffer_load_dwordx4 v2, s[20:23], s63 offen offset:2048 nt lds
    s_add_u32 m0, s67, 16928
    s_add_u32 s63, s61, 16384
    buffer_load_dwordx4 v2, s[20:23], s63 offen offset:3072 nt lds
    s_waitcnt vmcnt(8)
    s_barrier
    s_waitcnt vmcnt(4)
    s_barrier
    s_endpgm
L_exit:
    s_endpgm
.globl oproj_kernel
.p2align 8
.type oproj_kernel,@function
oproj_kernel:
    s_cmp_ge_u32 s2, 256
    s_cbranch_scc1 L2_exit
    s_load_dwordx2 s[4:5], s[0:1], 40
    s_load_dwordx2 s[6:7], s[0:1], 56
    s_getpc_b64 s[32:33]
L2_pc:
    v_lshlrev_b32 v4, 7, v0
    v_cmp_gt_u32 vcc, (L2_exit - L2_pc), v4
    s_and_saveexec_b64 s[34:35], vcc
    s_cbranch_execz L2_nct
    global_load_dword v5, v4, s[32:33]
L2_nct:
    s_mov_b64 exec, s[34:35]
    v_lshrrev_b32 v1, 6, v0
    v_and_b32 v2, 63, v0
    v_readfirstlane_b32 s3, v1
    s_and_b32 s20, s2, 7
    s_lshr_b32 s21, s2, 3
    s_lshr_b32 s22, s21, 3
    s_lshl_b32 s20, s20, 2
    s_add_u32 s20, s20, s22
    s_and_b32 s21, s21, 7
    v_lshlrev_b32 v3, 4, v2
    s_and_b32 s19, s3, 3
    s_mul_i32 s18, s19, 36864
    s_lshl_b32 s27, s19, 5
    s_lshl_b32 s23, s20, 7
    s_add_u32 s23, s23, s27
    s_mul_i32 s23, s23, 7168
    s_lshl_b32 s24, s21, 7
    s_add_u32 s24, s24, s27
    s_mul_i32 s24, s24, 5120
    s_add_u32 s24, s24, 33554432
    s_waitcnt lgkmcnt(0)
    s_mov_b32 s8, s6
    s_and_b32 s9, s7, 0xffff
    s_mov_b32 s10, 38797312
    s_mov_b32 s11, 0x20000
    s_mov_b32 s12, s4
    s_and_b32 s13, s5, 0xffff
    s_mov_b32 s14, 4587520
    s_mov_b32 s15, 0x20000
    s_cmp_lt_u32 s3, 4
    s_cbranch_scc1 L2_comp
    s_mov_b32 s25, 0
    s_mov_b32 s26, s18
    s_add_u32 s28, s18, 36864
    s_mov_b32 m0, s26
    s_nop 0
    buffer_load_dwordx4 v3, s[8:11], s23 offen offset:0 lds
    buffer_load_dwordx4 v3, s[8:11], s23 offen offset:1024 lds
    buffer_load_dwordx4 v3, s[8:11], s23 offen offset:2048 lds
    buffer_load_dwordx4 v3, s[8:11], s23 offen offset:3072 lds
    s_add_u32 m0, s26, 4096
    s_add_u32 s27, s23, 4096
    buffer_load_dwordx4 v3, s[8:11], s27 offen offset:0 lds
    buffer_load_dwordx4 v3, s[8:11], s27 offen offset:1024 lds
    buffer_load_dwordx4 v3, s[8:11], s27 offen offset:2048 lds
    s_add_u32 m0, s26, 7168
    s_nop 0
    buffer_load_dwordx4 v3, s[8:11], s24 offen offset:0 lds
    buffer_load_dwordx4 v3, s[8:11], s24 offen offset:1024 lds
    buffer_load_dwordx4 v3, s[8:11], s24 offen offset:2048 lds
    buffer_load_dwordx4 v3, s[8:11], s24 offen offset:3072 lds
    s_add_u32 m0, s26, 11264
    s_add_u32 s27, s24, 4096
    buffer_load_dwordx4 v3, s[8:11], s27 offen lds
    s_add_u32 s23, s23, 7168
    s_add_u32 s24, s24, 5120
    s_add_u32 s25, s25, 1
    s_cmp_ge_u32 s25, 32
    s_cselect_b32 s23, 1073741824, s23
    s_cselect_b32 s24, 1073741824, s24
    s_add_u32 s26, s26, 12288
    s_cmp_ge_u32 s26, s28
    s_cselect_b32 s26, s18, s26
    s_mov_b32 m0, s26
    s_nop 0
    buffer_load_dwordx4 v3, s[8:11], s23 offen offset:0 lds
    buffer_load_dwordx4 v3, s[8:11], s23 offen offset:1024 lds
    buffer_load_dwordx4 v3, s[8:11], s23 offen offset:2048 lds
    buffer_load_dwordx4 v3, s[8:11], s23 offen offset:3072 lds
    s_add_u32 m0, s26, 4096
    s_add_u32 s27, s23, 4096
    buffer_load_dwordx4 v3, s[8:11], s27 offen offset:0 lds
    buffer_load_dwordx4 v3, s[8:11], s27 offen offset:1024 lds
    buffer_load_dwordx4 v3, s[8:11], s27 offen offset:2048 lds
    s_add_u32 m0, s26, 7168
    s_nop 0
    buffer_load_dwordx4 v3, s[8:11], s24 offen offset:0 lds
    buffer_load_dwordx4 v3, s[8:11], s24 offen offset:1024 lds
    buffer_load_dwordx4 v3, s[8:11], s24 offen offset:2048 lds
    buffer_load_dwordx4 v3, s[8:11], s24 offen offset:3072 lds
    s_add_u32 m0, s26, 11264
    s_add_u32 s27, s24, 4096
    buffer_load_dwordx4 v3, s[8:11], s27 offen lds
    s_add_u32 s23, s23, 7168
    s_add_u32 s24, s24, 5120
    s_add_u32 s25, s25, 1
    s_cmp_ge_u32 s25, 32
    s_cselect_b32 s23, 1073741824, s23
    s_cselect_b32 s24, 1073741824, s24
    s_add_u32 s26, s26, 12288
    s_cmp_ge_u32 s26, s28
    s_cselect_b32 s26, s18, s26
    s_mov_b32 s29, 0
L2_ld:
    s_waitcnt vmcnt(12)
    s_barrier
    s_mov_b32 m0, s26
    s_nop 0
    buffer_load_dwordx4 v3, s[8:11], s23 offen offset:0 lds
    buffer_load_dwordx4 v3, s[8:11], s23 offen offset:1024 lds
    buffer_load_dwordx4 v3, s[8:11], s23 offen offset:2048 lds
    buffer_load_dwordx4 v3, s[8:11], s23 offen offset:3072 lds
    s_add_u32 m0, s26, 4096
    s_add_u32 s27, s23, 4096
    buffer_load_dwordx4 v3, s[8:11], s27 offen offset:0 lds
    buffer_load_dwordx4 v3, s[8:11], s27 offen offset:1024 lds
    buffer_load_dwordx4 v3, s[8:11], s27 offen offset:2048 lds
    s_add_u32 m0, s26, 7168
    s_nop 0
    buffer_load_dwordx4 v3, s[8:11], s24 offen offset:0 lds
    buffer_load_dwordx4 v3, s[8:11], s24 offen offset:1024 lds
    buffer_load_dwordx4 v3, s[8:11], s24 offen offset:2048 lds
    buffer_load_dwordx4 v3, s[8:11], s24 offen offset:3072 lds
    s_add_u32 m0, s26, 11264
    s_add_u32 s27, s24, 4096
    buffer_load_dwordx4 v3, s[8:11], s27 offen lds
    s_add_u32 s23, s23, 7168
    s_add_u32 s24, s24, 5120
    s_add_u32 s25, s25, 1
    s_cmp_ge_u32 s25, 32
    s_cselect_b32 s23, 1073741824, s23
    s_cselect_b32 s24, 1073741824, s24
    s_add_u32 s26, s26, 12288
    s_cmp_ge_u32 s26, s28
    s_cselect_b32 s26, s18, s26
    s_add_u32 s29, s29, 1
    s_cmp_lt_u32 s29, 30
    s_cbranch_scc1 L2_ld
    s_waitcnt vmcnt(12)
    s_barrier
    s_waitcnt vmcnt(0)
    s_barrier
    s_barrier
    s_barrier
    s_branch L2_red
L2_comp:
    v_add_u32 v4, s18, v3
    v_lshlrev_b32 v13, 7, v2
    v_mov_b32 v15, 0x7ff00000
    v_cmp_gt_u32 vcc, 42, v2
    s_nop 1
    v_cndmask_b32 v14, v15, v13, vcc
    v_cmp_gt_u32 vcc, 60, v2
    s_nop 1
    v_cndmask_b32 v13, v15, v13, vcc
    s_mul_i32 s25, s21, 5376
    s_add_u32 s23, s23, s25
    s_mul_i32 s25, s22, 7680
    s_add_u32 s24, s24, s25
    s_mov_b32 s25, 0
    v_mov_b32 v112, 0
    v_mov_b32 v113, 0
    v_mov_b32 v114, 0
    v_mov_b32 v115, 0
    v_mov_b32 v116, 0
    v_mov_b32 v117, 0
    v_mov_b32 v118, 0
    v_mov_b32 v119, 0
    v_mov_b32 v120, 0
    v_mov_b32 v121, 0
    v_mov_b32 v122, 0
    v_mov_b32 v123, 0
    v_mov_b32 v124, 0
    v_mov_b32 v125, 0
    v_mov_b32 v126, 0
    v_mov_b32 v127, 0
    v_mov_b32 v128, 0
    v_mov_b32 v129, 0
    v_mov_b32 v130, 0
    v_mov_b32 v131, 0
    v_mov_b32 v132, 0
    v_mov_b32 v133, 0
    v_mov_b32 v134, 0
    v_mov_b32 v135, 0
    v_mov_b32 v136, 0
    v_mov_b32 v137, 0
    v_mov_b32 v138, 0
    v_mov_b32 v139, 0
    v_mov_b32 v140, 0
    v_mov_b32 v141, 0
    v_mov_b32 v142, 0
    v_mov_b32 v143, 0
    v_mov_b32 v144, 0
    v_mov_b32 v145, 0
    v_mov_b32 v146, 0
    v_mov_b32 v147, 0
    v_mov_b32 v148, 0
    v_mov_b32 v149, 0
    v_mov_b32 v150, 0
    v_mov_b32 v151, 0
    v_mov_b32 v152, 0
    v_mov_b32 v153, 0
    v_mov_b32 v154, 0
    v_mov_b32 v155, 0
    v_mov_b32 v156, 0
    v_mov_b32 v157, 0
    v_mov_b32 v158, 0
    v_mov_b32 v159, 0
    v_mov_b32 v160, 0
    v_mov_b32 v161, 0
    v_mov_b32 v162, 0
    v_mov_b32 v163, 0
    v_mov_b32 v164, 0
    v_mov_b32 v165, 0
    v_mov_b32 v166, 0
    v_mov_b32 v167, 0
    v_mov_b32 v168, 0
    v_mov_b32 v169, 0
    v_mov_b32 v170, 0
    v_mov_b32 v171, 0
    v_mov_b32 v172, 0
    v_mov_b32 v173, 0
    v_mov_b32 v174, 0
    v_mov_b32 v175, 0
    v_mov_b32 v176, 0
    v_mov_b32 v177, 0
    v_mov_b32 v178, 0
    v_mov_b32 v179, 0
    v_mov_b32 v180, 0
    v_mov_b32 v181, 0
    v_mov_b32 v182, 0
    v_mov_b32 v183, 0
    v_mov_b32 v184, 0
    v_mov_b32 v185, 0
    v_mov_b32 v186, 0
    v_mov_b32 v187, 0
    v_mov_b32 v188, 0
    v_mov_b32 v189, 0
    v_mov_b32 v190, 0
    v_mov_b32 v191, 0
    v_mov_b32 v192, 0
    v_mov_b32 v193, 0
    v_mov_b32 v194, 0
    v_mov_b32 v195, 0
    v_mov_b32 v196, 0
    v_mov_b32 v197, 0
    v_mov_b32 v198, 0
    v_mov_b32 v199, 0
    v_mov_b32 v200, 0
    v_mov_b32 v201, 0
    v_mov_b32 v202, 0
    v_mov_b32 v203, 0
    v_mov_b32 v204, 0
    v_mov_b32 v205, 0
    v_mov_b32 v206, 0
    v_mov_b32 v207, 0
    v_mov_b32 v208, 0
    v_mov_b32 v209, 0
    v_mov_b32 v210, 0
    v_mov_b32 v211, 0
    v_mov_b32 v212, 0
    v_mov_b32 v213, 0
    v_mov_b32 v214, 0
    v_mov_b32 v215, 0
    v_mov_b32 v216, 0
    v_mov_b32 v217, 0
    v_mov_b32 v218, 0
    v_mov_b32 v219, 0
    v_mov_b32 v220, 0
    v_mov_b32 v221, 0
    v_mov_b32 v222, 0
    v_mov_b32 v223, 0
    v_mov_b32 v224, 0
    v_mov_b32 v225, 0
    v_mov_b32 v226, 0
    v_mov_b32 v227, 0
    v_mov_b32 v228, 0
    v_mov_b32 v229, 0
    v_mov_b32 v230, 0
    v_mov_b32 v231, 0
    v_mov_b32 v232, 0
    v_mov_b32 v233, 0
    v_mov_b32 v234, 0
    v_mov_b32 v235, 0
    v_mov_b32 v236, 0
    v_mov_b32 v237, 0
    v_mov_b32 v238, 0
    v_mov_b32 v239, 0
    v_mov_b32 v240, 0
    v_mov_b32 v241, 0
    v_mov_b32 v242, 0
    v_mov_b32 v243, 0
    v_mov_b32 v244, 0
    v_mov_b32 v245, 0
    v_mov_b32 v246, 0
    v_mov_b32 v247, 0
    v_mov_b32 v248, 0
    v_mov_b32 v249, 0
    v_mov_b32 v250, 0
    v_mov_b32 v251, 0
    v_mov_b32 v64, 0
    v_mov_b32 v65, 0
    v_mov_b32 v66, 0
    v_mov_b32 v67, 0
    v_mov_b32 v68, 0
    v_mov_b32 v69, 0
    v_mov_b32 v70, 0
    v_mov_b32 v71, 0
    v_mov_b32 v72, 0
    v_mov_b32 v73, 0
    v_mov_b32 v74, 0
    v_mov_b32 v75, 0
    v_mov_b32 v76, 0
    v_mov_b32 v77, 0
    v_mov_b32 v78, 0
    v_mov_b32 v79, 0
    v_mov_b32 v80, 0
    v_mov_b32 v81, 0
    v_mov_b32 v82, 0
    v_mov_b32 v83, 0
    v_mov_b32 v84, 0
    v_mov_b32 v85, 0
    v_mov_b32 v86, 0
    v_mov_b32 v87, 0
    v_mov_b32 v88, 0
    v_mov_b32 v89, 0
    v_mov_b32 v90, 0
    v_mov_b32 v91, 0
    v_mov_b32 v92, 0
    v_mov_b32 v93, 0
    v_mov_b32 v94, 0
    v_mov_b32 v95, 0
    v_mov_b32 v96, 0
    v_mov_b32 v97, 0
    v_mov_b32 v98, 0
    v_mov_b32 v99, 0
    v_mov_b32 v100, 0
    v_mov_b32 v101, 0
    v_mov_b32 v102, 0
    v_mov_b32 v103, 0
    v_mov_b32 v104, 0
    v_mov_b32 v105, 0
    v_mov_b32 v106, 0
    v_mov_b32 v107, 0
    v_mov_b32 v108, 0
    v_mov_b32 v109, 0
    v_mov_b32 v110, 0
    v_mov_b32 v111, 0
    s_mov_b32 s29, 0
L2_loop:
    s_barrier
    v_mfma_f32_16x16x32_bf16 v[112:115], v[92:95], v[64:67], v[112:115]
    ds_read_b128 v[16:19], v4 offset:0
    v_mfma_f32_16x16x32_bf16 v[116:119], v[92:95], v[68:71], v[116:119]
    v_mfma_f32_16x16x32_bf16 v[120:123], v[92:95], v[72:75], v[120:123]
    ds_read_b128 v[20:23], v4 offset:1024
    v_mfma_f32_16x16x32_bf16 v[124:127], v[92:95], v[76:79], v[124:127]
    v_mfma_f32_16x16x32_bf16 v[128:131], v[92:95], v[80:83], v[128:131]
    ds_read_b128 v[24:27], v4 offset:2048
    v_mfma_f32_16x16x32_bf16 v[132:135], v[92:95], v[84:87], v[132:135]
    v_mfma_f32_16x16x32_bf16 v[136:139], v[92:95], v[88:91], v[136:139]
    ds_read_b128 v[28:31], v4 offset:3072
    v_mfma_f32_16x16x32_bf16 v[140:143], v[96:99], v[64:67], v[140:143]
    v_mfma_f32_16x16x32_bf16 v[144:147], v[96:99], v[68:71], v[144:147]
    ds_read_b128 v[32:35], v4 offset:4096
    v_mfma_f32_16x16x32_bf16 v[148:151], v[96:99], v[72:75], v[148:151]
    v_mfma_f32_16x16x32_bf16 v[152:155], v[96:99], v[76:79], v[152:155]
    ds_read_b128 v[36:39], v4 offset:5120
    v_mfma_f32_16x16x32_bf16 v[156:159], v[96:99], v[80:83], v[156:159]
    v_mfma_f32_16x16x32_bf16 v[160:163], v[96:99], v[84:87], v[160:163]
    ds_read_b128 v[40:43], v4 offset:6144
    v_mfma_f32_16x16x32_bf16 v[164:167], v[96:99], v[88:91], v[164:167]
    v_mfma_f32_16x16x32_bf16 v[168:171], v[100:103], v[64:67], v[168:171]
    ds_read_b128 v[44:47], v4 offset:7168
    v_mfma_f32_16x16x32_bf16 v[172:175], v[100:103], v[68:71], v[172:175]
    v_mfma_f32_16x16x32_bf16 v[176:179], v[100:103], v[72:75], v[176:179]
    ds_read_b128 v[48:51], v4 offset:8192
    v_mfma_f32_16x16x32_bf16 v[180:183], v[100:103], v[76:79], v[180:183]
    v_mfma_f32_16x16x32_bf16 v[184:187], v[100:103], v[80:83], v[184:187]
    ds_read_b128 v[52:55], v4 offset:9216
    v_mfma_f32_16x16x32_bf16 v[188:191], v[100:103], v[84:87], v[188:191]
    v_mfma_f32_16x16x32_bf16 v[192:195], v[100:103], v[88:91], v[192:195]
    ds_read_b128 v[56:59], v4 offset:10240
    v_mfma_f32_16x16x32_bf16 v[196:199], v[104:107], v[64:67], v[196:199]
    v_mfma_f32_16x16x32_bf16 v[200:203], v[104:107], v[68:71], v[200:203]
    ds_read_b128 v[60:63], v4 offset:11264
    v_mfma_f32_16x16x32_bf16 v[204:207], v[104:107], v[72:75], v[204:207]
    v_mfma_f32_16x16x32_bf16 v[208:211], v[104:107], v[76:79], v[208:211]
    v_mfma_f32_16x16x32_bf16 v[212:215], v[104:107], v[80:83], v[212:215]
    v_mfma_f32_16x16x32_bf16 v[216:219], v[104:107], v[84:87], v[216:219]
    v_mfma_f32_16x16x32_bf16 v[220:223], v[104:107], v[88:91], v[220:223]
    v_mfma_f32_16x16x32_bf16 v[224:227], v[108:111], v[64:67], v[224:227]
    v_mfma_f32_16x16x32_bf16 v[228:231], v[108:111], v[68:71], v[228:231]
    v_mfma_f32_16x16x32_bf16 v[232:235], v[108:111], v[72:75], v[232:235]
    v_mfma_f32_16x16x32_bf16 v[236:239], v[108:111], v[76:79], v[236:239]
    v_mfma_f32_16x16x32_bf16 v[240:243], v[108:111], v[80:83], v[240:243]
    v_mfma_f32_16x16x32_bf16 v[244:247], v[108:111], v[84:87], v[244:247]
    v_mfma_f32_16x16x32_bf16 v[248:251], v[108:111], v[88:91], v[248:251]
    s_waitcnt lgkmcnt(0)
    s_add_u32 s29, s29, 1
    s_cmp_eq_u32 s29, 32
    s_cbranch_scc1 L2_done0
    s_barrier
    v_mfma_f32_16x16x32_bf16 v[112:115], v[44:47], v[16:19], v[112:115]
    ds_read_b128 v[64:67], v4 offset:12288
    v_mfma_f32_16x16x32_bf16 v[116:119], v[44:47], v[20:23], v[116:119]
    v_mfma_f32_16x16x32_bf16 v[120:123], v[44:47], v[24:27], v[120:123]
    ds_read_b128 v[68:71], v4 offset:13312
    v_mfma_f32_16x16x32_bf16 v[124:127], v[44:47], v[28:31], v[124:127]
    v_mfma_f32_16x16x32_bf16 v[128:131], v[44:47], v[32:35], v[128:131]
    ds_read_b128 v[72:75], v4 offset:14336
    v_mfma_f32_16x16x32_bf16 v[132:135], v[44:47], v[36:39], v[132:135]
    v_mfma_f32_16x16x32_bf16 v[136:139], v[44:47], v[40:43], v[136:139]
    ds_read_b128 v[76:79], v4 offset:15360
    v_mfma_f32_16x16x32_bf16 v[140:143], v[48:51], v[16:19], v[140:143]
    v_mfma_f32_16x16x32_bf16 v[144:147], v[48:51], v[20:23], v[144:147]
    ds_read_b128 v[80:83], v4 offset:16384
    v_mfma_f32_16x16x32_bf16 v[148:151], v[48:51], v[24:27], v[148:151]
    v_mfma_f32_16x16x32_bf16 v[152:155], v[48:51], v[28:31], v[152:155]
    ds_read_b128 v[84:87], v4 offset:17408
    v_mfma_f32_16x16x32_bf16 v[156:159], v[48:51], v[32:35], v[156:159]
    v_mfma_f32_16x16x32_bf16 v[160:163], v[48:51], v[36:39], v[160:163]
    ds_read_b128 v[88:91], v4 offset:18432
    v_mfma_f32_16x16x32_bf16 v[164:167], v[48:51], v[40:43], v[164:167]
    v_mfma_f32_16x16x32_bf16 v[168:171], v[52:55], v[16:19], v[168:171]
    ds_read_b128 v[92:95], v4 offset:19456
    v_mfma_f32_16x16x32_bf16 v[172:175], v[52:55], v[20:23], v[172:175]
    v_mfma_f32_16x16x32_bf16 v[176:179], v[52:55], v[24:27], v[176:179]
    ds_read_b128 v[96:99], v4 offset:20480
    v_mfma_f32_16x16x32_bf16 v[180:183], v[52:55], v[28:31], v[180:183]
    v_mfma_f32_16x16x32_bf16 v[184:187], v[52:55], v[32:35], v[184:187]
    ds_read_b128 v[100:103], v4 offset:21504
    v_mfma_f32_16x16x32_bf16 v[188:191], v[52:55], v[36:39], v[188:191]
    v_mfma_f32_16x16x32_bf16 v[192:195], v[52:55], v[40:43], v[192:195]
    ds_read_b128 v[104:107], v4 offset:22528
    v_mfma_f32_16x16x32_bf16 v[196:199], v[56:59], v[16:19], v[196:199]
    v_mfma_f32_16x16x32_bf16 v[200:203], v[56:59], v[20:23], v[200:203]
    ds_read_b128 v[108:111], v4 offset:23552
    v_mfma_f32_16x16x32_bf16 v[204:207], v[56:59], v[24:27], v[204:207]
    v_mfma_f32_16x16x32_bf16 v[208:211], v[56:59], v[28:31], v[208:211]
    v_mfma_f32_16x16x32_bf16 v[212:215], v[56:59], v[32:35], v[212:215]
    v_mfma_f32_16x16x32_bf16 v[216:219], v[56:59], v[36:39], v[216:219]
    v_mfma_f32_16x16x32_bf16 v[220:223], v[56:59], v[40:43], v[220:223]
    v_mfma_f32_16x16x32_bf16 v[224:227], v[60:63], v[16:19], v[224:227]
    v_mfma_f32_16x16x32_bf16 v[228:231], v[60:63], v[20:23], v[228:231]
    v_mfma_f32_16x16x32_bf16 v[232:235], v[60:63], v[24:27], v[232:235]
    v_mfma_f32_16x16x32_bf16 v[236:239], v[60:63], v[28:31], v[236:239]
    v_mfma_f32_16x16x32_bf16 v[240:243], v[60:63], v[32:35], v[240:243]
    v_mfma_f32_16x16x32_bf16 v[244:247], v[60:63], v[36:39], v[244:247]
    v_mfma_f32_16x16x32_bf16 v[248:251], v[60:63], v[40:43], v[248:251]
    s_waitcnt lgkmcnt(0)
    s_add_u32 s29, s29, 1
    s_cmp_eq_u32 s29, 32
    s_cbranch_scc1 L2_done1
    s_barrier
    v_mfma_f32_16x16x32_bf16 v[112:115], v[92:95], v[64:67], v[112:115]
    ds_read_b128 v[16:19], v4 offset:24576
    v_mfma_f32_16x16x32_bf16 v[116:119], v[92:95], v[68:71], v[116:119]
    v_mfma_f32_16x16x32_bf16 v[120:123], v[92:95], v[72:75], v[120:123]
    ds_read_b128 v[20:23], v4 offset:25600
    v_mfma_f32_16x16x32_bf16 v[124:127], v[92:95], v[76:79], v[124:127]
    v_mfma_f32_16x16x32_bf16 v[128:131], v[92:95], v[80:83], v[128:131]
    ds_read_b128 v[24:27], v4 offset:26624
    v_mfma_f32_16x16x32_bf16 v[132:135], v[92:95], v[84:87], v[132:135]
    v_mfma_f32_16x16x32_bf16 v[136:139], v[92:95], v[88:91], v[136:139]
    ds_read_b128 v[28:31], v4 offset:27648
    v_mfma_f32_16x16x32_bf16 v[140:143], v[96:99], v[64:67], v[140:143]
    v_mfma_f32_16x16x32_bf16 v[144:147], v[96:99], v[68:71], v[144:147]
    ds_read_b128 v[32:35], v4 offset:28672
    v_mfma_f32_16x16x32_bf16 v[148:151], v[96:99], v[72:75], v[148:151]
    v_mfma_f32_16x16x32_bf16 v[152:155], v[96:99], v[76:79], v[152:155]
    ds_read_b128 v[36:39], v4 offset:29696
    v_mfma_f32_16x16x32_bf16 v[156:159], v[96:99], v[80:83], v[156:159]
    v_mfma_f32_16x16x32_bf16 v[160:163], v[96:99], v[84:87], v[160:163]
    ds_read_b128 v[40:43], v4 offset:30720
    v_mfma_f32_16x16x32_bf16 v[164:167], v[96:99], v[88:91], v[164:167]
    v_mfma_f32_16x16x32_bf16 v[168:171], v[100:103], v[64:67], v[168:171]
    ds_read_b128 v[44:47], v4 offset:31744
    v_mfma_f32_16x16x32_bf16 v[172:175], v[100:103], v[68:71], v[172:175]
    v_mfma_f32_16x16x32_bf16 v[176:179], v[100:103], v[72:75], v[176:179]
    ds_read_b128 v[48:51], v4 offset:32768
    v_mfma_f32_16x16x32_bf16 v[180:183], v[100:103], v[76:79], v[180:183]
    v_mfma_f32_16x16x32_bf16 v[184:187], v[100:103], v[80:83], v[184:187]
    ds_read_b128 v[52:55], v4 offset:33792
    v_mfma_f32_16x16x32_bf16 v[188:191], v[100:103], v[84:87], v[188:191]
    v_mfma_f32_16x16x32_bf16 v[192:195], v[100:103], v[88:91], v[192:195]
    ds_read_b128 v[56:59], v4 offset:34816
    v_mfma_f32_16x16x32_bf16 v[196:199], v[104:107], v[64:67], v[196:199]
    v_mfma_f32_16x16x32_bf16 v[200:203], v[104:107], v[68:71], v[200:203]
    ds_read_b128 v[60:63], v4 offset:35840
    v_mfma_f32_16x16x32_bf16 v[204:207], v[104:107], v[72:75], v[204:207]
    v_mfma_f32_16x16x32_bf16 v[208:211], v[104:107], v[76:79], v[208:211]
    v_mfma_f32_16x16x32_bf16 v[212:215], v[104:107], v[80:83], v[212:215]
    v_mfma_f32_16x16x32_bf16 v[216:219], v[104:107], v[84:87], v[216:219]
    v_mfma_f32_16x16x32_bf16 v[220:223], v[104:107], v[88:91], v[220:223]
    v_mfma_f32_16x16x32_bf16 v[224:227], v[108:111], v[64:67], v[224:227]
    v_mfma_f32_16x16x32_bf16 v[228:231], v[108:111], v[68:71], v[228:231]
    v_mfma_f32_16x16x32_bf16 v[232:235], v[108:111], v[72:75], v[232:235]
    v_mfma_f32_16x16x32_bf16 v[236:239], v[108:111], v[76:79], v[236:239]
    v_mfma_f32_16x16x32_bf16 v[240:243], v[108:111], v[80:83], v[240:243]
    v_mfma_f32_16x16x32_bf16 v[244:247], v[108:111], v[84:87], v[244:247]
    v_mfma_f32_16x16x32_bf16 v[248:251], v[108:111], v[88:91], v[248:251]
    s_waitcnt lgkmcnt(0)
    s_add_u32 s29, s29, 1
    s_cmp_eq_u32 s29, 32
    s_cbranch_scc1 L2_done0
    s_barrier
    v_mfma_f32_16x16x32_bf16 v[112:115], v[44:47], v[16:19], v[112:115]
    ds_read_b128 v[64:67], v4 offset:0
    v_mfma_f32_16x16x32_bf16 v[116:119], v[44:47], v[20:23], v[116:119]
    v_mfma_f32_16x16x32_bf16 v[120:123], v[44:47], v[24:27], v[120:123]
    ds_read_b128 v[68:71], v4 offset:1024
    v_mfma_f32_16x16x32_bf16 v[124:127], v[44:47], v[28:31], v[124:127]
    v_mfma_f32_16x16x32_bf16 v[128:131], v[44:47], v[32:35], v[128:131]
    ds_read_b128 v[72:75], v4 offset:2048
    v_mfma_f32_16x16x32_bf16 v[132:135], v[44:47], v[36:39], v[132:135]
    v_mfma_f32_16x16x32_bf16 v[136:139], v[44:47], v[40:43], v[136:139]
    ds_read_b128 v[76:79], v4 offset:3072
    v_mfma_f32_16x16x32_bf16 v[140:143], v[48:51], v[16:19], v[140:143]
    v_mfma_f32_16x16x32_bf16 v[144:147], v[48:51], v[20:23], v[144:147]
    ds_read_b128 v[80:83], v4 offset:4096
    v_mfma_f32_16x16x32_bf16 v[148:151], v[48:51], v[24:27], v[148:151]
    v_mfma_f32_16x16x32_bf16 v[152:155], v[48:51], v[28:31], v[152:155]
    ds_read_b128 v[84:87], v4 offset:5120
    v_mfma_f32_16x16x32_bf16 v[156:159], v[48:51], v[32:35], v[156:159]
    v_mfma_f32_16x16x32_bf16 v[160:163], v[48:51], v[36:39], v[160:163]
    ds_read_b128 v[88:91], v4 offset:6144
    v_mfma_f32_16x16x32_bf16 v[164:167], v[48:51], v[40:43], v[164:167]
    v_mfma_f32_16x16x32_bf16 v[168:171], v[52:55], v[16:19], v[168:171]
    ds_read_b128 v[92:95], v4 offset:7168
    v_mfma_f32_16x16x32_bf16 v[172:175], v[52:55], v[20:23], v[172:175]
    v_mfma_f32_16x16x32_bf16 v[176:179], v[52:55], v[24:27], v[176:179]
    ds_read_b128 v[96:99], v4 offset:8192
    v_mfma_f32_16x16x32_bf16 v[180:183], v[52:55], v[28:31], v[180:183]
    v_mfma_f32_16x16x32_bf16 v[184:187], v[52:55], v[32:35], v[184:187]
    ds_read_b128 v[100:103], v4 offset:9216
    v_mfma_f32_16x16x32_bf16 v[188:191], v[52:55], v[36:39], v[188:191]
    v_mfma_f32_16x16x32_bf16 v[192:195], v[52:55], v[40:43], v[192:195]
    ds_read_b128 v[104:107], v4 offset:10240
    v_mfma_f32_16x16x32_bf16 v[196:199], v[56:59], v[16:19], v[196:199]
    v_mfma_f32_16x16x32_bf16 v[200:203], v[56:59], v[20:23], v[200:203]
    ds_read_b128 v[108:111], v4 offset:11264
    v_mfma_f32_16x16x32_bf16 v[204:207], v[56:59], v[24:27], v[204:207]
    v_mfma_f32_16x16x32_bf16 v[208:211], v[56:59], v[28:31], v[208:211]
    v_mfma_f32_16x16x32_bf16 v[212:215], v[56:59], v[32:35], v[212:215]
    v_mfma_f32_16x16x32_bf16 v[216:219], v[56:59], v[36:39], v[216:219]
    v_mfma_f32_16x16x32_bf16 v[220:223], v[56:59], v[40:43], v[220:223]
    v_mfma_f32_16x16x32_bf16 v[224:227], v[60:63], v[16:19], v[224:227]
    v_mfma_f32_16x16x32_bf16 v[228:231], v[60:63], v[20:23], v[228:231]
    v_mfma_f32_16x16x32_bf16 v[232:235], v[60:63], v[24:27], v[232:235]
    v_mfma_f32_16x16x32_bf16 v[236:239], v[60:63], v[28:31], v[236:239]
    v_mfma_f32_16x16x32_bf16 v[240:243], v[60:63], v[32:35], v[240:243]
    v_mfma_f32_16x16x32_bf16 v[244:247], v[60:63], v[36:39], v[244:247]
    v_mfma_f32_16x16x32_bf16 v[248:251], v[60:63], v[40:43], v[248:251]
    s_waitcnt lgkmcnt(0)
    s_add_u32 s29, s29, 1
    s_cmp_eq_u32 s29, 32
    s_cbranch_scc1 L2_done1
    s_barrier
    v_mfma_f32_16x16x32_bf16 v[112:115], v[92:95], v[64:67], v[112:115]
    ds_read_b128 v[16:19], v4 offset:12288
    v_mfma_f32_16x16x32_bf16 v[116:119], v[92:95], v[68:71], v[116:119]
    v_mfma_f32_16x16x32_bf16 v[120:123], v[92:95], v[72:75], v[120:123]
    ds_read_b128 v[20:23], v4 offset:13312
    v_mfma_f32_16x16x32_bf16 v[124:127], v[92:95], v[76:79], v[124:127]
    v_mfma_f32_16x16x32_bf16 v[128:131], v[92:95], v[80:83], v[128:131]
    ds_read_b128 v[24:27], v4 offset:14336
    v_mfma_f32_16x16x32_bf16 v[132:135], v[92:95], v[84:87], v[132:135]
    v_mfma_f32_16x16x32_bf16 v[136:139], v[92:95], v[88:91], v[136:139]
    ds_read_b128 v[28:31], v4 offset:15360
    v_mfma_f32_16x16x32_bf16 v[140:143], v[96:99], v[64:67], v[140:143]
    v_mfma_f32_16x16x32_bf16 v[144:147], v[96:99], v[68:71], v[144:147]
    ds_read_b128 v[32:35], v4 offset:16384
    v_mfma_f32_16x16x32_bf16 v[148:151], v[96:99], v[72:75], v[148:151]
    v_mfma_f32_16x16x32_bf16 v[152:155], v[96:99], v[76:79], v[152:155]
    ds_read_b128 v[36:39], v4 offset:17408
    v_mfma_f32_16x16x32_bf16 v[156:159], v[96:99], v[80:83], v[156:159]
    v_mfma_f32_16x16x32_bf16 v[160:163], v[96:99], v[84:87], v[160:163]
    ds_read_b128 v[40:43], v4 offset:18432
    v_mfma_f32_16x16x32_bf16 v[164:167], v[96:99], v[88:91], v[164:167]
    v_mfma_f32_16x16x32_bf16 v[168:171], v[100:103], v[64:67], v[168:171]
    ds_read_b128 v[44:47], v4 offset:19456
    v_mfma_f32_16x16x32_bf16 v[172:175], v[100:103], v[68:71], v[172:175]
    v_mfma_f32_16x16x32_bf16 v[176:179], v[100:103], v[72:75], v[176:179]
    ds_read_b128 v[48:51], v4 offset:20480
    v_mfma_f32_16x16x32_bf16 v[180:183], v[100:103], v[76:79], v[180:183]
    v_mfma_f32_16x16x32_bf16 v[184:187], v[100:103], v[80:83], v[184:187]
    ds_read_b128 v[52:55], v4 offset:21504
    v_mfma_f32_16x16x32_bf16 v[188:191], v[100:103], v[84:87], v[188:191]
    v_mfma_f32_16x16x32_bf16 v[192:195], v[100:103], v[88:91], v[192:195]
    ds_read_b128 v[56:59], v4 offset:22528
    v_mfma_f32_16x16x32_bf16 v[196:199], v[104:107], v[64:67], v[196:199]
    v_mfma_f32_16x16x32_bf16 v[200:203], v[104:107], v[68:71], v[200:203]
    ds_read_b128 v[60:63], v4 offset:23552
    v_mfma_f32_16x16x32_bf16 v[204:207], v[104:107], v[72:75], v[204:207]
    v_mfma_f32_16x16x32_bf16 v[208:211], v[104:107], v[76:79], v[208:211]
    v_mfma_f32_16x16x32_bf16 v[212:215], v[104:107], v[80:83], v[212:215]
    v_mfma_f32_16x16x32_bf16 v[216:219], v[104:107], v[84:87], v[216:219]
    v_mfma_f32_16x16x32_bf16 v[220:223], v[104:107], v[88:91], v[220:223]
    v_mfma_f32_16x16x32_bf16 v[224:227], v[108:111], v[64:67], v[224:227]
    v_mfma_f32_16x16x32_bf16 v[228:231], v[108:111], v[68:71], v[228:231]
    v_mfma_f32_16x16x32_bf16 v[232:235], v[108:111], v[72:75], v[232:235]
    v_mfma_f32_16x16x32_bf16 v[236:239], v[108:111], v[76:79], v[236:239]
    v_mfma_f32_16x16x32_bf16 v[240:243], v[108:111], v[80:83], v[240:243]
    v_mfma_f32_16x16x32_bf16 v[244:247], v[108:111], v[84:87], v[244:247]
    v_mfma_f32_16x16x32_bf16 v[248:251], v[108:111], v[88:91], v[248:251]
    s_waitcnt lgkmcnt(0)
    s_add_u32 s29, s29, 1
    s_cmp_eq_u32 s29, 32
    s_cbranch_scc1 L2_done0
    s_barrier
    v_mfma_f32_16x16x32_bf16 v[112:115], v[44:47], v[16:19], v[112:115]
    ds_read_b128 v[64:67], v4 offset:24576
    v_mfma_f32_16x16x32_bf16 v[116:119], v[44:47], v[20:23], v[116:119]
    v_mfma_f32_16x16x32_bf16 v[120:123], v[44:47], v[24:27], v[120:123]
    ds_read_b128 v[68:71], v4 offset:25600
    v_mfma_f32_16x16x32_bf16 v[124:127], v[44:47], v[28:31], v[124:127]
    v_mfma_f32_16x16x32_bf16 v[128:131], v[44:47], v[32:35], v[128:131]
    ds_read_b128 v[72:75], v4 offset:26624
    v_mfma_f32_16x16x32_bf16 v[132:135], v[44:47], v[36:39], v[132:135]
    v_mfma_f32_16x16x32_bf16 v[136:139], v[44:47], v[40:43], v[136:139]
    ds_read_b128 v[76:79], v4 offset:27648
    v_mfma_f32_16x16x32_bf16 v[140:143], v[48:51], v[16:19], v[140:143]
    v_mfma_f32_16x16x32_bf16 v[144:147], v[48:51], v[20:23], v[144:147]
    ds_read_b128 v[80:83], v4 offset:28672
    v_mfma_f32_16x16x32_bf16 v[148:151], v[48:51], v[24:27], v[148:151]
    v_mfma_f32_16x16x32_bf16 v[152:155], v[48:51], v[28:31], v[152:155]
    ds_read_b128 v[84:87], v4 offset:29696
    v_mfma_f32_16x16x32_bf16 v[156:159], v[48:51], v[32:35], v[156:159]
    v_mfma_f32_16x16x32_bf16 v[160:163], v[48:51], v[36:39], v[160:163]
    ds_read_b128 v[88:91], v4 offset:30720
    v_mfma_f32_16x16x32_bf16 v[164:167], v[48:51], v[40:43], v[164:167]
    v_mfma_f32_16x16x32_bf16 v[168:171], v[52:55], v[16:19], v[168:171]
    ds_read_b128 v[92:95], v4 offset:31744
    v_mfma_f32_16x16x32_bf16 v[172:175], v[52:55], v[20:23], v[172:175]
    v_mfma_f32_16x16x32_bf16 v[176:179], v[52:55], v[24:27], v[176:179]
    ds_read_b128 v[96:99], v4 offset:32768
    v_mfma_f32_16x16x32_bf16 v[180:183], v[52:55], v[28:31], v[180:183]
    v_mfma_f32_16x16x32_bf16 v[184:187], v[52:55], v[32:35], v[184:187]
    ds_read_b128 v[100:103], v4 offset:33792
    v_mfma_f32_16x16x32_bf16 v[188:191], v[52:55], v[36:39], v[188:191]
    v_mfma_f32_16x16x32_bf16 v[192:195], v[52:55], v[40:43], v[192:195]
    ds_read_b128 v[104:107], v4 offset:34816
    v_mfma_f32_16x16x32_bf16 v[196:199], v[56:59], v[16:19], v[196:199]
    v_mfma_f32_16x16x32_bf16 v[200:203], v[56:59], v[20:23], v[200:203]
    ds_read_b128 v[108:111], v4 offset:35840
    v_mfma_f32_16x16x32_bf16 v[204:207], v[56:59], v[24:27], v[204:207]
    v_mfma_f32_16x16x32_bf16 v[208:211], v[56:59], v[28:31], v[208:211]
    v_mfma_f32_16x16x32_bf16 v[212:215], v[56:59], v[32:35], v[212:215]
    v_mfma_f32_16x16x32_bf16 v[216:219], v[56:59], v[36:39], v[216:219]
    v_mfma_f32_16x16x32_bf16 v[220:223], v[56:59], v[40:43], v[220:223]
    v_mfma_f32_16x16x32_bf16 v[224:227], v[60:63], v[16:19], v[224:227]
    v_mfma_f32_16x16x32_bf16 v[228:231], v[60:63], v[20:23], v[228:231]
    v_mfma_f32_16x16x32_bf16 v[232:235], v[60:63], v[24:27], v[232:235]
    v_mfma_f32_16x16x32_bf16 v[236:239], v[60:63], v[28:31], v[236:239]
    v_mfma_f32_16x16x32_bf16 v[240:243], v[60:63], v[32:35], v[240:243]
    v_mfma_f32_16x16x32_bf16 v[244:247], v[60:63], v[36:39], v[244:247]
    v_mfma_f32_16x16x32_bf16 v[248:251], v[60:63], v[40:43], v[248:251]
    s_waitcnt lgkmcnt(0)
    s_add_u32 s29, s29, 1
    s_cmp_eq_u32 s29, 32
    s_cbranch_scc1 L2_done1
    s_branch L2_loop
L2_done0:
L2_done1:
    s_waitcnt vmcnt(0)
    s_mul_i32 s22, s19, 35840
    v_add_u32 v5, s22, v3
    s_barrier
    v_mfma_f32_16x16x32_bf16 v[112:115], v[92:95], v[64:67], v[112:115]
    v_mfma_f32_16x16x32_bf16 v[116:119], v[92:95], v[68:71], v[116:119]
    v_mfma_f32_16x16x32_bf16 v[120:123], v[92:95], v[72:75], v[120:123]
    v_mfma_f32_16x16x32_bf16 v[124:127], v[92:95], v[76:79], v[124:127]
    v_mfma_f32_16x16x32_bf16 v[128:131], v[92:95], v[80:83], v[128:131]
    v_mfma_f32_16x16x32_bf16 v[132:135], v[92:95], v[84:87], v[132:135]
    v_mfma_f32_16x16x32_bf16 v[136:139], v[92:95], v[88:91], v[136:139]
    v_mfma_f32_16x16x32_bf16 v[140:143], v[96:99], v[64:67], v[140:143]
    v_mfma_f32_16x16x32_bf16 v[144:147], v[96:99], v[68:71], v[144:147]
    ds_write_b128 v5, v[112:115] offset:0
    v_mfma_f32_16x16x32_bf16 v[148:151], v[96:99], v[72:75], v[148:151]
    ds_write_b128 v5, v[116:119] offset:1024
    v_mfma_f32_16x16x32_bf16 v[152:155], v[96:99], v[76:79], v[152:155]
    ds_write_b128 v5, v[120:123] offset:2048
    v_mfma_f32_16x16x32_bf16 v[156:159], v[96:99], v[80:83], v[156:159]
    ds_write_b128 v5, v[124:127] offset:3072
    v_mfma_f32_16x16x32_bf16 v[160:163], v[96:99], v[84:87], v[160:163]
    ds_write_b128 v5, v[128:131] offset:4096
    v_mfma_f32_16x16x32_bf16 v[164:167], v[96:99], v[88:91], v[164:167]
    ds_write_b128 v5, v[132:135] offset:5120
    v_mfma_f32_16x16x32_bf16 v[168:171], v[100:103], v[64:67], v[168:171]
    ds_write_b128 v5, v[136:139] offset:6144
    v_mfma_f32_16x16x32_bf16 v[172:175], v[100:103], v[68:71], v[172:175]
    ds_write_b128 v5, v[140:143] offset:7168
    v_mfma_f32_16x16x32_bf16 v[176:179], v[100:103], v[72:75], v[176:179]
    ds_write_b128 v5, v[144:147] offset:8192
    v_mfma_f32_16x16x32_bf16 v[180:183], v[100:103], v[76:79], v[180:183]
    ds_write_b128 v5, v[148:151] offset:9216
    v_mfma_f32_16x16x32_bf16 v[184:187], v[100:103], v[80:83], v[184:187]
    ds_write_b128 v5, v[152:155] offset:10240
    v_mfma_f32_16x16x32_bf16 v[188:191], v[100:103], v[84:87], v[188:191]
    ds_write_b128 v5, v[156:159] offset:11264
    v_mfma_f32_16x16x32_bf16 v[192:195], v[100:103], v[88:91], v[192:195]
    ds_write_b128 v5, v[160:163] offset:12288
    v_mfma_f32_16x16x32_bf16 v[196:199], v[104:107], v[64:67], v[196:199]
    ds_write_b128 v5, v[164:167] offset:13312
    v_mfma_f32_16x16x32_bf16 v[200:203], v[104:107], v[68:71], v[200:203]
    ds_write_b128 v5, v[168:171] offset:14336
    v_mfma_f32_16x16x32_bf16 v[204:207], v[104:107], v[72:75], v[204:207]
    ds_write_b128 v5, v[172:175] offset:15360
    v_mfma_f32_16x16x32_bf16 v[208:211], v[104:107], v[76:79], v[208:211]
    ds_write_b128 v5, v[176:179] offset:16384
    v_mfma_f32_16x16x32_bf16 v[212:215], v[104:107], v[80:83], v[212:215]
    ds_write_b128 v5, v[180:183] offset:17408
    v_mfma_f32_16x16x32_bf16 v[216:219], v[104:107], v[84:87], v[216:219]
    ds_write_b128 v5, v[184:187] offset:18432
    v_mfma_f32_16x16x32_bf16 v[220:223], v[104:107], v[88:91], v[220:223]
    ds_write_b128 v5, v[188:191] offset:19456
    v_mfma_f32_16x16x32_bf16 v[224:227], v[108:111], v[64:67], v[224:227]
    ds_write_b128 v5, v[192:195] offset:20480
    v_mfma_f32_16x16x32_bf16 v[228:231], v[108:111], v[68:71], v[228:231]
    ds_write_b128 v5, v[196:199] offset:21504
    v_mfma_f32_16x16x32_bf16 v[232:235], v[108:111], v[72:75], v[232:235]
    ds_write_b128 v5, v[200:203] offset:22528
    v_mfma_f32_16x16x32_bf16 v[236:239], v[108:111], v[76:79], v[236:239]
    ds_write_b128 v5, v[204:207] offset:23552
    v_mfma_f32_16x16x32_bf16 v[240:243], v[108:111], v[80:83], v[240:243]
    ds_write_b128 v5, v[208:211] offset:24576
    v_mfma_f32_16x16x32_bf16 v[244:247], v[108:111], v[84:87], v[244:247]
    ds_write_b128 v5, v[212:215] offset:25600
    v_mfma_f32_16x16x32_bf16 v[248:251], v[108:111], v[88:91], v[248:251]
    ds_write_b128 v5, v[216:219] offset:26624
    s_nop 7
    ds_write_b128 v5, v[220:223] offset:27648
    ds_write_b128 v5, v[224:227] offset:28672
    ds_write_b128 v5, v[228:231] offset:29696
    ds_write_b128 v5, v[232:235] offset:30720
    ds_write_b128 v5, v[236:239] offset:31744
    ds_write_b128 v5, v[240:243] offset:32768
    ds_write_b128 v5, v[244:247] offset:33792
    ds_write_b128 v5, v[248:251] offset:34816
    s_waitcnt lgkmcnt(0)
    s_barrier
L2_red:
    s_mul_i32 s22, s20, 143360
    s_mul_i32 s23, s21, 160
    s_add_u32 s22, s22, s23
    v_and_b32 v6, 15, v2
    v_mul_u32_u24 v6, 1280, v6
    v_lshrrev_b32 v7, 4, v2
    v_lshl_add_u32 v6, v7, 3, v6
    s_lshl_b32 s23, s3, 10
    v_add_u32 v8, s23, v3
    v_add_u32 v9, 35840, v8
    v_add_u32 v10, 71680, v8
    v_add_u32 v11, 107520, v8
    ds_read_b128 v[16:19], v8 offset:0
    ds_read_b128 v[20:23], v9 offset:0
    ds_read_b128 v[24:27], v10 offset:0
    ds_read_b128 v[28:31], v11 offset:0
    ds_read_b128 v[32:35], v8 offset:8192
    ds_read_b128 v[36:39], v9 offset:8192
    ds_read_b128 v[40:43], v10 offset:8192
    ds_read_b128 v[44:47], v11 offset:8192
    ds_read_b128 v[48:51], v8 offset:16384
    ds_read_b128 v[52:55], v9 offset:16384
    ds_read_b128 v[56:59], v10 offset:16384
    ds_read_b128 v[60:63], v11 offset:16384
    s_waitcnt lgkmcnt(8)
    ds_read_b128 v[64:67], v8 offset:24576
    ds_read_b128 v[68:71], v9 offset:24576
    ds_read_b128 v[72:75], v10 offset:24576
    ds_read_b128 v[76:79], v11 offset:24576
    s_waitcnt lgkmcnt(8)
    ds_read_b128 v[80:83], v8 offset:32768
    ds_read_b128 v[84:87], v9 offset:32768
    ds_read_b128 v[88:91], v10 offset:32768
    ds_read_b128 v[92:95], v11 offset:32768
    s_waitcnt lgkmcnt(0)
    s_add_u32 s24, s3, 0
    s_mul_i32 s25, s24, 37
    s_lshr_b32 s25, s25, 8
    s_mul_i32 s26, s25, 7
    s_sub_u32 s26, s24, s26
    s_mul_i32 s26, s26, 20480
    s_lshl_b32 s25, s25, 5
    s_add_u32 s26, s26, s25
    s_add_u32 s26, s26, s22
    s_cmp_ge_u32 s24, 35
    s_cselect_b32 s26, 1073741824, s26
    v_add_f32 v16, v16, v20
    v_add_f32 v24, v24, v28
    v_add_f32 v17, v17, v21
    v_add_f32 v25, v25, v29
    v_add_f32 v18, v18, v22
    v_add_f32 v26, v26, v30
    v_add_f32 v19, v19, v23
    v_add_f32 v27, v27, v31
    v_add_f32 v16, v16, v24
    v_add_f32 v17, v17, v25
    v_add_f32 v18, v18, v26
    v_add_f32 v19, v19, v27
    v_cvt_pk_bf16_f32 v20, v16, v17
    v_cvt_pk_bf16_f32 v21, v18, v19
    buffer_store_dwordx2 v[20:21], v6, s[12:15], s26 offen
    s_add_u32 s24, s3, 8
    s_mul_i32 s25, s24, 37
    s_lshr_b32 s25, s25, 8
    s_mul_i32 s26, s25, 7
    s_sub_u32 s26, s24, s26
    s_mul_i32 s26, s26, 20480
    s_lshl_b32 s25, s25, 5
    s_add_u32 s26, s26, s25
    s_add_u32 s26, s26, s22
    s_cmp_ge_u32 s24, 35
    s_cselect_b32 s26, 1073741824, s26
    v_add_f32 v32, v32, v36
    v_add_f32 v40, v40, v44
    v_add_f32 v33, v33, v37
    v_add_f32 v41, v41, v45
    v_add_f32 v34, v34, v38
    v_add_f32 v42, v42, v46
    v_add_f32 v35, v35, v39
    v_add_f32 v43, v43, v47
    v_add_f32 v32, v32, v40
    v_add_f32 v33, v33, v41
    v_add_f32 v34, v34, v42
    v_add_f32 v35, v35, v43
    v_cvt_pk_bf16_f32 v36, v32, v33
    v_cvt_pk_bf16_f32 v37, v34, v35
    buffer_store_dwordx2 v[36:37], v6, s[12:15], s26 offen
    s_add_u32 s24, s3, 16
    s_mul_i32 s25, s24, 37
    s_lshr_b32 s25, s25, 8
    s_mul_i32 s26, s25, 7
    s_sub_u32 s26, s24, s26
    s_mul_i32 s26, s26, 20480
    s_lshl_b32 s25, s25, 5
    s_add_u32 s26, s26, s25
    s_add_u32 s26, s26, s22
    s_cmp_ge_u32 s24, 35
    s_cselect_b32 s26, 1073741824, s26
    v_add_f32 v48, v48, v52
    v_add_f32 v56, v56, v60
    v_add_f32 v49, v49, v53
    v_add_f32 v57, v57, v61
    v_add_f32 v50, v50, v54
    v_add_f32 v58, v58, v62
    v_add_f32 v51, v51, v55
    v_add_f32 v59, v59, v63
    v_add_f32 v48, v48, v56
    v_add_f32 v49, v49, v57
    v_add_f32 v50, v50, v58
    v_add_f32 v51, v51, v59
    v_cvt_pk_bf16_f32 v52, v48, v49
    v_cvt_pk_bf16_f32 v53, v50, v51
    buffer_store_dwordx2 v[52:53], v6, s[12:15], s26 offen
    s_add_u32 s24, s3, 24
    s_mul_i32 s25, s24, 37
    s_lshr_b32 s25, s25, 8
    s_mul_i32 s26, s25, 7
    s_sub_u32 s26, s24, s26
    s_mul_i32 s26, s26, 20480
    s_lshl_b32 s25, s25, 5
    s_add_u32 s26, s26, s25
    s_add_u32 s26, s26, s22
    s_cmp_ge_u32 s24, 35
    s_cselect_b32 s26, 1073741824, s26
    v_add_f32 v64, v64, v68
    v_add_f32 v72, v72, v76
    v_add_f32 v65, v65, v69
    v_add_f32 v73, v73, v77
    v_add_f32 v66, v66, v70
    v_add_f32 v74, v74, v78
    v_add_f32 v67, v67, v71
    v_add_f32 v75, v75, v79
    v_add_f32 v64, v64, v72
    v_add_f32 v65, v65, v73
    v_add_f32 v66, v66, v74
    v_add_f32 v67, v67, v75
    v_cvt_pk_bf16_f32 v68, v64, v65
    v_cvt_pk_bf16_f32 v69, v66, v67
    buffer_store_dwordx2 v[68:69], v6, s[12:15], s26 offen
    s_add_u32 s24, s3, 32
    s_mul_i32 s25, s24, 37
    s_lshr_b32 s25, s25, 8
    s_mul_i32 s26, s25, 7
    s_sub_u32 s26, s24, s26
    s_mul_i32 s26, s26, 20480
    s_lshl_b32 s25, s25, 5
    s_add_u32 s26, s26, s25
    s_add_u32 s26, s26, s22
    s_cmp_ge_u32 s24, 35
    s_cselect_b32 s26, 1073741824, s26
    v_add_f32 v80, v80, v84
    v_add_f32 v88, v88, v92
    v_add_f32 v81, v81, v85
    v_add_f32 v89, v89, v93
    v_add_f32 v82, v82, v86
    v_add_f32 v90, v90, v94
    v_add_f32 v83, v83, v87
    v_add_f32 v91, v91, v95
    v_add_f32 v80, v80, v88
    v_add_f32 v81, v81, v89
    v_add_f32 v82, v82, v90
    v_add_f32 v83, v83, v91
    v_cvt_pk_bf16_f32 v84, v80, v81
    v_cvt_pk_bf16_f32 v85, v82, v83
    buffer_store_dwordx2 v[84:85], v6, s[12:15], s26 offen
L2_exit:
    s_endpgm
L_text_end:
.section .rodata,"a"
.p2align 6
.amdhsa_kernel attn_kernel
  .amdhsa_next_free_vgpr 256
  .amdhsa_next_free_sgpr 80
  .amdhsa_accum_offset 256
  .amdhsa_group_segment_fixed_size 0
  .amdhsa_kernarg_size 64
  .amdhsa_user_sgpr_count 2
  .amdhsa_user_sgpr_kernarg_segment_ptr 1
  .amdhsa_system_sgpr_workgroup_id_x 1
  .amdhsa_float_denorm_mode_32 3
  .amdhsa_float_denorm_mode_16_64 3
.end_amdhsa_kernel
.p2align 6
.amdhsa_kernel oproj_kernel
  .amdhsa_next_free_vgpr 256
  .amdhsa_next_free_sgpr 40
  .amdhsa_accum_offset 256
  .amdhsa_group_segment_fixed_size 0
  .amdhsa_kernarg_size 64
  .amdhsa_user_sgpr_count 2
  .amdhsa_user_sgpr_kernarg_segment_ptr 1
  .amdhsa_system_sgpr_workgroup_id_x 1
  .amdhsa_float_denorm_mode_32 3
  .amdhsa_float_denorm_mode_16_64 3
.end_amdhsa_kernel
```
